```python
import torch

def _softmax(x, axis=-1):
    return torch.softmax(x, dim=axis)
def _gelu(x):
    return torch.nn.functional.gelu(x, approximate="tanh")
def _silu(x):
    return torch.nn.functional.silu(x)
def _sigmoid(x):
    return torch.sigmoid(x)
def _layernorm(x, axis=-1, eps=1e-5):
    m = x.mean(dim=axis, keepdim=True)
    v = x.var(dim=axis, keepdim=True, unbiased=False)
    return (x - m) / torch.sqrt(v + eps)
def _scatter_add(tgt, idx, src, axis=0):
    return tgt.clone().index_add_(axis, idx, src)
def _segment_sum(src, seg, n):
    out = torch.zeros((n,) + src.shape[1:], dtype=src.dtype)
    return out.index_add_(0, seg, src)
def _pad(x, pw):
    flat = tuple(v for pair in reversed(pw) for v in pair)
    return torch.nn.functional.pad(x, flat)

kernel_name = 'concat_heads__sliding_block__sliding_block__prompt'

def setup_inputs():

    _w = (lambda a: (lambda t: t.to(torch.bfloat16) if t.is_floating_point() else t)(torch.as_tensor(a)))
    def _A_setup():
        B, S, D = 1, 2048, 1024
        return {
            "x": _w((lambda *s: torch.randn(*s, dtype=torch.bfloat16) * 0.2)(B, S, D)),
            "wqkv": _w((lambda *s: torch.randn(*s, dtype=torch.bfloat16) * 0.2)(D, 3 * D)),
            "wo": _w((lambda *s: torch.randn(*s, dtype=torch.bfloat16) * 0.05)(D, D)),
        }
    _A_in = _A_setup()

    def _B_setup():
        B, S, D = 1, 2048, 1024
        return {
            "x": _w((lambda *s: torch.randn(*s, dtype=torch.bfloat16) * 0.2)(B, S, D)),
            "wqkv": _w((lambda *s: torch.randn(*s, dtype=torch.bfloat16) * 0.2)(D, 3 * D)),
            "wo": _w((lambda *s: torch.randn(*s, dtype=torch.bfloat16) * 0.05)(D, D)),
        }
    _B_in = _B_setup()

    return {
        "A_x": _A_in["x"],
        "A_wqkv": _A_in["wqkv"],
        "A_wo": _A_in["wo"],
        "B_x": _B_in["x"],
        "B_wqkv": _B_in["wqkv"],
        "B_wo": _B_in["wo"],
    }

def reference(A_x, A_wqkv, A_wo, B_x, B_wqkv, B_wo):
    def _A_ref(x, wqkv, wo):
        B, S, D = x.shape
        H = 32; Dh = D // H; W = 256
        qkv = (lambda x, *d: x.permute(*d))((x @ wqkv).reshape(B, S, 3, H, Dh), 2, 0, 3, 1, 4)
        q, k, v = qkv[0], qkv[1], qkv[2]
        scores = torch.einsum("bhqd,bhkd->bhqk", q, k) * (Dh ** -0.5)
        idx = torch.arange(S)
        mask = (idx[:, None] - idx[None, :] >= 0) & (idx[:, None] - idx[None, :] < W)
        scores = torch.where(mask[None, None], scores, -1e9)
        p = _softmax(scores, axis=-1)
        o = torch.einsum("bhqk,bhkd->bhqd", p, v)
        return (lambda x, *d: x.permute(*d))(o, 0, 2, 1, 3).reshape(B, S, D) @ wo

    def _B_ref(x, wqkv, wo):
        B, S, D = x.shape
        H = 32; Dh = D // H; W = 256
        qkv = (lambda x, *d: x.permute(*d))((x @ wqkv).reshape(B, S, 3, H, Dh), 2, 0, 3, 1, 4)
        q, k, v = qkv[0], qkv[1], qkv[2]
        scores = torch.einsum("bhqd,bhkd->bhqk", q, k) * (Dh ** -0.5)
        idx = torch.arange(S)
        mask = (idx[:, None] - idx[None, :] >= 0) & (idx[:, None] - idx[None, :] < W)
        scores = torch.where(mask[None, None], scores, -1e9)
        p = _softmax(scores, axis=-1)
        o = torch.einsum("bhqk,bhkd->bhqd", p, v)
        return (lambda x, *d: x.permute(*d))(o, 0, 2, 1, 3).reshape(B, S, D) @ wo

    a = _A_ref(A_x, A_wqkv, A_wo)
    b = _B_ref(B_x, B_wqkv, B_wo)
    return torch.concatenate([a, b], axis=-1)
```

```asm
; @launch grid=(256,1,1) block=(512,1,1) lds=163840
.amdgcn_target "amdgcn-amd-amdhsa--gfx950"
.text
.globl concat_heads__sliding_block__sliding_block__prompt_kernel
.p2align 8
.type concat_heads__sliding_block__sliding_block__prompt_kernel,@function
concat_heads__sliding_block__sliding_block__prompt_kernel:
  s_cmp_ge_u32 s2, 256
  s_cbranch_scc1 K1_END
  s_load_dwordx16 s[16:31], s[0:1], 0
  s_load_dwordx2 s[32:33], s[0:1], 64
  v_cmp_gt_u32 vcc, 48, v0
  s_nop 1
  s_and_saveexec_b64 s[10:11], vcc
  s_nop 0
  s_cbranch_execz K1_NOCPF
  s_getpc_b64 s[8:9]
K1_PC:
  s_sub_u32 s8, s8, K1_PC-concat_heads__sliding_block__sliding_block__prompt_kernel
  s_subb_u32 s9, s9, 0
  s_lshr_b32 s12, s2, 3
  s_lshl_b32 s12, s12, 11
  v_lshlrev_b32 v2, 7, v0
  v_add_u32 v3, s12, v2
  v_cmp_gt_u32 vcc, 32, v0
  s_nop 1
  v_cndmask_b32 v2, v3, v2, vcc
  v_min_u32 v2, K1_END-concat_heads__sliding_block__sliding_block__prompt_kernel, v2
  global_load_dword v7, v2, s[8:9]
  s_nop 0
K1_NOCPF:
  s_mov_b64 exec, s[10:11]
  v_lshrrev_b32 v1, 6, v0
  v_and_b32 v0, 63, v0
  v_readfirstlane_b32 s3, v1
  s_and_b32 s8, s2, 7
  s_lshr_b32 s9, s2, 3
  s_lshr_b32 s4, s8, 2
  s_bfe_u32 s10, s8, 0x10001
  s_and_b32 s11, s8, 1
  s_lshl_b32 s5, s10, 2
  s_and_b32 s12, s9, 3
  s_add_u32 s5, s5, s12
  s_lshl_b32 s6, s11, 3
  s_lshr_b32 s12, s9, 2
  s_add_u32 s6, s6, s12
  s_lshl_b32 s7, s4, 7
  s_lshl_b32 s12, s5, 4
  s_add_u32 s7, s7, s12
  s_add_u32 s7, s7, s6
  s_mov_b32 s38, 0x400000
  s_mov_b32 s39, 0x20000
  s_mov_b32 s42, 0x600000
  s_mov_b32 s43, 0x20000
  s_mov_b32 s46, 67108864
  s_mov_b32 s47, 0x20000
  s_mov_b32 s54, 0x200000
  s_mov_b32 s55, 0x20000
  s_mov_b32 s98, 0x800000
  s_mov_b32 s99, 0x20000
  s_cmp_lt_u32 s3, 4
  s_cbranch_scc1 K1_COMPUTE
  s_sub_u32 s12, s3, 4
  v_lshrrev_b32 v12, 3, v0
  v_and_b32 v13, 7, v0
  v_lshrrev_b32 v14, 4, v0
  v_and_b32 v15, 1, v14
  v_lshlrev_b32 v15, 2, v15
  v_xor_b32 v15, v15, v13
  s_and_b32 s8, s12, 1
  s_lshl_b32 s8, s8, 1
  v_xor_b32 v15, s8, v15
  s_mul_i32 s8, s12, 49152
  s_lshl_b32 s15, s6, 7
  s_add_u32 s8, s8, s15
  v_mul_u32_u24 v16, 6144, v12
  v_lshl_add_u32 v16, v15, 4, v16
  v_add_u32 v9, s8, v16
  v_add_u32 v11, 4096, v9
  s_lshl_b32 s56, s12, 13
  s_lshr_b32 s57, s12, 1
  s_mul_i32 s57, s57, 6144
  s_and_b32 s8, s12, 1
  s_lshl_b32 s8, s8, 10
  s_add_u32 s57, s57, s8
  s_add_u32 s57, s57, 98304
  s_lshl_b32 s8, s5, 8
  s_lshl_b32 s9, s12, 5
  s_add_u32 s10, s8, s9
  s_add_u32 s11, s8, 224
  s_sub_u32 s11, s11, s9
  v_xor_b32 v15, v13, v14
  v_lshlrev_b32 v15, 4, v15
  v_add_lshl_u32 v16, s10, v12, 11
  v_add_lshl_u32 v17, s11, v12, 11
  v_add_u32 v1, v16, v15
  v_add_u32 v5, v17, v15
  v_xor_b32 v15, 64, v15
  v_add_u32 v16, v16, v15
  v_add_u32 v17, v17, v15
  v_add_u32 v2, 15360, v16
  v_add_u32 v3, 30720, v1
  v_add_u32 v4, 46080, v16
  v_add_u32 v6, 15360, v17
  v_add_u32 v7, 30720, v5
  v_add_u32 v8, 46080, v17
  s_cmp_eq_u32 s4, 0
  s_waitcnt lgkmcnt(0)
  s_cselect_b32 s36, s16, s22
  s_cselect_b32 s37, s17, s23
  s_cselect_b32 s40, s18, s24
  s_cselect_b32 s41, s19, s25
  s_cselect_b32 s52, s20, s26
  s_cselect_b32 s53, s21, s27
  s_mov_b32 s44, s32
  s_mov_b32 s45, s33
  s_mov_b32 s48, s30
  s_mov_b32 s49, s31
  s_mov_b32 s96, s28
  s_mov_b32 s97, s29
  s_mov_b32 s50, 0
  s_add_u32 m0, s57, 0
  s_nop 0
  buffer_load_dwordx4 v9, s[40:43], s50 offen offset:0  lds
  buffer_load_dwordx4 v9, s[40:43], s50 offen offset:2048  lds
  s_add_u32 m0, s57, 4096
  s_nop 0
  buffer_load_dwordx4 v11, s[40:43], s50 offen offset:0  lds
  s_mov_b32 s59, 196608
  s_add_u32 m0, s57, 12288
  s_nop 0
  buffer_load_dwordx4 v9, s[40:43], s59 offen offset:0  lds
  buffer_load_dwordx4 v9, s[40:43], s59 offen offset:2048  lds
  s_add_u32 m0, s57, 16384
  s_nop 0
  buffer_load_dwordx4 v11, s[40:43], s59 offen offset:0  lds
  s_mov_b32 s58, 0
  s_add_u32 m0, s56, 0
  s_nop 0
  buffer_load_dwordx4 v1, s[36:39], s58 offen offset:0  lds
  buffer_load_dwordx4 v2, s[36:39], s58 offen offset:1024  lds
  buffer_load_dwordx4 v3, s[36:39], s58 offen offset:2048  lds
  buffer_load_dwordx4 v4, s[36:39], s58 offen offset:3072  lds
  s_add_u32 m0, s56, 4096
  s_nop 0
  buffer_load_dwordx4 v5, s[36:39], s58 offen offset:0  lds
  buffer_load_dwordx4 v6, s[36:39], s58 offen offset:1024  lds
  buffer_load_dwordx4 v7, s[36:39], s58 offen offset:2048  lds
  buffer_load_dwordx4 v8, s[36:39], s58 offen offset:3072  lds
  s_mov_b32 s50, 393216
  s_add_u32 m0, s57, 24576
  s_nop 0
  buffer_load_dwordx4 v9, s[40:43], s50 offen offset:0  lds
  buffer_load_dwordx4 v9, s[40:43], s50 offen offset:2048  lds
  s_add_u32 m0, s57, 28672
  s_nop 0
  buffer_load_dwordx4 v11, s[40:43], s50 offen offset:0  lds
  s_mov_b32 s58, 128
  s_add_u32 m0, s56, 32768
  s_nop 0
  buffer_load_dwordx4 v1, s[36:39], s58 offen offset:0  lds
  buffer_load_dwordx4 v2, s[36:39], s58 offen offset:1024  lds
  buffer_load_dwordx4 v3, s[36:39], s58 offen offset:2048  lds
  buffer_load_dwordx4 v4, s[36:39], s58 offen offset:3072  lds
  v_mov_b32 v24, 0
  s_add_u32 s8, s2, s12
  s_cmp_lg_u32 s8, 0
  s_cbranch_scc1 K1_NONONCE
  s_memrealtime s[8:9]
  s_waitcnt lgkmcnt(0)
  s_lshl_b32 s9, s9, 20
  s_xor_b32 s8, s8, s9
  s_or_b32 s8, s8, 1
  v_mov_b32 v25, s8
  s_mov_b64 exec, 1
  global_store_dword v24, v25, s[48:49] sc1
  s_mov_b64 exec, -1
K1_NONONCE:
  s_lshr_b32 s8, s2, 3
  s_lshl_b32 s8, s8, 5
  s_lshl_b32 s9, s12, 3
  s_add_u32 s8, s8, s9
  v_add_u32 v17, s8, v12
  v_lshlrev_b32 v17, 11, v17
  v_lshl_add_u32 v17, v13, 7, v17
  s_and_b32 s8, s2, 1
  s_lshl_b32 s8, s8, 10
  v_add_u32 v18, s8, v17
  v_lshrrev_b32 v19, 2, v0
  v_min_u32 v19, 11, v19
  v_lshrrev_b32 v20, 2, v19
  v_and_b32 v19, 3, v19
  v_lshlrev_b32 v19, 7, v19
  v_lshl_add_u32 v19, v20, 11, v19
  s_lshr_b32 s8, s2, 3
  s_lshl_b32 s8, s8, 1
  s_lshr_b32 s9, s12, 1
  s_add_u32 s8, s8, s9
  s_mul_i32 s8, s8, 6144
  s_and_b32 s9, s12, 1
  s_lshl_b32 s9, s9, 9
  s_add_u32 s8, s8, s9
  s_and_b32 s9, s2, 1
  s_lshl_b32 s9, s9, 10
  s_add_u32 s8, s8, s9
  v_add_u32 v22, s8, v19
  s_lshr_b32 s8, s2, 3
  s_lshl_b32 s8, s8, 5
  s_lshl_b32 s9, s12, 3
  s_add_u32 s8, s8, s9
  s_bfe_u32 s9, s2, 0x10001
  s_lshl_b32 s9, s9, 10
  s_add_u32 s8, s8, s9
  v_add_u32 v23, s8, v12
  v_lshlrev_b32 v23, 11, v23
  v_and_b32 v19, 0, v0
  v_lshl_add_u32 v23, v19, 7, v23
  s_mov_b32 s51, 786432
  buffer_load_dword v15, v22, s[40:43], s51 offen
  buffer_load_dword v15, v23, s[36:39], 0 offen offset:256
  s_waitcnt vmcnt(9)
  s_barrier
  s_add_u32 m0, s56, 36864
  s_nop 0
  buffer_load_dwordx4 v5, s[36:39], s58 offen offset:0  lds
  buffer_load_dwordx4 v6, s[36:39], s58 offen offset:1024  lds
  buffer_load_dwordx4 v7, s[36:39], s58 offen offset:2048  lds
  buffer_load_dwordx4 v8, s[36:39], s58 offen offset:3072  lds
  s_mov_b32 s59, 589824
  s_add_u32 m0, s57, 36864
  s_nop 0
  buffer_load_dwordx4 v9, s[40:43], s59 offen offset:0  lds
  buffer_load_dwordx4 v9, s[40:43], s59 offen offset:2048  lds
  s_add_u32 m0, s57, 40960
  s_nop 0
  buffer_load_dwordx4 v11, s[40:43], s59 offen offset:0  lds
  s_mov_b32 s50, 786432
  s_add_u32 m0, s57, 49152
  s_nop 0
  buffer_load_dwordx4 v9, s[40:43], s50 offen offset:0  lds
  buffer_load_dwordx4 v9, s[40:43], s50 offen offset:2048  lds
  s_add_u32 m0, s57, 53248
  s_nop 0
  buffer_load_dwordx4 v11, s[40:43], s50 offen offset:0  lds
  s_mov_b32 s58, 256
  s_add_u32 m0, s56, 65536
  s_nop 0
  buffer_load_dwordx4 v1, s[36:39], s58 offen offset:0  lds
  buffer_load_dwordx4 v2, s[36:39], s58 offen offset:1024  lds
  buffer_load_dwordx4 v3, s[36:39], s58 offen offset:2048  lds
  buffer_load_dwordx4 v4, s[36:39], s58 offen offset:3072  lds
  s_add_u32 m0, s56, 69632
  s_nop 0
  buffer_load_dwordx4 v5, s[36:39], s58 offen offset:0  lds
  buffer_load_dwordx4 v6, s[36:39], s58 offen offset:1024  lds
  buffer_load_dwordx4 v7, s[36:39], s58 offen offset:2048  lds
  buffer_load_dwordx4 v8, s[36:39], s58 offen offset:3072  lds
  s_mov_b32 s51, 1179648
  buffer_load_dword v15, v22, s[40:43], s51 offen
  buffer_load_dword v15, v23, s[36:39], 0 offen offset:384
  s_waitcnt vmcnt(13)
  s_barrier
  s_mov_b32 s59, 983040
  s_add_u32 m0, s57, 0
  s_nop 0
  buffer_load_dwordx4 v9, s[40:43], s59 offen offset:0  lds
  buffer_load_dwordx4 v9, s[40:43], s59 offen offset:2048  lds
  s_add_u32 m0, s57, 4096
  s_nop 0
  buffer_load_dwordx4 v11, s[40:43], s59 offen offset:0  lds
  s_mov_b32 s50, 1179648
  s_add_u32 m0, s57, 12288
  s_nop 0
  buffer_load_dwordx4 v9, s[40:43], s50 offen offset:0  lds
  buffer_load_dwordx4 v9, s[40:43], s50 offen offset:2048  lds
  s_add_u32 m0, s57, 16384
  s_nop 0
  buffer_load_dwordx4 v11, s[40:43], s50 offen offset:0  lds
  s_mov_b32 s58, 384
  s_add_u32 m0, s56, 0
  s_nop 0
  buffer_load_dwordx4 v1, s[36:39], s58 offen offset:0  lds
  buffer_load_dwordx4 v2, s[36:39], s58 offen offset:1024  lds
  buffer_load_dwordx4 v3, s[36:39], s58 offen offset:2048  lds
  buffer_load_dwordx4 v4, s[36:39], s58 offen offset:3072  lds
  s_add_u32 m0, s56, 4096
  s_nop 0
  buffer_load_dwordx4 v5, s[36:39], s58 offen offset:0  lds
  buffer_load_dwordx4 v6, s[36:39], s58 offen offset:1024  lds
  buffer_load_dwordx4 v7, s[36:39], s58 offen offset:2048  lds
  buffer_load_dwordx4 v8, s[36:39], s58 offen offset:3072  lds
  s_mov_b32 s51, 1572864
  buffer_load_dword v15, v22, s[40:43], s51 offen
  buffer_load_dword v15, v23, s[36:39], 0 offen offset:512
  s_waitcnt vmcnt(13)
  s_barrier
  s_mov_b32 s59, 1376256
  s_add_u32 m0, s57, 24576
  s_nop 0
  buffer_load_dwordx4 v9, s[40:43], s59 offen offset:0  lds
  buffer_load_dwordx4 v9, s[40:43], s59 offen offset:2048  lds
  s_add_u32 m0, s57, 28672
  s_nop 0
  buffer_load_dwordx4 v11, s[40:43], s59 offen offset:0  lds
  s_mov_b32 s50, 1572864
  s_add_u32 m0, s57, 36864
  s_nop 0
  buffer_load_dwordx4 v9, s[40:43], s50 offen offset:0  lds
  buffer_load_dwordx4 v9, s[40:43], s50 offen offset:2048  lds
  s_add_u32 m0, s57, 40960
  s_nop 0
  buffer_load_dwordx4 v11, s[40:43], s50 offen offset:0  lds
  s_mov_b32 s58, 512
  s_add_u32 m0, s56, 32768
  s_nop 0
  buffer_load_dwordx4 v1, s[36:39], s58 offen offset:0  lds
  buffer_load_dwordx4 v2, s[36:39], s58 offen offset:1024  lds
  buffer_load_dwordx4 v3, s[36:39], s58 offen offset:2048  lds
  buffer_load_dwordx4 v4, s[36:39], s58 offen offset:3072  lds
  s_add_u32 m0, s56, 36864
  s_nop 0
  buffer_load_dwordx4 v5, s[36:39], s58 offen offset:0  lds
  buffer_load_dwordx4 v6, s[36:39], s58 offen offset:1024  lds
  buffer_load_dwordx4 v7, s[36:39], s58 offen offset:2048  lds
  buffer_load_dwordx4 v8, s[36:39], s58 offen offset:3072  lds
  s_mov_b32 s51, 1966080
  buffer_load_dword v15, v22, s[40:43], s51 offen
  buffer_load_dword v15, v23, s[36:39], 0 offen offset:640
  s_waitcnt vmcnt(13)
  s_barrier
  s_mov_b32 s59, 1769472
  s_add_u32 m0, s57, 49152
  s_nop 0
  buffer_load_dwordx4 v9, s[40:43], s59 offen offset:0  lds
  buffer_load_dwordx4 v9, s[40:43], s59 offen offset:2048  lds
  s_add_u32 m0, s57, 53248
  s_nop 0
  buffer_load_dwordx4 v11, s[40:43], s59 offen offset:0  lds
  s_mov_b32 s50, 1966080
  s_add_u32 m0, s57, 0
  s_nop 0
  buffer_load_dwordx4 v9, s[40:43], s50 offen offset:0  lds
  buffer_load_dwordx4 v9, s[40:43], s50 offen offset:2048  lds
  s_add_u32 m0, s57, 4096
  s_nop 0
  buffer_load_dwordx4 v11, s[40:43], s50 offen offset:0  lds
  s_mov_b32 s58, 640
  s_add_u32 m0, s56, 65536
  s_nop 0
  buffer_load_dwordx4 v1, s[36:39], s58 offen offset:0  lds
  buffer_load_dwordx4 v2, s[36:39], s58 offen offset:1024  lds
  buffer_load_dwordx4 v3, s[36:39], s58 offen offset:2048  lds
  buffer_load_dwordx4 v4, s[36:39], s58 offen offset:3072  lds
  s_add_u32 m0, s56, 69632
  s_nop 0
  buffer_load_dwordx4 v5, s[36:39], s58 offen offset:0  lds
  buffer_load_dwordx4 v6, s[36:39], s58 offen offset:1024  lds
  buffer_load_dwordx4 v7, s[36:39], s58 offen offset:2048  lds
  buffer_load_dwordx4 v8, s[36:39], s58 offen offset:3072  lds
  s_mov_b32 s51, 2359296
  buffer_load_dword v15, v22, s[40:43], s51 offen
  buffer_load_dword v15, v23, s[36:39], 0 offen offset:768
  s_waitcnt vmcnt(13)
  s_barrier
  s_mov_b32 s59, 2162688
  s_add_u32 m0, s57, 12288
  s_nop 0
  buffer_load_dwordx4 v9, s[40:43], s59 offen offset:0  lds
  buffer_load_dwordx4 v9, s[40:43], s59 offen offset:2048  lds
  s_add_u32 m0, s57, 16384
  s_nop 0
  buffer_load_dwordx4 v11, s[40:43], s59 offen offset:0  lds
  s_mov_b32 s50, 2359296
  s_add_u32 m0, s57, 24576
  s_nop 0
  buffer_load_dwordx4 v9, s[40:43], s50 offen offset:0  lds
  buffer_load_dwordx4 v9, s[40:43], s50 offen offset:2048  lds
  s_add_u32 m0, s57, 28672
  s_nop 0
  buffer_load_dwordx4 v11, s[40:43], s50 offen offset:0  lds
  s_mov_b32 s58, 768
  s_add_u32 m0, s56, 0
  s_nop 0
  buffer_load_dwordx4 v1, s[36:39], s58 offen offset:0  lds
  buffer_load_dwordx4 v2, s[36:39], s58 offen offset:1024  lds
  buffer_load_dwordx4 v3, s[36:39], s58 offen offset:2048  lds
  buffer_load_dwordx4 v4, s[36:39], s58 offen offset:3072  lds
  s_add_u32 m0, s56, 4096
  s_nop 0
  buffer_load_dwordx4 v5, s[36:39], s58 offen offset:0  lds
  buffer_load_dwordx4 v6, s[36:39], s58 offen offset:1024  lds
  buffer_load_dwordx4 v7, s[36:39], s58 offen offset:2048  lds
  buffer_load_dwordx4 v8, s[36:39], s58 offen offset:3072  lds
  s_mov_b32 s51, 2752512
  buffer_load_dword v15, v22, s[40:43], s51 offen
  buffer_load_dword v15, v23, s[36:39], 0 offen offset:896
  s_waitcnt vmcnt(13)
  s_barrier
  s_mov_b32 s59, 2555904
  s_add_u32 m0, s57, 36864
  s_nop 0
  buffer_load_dwordx4 v9, s[40:43], s59 offen offset:0  lds
  buffer_load_dwordx4 v9, s[40:43], s59 offen offset:2048  lds
  s_add_u32 m0, s57, 40960
  s_nop 0
  buffer_load_dwordx4 v11, s[40:43], s59 offen offset:0  lds
  s_mov_b32 s50, 2752512
  s_add_u32 m0, s57, 49152
  s_nop 0
  buffer_load_dwordx4 v9, s[40:43], s50 offen offset:0  lds
  buffer_load_dwordx4 v9, s[40:43], s50 offen offset:2048  lds
  s_add_u32 m0, s57, 53248
  s_nop 0
  buffer_load_dwordx4 v11, s[40:43], s50 offen offset:0  lds
  s_mov_b32 s58, 896
  s_add_u32 m0, s56, 32768
  s_nop 0
  buffer_load_dwordx4 v1, s[36:39], s58 offen offset:0  lds
  buffer_load_dwordx4 v2, s[36:39], s58 offen offset:1024  lds
  buffer_load_dwordx4 v3, s[36:39], s58 offen offset:2048  lds
  buffer_load_dwordx4 v4, s[36:39], s58 offen offset:3072  lds
  s_add_u32 m0, s56, 36864
  s_nop 0
  buffer_load_dwordx4 v5, s[36:39], s58 offen offset:0  lds
  buffer_load_dwordx4 v6, s[36:39], s58 offen offset:1024  lds
  buffer_load_dwordx4 v7, s[36:39], s58 offen offset:2048  lds
  buffer_load_dwordx4 v8, s[36:39], s58 offen offset:3072  lds
  s_mov_b32 s51, 3145728
  buffer_load_dword v15, v22, s[40:43], s51 offen
  buffer_load_dword v15, v23, s[36:39], 0 offen offset:1024
  s_waitcnt vmcnt(13)
  s_barrier
  s_mov_b32 s59, 2949120
  s_add_u32 m0, s57, 0
  s_nop 0
  buffer_load_dwordx4 v9, s[40:43], s59 offen offset:0  lds
  buffer_load_dwordx4 v9, s[40:43], s59 offen offset:2048  lds
  s_add_u32 m0, s57, 4096
  s_nop 0
  buffer_load_dwordx4 v11, s[40:43], s59 offen offset:0  lds
  s_mov_b32 s50, 3145728
  s_add_u32 m0, s57, 12288
  s_nop 0
  buffer_load_dwordx4 v9, s[40:43], s50 offen offset:0  lds
  buffer_load_dwordx4 v9, s[40:43], s50 offen offset:2048  lds
  s_add_u32 m0, s57, 16384
  s_nop 0
  buffer_load_dwordx4 v11, s[40:43], s50 offen offset:0  lds
  s_mov_b32 s58, 1024
  s_add_u32 m0, s56, 65536
  s_nop 0
  buffer_load_dwordx4 v1, s[36:39], s58 offen offset:0  lds
  buffer_load_dwordx4 v2, s[36:39], s58 offen offset:1024  lds
  buffer_load_dwordx4 v3, s[36:39], s58 offen offset:2048  lds
  buffer_load_dwordx4 v4, s[36:39], s58 offen offset:3072  lds
  s_add_u32 m0, s56, 69632
  s_nop 0
  buffer_load_dwordx4 v5, s[36:39], s58 offen offset:0  lds
  buffer_load_dwordx4 v6, s[36:39], s58 offen offset:1024  lds
  buffer_load_dwordx4 v7, s[36:39], s58 offen offset:2048  lds
  buffer_load_dwordx4 v8, s[36:39], s58 offen offset:3072  lds
  s_mov_b32 s51, 3538944
  buffer_load_dword v15, v22, s[40:43], s51 offen
  buffer_load_dword v15, v23, s[36:39], 0 offen offset:1152
  s_waitcnt vmcnt(13)
  s_barrier
  s_mov_b32 s59, 3342336
  s_add_u32 m0, s57, 24576
  s_nop 0
  buffer_load_dwordx4 v9, s[40:43], s59 offen offset:0  lds
  buffer_load_dwordx4 v9, s[40:43], s59 offen offset:2048  lds
  s_add_u32 m0, s57, 28672
  s_nop 0
  buffer_load_dwordx4 v11, s[40:43], s59 offen offset:0  lds
  s_mov_b32 s50, 3538944
  s_add_u32 m0, s57, 36864
  s_nop 0
  buffer_load_dwordx4 v9, s[40:43], s50 offen offset:0  lds
  buffer_load_dwordx4 v9, s[40:43], s50 offen offset:2048  lds
  s_add_u32 m0, s57, 40960
  s_nop 0
  buffer_load_dwordx4 v11, s[40:43], s50 offen offset:0  lds
  s_mov_b32 s58, 1152
  s_add_u32 m0, s56, 0
  s_nop 0
  buffer_load_dwordx4 v1, s[36:39], s58 offen offset:0  lds
  buffer_load_dwordx4 v2, s[36:39], s58 offen offset:1024  lds
  buffer_load_dwordx4 v3, s[36:39], s58 offen offset:2048  lds
  buffer_load_dwordx4 v4, s[36:39], s58 offen offset:3072  lds
  s_add_u32 m0, s56, 4096
  s_nop 0
  buffer_load_dwordx4 v5, s[36:39], s58 offen offset:0  lds
  buffer_load_dwordx4 v6, s[36:39], s58 offen offset:1024  lds
  buffer_load_dwordx4 v7, s[36:39], s58 offen offset:2048  lds
  buffer_load_dwordx4 v8, s[36:39], s58 offen offset:3072  lds
  s_mov_b32 s51, 3932160
  buffer_load_dword v15, v22, s[40:43], s51 offen
  buffer_load_dword v15, v23, s[36:39], 0 offen offset:1280
  s_waitcnt vmcnt(13)
  s_barrier
  s_mov_b32 s59, 3735552
  s_add_u32 m0, s57, 49152
  s_nop 0
  buffer_load_dwordx4 v9, s[40:43], s59 offen offset:0  lds
  buffer_load_dwordx4 v9, s[40:43], s59 offen offset:2048  lds
  s_add_u32 m0, s57, 53248
  s_nop 0
  buffer_load_dwordx4 v11, s[40:43], s59 offen offset:0  lds
  s_mov_b32 s50, 3932160
  s_add_u32 m0, s57, 0
  s_nop 0
  buffer_load_dwordx4 v9, s[40:43], s50 offen offset:0  lds
  buffer_load_dwordx4 v9, s[40:43], s50 offen offset:2048  lds
  s_add_u32 m0, s57, 4096
  s_nop 0
  buffer_load_dwordx4 v11, s[40:43], s50 offen offset:0  lds
  s_mov_b32 s58, 1280
  s_add_u32 m0, s56, 32768
  s_nop 0
  buffer_load_dwordx4 v1, s[36:39], s58 offen offset:0  lds
  buffer_load_dwordx4 v2, s[36:39], s58 offen offset:1024  lds
  buffer_load_dwordx4 v3, s[36:39], s58 offen offset:2048  lds
  buffer_load_dwordx4 v4, s[36:39], s58 offen offset:3072  lds
  s_add_u32 m0, s56, 36864
  s_nop 0
  buffer_load_dwordx4 v5, s[36:39], s58 offen offset:0  lds
  buffer_load_dwordx4 v6, s[36:39], s58 offen offset:1024  lds
  buffer_load_dwordx4 v7, s[36:39], s58 offen offset:2048  lds
  buffer_load_dwordx4 v8, s[36:39], s58 offen offset:3072  lds
  s_mov_b32 s51, 4325376
  buffer_load_dword v15, v22, s[40:43], s51 offen
  buffer_load_dword v15, v23, s[36:39], 0 offen offset:1408
  s_waitcnt vmcnt(13)
  s_barrier
  s_mov_b32 s59, 4128768
  s_add_u32 m0, s57, 12288
  s_nop 0
  buffer_load_dwordx4 v9, s[40:43], s59 offen offset:0  lds
  buffer_load_dwordx4 v9, s[40:43], s59 offen offset:2048  lds
  s_add_u32 m0, s57, 16384
  s_nop 0
  buffer_load_dwordx4 v11, s[40:43], s59 offen offset:0  lds
  s_mov_b32 s50, 4325376
  s_add_u32 m0, s57, 24576
  s_nop 0
  buffer_load_dwordx4 v9, s[40:43], s50 offen offset:0  lds
  buffer_load_dwordx4 v9, s[40:43], s50 offen offset:2048  lds
  s_add_u32 m0, s57, 28672
  s_nop 0
  buffer_load_dwordx4 v11, s[40:43], s50 offen offset:0  lds
  s_mov_b32 s58, 1408
  s_add_u32 m0, s56, 65536
  s_nop 0
  buffer_load_dwordx4 v1, s[36:39], s58 offen offset:0  lds
  buffer_load_dwordx4 v2, s[36:39], s58 offen offset:1024  lds
  buffer_load_dwordx4 v3, s[36:39], s58 offen offset:2048  lds
  buffer_load_dwordx4 v4, s[36:39], s58 offen offset:3072  lds
  s_add_u32 m0, s56, 69632
  s_nop 0
  buffer_load_dwordx4 v5, s[36:39], s58 offen offset:0  lds
  buffer_load_dwordx4 v6, s[36:39], s58 offen offset:1024  lds
  buffer_load_dwordx4 v7, s[36:39], s58 offen offset:2048  lds
  buffer_load_dwordx4 v8, s[36:39], s58 offen offset:3072  lds
  s_mov_b32 s51, 4718592
  buffer_load_dword v15, v22, s[40:43], s51 offen
  buffer_load_dword v15, v23, s[36:39], 0 offen offset:1536
  s_waitcnt vmcnt(13)
  s_barrier
  s_mov_b32 s59, 4521984
  s_add_u32 m0, s57, 36864
  s_nop 0
  buffer_load_dwordx4 v9, s[40:43], s59 offen offset:0  lds
  buffer_load_dwordx4 v9, s[40:43], s59 offen offset:2048  lds
  s_add_u32 m0, s57, 40960
  s_nop 0
  buffer_load_dwordx4 v11, s[40:43], s59 offen offset:0  lds
  s_mov_b32 s50, 4718592
  s_add_u32 m0, s57, 49152
  s_nop 0
  buffer_load_dwordx4 v9, s[40:43], s50 offen offset:0  lds
  buffer_load_dwordx4 v9, s[40:43], s50 offen offset:2048  lds
  s_add_u32 m0, s57, 53248
  s_nop 0
  buffer_load_dwordx4 v11, s[40:43], s50 offen offset:0  lds
  s_mov_b32 s58, 1536
  s_add_u32 m0, s56, 0
  s_nop 0
  buffer_load_dwordx4 v1, s[36:39], s58 offen offset:0  lds
  buffer_load_dwordx4 v2, s[36:39], s58 offen offset:1024  lds
  buffer_load_dwordx4 v3, s[36:39], s58 offen offset:2048  lds
  buffer_load_dwordx4 v4, s[36:39], s58 offen offset:3072  lds
  s_add_u32 m0, s56, 4096
  s_nop 0
  buffer_load_dwordx4 v5, s[36:39], s58 offen offset:0  lds
  buffer_load_dwordx4 v6, s[36:39], s58 offen offset:1024  lds
  buffer_load_dwordx4 v7, s[36:39], s58 offen offset:2048  lds
  buffer_load_dwordx4 v8, s[36:39], s58 offen offset:3072  lds
  s_mov_b32 s51, 5111808
  buffer_load_dword v15, v22, s[40:43], s51 offen
  buffer_load_dword v15, v23, s[36:39], 0 offen offset:1664
  s_waitcnt vmcnt(13)
  s_barrier
  s_mov_b32 s59, 4915200
  s_add_u32 m0, s57, 0
  s_nop 0
  buffer_load_dwordx4 v9, s[40:43], s59 offen offset:0  lds
  buffer_load_dwordx4 v9, s[40:43], s59 offen offset:2048  lds
  s_add_u32 m0, s57, 4096
  s_nop 0
  buffer_load_dwordx4 v11, s[40:43], s59 offen offset:0  lds
  s_mov_b32 s50, 5111808
  s_add_u32 m0, s57, 12288
  s_nop 0
  buffer_load_dwordx4 v9, s[40:43], s50 offen offset:0  lds
  buffer_load_dwordx4 v9, s[40:43], s50 offen offset:2048  lds
  s_add_u32 m0, s57, 16384
  s_nop 0
  buffer_load_dwordx4 v11, s[40:43], s50 offen offset:0  lds
  s_mov_b32 s58, 1664
  s_add_u32 m0, s56, 32768
  s_nop 0
  buffer_load_dwordx4 v1, s[36:39], s58 offen offset:0  lds
  buffer_load_dwordx4 v2, s[36:39], s58 offen offset:1024  lds
  buffer_load_dwordx4 v3, s[36:39], s58 offen offset:2048  lds
  buffer_load_dwordx4 v4, s[36:39], s58 offen offset:3072  lds
  s_add_u32 m0, s56, 36864
  s_nop 0
  buffer_load_dwordx4 v5, s[36:39], s58 offen offset:0  lds
  buffer_load_dwordx4 v6, s[36:39], s58 offen offset:1024  lds
  buffer_load_dwordx4 v7, s[36:39], s58 offen offset:2048  lds
  buffer_load_dwordx4 v8, s[36:39], s58 offen offset:3072  lds
  s_mov_b32 s51, 5505024
  buffer_load_dword v15, v22, s[40:43], s51 offen
  buffer_load_dword v15, v23, s[36:39], 0 offen offset:1792
  s_waitcnt vmcnt(13)
  s_barrier
  s_mov_b32 s59, 5308416
  s_add_u32 m0, s57, 24576
  s_nop 0
  buffer_load_dwordx4 v9, s[40:43], s59 offen offset:0  lds
  buffer_load_dwordx4 v9, s[40:43], s59 offen offset:2048  lds
  s_add_u32 m0, s57, 28672
  s_nop 0
  buffer_load_dwordx4 v11, s[40:43], s59 offen offset:0  lds
  s_mov_b32 s50, 5505024
  s_add_u32 m0, s57, 36864
  s_nop 0
  buffer_load_dwordx4 v9, s[40:43], s50 offen offset:0  lds
  buffer_load_dwordx4 v9, s[40:43], s50 offen offset:2048  lds
  s_add_u32 m0, s57, 40960
  s_nop 0
  buffer_load_dwordx4 v11, s[40:43], s50 offen offset:0  lds
  s_mov_b32 s58, 1792
  s_add_u32 m0, s56, 65536
  s_nop 0
  buffer_load_dwordx4 v1, s[36:39], s58 offen offset:0  lds
  buffer_load_dwordx4 v2, s[36:39], s58 offen offset:1024  lds
  buffer_load_dwordx4 v3, s[36:39], s58 offen offset:2048  lds
  buffer_load_dwordx4 v4, s[36:39], s58 offen offset:3072  lds
  s_add_u32 m0, s56, 69632
  s_nop 0
  buffer_load_dwordx4 v5, s[36:39], s58 offen offset:0  lds
  buffer_load_dwordx4 v6, s[36:39], s58 offen offset:1024  lds
  buffer_load_dwordx4 v7, s[36:39], s58 offen offset:2048  lds
  buffer_load_dwordx4 v8, s[36:39], s58 offen offset:3072  lds
  s_mov_b32 s51, 5898240
  buffer_load_dword v15, v22, s[40:43], s51 offen
  buffer_load_dword v15, v23, s[36:39], 0 offen offset:1920
  s_waitcnt vmcnt(13)
  s_barrier
  s_mov_b32 s59, 5701632
  s_add_u32 m0, s57, 49152
  s_nop 0
  buffer_load_dwordx4 v9, s[40:43], s59 offen offset:0  lds
  buffer_load_dwordx4 v9, s[40:43], s59 offen offset:2048  lds
  s_add_u32 m0, s57, 53248
  s_nop 0
  buffer_load_dwordx4 v11, s[40:43], s59 offen offset:0  lds
  s_mov_b32 s50, 5898240
  s_add_u32 m0, s57, 0
  s_nop 0
  buffer_load_dwordx4 v9, s[40:43], s50 offen offset:0  lds
  buffer_load_dwordx4 v9, s[40:43], s50 offen offset:2048  lds
  s_add_u32 m0, s57, 4096
  s_nop 0
  buffer_load_dwordx4 v11, s[40:43], s50 offen offset:0  lds
  s_mov_b32 s58, 1920
  s_add_u32 m0, s56, 0
  s_nop 0
  buffer_load_dwordx4 v1, s[36:39], s58 offen offset:0  lds
  buffer_load_dwordx4 v2, s[36:39], s58 offen offset:1024  lds
  buffer_load_dwordx4 v3, s[36:39], s58 offen offset:2048  lds
  buffer_load_dwordx4 v4, s[36:39], s58 offen offset:3072  lds
  s_add_u32 m0, s56, 4096
  s_nop 0
  buffer_load_dwordx4 v5, s[36:39], s58 offen offset:0  lds
  buffer_load_dwordx4 v6, s[36:39], s58 offen offset:1024  lds
  buffer_load_dwordx4 v7, s[36:39], s58 offen offset:2048  lds
  buffer_load_dwordx4 v8, s[36:39], s58 offen offset:3072  lds
  buffer_load_dword v15, v18, s[52:55], 0 offen
  s_cmp_lg_u32 s12, 0
  s_cbranch_scc1 K1_NORD
  global_load_dword v25, v24, s[48:49] sc1
K1_NORD:
  s_waitcnt vmcnt(12)
  s_barrier
  s_mov_b32 s59, 6094848
  s_add_u32 m0, s57, 12288
  s_nop 0
  buffer_load_dwordx4 v9, s[40:43], s59 offen offset:0  lds
  buffer_load_dwordx4 v9, s[40:43], s59 offen offset:2048  lds
  s_add_u32 m0, s57, 16384
  s_nop 0
  buffer_load_dwordx4 v11, s[40:43], s59 offen offset:0  lds
  s_waitcnt vmcnt(0)
  s_cmp_lg_u32 s12, 0
  s_cbranch_scc1 K1_NOWR
  s_waitcnt vmcnt(0)
  s_mov_b32 s51, 0
K1_NRETRY:
  v_readfirstlane_b32 s35, v25
  s_nop 1
  s_cmp_lg_u32 s35, 0
  s_nop 0
  s_cbranch_scc1 K1_NOK
  s_add_u32 s51, s51, 1
  s_cmp_ge_u32 s51, 131072
  s_cbranch_scc1 K1_NOK
  s_sleep 2
  global_load_dword v25, v24, s[48:49] sc1
  s_waitcnt vmcnt(0)
  s_branch K1_NRETRY
K1_NOK:
  v_mov_b32 v19, 122880
  v_mov_b32 v30, v25
  v_mov_b32 v31, 0
  ds_write_b64 v19, v[30:31]
  s_waitcnt lgkmcnt(0)
K1_NOWR:
  s_barrier
  v_mov_b32 v19, 122880
  ds_read_b32 v25, v19
  s_waitcnt lgkmcnt(0)
  v_readfirstlane_b32 s35, v25
  s_and_b32 s13, s12, 1
  s_and_b32 s14, s12, 2
  s_lshl_b32 s8, s13, 14
  s_lshl_b32 s9, s14, 12
  s_add_u32 s8, s8, s9
  s_add_u32 s8, s8, 135168
  v_lshlrev_b32 v12, 4, v0
  v_add_u32 v12, s8, v12
  s_add_u32 s14, s14, 1
  s_mov_b32 s34, 0
  s_cmp_eq_u32 s5, 0
  s_cselect_b32 s12, 1, 1
  v_mov_b32 v13, 122880
  s_barrier
  v_mov_b32 v14, s35
  ds_read_b128 v[192:195], v12
  ds_read_b128 v[196:199], v12 offset:1024
  ds_read_b128 v[200:203], v12 offset:2048
  ds_read_b128 v[204:207], v12 offset:3072
  s_branch K1_ATT
K1_COMPUTE:
  s_and_b32 s13, s3, 1
  s_lshr_b32 s14, s3, 1
  v_and_b32 v8, 15, v0
  v_lshrrev_b32 v9, 4, v0
  v_lshrrev_b32 v10, 1, v8
  v_xor_b32 v10, v10, v9
  v_lshlrev_b32 v11, 7, v8
  s_lshl_b32 s8, s14, 14
  v_add_u32 v11, s8, v11
  v_lshl_add_u32 v1, v10, 4, v11
  v_xor_b32 v2, 64, v1
  v_add_u32 v3, 0x10000, v1
  v_add_u32 v4, 0x10000, v2
  v_bfe_u32 v10, v0, 2, 2
  v_and_b32 v11, 1, v9
  v_lshl_add_u32 v12, v11, 3, v10
  v_lshlrev_b32 v12, 7, v12
  v_lshrrev_b32 v13, 1, v9
  v_mul_u32_u24 v13, 6144, v13
  v_add_u32 v12, v12, v13
  v_lshrrev_b32 v10, 1, v10
  v_xor_b32 v10, s13, v10
  v_lshl_add_u32 v12, v10, 6, v12
  v_lshl_add_u32 v12, v11, 5, v12
  v_and_b32 v10, 3, v0
  v_lshl_add_u32 v12, v10, 3, v12
  v_add_u32 v5, 98304, v12
  v_xor_b32 v6, 32, v5
  s_mov_b32 s56, 4096
  s_mov_b32 s57, 8192
  s_mov_b32 s58, 12288
  s_mov_b32 s15, 0x3e8293ee
  s_cmp_eq_u32 s4, 0
  s_waitcnt lgkmcnt(0)
  s_cselect_b32 s36, s16, s22
  s_cselect_b32 s37, s17, s23
  s_cselect_b32 s40, s18, s24
  s_cselect_b32 s41, s19, s25
  s_cselect_b32 s52, s20, s26
  s_cselect_b32 s53, s21, s27
  s_mov_b32 s44, s32
  s_mov_b32 s45, s33
  s_mov_b32 s48, s30
  s_mov_b32 s49, s31
  s_mov_b32 s96, s28
  s_mov_b32 s97, s29
  s_barrier
  ds_read_b64_tr_b16 v[232:233], v5 offset:0
  ds_read_b64_tr_b16 v[234:235], v5 offset:512
  ds_read_b64_tr_b16 v[236:237], v6 offset:0
  ds_read_b64_tr_b16 v[238:239], v6 offset:512
  ds_read_b64_tr_b16 v[240:241], v5 offset:2048
  ds_read_b64_tr_b16 v[242:243], v5 offset:2560
  ds_read_b128 v[200:203], v1 offset:0
  ds_read_b128 v[204:207], v1 offset:2048
  ds_read_b128 v[208:211], v1 offset:4096
  ds_read_b128 v[212:215], v1 offset:6144
  s_waitcnt lgkmcnt(0)
  ds_read_b64_tr_b16 v[244:245], v6 offset:2048
  ds_read_b64_tr_b16 v[246:247], v6 offset:2560
  ds_read_b64_tr_b16 v[248:249], v5 offset:4096
  ds_read_b64_tr_b16 v[250:251], v5 offset:4608
  ds_read_b64_tr_b16 v[252:253], v6 offset:4096
  ds_read_b64_tr_b16 v[254:255], v6 offset:4608
  ds_read_b128 v[216:219], v1 offset:8192
  ds_read_b128 v[220:223], v1 offset:10240
  ds_read_b128 v[224:227], v1 offset:12288
  ds_read_b128 v[228:231], v1 offset:14336
  v_mfma_f32_16x16x32_bf16 v[8:11], v[232:235], v[200:203], 0
  v_mfma_f32_16x16x32_bf16 v[12:15], v[236:239], v[200:203], 0
  v_mfma_f32_16x16x32_bf16 v[16:19], v[240:243], v[200:203], 0
  v_mfma_f32_16x16x32_bf16 v[32:35], v[232:235], v[204:207], 0
  v_mfma_f32_16x16x32_bf16 v[36:39], v[236:239], v[204:207], 0
  v_mfma_f32_16x16x32_bf16 v[40:43], v[240:243], v[204:207], 0
  v_mfma_f32_16x16x32_bf16 v[56:59], v[232:235], v[208:211], 0
  v_mfma_f32_16x16x32_bf16 v[60:63], v[236:239], v[208:211], 0
  v_mfma_f32_16x16x32_bf16 v[64:67], v[240:243], v[208:211], 0
  v_mfma_f32_16x16x32_bf16 v[80:83], v[232:235], v[212:215], 0
  v_mfma_f32_16x16x32_bf16 v[84:87], v[236:239], v[212:215], 0
  v_mfma_f32_16x16x32_bf16 v[88:91], v[240:243], v[212:215], 0
  s_waitcnt lgkmcnt(8)
  v_mfma_f32_16x16x32_bf16 v[20:23], v[244:247], v[200:203], 0
  s_waitcnt lgkmcnt(6)
  v_mfma_f32_16x16x32_bf16 v[24:27], v[200:203], v[248:251], 0
  s_waitcnt lgkmcnt(4)
  v_mfma_f32_16x16x32_bf16 v[28:31], v[200:203], v[252:255], 0
  ds_read_b128 v[200:203], v2 offset:0
  v_mfma_f32_16x16x32_bf16 v[44:47], v[244:247], v[204:207], 0
  v_mfma_f32_16x16x32_bf16 v[48:51], v[204:207], v[248:251], 0
  v_mfma_f32_16x16x32_bf16 v[52:55], v[204:207], v[252:255], 0
  ds_read_b128 v[204:207], v2 offset:2048
  v_mfma_f32_16x16x32_bf16 v[68:71], v[244:247], v[208:211], 0
  v_mfma_f32_16x16x32_bf16 v[72:75], v[208:211], v[248:251], 0
  v_mfma_f32_16x16x32_bf16 v[76:79], v[208:211], v[252:255], 0
  ds_read_b128 v[208:211], v2 offset:4096
  v_mfma_f32_16x16x32_bf16 v[92:95], v[244:247], v[212:215], 0
  v_mfma_f32_16x16x32_bf16 v[96:99], v[212:215], v[248:251], 0
  v_mfma_f32_16x16x32_bf16 v[100:103], v[212:215], v[252:255], 0
  ds_read_b128 v[212:215], v2 offset:6144
  s_waitcnt lgkmcnt(7)
  v_mfma_f32_16x16x32_bf16 v[116:119], v[244:247], v[216:219], 0
  s_waitcnt lgkmcnt(6)
  v_mfma_f32_16x16x32_bf16 v[140:143], v[244:247], v[220:223], 0
  s_waitcnt lgkmcnt(5)
  v_mfma_f32_16x16x32_bf16 v[164:167], v[244:247], v[224:227], 0
  s_waitcnt lgkmcnt(4)
  v_mfma_f32_16x16x32_bf16 v[188:191], v[244:247], v[228:231], 0
  ds_read_b64_tr_b16 v[244:245], v6 offset:14336
  ds_read_b64_tr_b16 v[246:247], v6 offset:14848
  v_mfma_f32_16x16x32_bf16 v[120:123], v[216:219], v[248:251], 0
  v_mfma_f32_16x16x32_bf16 v[144:147], v[220:223], v[248:251], 0
  v_mfma_f32_16x16x32_bf16 v[168:171], v[224:227], v[248:251], 0
  v_mfma_f32_16x16x32_bf16 v[192:195], v[228:231], v[248:251], 0
  ds_read_b64_tr_b16 v[248:249], v5 offset:16384
  ds_read_b64_tr_b16 v[250:251], v5 offset:16896
  v_mfma_f32_16x16x32_bf16 v[124:127], v[216:219], v[252:255], 0
  v_mfma_f32_16x16x32_bf16 v[148:151], v[220:223], v[252:255], 0
  v_mfma_f32_16x16x32_bf16 v[172:175], v[224:227], v[252:255], 0
  v_mfma_f32_16x16x32_bf16 v[196:199], v[228:231], v[252:255], 0
  ds_read_b64_tr_b16 v[252:253], v6 offset:16384
  ds_read_b64_tr_b16 v[254:255], v6 offset:16896
  v_mfma_f32_16x16x32_bf16 v[104:107], v[232:235], v[216:219], 0
  v_mfma_f32_16x16x32_bf16 v[128:131], v[232:235], v[220:223], 0
  v_mfma_f32_16x16x32_bf16 v[152:155], v[232:235], v[224:227], 0
  v_mfma_f32_16x16x32_bf16 v[176:179], v[232:235], v[228:231], 0
  ds_read_b64_tr_b16 v[232:233], v5 offset:12288
  ds_read_b64_tr_b16 v[234:235], v5 offset:12800
  v_mfma_f32_16x16x32_bf16 v[108:111], v[236:239], v[216:219], 0
  v_mfma_f32_16x16x32_bf16 v[132:135], v[236:239], v[220:223], 0
  v_mfma_f32_16x16x32_bf16 v[156:159], v[236:239], v[224:227], 0
  v_mfma_f32_16x16x32_bf16 v[180:183], v[236:239], v[228:231], 0
  ds_read_b64_tr_b16 v[236:237], v6 offset:12288
  ds_read_b64_tr_b16 v[238:239], v6 offset:12800
  v_mfma_f32_16x16x32_bf16 v[112:115], v[240:243], v[216:219], 0
  ds_read_b128 v[216:219], v2 offset:8192
  v_mfma_f32_16x16x32_bf16 v[136:139], v[240:243], v[220:223], 0
  ds_read_b128 v[220:223], v2 offset:10240
  v_mfma_f32_16x16x32_bf16 v[160:163], v[240:243], v[224:227], 0
  ds_read_b128 v[224:227], v2 offset:12288
  v_mfma_f32_16x16x32_bf16 v[184:187], v[240:243], v[228:231], 0
  ds_read_b128 v[228:231], v2 offset:14336
  ds_read_b64_tr_b16 v[240:241], v5 offset:14336
  ds_read_b64_tr_b16 v[242:243], v5 offset:14848
  s_waitcnt lgkmcnt(14)
  v_mfma_f32_16x16x32_bf16 v[20:23], v[244:247], v[200:203], v[20:23]
  s_waitcnt lgkmcnt(12)
  v_mfma_f32_16x16x32_bf16 v[24:27], v[200:203], v[248:251], v[24:27]
  s_waitcnt lgkmcnt(10)
  v_mfma_f32_16x16x32_bf16 v[28:31], v[200:203], v[252:255], v[28:31]
  v_mfma_f32_16x16x32_bf16 v[44:47], v[244:247], v[204:207], v[44:47]
  v_mfma_f32_16x16x32_bf16 v[48:51], v[204:207], v[248:251], v[48:51]
  v_mfma_f32_16x16x32_bf16 v[52:55], v[204:207], v[252:255], v[52:55]
  v_mfma_f32_16x16x32_bf16 v[68:71], v[244:247], v[208:211], v[68:71]
  v_mfma_f32_16x16x32_bf16 v[72:75], v[208:211], v[248:251], v[72:75]
  v_mfma_f32_16x16x32_bf16 v[76:79], v[208:211], v[252:255], v[76:79]
  v_mfma_f32_16x16x32_bf16 v[92:95], v[244:247], v[212:215], v[92:95]
  v_mfma_f32_16x16x32_bf16 v[96:99], v[212:215], v[248:251], v[96:99]
  v_mfma_f32_16x16x32_bf16 v[100:103], v[212:215], v[252:255], v[100:103]
  s_waitcnt lgkmcnt(8)
  v_mfma_f32_16x16x32_bf16 v[8:11], v[232:235], v[200:203], v[8:11]
  s_waitcnt lgkmcnt(6)
  v_mfma_f32_16x16x32_bf16 v[12:15], v[236:239], v[200:203], v[12:15]
  s_waitcnt lgkmcnt(0)
  v_mfma_f32_16x16x32_bf16 v[16:19], v[240:243], v[200:203], v[16:19]
  s_waitcnt lgkmcnt(0)
  s_barrier
  ds_read_b128 v[200:203], v1 offset:32768
  v_mfma_f32_16x16x32_bf16 v[32:35], v[232:235], v[204:207], v[32:35]
  v_mfma_f32_16x16x32_bf16 v[36:39], v[236:239], v[204:207], v[36:39]
  v_mfma_f32_16x16x32_bf16 v[40:43], v[240:243], v[204:207], v[40:43]
  ds_read_b128 v[204:207], v1 offset:34816
  v_mfma_f32_16x16x32_bf16 v[56:59], v[232:235], v[208:211], v[56:59]
  v_mfma_f32_16x16x32_bf16 v[60:63], v[236:239], v[208:211], v[60:63]
  v_mfma_f32_16x16x32_bf16 v[64:67], v[240:243], v[208:211], v[64:67]
  ds_read_b128 v[208:211], v1 offset:36864
  v_mfma_f32_16x16x32_bf16 v[80:83], v[232:235], v[212:215], v[80:83]
  v_mfma_f32_16x16x32_bf16 v[84:87], v[236:239], v[212:215], v[84:87]
  v_mfma_f32_16x16x32_bf16 v[88:91], v[240:243], v[212:215], v[88:91]
  ds_read_b128 v[212:215], v1 offset:38912
  v_mfma_f32_16x16x32_bf16 v[104:107], v[232:235], v[216:219], v[104:107]
  v_mfma_f32_16x16x32_bf16 v[128:131], v[232:235], v[220:223], v[128:131]
  v_mfma_f32_16x16x32_bf16 v[152:155], v[232:235], v[224:227], v[152:155]
  v_mfma_f32_16x16x32_bf16 v[176:179], v[232:235], v[228:231], v[176:179]
  ds_read_b64_tr_b16 v[232:233], v5 offset:24576
  ds_read_b64_tr_b16 v[234:235], v5 offset:25088
  v_mfma_f32_16x16x32_bf16 v[108:111], v[236:239], v[216:219], v[108:111]
  v_mfma_f32_16x16x32_bf16 v[132:135], v[236:239], v[220:223], v[132:135]
  v_mfma_f32_16x16x32_bf16 v[156:159], v[236:239], v[224:227], v[156:159]
  v_mfma_f32_16x16x32_bf16 v[180:183], v[236:239], v[228:231], v[180:183]
  ds_read_b64_tr_b16 v[236:237], v6 offset:24576
  ds_read_b64_tr_b16 v[238:239], v6 offset:25088
  v_mfma_f32_16x16x32_bf16 v[112:115], v[240:243], v[216:219], v[112:115]
  v_mfma_f32_16x16x32_bf16 v[136:139], v[240:243], v[220:223], v[136:139]
  v_mfma_f32_16x16x32_bf16 v[160:163], v[240:243], v[224:227], v[160:163]
  v_mfma_f32_16x16x32_bf16 v[184:187], v[240:243], v[228:231], v[184:187]
  ds_read_b64_tr_b16 v[240:241], v5 offset:26624
  ds_read_b64_tr_b16 v[242:243], v5 offset:27136
  v_mfma_f32_16x16x32_bf16 v[116:119], v[244:247], v[216:219], v[116:119]
  v_mfma_f32_16x16x32_bf16 v[140:143], v[244:247], v[220:223], v[140:143]
  v_mfma_f32_16x16x32_bf16 v[164:167], v[244:247], v[224:227], v[164:167]
  v_mfma_f32_16x16x32_bf16 v[188:191], v[244:247], v[228:231], v[188:191]
  ds_read_b64_tr_b16 v[244:245], v6 offset:26624
  ds_read_b64_tr_b16 v[246:247], v6 offset:27136
  v_mfma_f32_16x16x32_bf16 v[120:123], v[216:219], v[248:251], v[120:123]
  v_mfma_f32_16x16x32_bf16 v[144:147], v[220:223], v[248:251], v[144:147]
  v_mfma_f32_16x16x32_bf16 v[168:171], v[224:227], v[248:251], v[168:171]
  v_mfma_f32_16x16x32_bf16 v[192:195], v[228:231], v[248:251], v[192:195]
  ds_read_b64_tr_b16 v[248:249], v5 offset:28672
  ds_read_b64_tr_b16 v[250:251], v5 offset:29184
  v_mfma_f32_16x16x32_bf16 v[124:127], v[216:219], v[252:255], v[124:127]
  ds_read_b128 v[216:219], v1 offset:40960
  v_mfma_f32_16x16x32_bf16 v[148:151], v[220:223], v[252:255], v[148:151]
  ds_read_b128 v[220:223], v1 offset:43008
  v_mfma_f32_16x16x32_bf16 v[172:175], v[224:227], v[252:255], v[172:175]
  ds_read_b128 v[224:227], v1 offset:45056
  v_mfma_f32_16x16x32_bf16 v[196:199], v[228:231], v[252:255], v[196:199]
  ds_read_b128 v[228:231], v1 offset:47104
  ds_read_b64_tr_b16 v[252:253], v6 offset:28672
  ds_read_b64_tr_b16 v[254:255], v6 offset:29184
  s_waitcnt lgkmcnt(14)
  v_mfma_f32_16x16x32_bf16 v[8:11], v[232:235], v[200:203], v[8:11]
  s_waitcnt lgkmcnt(12)
  v_mfma_f32_16x16x32_bf16 v[12:15], v[236:239], v[200:203], v[12:15]
  s_waitcnt lgkmcnt(10)
  v_mfma_f32_16x16x32_bf16 v[16:19], v[240:243], v[200:203], v[16:19]
  v_mfma_f32_16x16x32_bf16 v[32:35], v[232:235], v[204:207], v[32:35]
  v_mfma_f32_16x16x32_bf16 v[36:39], v[236:239], v[204:207], v[36:39]
  v_mfma_f32_16x16x32_bf16 v[40:43], v[240:243], v[204:207], v[40:43]
  v_mfma_f32_16x16x32_bf16 v[56:59], v[232:235], v[208:211], v[56:59]
  v_mfma_f32_16x16x32_bf16 v[60:63], v[236:239], v[208:211], v[60:63]
  v_mfma_f32_16x16x32_bf16 v[64:67], v[240:243], v[208:211], v[64:67]
  v_mfma_f32_16x16x32_bf16 v[80:83], v[232:235], v[212:215], v[80:83]
  v_mfma_f32_16x16x32_bf16 v[84:87], v[236:239], v[212:215], v[84:87]
  v_mfma_f32_16x16x32_bf16 v[88:91], v[240:243], v[212:215], v[88:91]
  s_waitcnt lgkmcnt(8)
  v_mfma_f32_16x16x32_bf16 v[20:23], v[244:247], v[200:203], v[20:23]
  s_waitcnt lgkmcnt(6)
  v_mfma_f32_16x16x32_bf16 v[24:27], v[200:203], v[248:251], v[24:27]
  s_waitcnt lgkmcnt(0)
  v_mfma_f32_16x16x32_bf16 v[28:31], v[200:203], v[252:255], v[28:31]
  ds_read_b128 v[200:203], v2 offset:32768
  v_mfma_f32_16x16x32_bf16 v[44:47], v[244:247], v[204:207], v[44:47]
  v_mfma_f32_16x16x32_bf16 v[48:51], v[204:207], v[248:251], v[48:51]
  v_mfma_f32_16x16x32_bf16 v[52:55], v[204:207], v[252:255], v[52:55]
  ds_read_b128 v[204:207], v2 offset:34816
  v_mfma_f32_16x16x32_bf16 v[68:71], v[244:247], v[208:211], v[68:71]
  v_mfma_f32_16x16x32_bf16 v[72:75], v[208:211], v[248:251], v[72:75]
  v_mfma_f32_16x16x32_bf16 v[76:79], v[208:211], v[252:255], v[76:79]
  ds_read_b128 v[208:211], v2 offset:36864
  v_mfma_f32_16x16x32_bf16 v[92:95], v[244:247], v[212:215], v[92:95]
  v_mfma_f32_16x16x32_bf16 v[96:99], v[212:215], v[248:251], v[96:99]
  v_mfma_f32_16x16x32_bf16 v[100:103], v[212:215], v[252:255], v[100:103]
  ds_read_b128 v[212:215], v2 offset:38912
  v_mfma_f32_16x16x32_bf16 v[116:119], v[244:247], v[216:219], v[116:119]
  v_mfma_f32_16x16x32_bf16 v[140:143], v[244:247], v[220:223], v[140:143]
  v_mfma_f32_16x16x32_bf16 v[164:167], v[244:247], v[224:227], v[164:167]
  v_mfma_f32_16x16x32_bf16 v[188:191], v[244:247], v[228:231], v[188:191]
  ds_read_b64_tr_b16 v[244:245], v6 offset:38912
  ds_read_b64_tr_b16 v[246:247], v6 offset:39424
  v_mfma_f32_16x16x32_bf16 v[120:123], v[216:219], v[248:251], v[120:123]
  v_mfma_f32_16x16x32_bf16 v[144:147], v[220:223], v[248:251], v[144:147]
  v_mfma_f32_16x16x32_bf16 v[168:171], v[224:227], v[248:251], v[168:171]
  v_mfma_f32_16x16x32_bf16 v[192:195], v[228:231], v[248:251], v[192:195]
  ds_read_b64_tr_b16 v[248:249], v5 offset:40960
  ds_read_b64_tr_b16 v[250:251], v5 offset:41472
  v_mfma_f32_16x16x32_bf16 v[124:127], v[216:219], v[252:255], v[124:127]
  v_mfma_f32_16x16x32_bf16 v[148:151], v[220:223], v[252:255], v[148:151]
  v_mfma_f32_16x16x32_bf16 v[172:175], v[224:227], v[252:255], v[172:175]
  v_mfma_f32_16x16x32_bf16 v[196:199], v[228:231], v[252:255], v[196:199]
  ds_read_b64_tr_b16 v[252:253], v6 offset:40960
  ds_read_b64_tr_b16 v[254:255], v6 offset:41472
  v_mfma_f32_16x16x32_bf16 v[104:107], v[232:235], v[216:219], v[104:107]
  v_mfma_f32_16x16x32_bf16 v[128:131], v[232:235], v[220:223], v[128:131]
  v_mfma_f32_16x16x32_bf16 v[152:155], v[232:235], v[224:227], v[152:155]
  v_mfma_f32_16x16x32_bf16 v[176:179], v[232:235], v[228:231], v[176:179]
  ds_read_b64_tr_b16 v[232:233], v5 offset:36864
  ds_read_b64_tr_b16 v[234:235], v5 offset:37376
  v_mfma_f32_16x16x32_bf16 v[108:111], v[236:239], v[216:219], v[108:111]
  v_mfma_f32_16x16x32_bf16 v[132:135], v[236:239], v[220:223], v[132:135]
  v_mfma_f32_16x16x32_bf16 v[156:159], v[236:239], v[224:227], v[156:159]
  v_mfma_f32_16x16x32_bf16 v[180:183], v[236:239], v[228:231], v[180:183]
  ds_read_b64_tr_b16 v[236:237], v6 offset:36864
  ds_read_b64_tr_b16 v[238:239], v6 offset:37376
  v_mfma_f32_16x16x32_bf16 v[112:115], v[240:243], v[216:219], v[112:115]
  ds_read_b128 v[216:219], v2 offset:40960
  v_mfma_f32_16x16x32_bf16 v[136:139], v[240:243], v[220:223], v[136:139]
  ds_read_b128 v[220:223], v2 offset:43008
  v_mfma_f32_16x16x32_bf16 v[160:163], v[240:243], v[224:227], v[160:163]
  ds_read_b128 v[224:227], v2 offset:45056
  v_mfma_f32_16x16x32_bf16 v[184:187], v[240:243], v[228:231], v[184:187]
  ds_read_b128 v[228:231], v2 offset:47104
  ds_read_b64_tr_b16 v[240:241], v5 offset:38912
  ds_read_b64_tr_b16 v[242:243], v5 offset:39424
  s_waitcnt lgkmcnt(14)
  v_mfma_f32_16x16x32_bf16 v[20:23], v[244:247], v[200:203], v[20:23]
  s_waitcnt lgkmcnt(12)
  v_mfma_f32_16x16x32_bf16 v[24:27], v[200:203], v[248:251], v[24:27]
  s_waitcnt lgkmcnt(10)
  v_mfma_f32_16x16x32_bf16 v[28:31], v[200:203], v[252:255], v[28:31]
  v_mfma_f32_16x16x32_bf16 v[44:47], v[244:247], v[204:207], v[44:47]
  v_mfma_f32_16x16x32_bf16 v[48:51], v[204:207], v[248:251], v[48:51]
  v_mfma_f32_16x16x32_bf16 v[52:55], v[204:207], v[252:255], v[52:55]
  v_mfma_f32_16x16x32_bf16 v[68:71], v[244:247], v[208:211], v[68:71]
  v_mfma_f32_16x16x32_bf16 v[72:75], v[208:211], v[248:251], v[72:75]
  v_mfma_f32_16x16x32_bf16 v[76:79], v[208:211], v[252:255], v[76:79]
  v_mfma_f32_16x16x32_bf16 v[92:95], v[244:247], v[212:215], v[92:95]
  v_mfma_f32_16x16x32_bf16 v[96:99], v[212:215], v[248:251], v[96:99]
  v_mfma_f32_16x16x32_bf16 v[100:103], v[212:215], v[252:255], v[100:103]
  s_waitcnt lgkmcnt(8)
  v_mfma_f32_16x16x32_bf16 v[8:11], v[232:235], v[200:203], v[8:11]
  s_waitcnt lgkmcnt(6)
  v_mfma_f32_16x16x32_bf16 v[12:15], v[236:239], v[200:203], v[12:15]
  s_waitcnt lgkmcnt(0)
  v_mfma_f32_16x16x32_bf16 v[16:19], v[240:243], v[200:203], v[16:19]
  s_waitcnt lgkmcnt(0)
  s_barrier
  ds_read_b128 v[200:203], v3 offset:0
  v_mfma_f32_16x16x32_bf16 v[32:35], v[232:235], v[204:207], v[32:35]
  v_mfma_f32_16x16x32_bf16 v[36:39], v[236:239], v[204:207], v[36:39]
  v_mfma_f32_16x16x32_bf16 v[40:43], v[240:243], v[204:207], v[40:43]
  ds_read_b128 v[204:207], v3 offset:2048
  v_mfma_f32_16x16x32_bf16 v[56:59], v[232:235], v[208:211], v[56:59]
  v_mfma_f32_16x16x32_bf16 v[60:63], v[236:239], v[208:211], v[60:63]
  v_mfma_f32_16x16x32_bf16 v[64:67], v[240:243], v[208:211], v[64:67]
  ds_read_b128 v[208:211], v3 offset:4096
  v_mfma_f32_16x16x32_bf16 v[80:83], v[232:235], v[212:215], v[80:83]
  v_mfma_f32_16x16x32_bf16 v[84:87], v[236:239], v[212:215], v[84:87]
  v_mfma_f32_16x16x32_bf16 v[88:91], v[240:243], v[212:215], v[88:91]
  ds_read_b128 v[212:215], v3 offset:6144
  v_mfma_f32_16x16x32_bf16 v[104:107], v[232:235], v[216:219], v[104:107]
  v_mfma_f32_16x16x32_bf16 v[128:131], v[232:235], v[220:223], v[128:131]
  v_mfma_f32_16x16x32_bf16 v[152:155], v[232:235], v[224:227], v[152:155]
  v_mfma_f32_16x16x32_bf16 v[176:179], v[232:235], v[228:231], v[176:179]
  ds_read_b64_tr_b16 v[232:233], v5 offset:49152
  ds_read_b64_tr_b16 v[234:235], v5 offset:49664
  v_mfma_f32_16x16x32_bf16 v[108:111], v[236:239], v[216:219], v[108:111]
  v_mfma_f32_16x16x32_bf16 v[132:135], v[236:239], v[220:223], v[132:135]
  v_mfma_f32_16x16x32_bf16 v[156:159], v[236:239], v[224:227], v[156:159]
  v_mfma_f32_16x16x32_bf16 v[180:183], v[236:239], v[228:231], v[180:183]
  ds_read_b64_tr_b16 v[236:237], v6 offset:49152
  ds_read_b64_tr_b16 v[238:239], v6 offset:49664
  v_mfma_f32_16x16x32_bf16 v[112:115], v[240:243], v[216:219], v[112:115]
  v_mfma_f32_16x16x32_bf16 v[136:139], v[240:243], v[220:223], v[136:139]
  v_mfma_f32_16x16x32_bf16 v[160:163], v[240:243], v[224:227], v[160:163]
  v_mfma_f32_16x16x32_bf16 v[184:187], v[240:243], v[228:231], v[184:187]
  ds_read_b64_tr_b16 v[240:241], v5 offset:51200
  ds_read_b64_tr_b16 v[242:243], v5 offset:51712
  v_mfma_f32_16x16x32_bf16 v[116:119], v[244:247], v[216:219], v[116:119]
  v_mfma_f32_16x16x32_bf16 v[140:143], v[244:247], v[220:223], v[140:143]
  v_mfma_f32_16x16x32_bf16 v[164:167], v[244:247], v[224:227], v[164:167]
  v_mfma_f32_16x16x32_bf16 v[188:191], v[244:247], v[228:231], v[188:191]
  ds_read_b64_tr_b16 v[244:245], v6 offset:51200
  ds_read_b64_tr_b16 v[246:247], v6 offset:51712
  v_mfma_f32_16x16x32_bf16 v[120:123], v[216:219], v[248:251], v[120:123]
  v_mfma_f32_16x16x32_bf16 v[144:147], v[220:223], v[248:251], v[144:147]
  v_mfma_f32_16x16x32_bf16 v[168:171], v[224:227], v[248:251], v[168:171]
  v_mfma_f32_16x16x32_bf16 v[192:195], v[228:231], v[248:251], v[192:195]
  ds_read_b64_tr_b16 v[248:249], v5 offset:53248
  ds_read_b64_tr_b16 v[250:251], v5 offset:53760
  v_mfma_f32_16x16x32_bf16 v[124:127], v[216:219], v[252:255], v[124:127]
  ds_read_b128 v[216:219], v3 offset:8192
  v_mfma_f32_16x16x32_bf16 v[148:151], v[220:223], v[252:255], v[148:151]
  ds_read_b128 v[220:223], v3 offset:10240
  v_mfma_f32_16x16x32_bf16 v[172:175], v[224:227], v[252:255], v[172:175]
  ds_read_b128 v[224:227], v3 offset:12288
  v_mfma_f32_16x16x32_bf16 v[196:199], v[228:231], v[252:255], v[196:199]
  ds_read_b128 v[228:231], v3 offset:14336
  ds_read_b64_tr_b16 v[252:253], v6 offset:53248
  ds_read_b64_tr_b16 v[254:255], v6 offset:53760
  s_waitcnt lgkmcnt(14)
  v_mfma_f32_16x16x32_bf16 v[8:11], v[232:235], v[200:203], v[8:11]
  s_waitcnt lgkmcnt(12)
  v_mfma_f32_16x16x32_bf16 v[12:15], v[236:239], v[200:203], v[12:15]
  s_waitcnt lgkmcnt(10)
  v_mfma_f32_16x16x32_bf16 v[16:19], v[240:243], v[200:203], v[16:19]
  v_mfma_f32_16x16x32_bf16 v[32:35], v[232:235], v[204:207], v[32:35]
  v_mfma_f32_16x16x32_bf16 v[36:39], v[236:239], v[204:207], v[36:39]
  v_mfma_f32_16x16x32_bf16 v[40:43], v[240:243], v[204:207], v[40:43]
  v_mfma_f32_16x16x32_bf16 v[56:59], v[232:235], v[208:211], v[56:59]
  v_mfma_f32_16x16x32_bf16 v[60:63], v[236:239], v[208:211], v[60:63]
  v_mfma_f32_16x16x32_bf16 v[64:67], v[240:243], v[208:211], v[64:67]
  v_mfma_f32_16x16x32_bf16 v[80:83], v[232:235], v[212:215], v[80:83]
  v_mfma_f32_16x16x32_bf16 v[84:87], v[236:239], v[212:215], v[84:87]
  v_mfma_f32_16x16x32_bf16 v[88:91], v[240:243], v[212:215], v[88:91]
  s_waitcnt lgkmcnt(8)
  v_mfma_f32_16x16x32_bf16 v[20:23], v[244:247], v[200:203], v[20:23]
  s_waitcnt lgkmcnt(6)
  v_mfma_f32_16x16x32_bf16 v[24:27], v[200:203], v[248:251], v[24:27]
  s_waitcnt lgkmcnt(0)
  v_mfma_f32_16x16x32_bf16 v[28:31], v[200:203], v[252:255], v[28:31]
  ds_read_b128 v[200:203], v4 offset:0
  v_mfma_f32_16x16x32_bf16 v[44:47], v[244:247], v[204:207], v[44:47]
  v_mfma_f32_16x16x32_bf16 v[48:51], v[204:207], v[248:251], v[48:51]
  v_mfma_f32_16x16x32_bf16 v[52:55], v[204:207], v[252:255], v[52:55]
  ds_read_b128 v[204:207], v4 offset:2048
  v_mfma_f32_16x16x32_bf16 v[68:71], v[244:247], v[208:211], v[68:71]
  v_mfma_f32_16x16x32_bf16 v[72:75], v[208:211], v[248:251], v[72:75]
  v_mfma_f32_16x16x32_bf16 v[76:79], v[208:211], v[252:255], v[76:79]
  ds_read_b128 v[208:211], v4 offset:4096
  v_mfma_f32_16x16x32_bf16 v[92:95], v[244:247], v[212:215], v[92:95]
  v_mfma_f32_16x16x32_bf16 v[96:99], v[212:215], v[248:251], v[96:99]
  v_mfma_f32_16x16x32_bf16 v[100:103], v[212:215], v[252:255], v[100:103]
  ds_read_b128 v[212:215], v4 offset:6144
  v_mfma_f32_16x16x32_bf16 v[116:119], v[244:247], v[216:219], v[116:119]
  v_mfma_f32_16x16x32_bf16 v[140:143], v[244:247], v[220:223], v[140:143]
  v_mfma_f32_16x16x32_bf16 v[164:167], v[244:247], v[224:227], v[164:167]
  v_mfma_f32_16x16x32_bf16 v[188:191], v[244:247], v[228:231], v[188:191]
  ds_read_b64_tr_b16 v[244:245], v6 offset:2048
  ds_read_b64_tr_b16 v[246:247], v6 offset:2560
  v_mfma_f32_16x16x32_bf16 v[120:123], v[216:219], v[248:251], v[120:123]
  v_mfma_f32_16x16x32_bf16 v[144:147], v[220:223], v[248:251], v[144:147]
  v_mfma_f32_16x16x32_bf16 v[168:171], v[224:227], v[248:251], v[168:171]
  v_mfma_f32_16x16x32_bf16 v[192:195], v[228:231], v[248:251], v[192:195]
  ds_read_b64_tr_b16 v[248:249], v5 offset:4096
  ds_read_b64_tr_b16 v[250:251], v5 offset:4608
  v_mfma_f32_16x16x32_bf16 v[124:127], v[216:219], v[252:255], v[124:127]
  v_mfma_f32_16x16x32_bf16 v[148:151], v[220:223], v[252:255], v[148:151]
  v_mfma_f32_16x16x32_bf16 v[172:175], v[224:227], v[252:255], v[172:175]
  v_mfma_f32_16x16x32_bf16 v[196:199], v[228:231], v[252:255], v[196:199]
  ds_read_b64_tr_b16 v[252:253], v6 offset:4096
  ds_read_b64_tr_b16 v[254:255], v6 offset:4608
  v_mfma_f32_16x16x32_bf16 v[104:107], v[232:235], v[216:219], v[104:107]
  v_mfma_f32_16x16x32_bf16 v[128:131], v[232:235], v[220:223], v[128:131]
  v_mfma_f32_16x16x32_bf16 v[152:155], v[232:235], v[224:227], v[152:155]
  v_mfma_f32_16x16x32_bf16 v[176:179], v[232:235], v[228:231], v[176:179]
  ds_read_b64_tr_b16 v[232:233], v5 offset:0
  ds_read_b64_tr_b16 v[234:235], v5 offset:512
  v_mfma_f32_16x16x32_bf16 v[108:111], v[236:239], v[216:219], v[108:111]
  v_mfma_f32_16x16x32_bf16 v[132:135], v[236:239], v[220:223], v[132:135]
  v_mfma_f32_16x16x32_bf16 v[156:159], v[236:239], v[224:227], v[156:159]
  v_mfma_f32_16x16x32_bf16 v[180:183], v[236:239], v[228:231], v[180:183]
  ds_read_b64_tr_b16 v[236:237], v6 offset:0
  ds_read_b64_tr_b16 v[238:239], v6 offset:512
  v_mfma_f32_16x16x32_bf16 v[112:115], v[240:243], v[216:219], v[112:115]
  ds_read_b128 v[216:219], v4 offset:8192
  v_mfma_f32_16x16x32_bf16 v[136:139], v[240:243], v[220:223], v[136:139]
  ds_read_b128 v[220:223], v4 offset:10240
  v_mfma_f32_16x16x32_bf16 v[160:163], v[240:243], v[224:227], v[160:163]
  ds_read_b128 v[224:227], v4 offset:12288
  v_mfma_f32_16x16x32_bf16 v[184:187], v[240:243], v[228:231], v[184:187]
  ds_read_b128 v[228:231], v4 offset:14336
  ds_read_b64_tr_b16 v[240:241], v5 offset:2048
  ds_read_b64_tr_b16 v[242:243], v5 offset:2560
  s_waitcnt lgkmcnt(14)
  v_mfma_f32_16x16x32_bf16 v[20:23], v[244:247], v[200:203], v[20:23]
  s_waitcnt lgkmcnt(12)
  v_mfma_f32_16x16x32_bf16 v[24:27], v[200:203], v[248:251], v[24:27]
  s_waitcnt lgkmcnt(10)
  v_mfma_f32_16x16x32_bf16 v[28:31], v[200:203], v[252:255], v[28:31]
  v_mfma_f32_16x16x32_bf16 v[44:47], v[244:247], v[204:207], v[44:47]
  v_mfma_f32_16x16x32_bf16 v[48:51], v[204:207], v[248:251], v[48:51]
  v_mfma_f32_16x16x32_bf16 v[52:55], v[204:207], v[252:255], v[52:55]
  v_mfma_f32_16x16x32_bf16 v[68:71], v[244:247], v[208:211], v[68:71]
  v_mfma_f32_16x16x32_bf16 v[72:75], v[208:211], v[248:251], v[72:75]
  v_mfma_f32_16x16x32_bf16 v[76:79], v[208:211], v[252:255], v[76:79]
  v_mfma_f32_16x16x32_bf16 v[92:95], v[244:247], v[212:215], v[92:95]
  v_mfma_f32_16x16x32_bf16 v[96:99], v[212:215], v[248:251], v[96:99]
  v_mfma_f32_16x16x32_bf16 v[100:103], v[212:215], v[252:255], v[100:103]
  s_waitcnt lgkmcnt(8)
  v_mfma_f32_16x16x32_bf16 v[8:11], v[232:235], v[200:203], v[8:11]
  s_waitcnt lgkmcnt(6)
  v_mfma_f32_16x16x32_bf16 v[12:15], v[236:239], v[200:203], v[12:15]
  s_waitcnt lgkmcnt(0)
  v_mfma_f32_16x16x32_bf16 v[16:19], v[240:243], v[200:203], v[16:19]
  s_waitcnt lgkmcnt(0)
  s_barrier
  ds_read_b128 v[200:203], v1 offset:0
  v_mfma_f32_16x16x32_bf16 v[32:35], v[232:235], v[204:207], v[32:35]
  v_mfma_f32_16x16x32_bf16 v[36:39], v[236:239], v[204:207], v[36:39]
  v_mfma_f32_16x16x32_bf16 v[40:43], v[240:243], v[204:207], v[40:43]
  ds_read_b128 v[204:207], v1 offset:2048
  v_mfma_f32_16x16x32_bf16 v[56:59], v[232:235], v[208:211], v[56:59]
  v_mfma_f32_16x16x32_bf16 v[60:63], v[236:239], v[208:211], v[60:63]
  v_mfma_f32_16x16x32_bf16 v[64:67], v[240:243], v[208:211], v[64:67]
  ds_read_b128 v[208:211], v1 offset:4096
  v_mfma_f32_16x16x32_bf16 v[80:83], v[232:235], v[212:215], v[80:83]
  v_mfma_f32_16x16x32_bf16 v[84:87], v[236:239], v[212:215], v[84:87]
  v_mfma_f32_16x16x32_bf16 v[88:91], v[240:243], v[212:215], v[88:91]
  ds_read_b128 v[212:215], v1 offset:6144
  v_mfma_f32_16x16x32_bf16 v[104:107], v[232:235], v[216:219], v[104:107]
  v_mfma_f32_16x16x32_bf16 v[128:131], v[232:235], v[220:223], v[128:131]
  v_mfma_f32_16x16x32_bf16 v[152:155], v[232:235], v[224:227], v[152:155]
  v_mfma_f32_16x16x32_bf16 v[176:179], v[232:235], v[228:231], v[176:179]
  ds_read_b64_tr_b16 v[232:233], v5 offset:12288
  ds_read_b64_tr_b16 v[234:235], v5 offset:12800
  v_mfma_f32_16x16x32_bf16 v[108:111], v[236:239], v[216:219], v[108:111]
  v_mfma_f32_16x16x32_bf16 v[132:135], v[236:239], v[220:223], v[132:135]
  v_mfma_f32_16x16x32_bf16 v[156:159], v[236:239], v[224:227], v[156:159]
  v_mfma_f32_16x16x32_bf16 v[180:183], v[236:239], v[228:231], v[180:183]
  ds_read_b64_tr_b16 v[236:237], v6 offset:12288
  ds_read_b64_tr_b16 v[238:239], v6 offset:12800
  v_mfma_f32_16x16x32_bf16 v[112:115], v[240:243], v[216:219], v[112:115]
  v_mfma_f32_16x16x32_bf16 v[136:139], v[240:243], v[220:223], v[136:139]
  v_mfma_f32_16x16x32_bf16 v[160:163], v[240:243], v[224:227], v[160:163]
  v_mfma_f32_16x16x32_bf16 v[184:187], v[240:243], v[228:231], v[184:187]
  ds_read_b64_tr_b16 v[240:241], v5 offset:14336
  ds_read_b64_tr_b16 v[242:243], v5 offset:14848
  v_mfma_f32_16x16x32_bf16 v[116:119], v[244:247], v[216:219], v[116:119]
  v_mfma_f32_16x16x32_bf16 v[140:143], v[244:247], v[220:223], v[140:143]
  v_mfma_f32_16x16x32_bf16 v[164:167], v[244:247], v[224:227], v[164:167]
  v_mfma_f32_16x16x32_bf16 v[188:191], v[244:247], v[228:231], v[188:191]
  ds_read_b64_tr_b16 v[244:245], v6 offset:14336
  ds_read_b64_tr_b16 v[246:247], v6 offset:14848
  v_mfma_f32_16x16x32_bf16 v[120:123], v[216:219], v[248:251], v[120:123]
  v_mfma_f32_16x16x32_bf16 v[144:147], v[220:223], v[248:251], v[144:147]
  v_mfma_f32_16x16x32_bf16 v[168:171], v[224:227], v[248:251], v[168:171]
  v_mfma_f32_16x16x32_bf16 v[192:195], v[228:231], v[248:251], v[192:195]
  ds_read_b64_tr_b16 v[248:249], v5 offset:16384
  ds_read_b64_tr_b16 v[250:251], v5 offset:16896
  v_mfma_f32_16x16x32_bf16 v[124:127], v[216:219], v[252:255], v[124:127]
  ds_read_b128 v[216:219], v1 offset:8192
  v_mfma_f32_16x16x32_bf16 v[148:151], v[220:223], v[252:255], v[148:151]
  ds_read_b128 v[220:223], v1 offset:10240
  v_mfma_f32_16x16x32_bf16 v[172:175], v[224:227], v[252:255], v[172:175]
  ds_read_b128 v[224:227], v1 offset:12288
  v_mfma_f32_16x16x32_bf16 v[196:199], v[228:231], v[252:255], v[196:199]
  ds_read_b128 v[228:231], v1 offset:14336
  ds_read_b64_tr_b16 v[252:253], v6 offset:16384
  ds_read_b64_tr_b16 v[254:255], v6 offset:16896
  s_waitcnt lgkmcnt(14)
  v_mfma_f32_16x16x32_bf16 v[8:11], v[232:235], v[200:203], v[8:11]
  s_waitcnt lgkmcnt(12)
  v_mfma_f32_16x16x32_bf16 v[12:15], v[236:239], v[200:203], v[12:15]
  s_waitcnt lgkmcnt(10)
  v_mfma_f32_16x16x32_bf16 v[16:19], v[240:243], v[200:203], v[16:19]
  v_mfma_f32_16x16x32_bf16 v[32:35], v[232:235], v[204:207], v[32:35]
  v_mfma_f32_16x16x32_bf16 v[36:39], v[236:239], v[204:207], v[36:39]
  v_mfma_f32_16x16x32_bf16 v[40:43], v[240:243], v[204:207], v[40:43]
  v_mfma_f32_16x16x32_bf16 v[56:59], v[232:235], v[208:211], v[56:59]
  v_mfma_f32_16x16x32_bf16 v[60:63], v[236:239], v[208:211], v[60:63]
  v_mfma_f32_16x16x32_bf16 v[64:67], v[240:243], v[208:211], v[64:67]
  v_mfma_f32_16x16x32_bf16 v[80:83], v[232:235], v[212:215], v[80:83]
  v_mfma_f32_16x16x32_bf16 v[84:87], v[236:239], v[212:215], v[84:87]
  v_mfma_f32_16x16x32_bf16 v[88:91], v[240:243], v[212:215], v[88:91]
  s_waitcnt lgkmcnt(8)
  v_mfma_f32_16x16x32_bf16 v[20:23], v[244:247], v[200:203], v[20:23]
  s_waitcnt lgkmcnt(6)
  v_mfma_f32_16x16x32_bf16 v[24:27], v[200:203], v[248:251], v[24:27]
  s_waitcnt lgkmcnt(0)
  v_mfma_f32_16x16x32_bf16 v[28:31], v[200:203], v[252:255], v[28:31]
  ds_read_b128 v[200:203], v2 offset:0
  v_mfma_f32_16x16x32_bf16 v[44:47], v[244:247], v[204:207], v[44:47]
  v_mfma_f32_16x16x32_bf16 v[48:51], v[204:207], v[248:251], v[48:51]
  v_mfma_f32_16x16x32_bf16 v[52:55], v[204:207], v[252:255], v[52:55]
  ds_read_b128 v[204:207], v2 offset:2048
  v_mfma_f32_16x16x32_bf16 v[68:71], v[244:247], v[208:211], v[68:71]
  v_mfma_f32_16x16x32_bf16 v[72:75], v[208:211], v[248:251], v[72:75]
  v_mfma_f32_16x16x32_bf16 v[76:79], v[208:211], v[252:255], v[76:79]
  ds_read_b128 v[208:211], v2 offset:4096
  v_mfma_f32_16x16x32_bf16 v[92:95], v[244:247], v[212:215], v[92:95]
  v_mfma_f32_16x16x32_bf16 v[96:99], v[212:215], v[248:251], v[96:99]
  v_mfma_f32_16x16x32_bf16 v[100:103], v[212:215], v[252:255], v[100:103]
  ds_read_b128 v[212:215], v2 offset:6144
  v_mfma_f32_16x16x32_bf16 v[116:119], v[244:247], v[216:219], v[116:119]
  v_mfma_f32_16x16x32_bf16 v[140:143], v[244:247], v[220:223], v[140:143]
  v_mfma_f32_16x16x32_bf16 v[164:167], v[244:247], v[224:227], v[164:167]
  v_mfma_f32_16x16x32_bf16 v[188:191], v[244:247], v[228:231], v[188:191]
  ds_read_b64_tr_b16 v[244:245], v6 offset:26624
  ds_read_b64_tr_b16 v[246:247], v6 offset:27136
  v_mfma_f32_16x16x32_bf16 v[120:123], v[216:219], v[248:251], v[120:123]
  v_mfma_f32_16x16x32_bf16 v[144:147], v[220:223], v[248:251], v[144:147]
  v_mfma_f32_16x16x32_bf16 v[168:171], v[224:227], v[248:251], v[168:171]
  v_mfma_f32_16x16x32_bf16 v[192:195], v[228:231], v[248:251], v[192:195]
  ds_read_b64_tr_b16 v[248:249], v5 offset:28672
  ds_read_b64_tr_b16 v[250:251], v5 offset:29184
  v_mfma_f32_16x16x32_bf16 v[124:127], v[216:219], v[252:255], v[124:127]
  v_mfma_f32_16x16x32_bf16 v[148:151], v[220:223], v[252:255], v[148:151]
  v_mfma_f32_16x16x32_bf16 v[172:175], v[224:227], v[252:255], v[172:175]
  v_mfma_f32_16x16x32_bf16 v[196:199], v[228:231], v[252:255], v[196:199]
  ds_read_b64_tr_b16 v[252:253], v6 offset:28672
  ds_read_b64_tr_b16 v[254:255], v6 offset:29184
  v_mfma_f32_16x16x32_bf16 v[104:107], v[232:235], v[216:219], v[104:107]
  v_mfma_f32_16x16x32_bf16 v[128:131], v[232:235], v[220:223], v[128:131]
  v_mfma_f32_16x16x32_bf16 v[152:155], v[232:235], v[224:227], v[152:155]
  v_mfma_f32_16x16x32_bf16 v[176:179], v[232:235], v[228:231], v[176:179]
  ds_read_b64_tr_b16 v[232:233], v5 offset:24576
  ds_read_b64_tr_b16 v[234:235], v5 offset:25088
  v_mfma_f32_16x16x32_bf16 v[108:111], v[236:239], v[216:219], v[108:111]
  v_mfma_f32_16x16x32_bf16 v[132:135], v[236:239], v[220:223], v[132:135]
  v_mfma_f32_16x16x32_bf16 v[156:159], v[236:239], v[224:227], v[156:159]
  v_mfma_f32_16x16x32_bf16 v[180:183], v[236:239], v[228:231], v[180:183]
  ds_read_b64_tr_b16 v[236:237], v6 offset:24576
  ds_read_b64_tr_b16 v[238:239], v6 offset:25088
  v_mfma_f32_16x16x32_bf16 v[112:115], v[240:243], v[216:219], v[112:115]
  ds_read_b128 v[216:219], v2 offset:8192
  v_mfma_f32_16x16x32_bf16 v[136:139], v[240:243], v[220:223], v[136:139]
  ds_read_b128 v[220:223], v2 offset:10240
  v_mfma_f32_16x16x32_bf16 v[160:163], v[240:243], v[224:227], v[160:163]
  ds_read_b128 v[224:227], v2 offset:12288
  v_mfma_f32_16x16x32_bf16 v[184:187], v[240:243], v[228:231], v[184:187]
  ds_read_b128 v[228:231], v2 offset:14336
  ds_read_b64_tr_b16 v[240:241], v5 offset:26624
  ds_read_b64_tr_b16 v[242:243], v5 offset:27136
  s_waitcnt lgkmcnt(14)
  v_mfma_f32_16x16x32_bf16 v[20:23], v[244:247], v[200:203], v[20:23]
  s_waitcnt lgkmcnt(12)
  v_mfma_f32_16x16x32_bf16 v[24:27], v[200:203], v[248:251], v[24:27]
  s_waitcnt lgkmcnt(10)
  v_mfma_f32_16x16x32_bf16 v[28:31], v[200:203], v[252:255], v[28:31]
  v_mfma_f32_16x16x32_bf16 v[44:47], v[244:247], v[204:207], v[44:47]
  v_mfma_f32_16x16x32_bf16 v[48:51], v[204:207], v[248:251], v[48:51]
  v_mfma_f32_16x16x32_bf16 v[52:55], v[204:207], v[252:255], v[52:55]
  v_mfma_f32_16x16x32_bf16 v[68:71], v[244:247], v[208:211], v[68:71]
  v_mfma_f32_16x16x32_bf16 v[72:75], v[208:211], v[248:251], v[72:75]
  v_mfma_f32_16x16x32_bf16 v[76:79], v[208:211], v[252:255], v[76:79]
  v_mfma_f32_16x16x32_bf16 v[92:95], v[244:247], v[212:215], v[92:95]
  v_mfma_f32_16x16x32_bf16 v[96:99], v[212:215], v[248:251], v[96:99]
  v_mfma_f32_16x16x32_bf16 v[100:103], v[212:215], v[252:255], v[100:103]
  s_waitcnt lgkmcnt(8)
  v_mfma_f32_16x16x32_bf16 v[8:11], v[232:235], v[200:203], v[8:11]
  s_waitcnt lgkmcnt(6)
  v_mfma_f32_16x16x32_bf16 v[12:15], v[236:239], v[200:203], v[12:15]
  s_waitcnt lgkmcnt(0)
  v_mfma_f32_16x16x32_bf16 v[16:19], v[240:243], v[200:203], v[16:19]
  s_waitcnt lgkmcnt(0)
  s_barrier
  ds_read_b128 v[200:203], v1 offset:32768
  v_mfma_f32_16x16x32_bf16 v[32:35], v[232:235], v[204:207], v[32:35]
  v_mfma_f32_16x16x32_bf16 v[36:39], v[236:239], v[204:207], v[36:39]
  v_mfma_f32_16x16x32_bf16 v[40:43], v[240:243], v[204:207], v[40:43]
  ds_read_b128 v[204:207], v1 offset:34816
  v_mfma_f32_16x16x32_bf16 v[56:59], v[232:235], v[208:211], v[56:59]
  v_mfma_f32_16x16x32_bf16 v[60:63], v[236:239], v[208:211], v[60:63]
  v_mfma_f32_16x16x32_bf16 v[64:67], v[240:243], v[208:211], v[64:67]
  ds_read_b128 v[208:211], v1 offset:36864
  v_mfma_f32_16x16x32_bf16 v[80:83], v[232:235], v[212:215], v[80:83]
  v_mfma_f32_16x16x32_bf16 v[84:87], v[236:239], v[212:215], v[84:87]
  v_mfma_f32_16x16x32_bf16 v[88:91], v[240:243], v[212:215], v[88:91]
  ds_read_b128 v[212:215], v1 offset:38912
  v_mfma_f32_16x16x32_bf16 v[104:107], v[232:235], v[216:219], v[104:107]
  v_mfma_f32_16x16x32_bf16 v[128:131], v[232:235], v[220:223], v[128:131]
  v_mfma_f32_16x16x32_bf16 v[152:155], v[232:235], v[224:227], v[152:155]
  v_mfma_f32_16x16x32_bf16 v[176:179], v[232:235], v[228:231], v[176:179]
  ds_read_b64_tr_b16 v[232:233], v5 offset:36864
  ds_read_b64_tr_b16 v[234:235], v5 offset:37376
  v_mfma_f32_16x16x32_bf16 v[108:111], v[236:239], v[216:219], v[108:111]
  v_mfma_f32_16x16x32_bf16 v[132:135], v[236:239], v[220:223], v[132:135]
  v_mfma_f32_16x16x32_bf16 v[156:159], v[236:239], v[224:227], v[156:159]
  v_mfma_f32_16x16x32_bf16 v[180:183], v[236:239], v[228:231], v[180:183]
  ds_read_b64_tr_b16 v[236:237], v6 offset:36864
  ds_read_b64_tr_b16 v[238:239], v6 offset:37376
  v_mfma_f32_16x16x32_bf16 v[112:115], v[240:243], v[216:219], v[112:115]
  v_mfma_f32_16x16x32_bf16 v[136:139], v[240:243], v[220:223], v[136:139]
  v_mfma_f32_16x16x32_bf16 v[160:163], v[240:243], v[224:227], v[160:163]
  v_mfma_f32_16x16x32_bf16 v[184:187], v[240:243], v[228:231], v[184:187]
  ds_read_b64_tr_b16 v[240:241], v5 offset:38912
  ds_read_b64_tr_b16 v[242:243], v5 offset:39424
  v_mfma_f32_16x16x32_bf16 v[116:119], v[244:247], v[216:219], v[116:119]
  v_mfma_f32_16x16x32_bf16 v[140:143], v[244:247], v[220:223], v[140:143]
  v_mfma_f32_16x16x32_bf16 v[164:167], v[244:247], v[224:227], v[164:167]
  v_mfma_f32_16x16x32_bf16 v[188:191], v[244:247], v[228:231], v[188:191]
  ds_read_b64_tr_b16 v[244:245], v6 offset:38912
  ds_read_b64_tr_b16 v[246:247], v6 offset:39424
  v_mfma_f32_16x16x32_bf16 v[120:123], v[216:219], v[248:251], v[120:123]
  v_mfma_f32_16x16x32_bf16 v[144:147], v[220:223], v[248:251], v[144:147]
  v_mfma_f32_16x16x32_bf16 v[168:171], v[224:227], v[248:251], v[168:171]
  v_mfma_f32_16x16x32_bf16 v[192:195], v[228:231], v[248:251], v[192:195]
  ds_read_b64_tr_b16 v[248:249], v5 offset:40960
  ds_read_b64_tr_b16 v[250:251], v5 offset:41472
  v_mfma_f32_16x16x32_bf16 v[124:127], v[216:219], v[252:255], v[124:127]
  ds_read_b128 v[216:219], v1 offset:40960
  v_mfma_f32_16x16x32_bf16 v[148:151], v[220:223], v[252:255], v[148:151]
  ds_read_b128 v[220:223], v1 offset:43008
  v_mfma_f32_16x16x32_bf16 v[172:175], v[224:227], v[252:255], v[172:175]
  ds_read_b128 v[224:227], v1 offset:45056
  v_mfma_f32_16x16x32_bf16 v[196:199], v[228:231], v[252:255], v[196:199]
  ds_read_b128 v[228:231], v1 offset:47104
  ds_read_b64_tr_b16 v[252:253], v6 offset:40960
  ds_read_b64_tr_b16 v[254:255], v6 offset:41472
  s_waitcnt lgkmcnt(14)
  v_mfma_f32_16x16x32_bf16 v[8:11], v[232:235], v[200:203], v[8:11]
  s_waitcnt lgkmcnt(12)
  v_mfma_f32_16x16x32_bf16 v[12:15], v[236:239], v[200:203], v[12:15]
  s_waitcnt lgkmcnt(10)
  v_mfma_f32_16x16x32_bf16 v[16:19], v[240:243], v[200:203], v[16:19]
  v_mfma_f32_16x16x32_bf16 v[32:35], v[232:235], v[204:207], v[32:35]
  v_mfma_f32_16x16x32_bf16 v[36:39], v[236:239], v[204:207], v[36:39]
  v_mfma_f32_16x16x32_bf16 v[40:43], v[240:243], v[204:207], v[40:43]
  v_mfma_f32_16x16x32_bf16 v[56:59], v[232:235], v[208:211], v[56:59]
  v_mfma_f32_16x16x32_bf16 v[60:63], v[236:239], v[208:211], v[60:63]
  v_mfma_f32_16x16x32_bf16 v[64:67], v[240:243], v[208:211], v[64:67]
  v_mfma_f32_16x16x32_bf16 v[80:83], v[232:235], v[212:215], v[80:83]
  v_mfma_f32_16x16x32_bf16 v[84:87], v[236:239], v[212:215], v[84:87]
  v_mfma_f32_16x16x32_bf16 v[88:91], v[240:243], v[212:215], v[88:91]
  s_waitcnt lgkmcnt(8)
  v_mfma_f32_16x16x32_bf16 v[20:23], v[244:247], v[200:203], v[20:23]
  s_waitcnt lgkmcnt(6)
  v_mfma_f32_16x16x32_bf16 v[24:27], v[200:203], v[248:251], v[24:27]
  s_waitcnt lgkmcnt(0)
  v_mfma_f32_16x16x32_bf16 v[28:31], v[200:203], v[252:255], v[28:31]
  ds_read_b128 v[200:203], v2 offset:32768
  v_mfma_f32_16x16x32_bf16 v[44:47], v[244:247], v[204:207], v[44:47]
  v_mfma_f32_16x16x32_bf16 v[48:51], v[204:207], v[248:251], v[48:51]
  v_mfma_f32_16x16x32_bf16 v[52:55], v[204:207], v[252:255], v[52:55]
  ds_read_b128 v[204:207], v2 offset:34816
  v_mfma_f32_16x16x32_bf16 v[68:71], v[244:247], v[208:211], v[68:71]
  v_mfma_f32_16x16x32_bf16 v[72:75], v[208:211], v[248:251], v[72:75]
  v_mfma_f32_16x16x32_bf16 v[76:79], v[208:211], v[252:255], v[76:79]
  ds_read_b128 v[208:211], v2 offset:36864
  v_mfma_f32_16x16x32_bf16 v[92:95], v[244:247], v[212:215], v[92:95]
  v_mfma_f32_16x16x32_bf16 v[96:99], v[212:215], v[248:251], v[96:99]
  v_mfma_f32_16x16x32_bf16 v[100:103], v[212:215], v[252:255], v[100:103]
  ds_read_b128 v[212:215], v2 offset:38912
  v_mfma_f32_16x16x32_bf16 v[116:119], v[244:247], v[216:219], v[116:119]
  v_mfma_f32_16x16x32_bf16 v[140:143], v[244:247], v[220:223], v[140:143]
  v_mfma_f32_16x16x32_bf16 v[164:167], v[244:247], v[224:227], v[164:167]
  v_mfma_f32_16x16x32_bf16 v[188:191], v[244:247], v[228:231], v[188:191]
  ds_read_b64_tr_b16 v[244:245], v6 offset:51200
  ds_read_b64_tr_b16 v[246:247], v6 offset:51712
  v_mfma_f32_16x16x32_bf16 v[120:123], v[216:219], v[248:251], v[120:123]
  v_mfma_f32_16x16x32_bf16 v[144:147], v[220:223], v[248:251], v[144:147]
  v_mfma_f32_16x16x32_bf16 v[168:171], v[224:227], v[248:251], v[168:171]
  v_mfma_f32_16x16x32_bf16 v[192:195], v[228:231], v[248:251], v[192:195]
  ds_read_b64_tr_b16 v[248:249], v5 offset:53248
  ds_read_b64_tr_b16 v[250:251], v5 offset:53760
  v_mfma_f32_16x16x32_bf16 v[124:127], v[216:219], v[252:255], v[124:127]
  v_mfma_f32_16x16x32_bf16 v[148:151], v[220:223], v[252:255], v[148:151]
  v_mfma_f32_16x16x32_bf16 v[172:175], v[224:227], v[252:255], v[172:175]
  v_mfma_f32_16x16x32_bf16 v[196:199], v[228:231], v[252:255], v[196:199]
  ds_read_b64_tr_b16 v[252:253], v6 offset:53248
  ds_read_b64_tr_b16 v[254:255], v6 offset:53760
  v_mfma_f32_16x16x32_bf16 v[104:107], v[232:235], v[216:219], v[104:107]
  v_mfma_f32_16x16x32_bf16 v[128:131], v[232:235], v[220:223], v[128:131]
  v_mfma_f32_16x16x32_bf16 v[152:155], v[232:235], v[224:227], v[152:155]
  v_mfma_f32_16x16x32_bf16 v[176:179], v[232:235], v[228:231], v[176:179]
  ds_read_b64_tr_b16 v[232:233], v5 offset:49152
  ds_read_b64_tr_b16 v[234:235], v5 offset:49664
  v_mfma_f32_16x16x32_bf16 v[108:111], v[236:239], v[216:219], v[108:111]
  v_mfma_f32_16x16x32_bf16 v[132:135], v[236:239], v[220:223], v[132:135]
  v_mfma_f32_16x16x32_bf16 v[156:159], v[236:239], v[224:227], v[156:159]
  v_mfma_f32_16x16x32_bf16 v[180:183], v[236:239], v[228:231], v[180:183]
  ds_read_b64_tr_b16 v[236:237], v6 offset:49152
  ds_read_b64_tr_b16 v[238:239], v6 offset:49664
  v_mfma_f32_16x16x32_bf16 v[112:115], v[240:243], v[216:219], v[112:115]
  ds_read_b128 v[216:219], v2 offset:40960
  v_mfma_f32_16x16x32_bf16 v[136:139], v[240:243], v[220:223], v[136:139]
  ds_read_b128 v[220:223], v2 offset:43008
  v_mfma_f32_16x16x32_bf16 v[160:163], v[240:243], v[224:227], v[160:163]
  ds_read_b128 v[224:227], v2 offset:45056
  v_mfma_f32_16x16x32_bf16 v[184:187], v[240:243], v[228:231], v[184:187]
  ds_read_b128 v[228:231], v2 offset:47104
  ds_read_b64_tr_b16 v[240:241], v5 offset:51200
  ds_read_b64_tr_b16 v[242:243], v5 offset:51712
  s_waitcnt lgkmcnt(14)
  v_mfma_f32_16x16x32_bf16 v[20:23], v[244:247], v[200:203], v[20:23]
  s_waitcnt lgkmcnt(12)
  v_mfma_f32_16x16x32_bf16 v[24:27], v[200:203], v[248:251], v[24:27]
  s_waitcnt lgkmcnt(10)
  v_mfma_f32_16x16x32_bf16 v[28:31], v[200:203], v[252:255], v[28:31]
  v_mfma_f32_16x16x32_bf16 v[44:47], v[244:247], v[204:207], v[44:47]
  v_mfma_f32_16x16x32_bf16 v[48:51], v[204:207], v[248:251], v[48:51]
  v_mfma_f32_16x16x32_bf16 v[52:55], v[204:207], v[252:255], v[52:55]
  v_mfma_f32_16x16x32_bf16 v[68:71], v[244:247], v[208:211], v[68:71]
  v_mfma_f32_16x16x32_bf16 v[72:75], v[208:211], v[248:251], v[72:75]
  v_mfma_f32_16x16x32_bf16 v[76:79], v[208:211], v[252:255], v[76:79]
  v_mfma_f32_16x16x32_bf16 v[92:95], v[244:247], v[212:215], v[92:95]
  v_mfma_f32_16x16x32_bf16 v[96:99], v[212:215], v[248:251], v[96:99]
  v_mfma_f32_16x16x32_bf16 v[100:103], v[212:215], v[252:255], v[100:103]
  s_waitcnt lgkmcnt(8)
  v_mfma_f32_16x16x32_bf16 v[8:11], v[232:235], v[200:203], v[8:11]
  s_waitcnt lgkmcnt(6)
  v_mfma_f32_16x16x32_bf16 v[12:15], v[236:239], v[200:203], v[12:15]
  s_waitcnt lgkmcnt(0)
  v_mfma_f32_16x16x32_bf16 v[16:19], v[240:243], v[200:203], v[16:19]
  s_waitcnt lgkmcnt(0)
  s_barrier
  ds_read_b128 v[200:203], v3 offset:0
  v_mfma_f32_16x16x32_bf16 v[32:35], v[232:235], v[204:207], v[32:35]
  v_mfma_f32_16x16x32_bf16 v[36:39], v[236:239], v[204:207], v[36:39]
  v_mfma_f32_16x16x32_bf16 v[40:43], v[240:243], v[204:207], v[40:43]
  ds_read_b128 v[204:207], v3 offset:2048
  v_mfma_f32_16x16x32_bf16 v[56:59], v[232:235], v[208:211], v[56:59]
  v_mfma_f32_16x16x32_bf16 v[60:63], v[236:239], v[208:211], v[60:63]
  v_mfma_f32_16x16x32_bf16 v[64:67], v[240:243], v[208:211], v[64:67]
  ds_read_b128 v[208:211], v3 offset:4096
  v_mfma_f32_16x16x32_bf16 v[80:83], v[232:235], v[212:215], v[80:83]
  v_mfma_f32_16x16x32_bf16 v[84:87], v[236:239], v[212:215], v[84:87]
  v_mfma_f32_16x16x32_bf16 v[88:91], v[240:243], v[212:215], v[88:91]
  ds_read_b128 v[212:215], v3 offset:6144
  v_mfma_f32_16x16x32_bf16 v[104:107], v[232:235], v[216:219], v[104:107]
  v_mfma_f32_16x16x32_bf16 v[128:131], v[232:235], v[220:223], v[128:131]
  v_mfma_f32_16x16x32_bf16 v[152:155], v[232:235], v[224:227], v[152:155]
  v_mfma_f32_16x16x32_bf16 v[176:179], v[232:235], v[228:231], v[176:179]
  ds_read_b64_tr_b16 v[232:233], v5 offset:0
  ds_read_b64_tr_b16 v[234:235], v5 offset:512
  v_mfma_f32_16x16x32_bf16 v[108:111], v[236:239], v[216:219], v[108:111]
  v_mfma_f32_16x16x32_bf16 v[132:135], v[236:239], v[220:223], v[132:135]
  v_mfma_f32_16x16x32_bf16 v[156:159], v[236:239], v[224:227], v[156:159]
  v_mfma_f32_16x16x32_bf16 v[180:183], v[236:239], v[228:231], v[180:183]
  ds_read_b64_tr_b16 v[236:237], v6 offset:0
  ds_read_b64_tr_b16 v[238:239], v6 offset:512
  v_mfma_f32_16x16x32_bf16 v[112:115], v[240:243], v[216:219], v[112:115]
  v_mfma_f32_16x16x32_bf16 v[136:139], v[240:243], v[220:223], v[136:139]
  v_mfma_f32_16x16x32_bf16 v[160:163], v[240:243], v[224:227], v[160:163]
  v_mfma_f32_16x16x32_bf16 v[184:187], v[240:243], v[228:231], v[184:187]
  ds_read_b64_tr_b16 v[240:241], v5 offset:2048
  ds_read_b64_tr_b16 v[242:243], v5 offset:2560
  v_mfma_f32_16x16x32_bf16 v[116:119], v[244:247], v[216:219], v[116:119]
  v_mfma_f32_16x16x32_bf16 v[140:143], v[244:247], v[220:223], v[140:143]
  v_mfma_f32_16x16x32_bf16 v[164:167], v[244:247], v[224:227], v[164:167]
  v_mfma_f32_16x16x32_bf16 v[188:191], v[244:247], v[228:231], v[188:191]
  ds_read_b64_tr_b16 v[244:245], v6 offset:2048
  ds_read_b64_tr_b16 v[246:247], v6 offset:2560
  v_mfma_f32_16x16x32_bf16 v[120:123], v[216:219], v[248:251], v[120:123]
  v_mfma_f32_16x16x32_bf16 v[144:147], v[220:223], v[248:251], v[144:147]
  v_mfma_f32_16x16x32_bf16 v[168:171], v[224:227], v[248:251], v[168:171]
  v_mfma_f32_16x16x32_bf16 v[192:195], v[228:231], v[248:251], v[192:195]
  ds_read_b64_tr_b16 v[248:249], v5 offset:4096
  ds_read_b64_tr_b16 v[250:251], v5 offset:4608
  v_mfma_f32_16x16x32_bf16 v[124:127], v[216:219], v[252:255], v[124:127]
  ds_read_b128 v[216:219], v3 offset:8192
  v_mfma_f32_16x16x32_bf16 v[148:151], v[220:223], v[252:255], v[148:151]
  ds_read_b128 v[220:223], v3 offset:10240
  v_mfma_f32_16x16x32_bf16 v[172:175], v[224:227], v[252:255], v[172:175]
  ds_read_b128 v[224:227], v3 offset:12288
  v_mfma_f32_16x16x32_bf16 v[196:199], v[228:231], v[252:255], v[196:199]
  ds_read_b128 v[228:231], v3 offset:14336
  ds_read_b64_tr_b16 v[252:253], v6 offset:4096
  ds_read_b64_tr_b16 v[254:255], v6 offset:4608
  s_waitcnt lgkmcnt(14)
  v_mfma_f32_16x16x32_bf16 v[8:11], v[232:235], v[200:203], v[8:11]
  s_waitcnt lgkmcnt(12)
  v_mfma_f32_16x16x32_bf16 v[12:15], v[236:239], v[200:203], v[12:15]
  s_waitcnt lgkmcnt(10)
  v_mfma_f32_16x16x32_bf16 v[16:19], v[240:243], v[200:203], v[16:19]
  v_mfma_f32_16x16x32_bf16 v[32:35], v[232:235], v[204:207], v[32:35]
  v_mfma_f32_16x16x32_bf16 v[36:39], v[236:239], v[204:207], v[36:39]
  v_mfma_f32_16x16x32_bf16 v[40:43], v[240:243], v[204:207], v[40:43]
  v_mfma_f32_16x16x32_bf16 v[56:59], v[232:235], v[208:211], v[56:59]
  v_mfma_f32_16x16x32_bf16 v[60:63], v[236:239], v[208:211], v[60:63]
  v_mfma_f32_16x16x32_bf16 v[64:67], v[240:243], v[208:211], v[64:67]
  v_mfma_f32_16x16x32_bf16 v[80:83], v[232:235], v[212:215], v[80:83]
  v_mfma_f32_16x16x32_bf16 v[84:87], v[236:239], v[212:215], v[84:87]
  v_mfma_f32_16x16x32_bf16 v[88:91], v[240:243], v[212:215], v[88:91]
  s_waitcnt lgkmcnt(8)
  v_mfma_f32_16x16x32_bf16 v[20:23], v[244:247], v[200:203], v[20:23]
  s_waitcnt lgkmcnt(6)
  v_mfma_f32_16x16x32_bf16 v[24:27], v[200:203], v[248:251], v[24:27]
  s_waitcnt lgkmcnt(0)
  v_mfma_f32_16x16x32_bf16 v[28:31], v[200:203], v[252:255], v[28:31]
  ds_read_b128 v[200:203], v4 offset:0
  v_mfma_f32_16x16x32_bf16 v[44:47], v[244:247], v[204:207], v[44:47]
  v_mfma_f32_16x16x32_bf16 v[48:51], v[204:207], v[248:251], v[48:51]
  v_mfma_f32_16x16x32_bf16 v[52:55], v[204:207], v[252:255], v[52:55]
  ds_read_b128 v[204:207], v4 offset:2048
  v_mfma_f32_16x16x32_bf16 v[68:71], v[244:247], v[208:211], v[68:71]
  v_mfma_f32_16x16x32_bf16 v[72:75], v[208:211], v[248:251], v[72:75]
  v_mfma_f32_16x16x32_bf16 v[76:79], v[208:211], v[252:255], v[76:79]
  ds_read_b128 v[208:211], v4 offset:4096
  v_mfma_f32_16x16x32_bf16 v[92:95], v[244:247], v[212:215], v[92:95]
  v_mfma_f32_16x16x32_bf16 v[96:99], v[212:215], v[248:251], v[96:99]
  v_mfma_f32_16x16x32_bf16 v[100:103], v[212:215], v[252:255], v[100:103]
  ds_read_b128 v[212:215], v4 offset:6144
  v_mfma_f32_16x16x32_bf16 v[116:119], v[244:247], v[216:219], v[116:119]
  v_mfma_f32_16x16x32_bf16 v[140:143], v[244:247], v[220:223], v[140:143]
  v_mfma_f32_16x16x32_bf16 v[164:167], v[244:247], v[224:227], v[164:167]
  v_mfma_f32_16x16x32_bf16 v[188:191], v[244:247], v[228:231], v[188:191]
  ds_read_b64_tr_b16 v[244:245], v6 offset:14336
  ds_read_b64_tr_b16 v[246:247], v6 offset:14848
  v_mfma_f32_16x16x32_bf16 v[120:123], v[216:219], v[248:251], v[120:123]
  v_mfma_f32_16x16x32_bf16 v[144:147], v[220:223], v[248:251], v[144:147]
  v_mfma_f32_16x16x32_bf16 v[168:171], v[224:227], v[248:251], v[168:171]
  v_mfma_f32_16x16x32_bf16 v[192:195], v[228:231], v[248:251], v[192:195]
  ds_read_b64_tr_b16 v[248:249], v5 offset:16384
  ds_read_b64_tr_b16 v[250:251], v5 offset:16896
  v_mfma_f32_16x16x32_bf16 v[124:127], v[216:219], v[252:255], v[124:127]
  v_mfma_f32_16x16x32_bf16 v[148:151], v[220:223], v[252:255], v[148:151]
  v_mfma_f32_16x16x32_bf16 v[172:175], v[224:227], v[252:255], v[172:175]
  v_mfma_f32_16x16x32_bf16 v[196:199], v[228:231], v[252:255], v[196:199]
  ds_read_b64_tr_b16 v[252:253], v6 offset:16384
  ds_read_b64_tr_b16 v[254:255], v6 offset:16896
  v_mfma_f32_16x16x32_bf16 v[104:107], v[232:235], v[216:219], v[104:107]
  v_mfma_f32_16x16x32_bf16 v[128:131], v[232:235], v[220:223], v[128:131]
  v_mfma_f32_16x16x32_bf16 v[152:155], v[232:235], v[224:227], v[152:155]
  v_mfma_f32_16x16x32_bf16 v[176:179], v[232:235], v[228:231], v[176:179]
  ds_read_b64_tr_b16 v[232:233], v5 offset:12288
  ds_read_b64_tr_b16 v[234:235], v5 offset:12800
  v_mfma_f32_16x16x32_bf16 v[108:111], v[236:239], v[216:219], v[108:111]
  v_mfma_f32_16x16x32_bf16 v[132:135], v[236:239], v[220:223], v[132:135]
  v_mfma_f32_16x16x32_bf16 v[156:159], v[236:239], v[224:227], v[156:159]
  v_mfma_f32_16x16x32_bf16 v[180:183], v[236:239], v[228:231], v[180:183]
  ds_read_b64_tr_b16 v[236:237], v6 offset:12288
  ds_read_b64_tr_b16 v[238:239], v6 offset:12800
  v_mfma_f32_16x16x32_bf16 v[112:115], v[240:243], v[216:219], v[112:115]
  ds_read_b128 v[216:219], v4 offset:8192
  v_mfma_f32_16x16x32_bf16 v[136:139], v[240:243], v[220:223], v[136:139]
  ds_read_b128 v[220:223], v4 offset:10240
  v_mfma_f32_16x16x32_bf16 v[160:163], v[240:243], v[224:227], v[160:163]
  ds_read_b128 v[224:227], v4 offset:12288
  v_mfma_f32_16x16x32_bf16 v[184:187], v[240:243], v[228:231], v[184:187]
  ds_read_b128 v[228:231], v4 offset:14336
  ds_read_b64_tr_b16 v[240:241], v5 offset:14336
  ds_read_b64_tr_b16 v[242:243], v5 offset:14848
  s_waitcnt lgkmcnt(14)
  v_mfma_f32_16x16x32_bf16 v[20:23], v[244:247], v[200:203], v[20:23]
  s_waitcnt lgkmcnt(12)
  v_mfma_f32_16x16x32_bf16 v[24:27], v[200:203], v[248:251], v[24:27]
  s_waitcnt lgkmcnt(10)
  v_mfma_f32_16x16x32_bf16 v[28:31], v[200:203], v[252:255], v[28:31]
  v_mfma_f32_16x16x32_bf16 v[44:47], v[244:247], v[204:207], v[44:47]
  v_mfma_f32_16x16x32_bf16 v[48:51], v[204:207], v[248:251], v[48:51]
  v_mfma_f32_16x16x32_bf16 v[52:55], v[204:207], v[252:255], v[52:55]
  v_mfma_f32_16x16x32_bf16 v[68:71], v[244:247], v[208:211], v[68:71]
  v_mfma_f32_16x16x32_bf16 v[72:75], v[208:211], v[248:251], v[72:75]
  v_mfma_f32_16x16x32_bf16 v[76:79], v[208:211], v[252:255], v[76:79]
  v_mfma_f32_16x16x32_bf16 v[92:95], v[244:247], v[212:215], v[92:95]
  v_mfma_f32_16x16x32_bf16 v[96:99], v[212:215], v[248:251], v[96:99]
  v_mfma_f32_16x16x32_bf16 v[100:103], v[212:215], v[252:255], v[100:103]
  s_waitcnt lgkmcnt(8)
  v_mfma_f32_16x16x32_bf16 v[8:11], v[232:235], v[200:203], v[8:11]
  s_waitcnt lgkmcnt(6)
  v_mfma_f32_16x16x32_bf16 v[12:15], v[236:239], v[200:203], v[12:15]
  s_waitcnt lgkmcnt(0)
  v_mfma_f32_16x16x32_bf16 v[16:19], v[240:243], v[200:203], v[16:19]
  s_waitcnt lgkmcnt(0)
  s_barrier
  ds_read_b128 v[200:203], v1 offset:0
  v_mfma_f32_16x16x32_bf16 v[32:35], v[232:235], v[204:207], v[32:35]
  v_mfma_f32_16x16x32_bf16 v[36:39], v[236:239], v[204:207], v[36:39]
  v_mfma_f32_16x16x32_bf16 v[40:43], v[240:243], v[204:207], v[40:43]
  ds_read_b128 v[204:207], v1 offset:2048
  v_mfma_f32_16x16x32_bf16 v[56:59], v[232:235], v[208:211], v[56:59]
  v_mfma_f32_16x16x32_bf16 v[60:63], v[236:239], v[208:211], v[60:63]
  v_mfma_f32_16x16x32_bf16 v[64:67], v[240:243], v[208:211], v[64:67]
  ds_read_b128 v[208:211], v1 offset:4096
  v_mfma_f32_16x16x32_bf16 v[80:83], v[232:235], v[212:215], v[80:83]
  v_mfma_f32_16x16x32_bf16 v[84:87], v[236:239], v[212:215], v[84:87]
  v_mfma_f32_16x16x32_bf16 v[88:91], v[240:243], v[212:215], v[88:91]
  ds_read_b128 v[212:215], v1 offset:6144
  v_mfma_f32_16x16x32_bf16 v[104:107], v[232:235], v[216:219], v[104:107]
  v_mfma_f32_16x16x32_bf16 v[128:131], v[232:235], v[220:223], v[128:131]
  v_mfma_f32_16x16x32_bf16 v[152:155], v[232:235], v[224:227], v[152:155]
  v_mfma_f32_16x16x32_bf16 v[176:179], v[232:235], v[228:231], v[176:179]
  ds_read_b64_tr_b16 v[232:233], v5 offset:24576
  ds_read_b64_tr_b16 v[234:235], v5 offset:25088
  v_mfma_f32_16x16x32_bf16 v[108:111], v[236:239], v[216:219], v[108:111]
  v_mfma_f32_16x16x32_bf16 v[132:135], v[236:239], v[220:223], v[132:135]
  v_mfma_f32_16x16x32_bf16 v[156:159], v[236:239], v[224:227], v[156:159]
  v_mfma_f32_16x16x32_bf16 v[180:183], v[236:239], v[228:231], v[180:183]
  ds_read_b64_tr_b16 v[236:237], v6 offset:24576
  ds_read_b64_tr_b16 v[238:239], v6 offset:25088
  v_mfma_f32_16x16x32_bf16 v[112:115], v[240:243], v[216:219], v[112:115]
  v_mfma_f32_16x16x32_bf16 v[136:139], v[240:243], v[220:223], v[136:139]
  v_mfma_f32_16x16x32_bf16 v[160:163], v[240:243], v[224:227], v[160:163]
  v_mfma_f32_16x16x32_bf16 v[184:187], v[240:243], v[228:231], v[184:187]
  ds_read_b64_tr_b16 v[240:241], v5 offset:26624
  ds_read_b64_tr_b16 v[242:243], v5 offset:27136
  v_mfma_f32_16x16x32_bf16 v[116:119], v[244:247], v[216:219], v[116:119]
  v_mfma_f32_16x16x32_bf16 v[140:143], v[244:247], v[220:223], v[140:143]
  v_mfma_f32_16x16x32_bf16 v[164:167], v[244:247], v[224:227], v[164:167]
  v_mfma_f32_16x16x32_bf16 v[188:191], v[244:247], v[228:231], v[188:191]
  ds_read_b64_tr_b16 v[244:245], v6 offset:26624
  ds_read_b64_tr_b16 v[246:247], v6 offset:27136
  v_mfma_f32_16x16x32_bf16 v[120:123], v[216:219], v[248:251], v[120:123]
  v_mfma_f32_16x16x32_bf16 v[144:147], v[220:223], v[248:251], v[144:147]
  v_mfma_f32_16x16x32_bf16 v[168:171], v[224:227], v[248:251], v[168:171]
  v_mfma_f32_16x16x32_bf16 v[192:195], v[228:231], v[248:251], v[192:195]
  ds_read_b64_tr_b16 v[248:249], v5 offset:28672
  ds_read_b64_tr_b16 v[250:251], v5 offset:29184
  v_mfma_f32_16x16x32_bf16 v[124:127], v[216:219], v[252:255], v[124:127]
  ds_read_b128 v[216:219], v1 offset:8192
  v_mfma_f32_16x16x32_bf16 v[148:151], v[220:223], v[252:255], v[148:151]
  ds_read_b128 v[220:223], v1 offset:10240
  v_mfma_f32_16x16x32_bf16 v[172:175], v[224:227], v[252:255], v[172:175]
  ds_read_b128 v[224:227], v1 offset:12288
  v_mfma_f32_16x16x32_bf16 v[196:199], v[228:231], v[252:255], v[196:199]
  ds_read_b128 v[228:231], v1 offset:14336
  ds_read_b64_tr_b16 v[252:253], v6 offset:28672
  ds_read_b64_tr_b16 v[254:255], v6 offset:29184
  s_waitcnt lgkmcnt(14)
  v_mfma_f32_16x16x32_bf16 v[8:11], v[232:235], v[200:203], v[8:11]
  s_waitcnt lgkmcnt(12)
  v_mfma_f32_16x16x32_bf16 v[12:15], v[236:239], v[200:203], v[12:15]
  s_waitcnt lgkmcnt(10)
  v_mfma_f32_16x16x32_bf16 v[16:19], v[240:243], v[200:203], v[16:19]
  v_mfma_f32_16x16x32_bf16 v[32:35], v[232:235], v[204:207], v[32:35]
  v_mfma_f32_16x16x32_bf16 v[36:39], v[236:239], v[204:207], v[36:39]
  v_mfma_f32_16x16x32_bf16 v[40:43], v[240:243], v[204:207], v[40:43]
  v_mfma_f32_16x16x32_bf16 v[56:59], v[232:235], v[208:211], v[56:59]
  v_mfma_f32_16x16x32_bf16 v[60:63], v[236:239], v[208:211], v[60:63]
  v_mfma_f32_16x16x32_bf16 v[64:67], v[240:243], v[208:211], v[64:67]
  v_mfma_f32_16x16x32_bf16 v[80:83], v[232:235], v[212:215], v[80:83]
  v_mfma_f32_16x16x32_bf16 v[84:87], v[236:239], v[212:215], v[84:87]
  v_mfma_f32_16x16x32_bf16 v[88:91], v[240:243], v[212:215], v[88:91]
  s_waitcnt lgkmcnt(8)
  v_mfma_f32_16x16x32_bf16 v[20:23], v[244:247], v[200:203], v[20:23]
  s_waitcnt lgkmcnt(6)
  v_mfma_f32_16x16x32_bf16 v[24:27], v[200:203], v[248:251], v[24:27]
  s_waitcnt lgkmcnt(0)
  v_mfma_f32_16x16x32_bf16 v[28:31], v[200:203], v[252:255], v[28:31]
  ds_read_b128 v[200:203], v2 offset:0
  v_mfma_f32_16x16x32_bf16 v[44:47], v[244:247], v[204:207], v[44:47]
  v_mfma_f32_16x16x32_bf16 v[48:51], v[204:207], v[248:251], v[48:51]
  v_mfma_f32_16x16x32_bf16 v[52:55], v[204:207], v[252:255], v[52:55]
  ds_read_b128 v[204:207], v2 offset:2048
  v_mfma_f32_16x16x32_bf16 v[68:71], v[244:247], v[208:211], v[68:71]
  v_mfma_f32_16x16x32_bf16 v[72:75], v[208:211], v[248:251], v[72:75]
  v_mfma_f32_16x16x32_bf16 v[76:79], v[208:211], v[252:255], v[76:79]
  ds_read_b128 v[208:211], v2 offset:4096
  v_mfma_f32_16x16x32_bf16 v[92:95], v[244:247], v[212:215], v[92:95]
  v_mfma_f32_16x16x32_bf16 v[96:99], v[212:215], v[248:251], v[96:99]
  v_mfma_f32_16x16x32_bf16 v[100:103], v[212:215], v[252:255], v[100:103]
  ds_read_b128 v[212:215], v2 offset:6144
  v_mfma_f32_16x16x32_bf16 v[116:119], v[244:247], v[216:219], v[116:119]
  v_mfma_f32_16x16x32_bf16 v[140:143], v[244:247], v[220:223], v[140:143]
  v_mfma_f32_16x16x32_bf16 v[164:167], v[244:247], v[224:227], v[164:167]
  v_mfma_f32_16x16x32_bf16 v[188:191], v[244:247], v[228:231], v[188:191]
  ds_read_b64_tr_b16 v[244:245], v6 offset:38912
  ds_read_b64_tr_b16 v[246:247], v6 offset:39424
  v_mfma_f32_16x16x32_bf16 v[120:123], v[216:219], v[248:251], v[120:123]
  v_mfma_f32_16x16x32_bf16 v[144:147], v[220:223], v[248:251], v[144:147]
  v_mfma_f32_16x16x32_bf16 v[168:171], v[224:227], v[248:251], v[168:171]
  v_mfma_f32_16x16x32_bf16 v[192:195], v[228:231], v[248:251], v[192:195]
  ds_read_b64_tr_b16 v[248:249], v5 offset:40960
  ds_read_b64_tr_b16 v[250:251], v5 offset:41472
  v_mfma_f32_16x16x32_bf16 v[124:127], v[216:219], v[252:255], v[124:127]
  v_mfma_f32_16x16x32_bf16 v[148:151], v[220:223], v[252:255], v[148:151]
  v_mfma_f32_16x16x32_bf16 v[172:175], v[224:227], v[252:255], v[172:175]
  v_mfma_f32_16x16x32_bf16 v[196:199], v[228:231], v[252:255], v[196:199]
  ds_read_b64_tr_b16 v[252:253], v6 offset:40960
  ds_read_b64_tr_b16 v[254:255], v6 offset:41472
  v_mfma_f32_16x16x32_bf16 v[104:107], v[232:235], v[216:219], v[104:107]
  v_mfma_f32_16x16x32_bf16 v[128:131], v[232:235], v[220:223], v[128:131]
  v_mfma_f32_16x16x32_bf16 v[152:155], v[232:235], v[224:227], v[152:155]
  v_mfma_f32_16x16x32_bf16 v[176:179], v[232:235], v[228:231], v[176:179]
  ds_read_b64_tr_b16 v[232:233], v5 offset:36864
  ds_read_b64_tr_b16 v[234:235], v5 offset:37376
  v_mfma_f32_16x16x32_bf16 v[108:111], v[236:239], v[216:219], v[108:111]
  v_mfma_f32_16x16x32_bf16 v[132:135], v[236:239], v[220:223], v[132:135]
  v_mfma_f32_16x16x32_bf16 v[156:159], v[236:239], v[224:227], v[156:159]
  v_mfma_f32_16x16x32_bf16 v[180:183], v[236:239], v[228:231], v[180:183]
  ds_read_b64_tr_b16 v[236:237], v6 offset:36864
  ds_read_b64_tr_b16 v[238:239], v6 offset:37376
  v_mfma_f32_16x16x32_bf16 v[112:115], v[240:243], v[216:219], v[112:115]
  ds_read_b128 v[216:219], v2 offset:8192
  v_mfma_f32_16x16x32_bf16 v[136:139], v[240:243], v[220:223], v[136:139]
  ds_read_b128 v[220:223], v2 offset:10240
  v_mfma_f32_16x16x32_bf16 v[160:163], v[240:243], v[224:227], v[160:163]
  ds_read_b128 v[224:227], v2 offset:12288
  v_mfma_f32_16x16x32_bf16 v[184:187], v[240:243], v[228:231], v[184:187]
  ds_read_b128 v[228:231], v2 offset:14336
  ds_read_b64_tr_b16 v[240:241], v5 offset:38912
  ds_read_b64_tr_b16 v[242:243], v5 offset:39424
  s_waitcnt lgkmcnt(14)
  v_mfma_f32_16x16x32_bf16 v[20:23], v[244:247], v[200:203], v[20:23]
  s_waitcnt lgkmcnt(12)
  v_mfma_f32_16x16x32_bf16 v[24:27], v[200:203], v[248:251], v[24:27]
  s_waitcnt lgkmcnt(10)
  v_mfma_f32_16x16x32_bf16 v[28:31], v[200:203], v[252:255], v[28:31]
  v_mfma_f32_16x16x32_bf16 v[44:47], v[244:247], v[204:207], v[44:47]
  v_mfma_f32_16x16x32_bf16 v[48:51], v[204:207], v[248:251], v[48:51]
  v_mfma_f32_16x16x32_bf16 v[52:55], v[204:207], v[252:255], v[52:55]
  v_mfma_f32_16x16x32_bf16 v[68:71], v[244:247], v[208:211], v[68:71]
  v_mfma_f32_16x16x32_bf16 v[72:75], v[208:211], v[248:251], v[72:75]
  v_mfma_f32_16x16x32_bf16 v[76:79], v[208:211], v[252:255], v[76:79]
  v_mfma_f32_16x16x32_bf16 v[92:95], v[244:247], v[212:215], v[92:95]
  v_mfma_f32_16x16x32_bf16 v[96:99], v[212:215], v[248:251], v[96:99]
  v_mfma_f32_16x16x32_bf16 v[100:103], v[212:215], v[252:255], v[100:103]
  s_waitcnt lgkmcnt(8)
  v_mfma_f32_16x16x32_bf16 v[8:11], v[232:235], v[200:203], v[8:11]
  s_waitcnt lgkmcnt(6)
  v_mfma_f32_16x16x32_bf16 v[12:15], v[236:239], v[200:203], v[12:15]
  s_waitcnt lgkmcnt(0)
  v_mfma_f32_16x16x32_bf16 v[16:19], v[240:243], v[200:203], v[16:19]
  s_waitcnt lgkmcnt(0)
  s_barrier
  ds_read_b128 v[200:203], v1 offset:32768
  v_mfma_f32_16x16x32_bf16 v[32:35], v[232:235], v[204:207], v[32:35]
  v_mfma_f32_16x16x32_bf16 v[36:39], v[236:239], v[204:207], v[36:39]
  v_mfma_f32_16x16x32_bf16 v[40:43], v[240:243], v[204:207], v[40:43]
  ds_read_b128 v[204:207], v1 offset:34816
  v_mfma_f32_16x16x32_bf16 v[56:59], v[232:235], v[208:211], v[56:59]
  v_mfma_f32_16x16x32_bf16 v[60:63], v[236:239], v[208:211], v[60:63]
  v_mfma_f32_16x16x32_bf16 v[64:67], v[240:243], v[208:211], v[64:67]
  ds_read_b128 v[208:211], v1 offset:36864
  v_mfma_f32_16x16x32_bf16 v[80:83], v[232:235], v[212:215], v[80:83]
  v_mfma_f32_16x16x32_bf16 v[84:87], v[236:239], v[212:215], v[84:87]
  v_mfma_f32_16x16x32_bf16 v[88:91], v[240:243], v[212:215], v[88:91]
  ds_read_b128 v[212:215], v1 offset:38912
  v_mfma_f32_16x16x32_bf16 v[104:107], v[232:235], v[216:219], v[104:107]
  v_mfma_f32_16x16x32_bf16 v[128:131], v[232:235], v[220:223], v[128:131]
  v_mfma_f32_16x16x32_bf16 v[152:155], v[232:235], v[224:227], v[152:155]
  v_mfma_f32_16x16x32_bf16 v[176:179], v[232:235], v[228:231], v[176:179]
  ds_read_b64_tr_b16 v[232:233], v5 offset:49152
  ds_read_b64_tr_b16 v[234:235], v5 offset:49664
  v_mfma_f32_16x16x32_bf16 v[108:111], v[236:239], v[216:219], v[108:111]
  v_mfma_f32_16x16x32_bf16 v[132:135], v[236:239], v[220:223], v[132:135]
  v_mfma_f32_16x16x32_bf16 v[156:159], v[236:239], v[224:227], v[156:159]
  v_mfma_f32_16x16x32_bf16 v[180:183], v[236:239], v[228:231], v[180:183]
  ds_read_b64_tr_b16 v[236:237], v6 offset:49152
  ds_read_b64_tr_b16 v[238:239], v6 offset:49664
  v_mfma_f32_16x16x32_bf16 v[112:115], v[240:243], v[216:219], v[112:115]
  v_mfma_f32_16x16x32_bf16 v[136:139], v[240:243], v[220:223], v[136:139]
  v_mfma_f32_16x16x32_bf16 v[160:163], v[240:243], v[224:227], v[160:163]
  v_mfma_f32_16x16x32_bf16 v[184:187], v[240:243], v[228:231], v[184:187]
  ds_read_b64_tr_b16 v[240:241], v5 offset:51200
  ds_read_b64_tr_b16 v[242:243], v5 offset:51712
  v_mfma_f32_16x16x32_bf16 v[116:119], v[244:247], v[216:219], v[116:119]
  v_mfma_f32_16x16x32_bf16 v[140:143], v[244:247], v[220:223], v[140:143]
  v_mfma_f32_16x16x32_bf16 v[164:167], v[244:247], v[224:227], v[164:167]
  v_mfma_f32_16x16x32_bf16 v[188:191], v[244:247], v[228:231], v[188:191]
  ds_read_b64_tr_b16 v[244:245], v6 offset:51200
  ds_read_b64_tr_b16 v[246:247], v6 offset:51712
  v_mfma_f32_16x16x32_bf16 v[120:123], v[216:219], v[248:251], v[120:123]
  v_mfma_f32_16x16x32_bf16 v[144:147], v[220:223], v[248:251], v[144:147]
  v_mfma_f32_16x16x32_bf16 v[168:171], v[224:227], v[248:251], v[168:171]
  v_mfma_f32_16x16x32_bf16 v[192:195], v[228:231], v[248:251], v[192:195]
  ds_read_b64_tr_b16 v[248:249], v5 offset:53248
  ds_read_b64_tr_b16 v[250:251], v5 offset:53760
  v_mfma_f32_16x16x32_bf16 v[124:127], v[216:219], v[252:255], v[124:127]
  ds_read_b128 v[216:219], v1 offset:40960
  v_mfma_f32_16x16x32_bf16 v[148:151], v[220:223], v[252:255], v[148:151]
  ds_read_b128 v[220:223], v1 offset:43008
  v_mfma_f32_16x16x32_bf16 v[172:175], v[224:227], v[252:255], v[172:175]
  ds_read_b128 v[224:227], v1 offset:45056
  v_mfma_f32_16x16x32_bf16 v[196:199], v[228:231], v[252:255], v[196:199]
  ds_read_b128 v[228:231], v1 offset:47104
  ds_read_b64_tr_b16 v[252:253], v6 offset:53248
  ds_read_b64_tr_b16 v[254:255], v6 offset:53760
  s_waitcnt lgkmcnt(14)
  v_mfma_f32_16x16x32_bf16 v[8:11], v[232:235], v[200:203], v[8:11]
  s_waitcnt lgkmcnt(12)
  v_mfma_f32_16x16x32_bf16 v[12:15], v[236:239], v[200:203], v[12:15]
  s_waitcnt lgkmcnt(10)
  v_mfma_f32_16x16x32_bf16 v[16:19], v[240:243], v[200:203], v[16:19]
  v_mfma_f32_16x16x32_bf16 v[32:35], v[232:235], v[204:207], v[32:35]
  v_mfma_f32_16x16x32_bf16 v[36:39], v[236:239], v[204:207], v[36:39]
  v_mfma_f32_16x16x32_bf16 v[40:43], v[240:243], v[204:207], v[40:43]
  v_mfma_f32_16x16x32_bf16 v[56:59], v[232:235], v[208:211], v[56:59]
  v_mfma_f32_16x16x32_bf16 v[60:63], v[236:239], v[208:211], v[60:63]
  v_mfma_f32_16x16x32_bf16 v[64:67], v[240:243], v[208:211], v[64:67]
  v_mfma_f32_16x16x32_bf16 v[80:83], v[232:235], v[212:215], v[80:83]
  v_mfma_f32_16x16x32_bf16 v[84:87], v[236:239], v[212:215], v[84:87]
  v_mfma_f32_16x16x32_bf16 v[88:91], v[240:243], v[212:215], v[88:91]
  s_waitcnt lgkmcnt(8)
  v_mfma_f32_16x16x32_bf16 v[20:23], v[244:247], v[200:203], v[20:23]
  s_waitcnt lgkmcnt(6)
  v_mfma_f32_16x16x32_bf16 v[24:27], v[200:203], v[248:251], v[24:27]
  s_waitcnt lgkmcnt(0)
  v_mfma_f32_16x16x32_bf16 v[28:31], v[200:203], v[252:255], v[28:31]
  ds_read_b128 v[200:203], v2 offset:32768
  v_mfma_f32_16x16x32_bf16 v[44:47], v[244:247], v[204:207], v[44:47]
  v_mfma_f32_16x16x32_bf16 v[48:51], v[204:207], v[248:251], v[48:51]
  v_mfma_f32_16x16x32_bf16 v[52:55], v[204:207], v[252:255], v[52:55]
  ds_read_b128 v[204:207], v2 offset:34816
  v_mfma_f32_16x16x32_bf16 v[68:71], v[244:247], v[208:211], v[68:71]
  v_mfma_f32_16x16x32_bf16 v[72:75], v[208:211], v[248:251], v[72:75]
  v_mfma_f32_16x16x32_bf16 v[76:79], v[208:211], v[252:255], v[76:79]
  ds_read_b128 v[208:211], v2 offset:36864
  v_mfma_f32_16x16x32_bf16 v[92:95], v[244:247], v[212:215], v[92:95]
  v_mfma_f32_16x16x32_bf16 v[96:99], v[212:215], v[248:251], v[96:99]
  v_mfma_f32_16x16x32_bf16 v[100:103], v[212:215], v[252:255], v[100:103]
  ds_read_b128 v[212:215], v2 offset:38912
  v_mfma_f32_16x16x32_bf16 v[116:119], v[244:247], v[216:219], v[116:119]
  v_mfma_f32_16x16x32_bf16 v[140:143], v[244:247], v[220:223], v[140:143]
  v_mfma_f32_16x16x32_bf16 v[164:167], v[244:247], v[224:227], v[164:167]
  v_mfma_f32_16x16x32_bf16 v[188:191], v[244:247], v[228:231], v[188:191]
  ds_read_b64_tr_b16 v[244:245], v6 offset:2048
  ds_read_b64_tr_b16 v[246:247], v6 offset:2560
  v_mfma_f32_16x16x32_bf16 v[120:123], v[216:219], v[248:251], v[120:123]
  v_mfma_f32_16x16x32_bf16 v[144:147], v[220:223], v[248:251], v[144:147]
  v_mfma_f32_16x16x32_bf16 v[168:171], v[224:227], v[248:251], v[168:171]
  v_mfma_f32_16x16x32_bf16 v[192:195], v[228:231], v[248:251], v[192:195]
  ds_read_b64_tr_b16 v[248:249], v5 offset:4096
  ds_read_b64_tr_b16 v[250:251], v5 offset:4608
  v_mfma_f32_16x16x32_bf16 v[124:127], v[216:219], v[252:255], v[124:127]
  v_mfma_f32_16x16x32_bf16 v[148:151], v[220:223], v[252:255], v[148:151]
  v_mfma_f32_16x16x32_bf16 v[172:175], v[224:227], v[252:255], v[172:175]
  v_mfma_f32_16x16x32_bf16 v[196:199], v[228:231], v[252:255], v[196:199]
  ds_read_b64_tr_b16 v[252:253], v6 offset:4096
  ds_read_b64_tr_b16 v[254:255], v6 offset:4608
  v_mfma_f32_16x16x32_bf16 v[104:107], v[232:235], v[216:219], v[104:107]
  v_mfma_f32_16x16x32_bf16 v[128:131], v[232:235], v[220:223], v[128:131]
  v_mfma_f32_16x16x32_bf16 v[152:155], v[232:235], v[224:227], v[152:155]
  v_mfma_f32_16x16x32_bf16 v[176:179], v[232:235], v[228:231], v[176:179]
  ds_read_b64_tr_b16 v[232:233], v5 offset:0
  ds_read_b64_tr_b16 v[234:235], v5 offset:512
  v_mfma_f32_16x16x32_bf16 v[108:111], v[236:239], v[216:219], v[108:111]
  v_mfma_f32_16x16x32_bf16 v[132:135], v[236:239], v[220:223], v[132:135]
  v_mfma_f32_16x16x32_bf16 v[156:159], v[236:239], v[224:227], v[156:159]
  v_mfma_f32_16x16x32_bf16 v[180:183], v[236:239], v[228:231], v[180:183]
  ds_read_b64_tr_b16 v[236:237], v6 offset:0
  ds_read_b64_tr_b16 v[238:239], v6 offset:512
  v_mfma_f32_16x16x32_bf16 v[112:115], v[240:243], v[216:219], v[112:115]
  ds_read_b128 v[216:219], v2 offset:40960
  v_mfma_f32_16x16x32_bf16 v[136:139], v[240:243], v[220:223], v[136:139]
  ds_read_b128 v[220:223], v2 offset:43008
  v_mfma_f32_16x16x32_bf16 v[160:163], v[240:243], v[224:227], v[160:163]
  ds_read_b128 v[224:227], v2 offset:45056
  v_mfma_f32_16x16x32_bf16 v[184:187], v[240:243], v[228:231], v[184:187]
  ds_read_b128 v[228:231], v2 offset:47104
  ds_read_b64_tr_b16 v[240:241], v5 offset:2048
  ds_read_b64_tr_b16 v[242:243], v5 offset:2560
  s_waitcnt lgkmcnt(14)
  v_mfma_f32_16x16x32_bf16 v[20:23], v[244:247], v[200:203], v[20:23]
  s_waitcnt lgkmcnt(12)
  v_mfma_f32_16x16x32_bf16 v[24:27], v[200:203], v[248:251], v[24:27]
  s_waitcnt lgkmcnt(10)
  v_mfma_f32_16x16x32_bf16 v[28:31], v[200:203], v[252:255], v[28:31]
  v_mfma_f32_16x16x32_bf16 v[44:47], v[244:247], v[204:207], v[44:47]
  v_mfma_f32_16x16x32_bf16 v[48:51], v[204:207], v[248:251], v[48:51]
  v_mfma_f32_16x16x32_bf16 v[52:55], v[204:207], v[252:255], v[52:55]
  v_mfma_f32_16x16x32_bf16 v[68:71], v[244:247], v[208:211], v[68:71]
  v_mfma_f32_16x16x32_bf16 v[72:75], v[208:211], v[248:251], v[72:75]
  v_mfma_f32_16x16x32_bf16 v[76:79], v[208:211], v[252:255], v[76:79]
  v_mfma_f32_16x16x32_bf16 v[92:95], v[244:247], v[212:215], v[92:95]
  v_mfma_f32_16x16x32_bf16 v[96:99], v[212:215], v[248:251], v[96:99]
  v_mfma_f32_16x16x32_bf16 v[100:103], v[212:215], v[252:255], v[100:103]
  s_waitcnt lgkmcnt(8)
  v_mfma_f32_16x16x32_bf16 v[8:11], v[232:235], v[200:203], v[8:11]
  s_waitcnt lgkmcnt(6)
  v_mfma_f32_16x16x32_bf16 v[12:15], v[236:239], v[200:203], v[12:15]
  s_waitcnt lgkmcnt(0)
  v_mfma_f32_16x16x32_bf16 v[16:19], v[240:243], v[200:203], v[16:19]
  s_waitcnt lgkmcnt(0)
  s_barrier
  ds_read_b128 v[200:203], v3 offset:0
  v_mfma_f32_16x16x32_bf16 v[32:35], v[232:235], v[204:207], v[32:35]
  v_mfma_f32_16x16x32_bf16 v[36:39], v[236:239], v[204:207], v[36:39]
  v_mfma_f32_16x16x32_bf16 v[40:43], v[240:243], v[204:207], v[40:43]
  ds_read_b128 v[204:207], v3 offset:2048
  v_mfma_f32_16x16x32_bf16 v[56:59], v[232:235], v[208:211], v[56:59]
  v_mfma_f32_16x16x32_bf16 v[60:63], v[236:239], v[208:211], v[60:63]
  v_mfma_f32_16x16x32_bf16 v[64:67], v[240:243], v[208:211], v[64:67]
  ds_read_b128 v[208:211], v3 offset:4096
  v_mfma_f32_16x16x32_bf16 v[80:83], v[232:235], v[212:215], v[80:83]
  v_mfma_f32_16x16x32_bf16 v[84:87], v[236:239], v[212:215], v[84:87]
  v_mfma_f32_16x16x32_bf16 v[88:91], v[240:243], v[212:215], v[88:91]
  ds_read_b128 v[212:215], v3 offset:6144
  v_mfma_f32_16x16x32_bf16 v[104:107], v[232:235], v[216:219], v[104:107]
  v_mfma_f32_16x16x32_bf16 v[128:131], v[232:235], v[220:223], v[128:131]
  v_mfma_f32_16x16x32_bf16 v[152:155], v[232:235], v[224:227], v[152:155]
  v_mfma_f32_16x16x32_bf16 v[176:179], v[232:235], v[228:231], v[176:179]
  ds_read_b64_tr_b16 v[232:233], v5 offset:12288
  ds_read_b64_tr_b16 v[234:235], v5 offset:12800
  v_mfma_f32_16x16x32_bf16 v[108:111], v[236:239], v[216:219], v[108:111]
  v_mfma_f32_16x16x32_bf16 v[132:135], v[236:239], v[220:223], v[132:135]
  v_mfma_f32_16x16x32_bf16 v[156:159], v[236:239], v[224:227], v[156:159]
  v_mfma_f32_16x16x32_bf16 v[180:183], v[236:239], v[228:231], v[180:183]
  ds_read_b64_tr_b16 v[236:237], v6 offset:12288
  ds_read_b64_tr_b16 v[238:239], v6 offset:12800
  v_mfma_f32_16x16x32_bf16 v[112:115], v[240:243], v[216:219], v[112:115]
  v_mfma_f32_16x16x32_bf16 v[136:139], v[240:243], v[220:223], v[136:139]
  v_mfma_f32_16x16x32_bf16 v[160:163], v[240:243], v[224:227], v[160:163]
  v_mfma_f32_16x16x32_bf16 v[184:187], v[240:243], v[228:231], v[184:187]
  ds_read_b64_tr_b16 v[240:241], v5 offset:14336
  ds_read_b64_tr_b16 v[242:243], v5 offset:14848
  v_mfma_f32_16x16x32_bf16 v[116:119], v[244:247], v[216:219], v[116:119]
  v_mfma_f32_16x16x32_bf16 v[140:143], v[244:247], v[220:223], v[140:143]
  v_mfma_f32_16x16x32_bf16 v[164:167], v[244:247], v[224:227], v[164:167]
  v_mfma_f32_16x16x32_bf16 v[188:191], v[244:247], v[228:231], v[188:191]
  ds_read_b64_tr_b16 v[244:245], v6 offset:14336
  ds_read_b64_tr_b16 v[246:247], v6 offset:14848
  v_mfma_f32_16x16x32_bf16 v[120:123], v[216:219], v[248:251], v[120:123]
  v_mfma_f32_16x16x32_bf16 v[144:147], v[220:223], v[248:251], v[144:147]
  v_mfma_f32_16x16x32_bf16 v[168:171], v[224:227], v[248:251], v[168:171]
  v_mfma_f32_16x16x32_bf16 v[192:195], v[228:231], v[248:251], v[192:195]
  ds_read_b64_tr_b16 v[248:249], v5 offset:16384
  ds_read_b64_tr_b16 v[250:251], v5 offset:16896
  v_mfma_f32_16x16x32_bf16 v[124:127], v[216:219], v[252:255], v[124:127]
  ds_read_b128 v[216:219], v3 offset:8192
  v_mfma_f32_16x16x32_bf16 v[148:151], v[220:223], v[252:255], v[148:151]
  ds_read_b128 v[220:223], v3 offset:10240
  v_mfma_f32_16x16x32_bf16 v[172:175], v[224:227], v[252:255], v[172:175]
  ds_read_b128 v[224:227], v3 offset:12288
  v_mfma_f32_16x16x32_bf16 v[196:199], v[228:231], v[252:255], v[196:199]
  ds_read_b128 v[228:231], v3 offset:14336
  ds_read_b64_tr_b16 v[252:253], v6 offset:16384
  ds_read_b64_tr_b16 v[254:255], v6 offset:16896
  s_waitcnt lgkmcnt(14)
  v_mfma_f32_16x16x32_bf16 v[8:11], v[232:235], v[200:203], v[8:11]
  s_waitcnt lgkmcnt(12)
  v_mfma_f32_16x16x32_bf16 v[12:15], v[236:239], v[200:203], v[12:15]
  s_waitcnt lgkmcnt(10)
  v_mfma_f32_16x16x32_bf16 v[16:19], v[240:243], v[200:203], v[16:19]
  v_mfma_f32_16x16x32_bf16 v[32:35], v[232:235], v[204:207], v[32:35]
  v_mfma_f32_16x16x32_bf16 v[36:39], v[236:239], v[204:207], v[36:39]
  v_mfma_f32_16x16x32_bf16 v[40:43], v[240:243], v[204:207], v[40:43]
  v_mfma_f32_16x16x32_bf16 v[56:59], v[232:235], v[208:211], v[56:59]
  v_mfma_f32_16x16x32_bf16 v[60:63], v[236:239], v[208:211], v[60:63]
  v_mfma_f32_16x16x32_bf16 v[64:67], v[240:243], v[208:211], v[64:67]
  v_mfma_f32_16x16x32_bf16 v[80:83], v[232:235], v[212:215], v[80:83]
  v_mfma_f32_16x16x32_bf16 v[84:87], v[236:239], v[212:215], v[84:87]
  v_mfma_f32_16x16x32_bf16 v[88:91], v[240:243], v[212:215], v[88:91]
  s_waitcnt lgkmcnt(8)
  v_mfma_f32_16x16x32_bf16 v[20:23], v[244:247], v[200:203], v[20:23]
  s_waitcnt lgkmcnt(6)
  v_mfma_f32_16x16x32_bf16 v[24:27], v[200:203], v[248:251], v[24:27]
  s_waitcnt lgkmcnt(0)
  v_mfma_f32_16x16x32_bf16 v[28:31], v[200:203], v[252:255], v[28:31]
  ds_read_b128 v[200:203], v4 offset:0
  v_mfma_f32_16x16x32_bf16 v[44:47], v[244:247], v[204:207], v[44:47]
  v_mfma_f32_16x16x32_bf16 v[48:51], v[204:207], v[248:251], v[48:51]
  v_mfma_f32_16x16x32_bf16 v[52:55], v[204:207], v[252:255], v[52:55]
  ds_read_b128 v[204:207], v4 offset:2048
  v_mfma_f32_16x16x32_bf16 v[68:71], v[244:247], v[208:211], v[68:71]
  v_mfma_f32_16x16x32_bf16 v[72:75], v[208:211], v[248:251], v[72:75]
  v_mfma_f32_16x16x32_bf16 v[76:79], v[208:211], v[252:255], v[76:79]
  ds_read_b128 v[208:211], v4 offset:4096
  v_mfma_f32_16x16x32_bf16 v[92:95], v[244:247], v[212:215], v[92:95]
  v_mfma_f32_16x16x32_bf16 v[96:99], v[212:215], v[248:251], v[96:99]
  v_mfma_f32_16x16x32_bf16 v[100:103], v[212:215], v[252:255], v[100:103]
  ds_read_b128 v[212:215], v4 offset:6144
  v_mfma_f32_16x16x32_bf16 v[116:119], v[244:247], v[216:219], v[116:119]
  v_mfma_f32_16x16x32_bf16 v[140:143], v[244:247], v[220:223], v[140:143]
  v_mfma_f32_16x16x32_bf16 v[164:167], v[244:247], v[224:227], v[164:167]
  v_mfma_f32_16x16x32_bf16 v[188:191], v[244:247], v[228:231], v[188:191]
  ds_read_b64_tr_b16 v[244:245], v6 offset:26624
  ds_read_b64_tr_b16 v[246:247], v6 offset:27136
  v_mfma_f32_16x16x32_bf16 v[120:123], v[216:219], v[248:251], v[120:123]
  v_mfma_f32_16x16x32_bf16 v[144:147], v[220:223], v[248:251], v[144:147]
  v_mfma_f32_16x16x32_bf16 v[168:171], v[224:227], v[248:251], v[168:171]
  v_mfma_f32_16x16x32_bf16 v[192:195], v[228:231], v[248:251], v[192:195]
  ds_read_b64_tr_b16 v[248:249], v5 offset:28672
  ds_read_b64_tr_b16 v[250:251], v5 offset:29184
  v_mfma_f32_16x16x32_bf16 v[124:127], v[216:219], v[252:255], v[124:127]
  v_mfma_f32_16x16x32_bf16 v[148:151], v[220:223], v[252:255], v[148:151]
  v_mfma_f32_16x16x32_bf16 v[172:175], v[224:227], v[252:255], v[172:175]
  v_mfma_f32_16x16x32_bf16 v[196:199], v[228:231], v[252:255], v[196:199]
  ds_read_b64_tr_b16 v[252:253], v6 offset:28672
  ds_read_b64_tr_b16 v[254:255], v6 offset:29184
  v_mfma_f32_16x16x32_bf16 v[104:107], v[232:235], v[216:219], v[104:107]
  v_mfma_f32_16x16x32_bf16 v[128:131], v[232:235], v[220:223], v[128:131]
  v_mfma_f32_16x16x32_bf16 v[152:155], v[232:235], v[224:227], v[152:155]
  v_mfma_f32_16x16x32_bf16 v[176:179], v[232:235], v[228:231], v[176:179]
  ds_read_b64_tr_b16 v[232:233], v5 offset:24576
  ds_read_b64_tr_b16 v[234:235], v5 offset:25088
  v_mfma_f32_16x16x32_bf16 v[108:111], v[236:239], v[216:219], v[108:111]
  v_mfma_f32_16x16x32_bf16 v[132:135], v[236:239], v[220:223], v[132:135]
  v_mfma_f32_16x16x32_bf16 v[156:159], v[236:239], v[224:227], v[156:159]
  v_mfma_f32_16x16x32_bf16 v[180:183], v[236:239], v[228:231], v[180:183]
  ds_read_b64_tr_b16 v[236:237], v6 offset:24576
  ds_read_b64_tr_b16 v[238:239], v6 offset:25088
  v_mfma_f32_16x16x32_bf16 v[112:115], v[240:243], v[216:219], v[112:115]
  ds_read_b128 v[216:219], v4 offset:8192
  v_mfma_f32_16x16x32_bf16 v[136:139], v[240:243], v[220:223], v[136:139]
  ds_read_b128 v[220:223], v4 offset:10240
  v_mfma_f32_16x16x32_bf16 v[160:163], v[240:243], v[224:227], v[160:163]
  ds_read_b128 v[224:227], v4 offset:12288
  v_mfma_f32_16x16x32_bf16 v[184:187], v[240:243], v[228:231], v[184:187]
  ds_read_b128 v[228:231], v4 offset:14336
  ds_read_b64_tr_b16 v[240:241], v5 offset:26624
  ds_read_b64_tr_b16 v[242:243], v5 offset:27136
  s_waitcnt lgkmcnt(14)
  v_mfma_f32_16x16x32_bf16 v[20:23], v[244:247], v[200:203], v[20:23]
  s_waitcnt lgkmcnt(12)
  v_mfma_f32_16x16x32_bf16 v[24:27], v[200:203], v[248:251], v[24:27]
  s_waitcnt lgkmcnt(10)
  v_mfma_f32_16x16x32_bf16 v[28:31], v[200:203], v[252:255], v[28:31]
  v_mfma_f32_16x16x32_bf16 v[44:47], v[244:247], v[204:207], v[44:47]
  v_mfma_f32_16x16x32_bf16 v[48:51], v[204:207], v[248:251], v[48:51]
  v_mfma_f32_16x16x32_bf16 v[52:55], v[204:207], v[252:255], v[52:55]
  v_mfma_f32_16x16x32_bf16 v[68:71], v[244:247], v[208:211], v[68:71]
  v_mfma_f32_16x16x32_bf16 v[72:75], v[208:211], v[248:251], v[72:75]
  v_mfma_f32_16x16x32_bf16 v[76:79], v[208:211], v[252:255], v[76:79]
  v_mfma_f32_16x16x32_bf16 v[92:95], v[244:247], v[212:215], v[92:95]
  v_mfma_f32_16x16x32_bf16 v[96:99], v[212:215], v[248:251], v[96:99]
  v_mfma_f32_16x16x32_bf16 v[100:103], v[212:215], v[252:255], v[100:103]
  s_waitcnt lgkmcnt(8)
  v_mfma_f32_16x16x32_bf16 v[8:11], v[232:235], v[200:203], v[8:11]
  s_waitcnt lgkmcnt(6)
  v_mfma_f32_16x16x32_bf16 v[12:15], v[236:239], v[200:203], v[12:15]
  s_waitcnt lgkmcnt(0)
  v_mfma_f32_16x16x32_bf16 v[16:19], v[240:243], v[200:203], v[16:19]
  s_waitcnt lgkmcnt(0)
  s_barrier
  ds_read_b128 v[200:203], v1 offset:0
  v_mfma_f32_16x16x32_bf16 v[32:35], v[232:235], v[204:207], v[32:35]
  v_mfma_f32_16x16x32_bf16 v[36:39], v[236:239], v[204:207], v[36:39]
  v_mfma_f32_16x16x32_bf16 v[40:43], v[240:243], v[204:207], v[40:43]
  ds_read_b128 v[204:207], v1 offset:2048
  v_mfma_f32_16x16x32_bf16 v[56:59], v[232:235], v[208:211], v[56:59]
  v_mfma_f32_16x16x32_bf16 v[60:63], v[236:239], v[208:211], v[60:63]
  v_mfma_f32_16x16x32_bf16 v[64:67], v[240:243], v[208:211], v[64:67]
  ds_read_b128 v[208:211], v1 offset:4096
  v_mfma_f32_16x16x32_bf16 v[80:83], v[232:235], v[212:215], v[80:83]
  v_mfma_f32_16x16x32_bf16 v[84:87], v[236:239], v[212:215], v[84:87]
  v_mfma_f32_16x16x32_bf16 v[88:91], v[240:243], v[212:215], v[88:91]
  ds_read_b128 v[212:215], v1 offset:6144
  v_mfma_f32_16x16x32_bf16 v[104:107], v[232:235], v[216:219], v[104:107]
  v_mfma_f32_16x16x32_bf16 v[128:131], v[232:235], v[220:223], v[128:131]
  v_mfma_f32_16x16x32_bf16 v[152:155], v[232:235], v[224:227], v[152:155]
  v_mfma_f32_16x16x32_bf16 v[176:179], v[232:235], v[228:231], v[176:179]
  ds_read_b64_tr_b16 v[232:233], v5 offset:36864
  ds_read_b64_tr_b16 v[234:235], v5 offset:37376
  v_mfma_f32_16x16x32_bf16 v[108:111], v[236:239], v[216:219], v[108:111]
  v_mfma_f32_16x16x32_bf16 v[132:135], v[236:239], v[220:223], v[132:135]
  v_mfma_f32_16x16x32_bf16 v[156:159], v[236:239], v[224:227], v[156:159]
  v_mfma_f32_16x16x32_bf16 v[180:183], v[236:239], v[228:231], v[180:183]
  ds_read_b64_tr_b16 v[236:237], v6 offset:36864
  ds_read_b64_tr_b16 v[238:239], v6 offset:37376
  v_mfma_f32_16x16x32_bf16 v[112:115], v[240:243], v[216:219], v[112:115]
  v_mfma_f32_16x16x32_bf16 v[136:139], v[240:243], v[220:223], v[136:139]
  v_mfma_f32_16x16x32_bf16 v[160:163], v[240:243], v[224:227], v[160:163]
  v_mfma_f32_16x16x32_bf16 v[184:187], v[240:243], v[228:231], v[184:187]
  ds_read_b64_tr_b16 v[240:241], v5 offset:38912
  ds_read_b64_tr_b16 v[242:243], v5 offset:39424
  v_mfma_f32_16x16x32_bf16 v[116:119], v[244:247], v[216:219], v[116:119]
  v_mfma_f32_16x16x32_bf16 v[140:143], v[244:247], v[220:223], v[140:143]
  v_mfma_f32_16x16x32_bf16 v[164:167], v[244:247], v[224:227], v[164:167]
  v_mfma_f32_16x16x32_bf16 v[188:191], v[244:247], v[228:231], v[188:191]
  ds_read_b64_tr_b16 v[244:245], v6 offset:38912
  ds_read_b64_tr_b16 v[246:247], v6 offset:39424
  v_mfma_f32_16x16x32_bf16 v[120:123], v[216:219], v[248:251], v[120:123]
  v_mfma_f32_16x16x32_bf16 v[144:147], v[220:223], v[248:251], v[144:147]
  v_mfma_f32_16x16x32_bf16 v[168:171], v[224:227], v[248:251], v[168:171]
  v_mfma_f32_16x16x32_bf16 v[192:195], v[228:231], v[248:251], v[192:195]
  ds_read_b64_tr_b16 v[248:249], v5 offset:40960
  ds_read_b64_tr_b16 v[250:251], v5 offset:41472
  v_mfma_f32_16x16x32_bf16 v[124:127], v[216:219], v[252:255], v[124:127]
  ds_read_b128 v[216:219], v1 offset:8192
  v_mfma_f32_16x16x32_bf16 v[148:151], v[220:223], v[252:255], v[148:151]
  ds_read_b128 v[220:223], v1 offset:10240
  v_mfma_f32_16x16x32_bf16 v[172:175], v[224:227], v[252:255], v[172:175]
  ds_read_b128 v[224:227], v1 offset:12288
  v_mfma_f32_16x16x32_bf16 v[196:199], v[228:231], v[252:255], v[196:199]
  ds_read_b128 v[228:231], v1 offset:14336
  ds_read_b64_tr_b16 v[252:253], v6 offset:40960
  ds_read_b64_tr_b16 v[254:255], v6 offset:41472
  s_waitcnt lgkmcnt(14)
  v_mfma_f32_16x16x32_bf16 v[8:11], v[232:235], v[200:203], v[8:11]
  s_waitcnt lgkmcnt(12)
  v_mfma_f32_16x16x32_bf16 v[12:15], v[236:239], v[200:203], v[12:15]
  s_waitcnt lgkmcnt(10)
  v_mfma_f32_16x16x32_bf16 v[16:19], v[240:243], v[200:203], v[16:19]
  v_mfma_f32_16x16x32_bf16 v[32:35], v[232:235], v[204:207], v[32:35]
  v_mfma_f32_16x16x32_bf16 v[36:39], v[236:239], v[204:207], v[36:39]
  v_mfma_f32_16x16x32_bf16 v[40:43], v[240:243], v[204:207], v[40:43]
  v_mfma_f32_16x16x32_bf16 v[56:59], v[232:235], v[208:211], v[56:59]
  v_mfma_f32_16x16x32_bf16 v[60:63], v[236:239], v[208:211], v[60:63]
  v_mfma_f32_16x16x32_bf16 v[64:67], v[240:243], v[208:211], v[64:67]
  v_mfma_f32_16x16x32_bf16 v[80:83], v[232:235], v[212:215], v[80:83]
  v_mfma_f32_16x16x32_bf16 v[84:87], v[236:239], v[212:215], v[84:87]
  v_mfma_f32_16x16x32_bf16 v[88:91], v[240:243], v[212:215], v[88:91]
  s_waitcnt lgkmcnt(8)
  v_mfma_f32_16x16x32_bf16 v[20:23], v[244:247], v[200:203], v[20:23]
  s_waitcnt lgkmcnt(6)
  v_mfma_f32_16x16x32_bf16 v[24:27], v[200:203], v[248:251], v[24:27]
  s_waitcnt lgkmcnt(0)
  v_mfma_f32_16x16x32_bf16 v[28:31], v[200:203], v[252:255], v[28:31]
  ds_read_b128 v[200:203], v2 offset:0
  v_mfma_f32_16x16x32_bf16 v[44:47], v[244:247], v[204:207], v[44:47]
  v_mfma_f32_16x16x32_bf16 v[48:51], v[204:207], v[248:251], v[48:51]
  v_mfma_f32_16x16x32_bf16 v[52:55], v[204:207], v[252:255], v[52:55]
  ds_read_b128 v[204:207], v2 offset:2048
  v_mfma_f32_16x16x32_bf16 v[68:71], v[244:247], v[208:211], v[68:71]
  v_mfma_f32_16x16x32_bf16 v[72:75], v[208:211], v[248:251], v[72:75]
  v_mfma_f32_16x16x32_bf16 v[76:79], v[208:211], v[252:255], v[76:79]
  ds_read_b128 v[208:211], v2 offset:4096
  v_mfma_f32_16x16x32_bf16 v[92:95], v[244:247], v[212:215], v[92:95]
  v_mfma_f32_16x16x32_bf16 v[96:99], v[212:215], v[248:251], v[96:99]
  v_mfma_f32_16x16x32_bf16 v[100:103], v[212:215], v[252:255], v[100:103]
  ds_read_b128 v[212:215], v2 offset:6144
  v_mfma_f32_16x16x32_bf16 v[116:119], v[244:247], v[216:219], v[116:119]
  v_mfma_f32_16x16x32_bf16 v[140:143], v[244:247], v[220:223], v[140:143]
  v_mfma_f32_16x16x32_bf16 v[164:167], v[244:247], v[224:227], v[164:167]
  v_mfma_f32_16x16x32_bf16 v[188:191], v[244:247], v[228:231], v[188:191]
  ds_read_b64_tr_b16 v[244:245], v6 offset:51200
  ds_read_b64_tr_b16 v[246:247], v6 offset:51712
  v_mfma_f32_16x16x32_bf16 v[120:123], v[216:219], v[248:251], v[120:123]
  v_mfma_f32_16x16x32_bf16 v[144:147], v[220:223], v[248:251], v[144:147]
  v_mfma_f32_16x16x32_bf16 v[168:171], v[224:227], v[248:251], v[168:171]
  v_mfma_f32_16x16x32_bf16 v[192:195], v[228:231], v[248:251], v[192:195]
  ds_read_b64_tr_b16 v[248:249], v5 offset:53248
  ds_read_b64_tr_b16 v[250:251], v5 offset:53760
  v_mfma_f32_16x16x32_bf16 v[124:127], v[216:219], v[252:255], v[124:127]
  v_mfma_f32_16x16x32_bf16 v[148:151], v[220:223], v[252:255], v[148:151]
  v_mfma_f32_16x16x32_bf16 v[172:175], v[224:227], v[252:255], v[172:175]
  v_mfma_f32_16x16x32_bf16 v[196:199], v[228:231], v[252:255], v[196:199]
  ds_read_b64_tr_b16 v[252:253], v6 offset:53248
  ds_read_b64_tr_b16 v[254:255], v6 offset:53760
  v_mfma_f32_16x16x32_bf16 v[104:107], v[232:235], v[216:219], v[104:107]
  v_mfma_f32_16x16x32_bf16 v[128:131], v[232:235], v[220:223], v[128:131]
  v_mfma_f32_16x16x32_bf16 v[152:155], v[232:235], v[224:227], v[152:155]
  v_mfma_f32_16x16x32_bf16 v[176:179], v[232:235], v[228:231], v[176:179]
  ds_read_b64_tr_b16 v[232:233], v5 offset:49152
  ds_read_b64_tr_b16 v[234:235], v5 offset:49664
  v_mfma_f32_16x16x32_bf16 v[108:111], v[236:239], v[216:219], v[108:111]
  v_mfma_f32_16x16x32_bf16 v[132:135], v[236:239], v[220:223], v[132:135]
  v_mfma_f32_16x16x32_bf16 v[156:159], v[236:239], v[224:227], v[156:159]
  v_mfma_f32_16x16x32_bf16 v[180:183], v[236:239], v[228:231], v[180:183]
  ds_read_b64_tr_b16 v[236:237], v6 offset:49152
  ds_read_b64_tr_b16 v[238:239], v6 offset:49664
  v_mfma_f32_16x16x32_bf16 v[112:115], v[240:243], v[216:219], v[112:115]
  ds_read_b128 v[216:219], v2 offset:8192
  v_mfma_f32_16x16x32_bf16 v[136:139], v[240:243], v[220:223], v[136:139]
  ds_read_b128 v[220:223], v2 offset:10240
  v_mfma_f32_16x16x32_bf16 v[160:163], v[240:243], v[224:227], v[160:163]
  ds_read_b128 v[224:227], v2 offset:12288
  v_mfma_f32_16x16x32_bf16 v[184:187], v[240:243], v[228:231], v[184:187]
  ds_read_b128 v[228:231], v2 offset:14336
  ds_read_b64_tr_b16 v[240:241], v5 offset:51200
  ds_read_b64_tr_b16 v[242:243], v5 offset:51712
  s_waitcnt lgkmcnt(14)
  v_mfma_f32_16x16x32_bf16 v[20:23], v[244:247], v[200:203], v[20:23]
  s_waitcnt lgkmcnt(12)
  v_mfma_f32_16x16x32_bf16 v[24:27], v[200:203], v[248:251], v[24:27]
  s_waitcnt lgkmcnt(10)
  v_mfma_f32_16x16x32_bf16 v[28:31], v[200:203], v[252:255], v[28:31]
  v_mfma_f32_16x16x32_bf16 v[44:47], v[244:247], v[204:207], v[44:47]
  v_mfma_f32_16x16x32_bf16 v[48:51], v[204:207], v[248:251], v[48:51]
  v_mfma_f32_16x16x32_bf16 v[52:55], v[204:207], v[252:255], v[52:55]
  v_mfma_f32_16x16x32_bf16 v[68:71], v[244:247], v[208:211], v[68:71]
  v_mfma_f32_16x16x32_bf16 v[72:75], v[208:211], v[248:251], v[72:75]
  v_mfma_f32_16x16x32_bf16 v[76:79], v[208:211], v[252:255], v[76:79]
  v_mfma_f32_16x16x32_bf16 v[92:95], v[244:247], v[212:215], v[92:95]
  v_mfma_f32_16x16x32_bf16 v[96:99], v[212:215], v[248:251], v[96:99]
  v_mfma_f32_16x16x32_bf16 v[100:103], v[212:215], v[252:255], v[100:103]
  s_waitcnt lgkmcnt(8)
  v_mfma_f32_16x16x32_bf16 v[8:11], v[232:235], v[200:203], v[8:11]
  s_waitcnt lgkmcnt(6)
  v_mfma_f32_16x16x32_bf16 v[12:15], v[236:239], v[200:203], v[12:15]
  s_waitcnt lgkmcnt(0)
  v_mfma_f32_16x16x32_bf16 v[16:19], v[240:243], v[200:203], v[16:19]
  s_waitcnt lgkmcnt(0)
  s_barrier
  ds_read_b128 v[200:203], v1 offset:32768
  v_mfma_f32_16x16x32_bf16 v[32:35], v[232:235], v[204:207], v[32:35]
  v_mfma_f32_16x16x32_bf16 v[36:39], v[236:239], v[204:207], v[36:39]
  v_mfma_f32_16x16x32_bf16 v[40:43], v[240:243], v[204:207], v[40:43]
  ds_read_b128 v[204:207], v1 offset:34816
  v_mfma_f32_16x16x32_bf16 v[56:59], v[232:235], v[208:211], v[56:59]
  v_mfma_f32_16x16x32_bf16 v[60:63], v[236:239], v[208:211], v[60:63]
  v_mfma_f32_16x16x32_bf16 v[64:67], v[240:243], v[208:211], v[64:67]
  ds_read_b128 v[208:211], v1 offset:36864
  v_mfma_f32_16x16x32_bf16 v[80:83], v[232:235], v[212:215], v[80:83]
  v_mfma_f32_16x16x32_bf16 v[84:87], v[236:239], v[212:215], v[84:87]
  v_mfma_f32_16x16x32_bf16 v[88:91], v[240:243], v[212:215], v[88:91]
  ds_read_b128 v[212:215], v1 offset:38912
  v_mfma_f32_16x16x32_bf16 v[104:107], v[232:235], v[216:219], v[104:107]
  v_mfma_f32_16x16x32_bf16 v[128:131], v[232:235], v[220:223], v[128:131]
  v_mfma_f32_16x16x32_bf16 v[152:155], v[232:235], v[224:227], v[152:155]
  v_mfma_f32_16x16x32_bf16 v[176:179], v[232:235], v[228:231], v[176:179]
  ds_read_b64_tr_b16 v[232:233], v5 offset:0
  ds_read_b64_tr_b16 v[234:235], v5 offset:512
  v_mfma_f32_16x16x32_bf16 v[108:111], v[236:239], v[216:219], v[108:111]
  v_mfma_f32_16x16x32_bf16 v[132:135], v[236:239], v[220:223], v[132:135]
  v_mfma_f32_16x16x32_bf16 v[156:159], v[236:239], v[224:227], v[156:159]
  v_mfma_f32_16x16x32_bf16 v[180:183], v[236:239], v[228:231], v[180:183]
  ds_read_b64_tr_b16 v[236:237], v6 offset:0
  ds_read_b64_tr_b16 v[238:239], v6 offset:512
  v_mfma_f32_16x16x32_bf16 v[112:115], v[240:243], v[216:219], v[112:115]
  v_mfma_f32_16x16x32_bf16 v[136:139], v[240:243], v[220:223], v[136:139]
  v_mfma_f32_16x16x32_bf16 v[160:163], v[240:243], v[224:227], v[160:163]
  v_mfma_f32_16x16x32_bf16 v[184:187], v[240:243], v[228:231], v[184:187]
  ds_read_b64_tr_b16 v[240:241], v5 offset:2048
  ds_read_b64_tr_b16 v[242:243], v5 offset:2560
  v_mfma_f32_16x16x32_bf16 v[116:119], v[244:247], v[216:219], v[116:119]
  v_mfma_f32_16x16x32_bf16 v[140:143], v[244:247], v[220:223], v[140:143]
  v_mfma_f32_16x16x32_bf16 v[164:167], v[244:247], v[224:227], v[164:167]
  v_mfma_f32_16x16x32_bf16 v[188:191], v[244:247], v[228:231], v[188:191]
  ds_read_b64_tr_b16 v[244:245], v6 offset:2048
  ds_read_b64_tr_b16 v[246:247], v6 offset:2560
  v_mfma_f32_16x16x32_bf16 v[120:123], v[216:219], v[248:251], v[120:123]
  v_mfma_f32_16x16x32_bf16 v[144:147], v[220:223], v[248:251], v[144:147]
  v_mfma_f32_16x16x32_bf16 v[168:171], v[224:227], v[248:251], v[168:171]
  v_mfma_f32_16x16x32_bf16 v[192:195], v[228:231], v[248:251], v[192:195]
  ds_read_b64_tr_b16 v[248:249], v5 offset:4096
  ds_read_b64_tr_b16 v[250:251], v5 offset:4608
  v_mfma_f32_16x16x32_bf16 v[124:127], v[216:219], v[252:255], v[124:127]
  ds_read_b128 v[216:219], v1 offset:40960
  v_mfma_f32_16x16x32_bf16 v[148:151], v[220:223], v[252:255], v[148:151]
  ds_read_b128 v[220:223], v1 offset:43008
  v_mfma_f32_16x16x32_bf16 v[172:175], v[224:227], v[252:255], v[172:175]
  ds_read_b128 v[224:227], v1 offset:45056
  v_mfma_f32_16x16x32_bf16 v[196:199], v[228:231], v[252:255], v[196:199]
  ds_read_b128 v[228:231], v1 offset:47104
  ds_read_b64_tr_b16 v[252:253], v6 offset:4096
  ds_read_b64_tr_b16 v[254:255], v6 offset:4608
  s_waitcnt lgkmcnt(14)
  v_mfma_f32_16x16x32_bf16 v[8:11], v[232:235], v[200:203], v[8:11]
  s_waitcnt lgkmcnt(12)
  v_mfma_f32_16x16x32_bf16 v[12:15], v[236:239], v[200:203], v[12:15]
  s_waitcnt lgkmcnt(10)
  v_mfma_f32_16x16x32_bf16 v[16:19], v[240:243], v[200:203], v[16:19]
  v_mfma_f32_16x16x32_bf16 v[32:35], v[232:235], v[204:207], v[32:35]
  v_mfma_f32_16x16x32_bf16 v[36:39], v[236:239], v[204:207], v[36:39]
  v_mfma_f32_16x16x32_bf16 v[40:43], v[240:243], v[204:207], v[40:43]
  v_mfma_f32_16x16x32_bf16 v[56:59], v[232:235], v[208:211], v[56:59]
  v_mfma_f32_16x16x32_bf16 v[60:63], v[236:239], v[208:211], v[60:63]
  v_mfma_f32_16x16x32_bf16 v[64:67], v[240:243], v[208:211], v[64:67]
  v_mfma_f32_16x16x32_bf16 v[80:83], v[232:235], v[212:215], v[80:83]
  v_mfma_f32_16x16x32_bf16 v[84:87], v[236:239], v[212:215], v[84:87]
  v_mfma_f32_16x16x32_bf16 v[88:91], v[240:243], v[212:215], v[88:91]
  s_waitcnt lgkmcnt(8)
  v_mfma_f32_16x16x32_bf16 v[20:23], v[244:247], v[200:203], v[20:23]
  s_waitcnt lgkmcnt(6)
  v_mfma_f32_16x16x32_bf16 v[24:27], v[200:203], v[248:251], v[24:27]
  s_waitcnt lgkmcnt(0)
  v_mfma_f32_16x16x32_bf16 v[28:31], v[200:203], v[252:255], v[28:31]
  ds_read_b128 v[200:203], v2 offset:32768
  v_mfma_f32_16x16x32_bf16 v[44:47], v[244:247], v[204:207], v[44:47]
  v_mfma_f32_16x16x32_bf16 v[48:51], v[204:207], v[248:251], v[48:51]
  v_mfma_f32_16x16x32_bf16 v[52:55], v[204:207], v[252:255], v[52:55]
  ds_read_b128 v[204:207], v2 offset:34816
  v_mfma_f32_16x16x32_bf16 v[68:71], v[244:247], v[208:211], v[68:71]
  v_mfma_f32_16x16x32_bf16 v[72:75], v[208:211], v[248:251], v[72:75]
  v_mfma_f32_16x16x32_bf16 v[76:79], v[208:211], v[252:255], v[76:79]
  ds_read_b128 v[208:211], v2 offset:36864
  v_mfma_f32_16x16x32_bf16 v[92:95], v[244:247], v[212:215], v[92:95]
  v_mfma_f32_16x16x32_bf16 v[96:99], v[212:215], v[248:251], v[96:99]
  v_mfma_f32_16x16x32_bf16 v[100:103], v[212:215], v[252:255], v[100:103]
  ds_read_b128 v[212:215], v2 offset:38912
  v_mfma_f32_16x16x32_bf16 v[116:119], v[244:247], v[216:219], v[116:119]
  v_mfma_f32_16x16x32_bf16 v[140:143], v[244:247], v[220:223], v[140:143]
  v_mfma_f32_16x16x32_bf16 v[164:167], v[244:247], v[224:227], v[164:167]
  v_mfma_f32_16x16x32_bf16 v[188:191], v[244:247], v[228:231], v[188:191]
  ds_read_b64_tr_b16 v[244:245], v6 offset:14336
  ds_read_b64_tr_b16 v[246:247], v6 offset:14848
  v_mfma_f32_16x16x32_bf16 v[120:123], v[216:219], v[248:251], v[120:123]
  v_mfma_f32_16x16x32_bf16 v[144:147], v[220:223], v[248:251], v[144:147]
  v_mfma_f32_16x16x32_bf16 v[168:171], v[224:227], v[248:251], v[168:171]
  v_mfma_f32_16x16x32_bf16 v[192:195], v[228:231], v[248:251], v[192:195]
  ds_read_b64_tr_b16 v[248:249], v5 offset:16384
  ds_read_b64_tr_b16 v[250:251], v5 offset:16896
  v_mfma_f32_16x16x32_bf16 v[124:127], v[216:219], v[252:255], v[124:127]
  v_mfma_f32_16x16x32_bf16 v[148:151], v[220:223], v[252:255], v[148:151]
  v_mfma_f32_16x16x32_bf16 v[172:175], v[224:227], v[252:255], v[172:175]
  v_mfma_f32_16x16x32_bf16 v[196:199], v[228:231], v[252:255], v[196:199]
  ds_read_b64_tr_b16 v[252:253], v6 offset:16384
  ds_read_b64_tr_b16 v[254:255], v6 offset:16896
  v_mfma_f32_16x16x32_bf16 v[104:107], v[232:235], v[216:219], v[104:107]
  v_mfma_f32_16x16x32_bf16 v[128:131], v[232:235], v[220:223], v[128:131]
  v_mfma_f32_16x16x32_bf16 v[152:155], v[232:235], v[224:227], v[152:155]
  v_mfma_f32_16x16x32_bf16 v[176:179], v[232:235], v[228:231], v[176:179]
  ds_read_b64_tr_b16 v[232:233], v5 offset:12288
  ds_read_b64_tr_b16 v[234:235], v5 offset:12800
  v_mfma_f32_16x16x32_bf16 v[108:111], v[236:239], v[216:219], v[108:111]
  v_mfma_f32_16x16x32_bf16 v[132:135], v[236:239], v[220:223], v[132:135]
  v_mfma_f32_16x16x32_bf16 v[156:159], v[236:239], v[224:227], v[156:159]
  v_mfma_f32_16x16x32_bf16 v[180:183], v[236:239], v[228:231], v[180:183]
  ds_read_b64_tr_b16 v[236:237], v6 offset:12288
  ds_read_b64_tr_b16 v[238:239], v6 offset:12800
  v_mfma_f32_16x16x32_bf16 v[112:115], v[240:243], v[216:219], v[112:115]
  ds_read_b128 v[216:219], v2 offset:40960
  v_mfma_f32_16x16x32_bf16 v[136:139], v[240:243], v[220:223], v[136:139]
  ds_read_b128 v[220:223], v2 offset:43008
  v_mfma_f32_16x16x32_bf16 v[160:163], v[240:243], v[224:227], v[160:163]
  ds_read_b128 v[224:227], v2 offset:45056
  v_mfma_f32_16x16x32_bf16 v[184:187], v[240:243], v[228:231], v[184:187]
  ds_read_b128 v[228:231], v2 offset:47104
  ds_read_b64_tr_b16 v[240:241], v5 offset:14336
  ds_read_b64_tr_b16 v[242:243], v5 offset:14848
  s_waitcnt lgkmcnt(14)
  v_mfma_f32_16x16x32_bf16 v[20:23], v[244:247], v[200:203], v[20:23]
  s_waitcnt lgkmcnt(12)
  v_mfma_f32_16x16x32_bf16 v[24:27], v[200:203], v[248:251], v[24:27]
  s_waitcnt lgkmcnt(10)
  v_mfma_f32_16x16x32_bf16 v[28:31], v[200:203], v[252:255], v[28:31]
  v_mfma_f32_16x16x32_bf16 v[44:47], v[244:247], v[204:207], v[44:47]
  v_mfma_f32_16x16x32_bf16 v[48:51], v[204:207], v[248:251], v[48:51]
  v_mfma_f32_16x16x32_bf16 v[52:55], v[204:207], v[252:255], v[52:55]
  v_mfma_f32_16x16x32_bf16 v[68:71], v[244:247], v[208:211], v[68:71]
  v_mfma_f32_16x16x32_bf16 v[72:75], v[208:211], v[248:251], v[72:75]
  v_mfma_f32_16x16x32_bf16 v[76:79], v[208:211], v[252:255], v[76:79]
  v_mfma_f32_16x16x32_bf16 v[92:95], v[244:247], v[212:215], v[92:95]
  v_mfma_f32_16x16x32_bf16 v[96:99], v[212:215], v[248:251], v[96:99]
  v_mfma_f32_16x16x32_bf16 v[100:103], v[212:215], v[252:255], v[100:103]
  s_waitcnt lgkmcnt(8)
  v_mfma_f32_16x16x32_bf16 v[8:11], v[232:235], v[200:203], v[8:11]
  s_waitcnt lgkmcnt(6)
  v_mfma_f32_16x16x32_bf16 v[12:15], v[236:239], v[200:203], v[12:15]
  s_waitcnt lgkmcnt(0)
  v_mfma_f32_16x16x32_bf16 v[16:19], v[240:243], v[200:203], v[16:19]
  s_waitcnt lgkmcnt(0)
  s_barrier
  ds_read_b128 v[200:203], v3 offset:0
  v_mfma_f32_16x16x32_bf16 v[32:35], v[232:235], v[204:207], v[32:35]
  v_mfma_f32_16x16x32_bf16 v[36:39], v[236:239], v[204:207], v[36:39]
  v_mfma_f32_16x16x32_bf16 v[40:43], v[240:243], v[204:207], v[40:43]
  ds_read_b128 v[204:207], v3 offset:2048
  v_mfma_f32_16x16x32_bf16 v[56:59], v[232:235], v[208:211], v[56:59]
  v_mfma_f32_16x16x32_bf16 v[60:63], v[236:239], v[208:211], v[60:63]
  v_mfma_f32_16x16x32_bf16 v[64:67], v[240:243], v[208:211], v[64:67]
  ds_read_b128 v[208:211], v3 offset:4096
  v_mfma_f32_16x16x32_bf16 v[80:83], v[232:235], v[212:215], v[80:83]
  v_mfma_f32_16x16x32_bf16 v[84:87], v[236:239], v[212:215], v[84:87]
  v_mfma_f32_16x16x32_bf16 v[88:91], v[240:243], v[212:215], v[88:91]
  ds_read_b128 v[212:215], v3 offset:6144
  v_mfma_f32_16x16x32_bf16 v[104:107], v[232:235], v[216:219], v[104:107]
  v_mfma_f32_16x16x32_bf16 v[128:131], v[232:235], v[220:223], v[128:131]
  v_mfma_f32_16x16x32_bf16 v[152:155], v[232:235], v[224:227], v[152:155]
  v_mfma_f32_16x16x32_bf16 v[176:179], v[232:235], v[228:231], v[176:179]
  ds_read_b64_tr_b16 v[232:233], v5 offset:24576
  ds_read_b64_tr_b16 v[234:235], v5 offset:25088
  v_mfma_f32_16x16x32_bf16 v[108:111], v[236:239], v[216:219], v[108:111]
  v_mfma_f32_16x16x32_bf16 v[132:135], v[236:239], v[220:223], v[132:135]
  v_mfma_f32_16x16x32_bf16 v[156:159], v[236:239], v[224:227], v[156:159]
  v_mfma_f32_16x16x32_bf16 v[180:183], v[236:239], v[228:231], v[180:183]
  ds_read_b64_tr_b16 v[236:237], v6 offset:24576
  ds_read_b64_tr_b16 v[238:239], v6 offset:25088
  v_mfma_f32_16x16x32_bf16 v[112:115], v[240:243], v[216:219], v[112:115]
  v_mfma_f32_16x16x32_bf16 v[136:139], v[240:243], v[220:223], v[136:139]
  v_mfma_f32_16x16x32_bf16 v[160:163], v[240:243], v[224:227], v[160:163]
  v_mfma_f32_16x16x32_bf16 v[184:187], v[240:243], v[228:231], v[184:187]
  ds_read_b64_tr_b16 v[240:241], v5 offset:26624
  ds_read_b64_tr_b16 v[242:243], v5 offset:27136
  v_mfma_f32_16x16x32_bf16 v[116:119], v[244:247], v[216:219], v[116:119]
  v_mfma_f32_16x16x32_bf16 v[140:143], v[244:247], v[220:223], v[140:143]
  v_mfma_f32_16x16x32_bf16 v[164:167], v[244:247], v[224:227], v[164:167]
  v_mfma_f32_16x16x32_bf16 v[188:191], v[244:247], v[228:231], v[188:191]
  ds_read_b64_tr_b16 v[244:245], v6 offset:26624
  ds_read_b64_tr_b16 v[246:247], v6 offset:27136
  v_mfma_f32_16x16x32_bf16 v[120:123], v[216:219], v[248:251], v[120:123]
  v_mfma_f32_16x16x32_bf16 v[144:147], v[220:223], v[248:251], v[144:147]
  v_mfma_f32_16x16x32_bf16 v[168:171], v[224:227], v[248:251], v[168:171]
  v_mfma_f32_16x16x32_bf16 v[192:195], v[228:231], v[248:251], v[192:195]
  ds_read_b64_tr_b16 v[248:249], v5 offset:28672
  ds_read_b64_tr_b16 v[250:251], v5 offset:29184
  v_mfma_f32_16x16x32_bf16 v[124:127], v[216:219], v[252:255], v[124:127]
  ds_read_b128 v[216:219], v3 offset:8192
  v_mfma_f32_16x16x32_bf16 v[148:151], v[220:223], v[252:255], v[148:151]
  ds_read_b128 v[220:223], v3 offset:10240
  v_mfma_f32_16x16x32_bf16 v[172:175], v[224:227], v[252:255], v[172:175]
  ds_read_b128 v[224:227], v3 offset:12288
  v_mfma_f32_16x16x32_bf16 v[196:199], v[228:231], v[252:255], v[196:199]
  ds_read_b128 v[228:231], v3 offset:14336
  ds_read_b64_tr_b16 v[252:253], v6 offset:28672
  ds_read_b64_tr_b16 v[254:255], v6 offset:29184
  s_waitcnt lgkmcnt(14)
  v_mfma_f32_16x16x32_bf16 v[8:11], v[232:235], v[200:203], v[8:11]
  s_waitcnt lgkmcnt(12)
  v_mfma_f32_16x16x32_bf16 v[12:15], v[236:239], v[200:203], v[12:15]
  s_waitcnt lgkmcnt(10)
  v_mfma_f32_16x16x32_bf16 v[16:19], v[240:243], v[200:203], v[16:19]
  v_mfma_f32_16x16x32_bf16 v[32:35], v[232:235], v[204:207], v[32:35]
  v_mfma_f32_16x16x32_bf16 v[36:39], v[236:239], v[204:207], v[36:39]
  v_mfma_f32_16x16x32_bf16 v[40:43], v[240:243], v[204:207], v[40:43]
  v_mfma_f32_16x16x32_bf16 v[56:59], v[232:235], v[208:211], v[56:59]
  v_mfma_f32_16x16x32_bf16 v[60:63], v[236:239], v[208:211], v[60:63]
  v_mfma_f32_16x16x32_bf16 v[64:67], v[240:243], v[208:211], v[64:67]
  v_mfma_f32_16x16x32_bf16 v[80:83], v[232:235], v[212:215], v[80:83]
  v_mfma_f32_16x16x32_bf16 v[84:87], v[236:239], v[212:215], v[84:87]
  v_mfma_f32_16x16x32_bf16 v[88:91], v[240:243], v[212:215], v[88:91]
  s_waitcnt lgkmcnt(8)
  v_mfma_f32_16x16x32_bf16 v[20:23], v[244:247], v[200:203], v[20:23]
  s_waitcnt lgkmcnt(6)
  v_mfma_f32_16x16x32_bf16 v[24:27], v[200:203], v[248:251], v[24:27]
  s_waitcnt lgkmcnt(0)
  v_mfma_f32_16x16x32_bf16 v[28:31], v[200:203], v[252:255], v[28:31]
  ds_read_b128 v[200:203], v4 offset:0
  v_mfma_f32_16x16x32_bf16 v[44:47], v[244:247], v[204:207], v[44:47]
  v_mfma_f32_16x16x32_bf16 v[48:51], v[204:207], v[248:251], v[48:51]
  v_mfma_f32_16x16x32_bf16 v[52:55], v[204:207], v[252:255], v[52:55]
  ds_read_b128 v[204:207], v4 offset:2048
  v_mfma_f32_16x16x32_bf16 v[68:71], v[244:247], v[208:211], v[68:71]
  v_mfma_f32_16x16x32_bf16 v[72:75], v[208:211], v[248:251], v[72:75]
  v_mfma_f32_16x16x32_bf16 v[76:79], v[208:211], v[252:255], v[76:79]
  ds_read_b128 v[208:211], v4 offset:4096
  v_mfma_f32_16x16x32_bf16 v[92:95], v[244:247], v[212:215], v[92:95]
  v_mfma_f32_16x16x32_bf16 v[96:99], v[212:215], v[248:251], v[96:99]
  v_mfma_f32_16x16x32_bf16 v[100:103], v[212:215], v[252:255], v[100:103]
  ds_read_b128 v[212:215], v4 offset:6144
  v_mfma_f32_16x16x32_bf16 v[116:119], v[244:247], v[216:219], v[116:119]
  v_mfma_f32_16x16x32_bf16 v[140:143], v[244:247], v[220:223], v[140:143]
  v_mfma_f32_16x16x32_bf16 v[164:167], v[244:247], v[224:227], v[164:167]
  v_mfma_f32_16x16x32_bf16 v[188:191], v[244:247], v[228:231], v[188:191]
  ds_read_b64_tr_b16 v[244:245], v6 offset:38912
  ds_read_b64_tr_b16 v[246:247], v6 offset:39424
  v_mfma_f32_16x16x32_bf16 v[120:123], v[216:219], v[248:251], v[120:123]
  v_mfma_f32_16x16x32_bf16 v[144:147], v[220:223], v[248:251], v[144:147]
  v_mfma_f32_16x16x32_bf16 v[168:171], v[224:227], v[248:251], v[168:171]
  v_mfma_f32_16x16x32_bf16 v[192:195], v[228:231], v[248:251], v[192:195]
  ds_read_b64_tr_b16 v[248:249], v5 offset:40960
  ds_read_b64_tr_b16 v[250:251], v5 offset:41472
  v_mfma_f32_16x16x32_bf16 v[124:127], v[216:219], v[252:255], v[124:127]
  v_mfma_f32_16x16x32_bf16 v[148:151], v[220:223], v[252:255], v[148:151]
  v_mfma_f32_16x16x32_bf16 v[172:175], v[224:227], v[252:255], v[172:175]
  v_mfma_f32_16x16x32_bf16 v[196:199], v[228:231], v[252:255], v[196:199]
  ds_read_b64_tr_b16 v[252:253], v6 offset:40960
  ds_read_b64_tr_b16 v[254:255], v6 offset:41472
  v_mfma_f32_16x16x32_bf16 v[104:107], v[232:235], v[216:219], v[104:107]
  v_mfma_f32_16x16x32_bf16 v[128:131], v[232:235], v[220:223], v[128:131]
  v_mfma_f32_16x16x32_bf16 v[152:155], v[232:235], v[224:227], v[152:155]
  v_mfma_f32_16x16x32_bf16 v[176:179], v[232:235], v[228:231], v[176:179]
  ds_read_b64_tr_b16 v[232:233], v5 offset:36864
  ds_read_b64_tr_b16 v[234:235], v5 offset:37376
  v_mfma_f32_16x16x32_bf16 v[108:111], v[236:239], v[216:219], v[108:111]
  v_mfma_f32_16x16x32_bf16 v[132:135], v[236:239], v[220:223], v[132:135]
  v_mfma_f32_16x16x32_bf16 v[156:159], v[236:239], v[224:227], v[156:159]
  v_mfma_f32_16x16x32_bf16 v[180:183], v[236:239], v[228:231], v[180:183]
  ds_read_b64_tr_b16 v[236:237], v6 offset:36864
  ds_read_b64_tr_b16 v[238:239], v6 offset:37376
  v_mfma_f32_16x16x32_bf16 v[112:115], v[240:243], v[216:219], v[112:115]
  ds_read_b128 v[216:219], v4 offset:8192
  v_mfma_f32_16x16x32_bf16 v[136:139], v[240:243], v[220:223], v[136:139]
  ds_read_b128 v[220:223], v4 offset:10240
  v_mfma_f32_16x16x32_bf16 v[160:163], v[240:243], v[224:227], v[160:163]
  ds_read_b128 v[224:227], v4 offset:12288
  v_mfma_f32_16x16x32_bf16 v[184:187], v[240:243], v[228:231], v[184:187]
  ds_read_b128 v[228:231], v4 offset:14336
  ds_read_b64_tr_b16 v[240:241], v5 offset:38912
  ds_read_b64_tr_b16 v[242:243], v5 offset:39424
  s_waitcnt lgkmcnt(14)
  v_mfma_f32_16x16x32_bf16 v[20:23], v[244:247], v[200:203], v[20:23]
  s_waitcnt lgkmcnt(12)
  v_mfma_f32_16x16x32_bf16 v[24:27], v[200:203], v[248:251], v[24:27]
  s_waitcnt lgkmcnt(10)
  v_mfma_f32_16x16x32_bf16 v[28:31], v[200:203], v[252:255], v[28:31]
  v_mfma_f32_16x16x32_bf16 v[44:47], v[244:247], v[204:207], v[44:47]
  v_mfma_f32_16x16x32_bf16 v[48:51], v[204:207], v[248:251], v[48:51]
  v_mfma_f32_16x16x32_bf16 v[52:55], v[204:207], v[252:255], v[52:55]
  v_mfma_f32_16x16x32_bf16 v[68:71], v[244:247], v[208:211], v[68:71]
  v_mfma_f32_16x16x32_bf16 v[72:75], v[208:211], v[248:251], v[72:75]
  v_mfma_f32_16x16x32_bf16 v[76:79], v[208:211], v[252:255], v[76:79]
  v_mfma_f32_16x16x32_bf16 v[92:95], v[244:247], v[212:215], v[92:95]
  v_mfma_f32_16x16x32_bf16 v[96:99], v[212:215], v[248:251], v[96:99]
  v_mfma_f32_16x16x32_bf16 v[100:103], v[212:215], v[252:255], v[100:103]
  s_waitcnt lgkmcnt(8)
  v_mfma_f32_16x16x32_bf16 v[8:11], v[232:235], v[200:203], v[8:11]
  s_waitcnt lgkmcnt(6)
  v_mfma_f32_16x16x32_bf16 v[12:15], v[236:239], v[200:203], v[12:15]
  s_waitcnt lgkmcnt(0)
  v_mfma_f32_16x16x32_bf16 v[16:19], v[240:243], v[200:203], v[16:19]
  s_waitcnt lgkmcnt(0)
  s_barrier
  ds_read_b128 v[200:203], v1 offset:0
  v_mfma_f32_16x16x32_bf16 v[32:35], v[232:235], v[204:207], v[32:35]
  v_mfma_f32_16x16x32_bf16 v[36:39], v[236:239], v[204:207], v[36:39]
  v_mfma_f32_16x16x32_bf16 v[40:43], v[240:243], v[204:207], v[40:43]
  ds_read_b128 v[204:207], v1 offset:2048
  v_mfma_f32_16x16x32_bf16 v[56:59], v[232:235], v[208:211], v[56:59]
  v_mfma_f32_16x16x32_bf16 v[60:63], v[236:239], v[208:211], v[60:63]
  v_mfma_f32_16x16x32_bf16 v[64:67], v[240:243], v[208:211], v[64:67]
  ds_read_b128 v[208:211], v1 offset:4096
  v_mfma_f32_16x16x32_bf16 v[80:83], v[232:235], v[212:215], v[80:83]
  v_mfma_f32_16x16x32_bf16 v[84:87], v[236:239], v[212:215], v[84:87]
  v_mfma_f32_16x16x32_bf16 v[88:91], v[240:243], v[212:215], v[88:91]
  ds_read_b128 v[212:215], v1 offset:6144
  v_mfma_f32_16x16x32_bf16 v[104:107], v[232:235], v[216:219], v[104:107]
  v_mfma_f32_16x16x32_bf16 v[128:131], v[232:235], v[220:223], v[128:131]
  v_mfma_f32_16x16x32_bf16 v[152:155], v[232:235], v[224:227], v[152:155]
  v_mfma_f32_16x16x32_bf16 v[176:179], v[232:235], v[228:231], v[176:179]
  ds_read_b64_tr_b16 v[232:233], v5 offset:49152
  ds_read_b64_tr_b16 v[234:235], v5 offset:49664
  v_mfma_f32_16x16x32_bf16 v[108:111], v[236:239], v[216:219], v[108:111]
  v_mfma_f32_16x16x32_bf16 v[132:135], v[236:239], v[220:223], v[132:135]
  v_mfma_f32_16x16x32_bf16 v[156:159], v[236:239], v[224:227], v[156:159]
  v_mfma_f32_16x16x32_bf16 v[180:183], v[236:239], v[228:231], v[180:183]
  ds_read_b64_tr_b16 v[236:237], v6 offset:49152
  ds_read_b64_tr_b16 v[238:239], v6 offset:49664
  v_mfma_f32_16x16x32_bf16 v[112:115], v[240:243], v[216:219], v[112:115]
  v_mfma_f32_16x16x32_bf16 v[136:139], v[240:243], v[220:223], v[136:139]
  v_mfma_f32_16x16x32_bf16 v[160:163], v[240:243], v[224:227], v[160:163]
  v_mfma_f32_16x16x32_bf16 v[184:187], v[240:243], v[228:231], v[184:187]
  ds_read_b64_tr_b16 v[240:241], v5 offset:51200
  ds_read_b64_tr_b16 v[242:243], v5 offset:51712
  v_mfma_f32_16x16x32_bf16 v[116:119], v[244:247], v[216:219], v[116:119]
  v_mfma_f32_16x16x32_bf16 v[140:143], v[244:247], v[220:223], v[140:143]
  v_mfma_f32_16x16x32_bf16 v[164:167], v[244:247], v[224:227], v[164:167]
  v_mfma_f32_16x16x32_bf16 v[188:191], v[244:247], v[228:231], v[188:191]
  ds_read_b64_tr_b16 v[244:245], v6 offset:51200
  ds_read_b64_tr_b16 v[246:247], v6 offset:51712
  v_mfma_f32_16x16x32_bf16 v[120:123], v[216:219], v[248:251], v[120:123]
  v_mfma_f32_16x16x32_bf16 v[144:147], v[220:223], v[248:251], v[144:147]
  v_mfma_f32_16x16x32_bf16 v[168:171], v[224:227], v[248:251], v[168:171]
  v_mfma_f32_16x16x32_bf16 v[192:195], v[228:231], v[248:251], v[192:195]
  ds_read_b64_tr_b16 v[248:249], v5 offset:53248
  ds_read_b64_tr_b16 v[250:251], v5 offset:53760
  v_mfma_f32_16x16x32_bf16 v[124:127], v[216:219], v[252:255], v[124:127]
  ds_read_b128 v[216:219], v1 offset:8192
  v_mfma_f32_16x16x32_bf16 v[148:151], v[220:223], v[252:255], v[148:151]
  ds_read_b128 v[220:223], v1 offset:10240
  v_mfma_f32_16x16x32_bf16 v[172:175], v[224:227], v[252:255], v[172:175]
  ds_read_b128 v[224:227], v1 offset:12288
  v_mfma_f32_16x16x32_bf16 v[196:199], v[228:231], v[252:255], v[196:199]
  ds_read_b128 v[228:231], v1 offset:14336
  ds_read_b64_tr_b16 v[252:253], v6 offset:53248
  ds_read_b64_tr_b16 v[254:255], v6 offset:53760
  s_waitcnt lgkmcnt(14)
  v_mfma_f32_16x16x32_bf16 v[8:11], v[232:235], v[200:203], v[8:11]
  s_waitcnt lgkmcnt(12)
  v_mfma_f32_16x16x32_bf16 v[12:15], v[236:239], v[200:203], v[12:15]
  s_waitcnt lgkmcnt(10)
  v_mfma_f32_16x16x32_bf16 v[16:19], v[240:243], v[200:203], v[16:19]
  v_mfma_f32_16x16x32_bf16 v[32:35], v[232:235], v[204:207], v[32:35]
  v_mfma_f32_16x16x32_bf16 v[36:39], v[236:239], v[204:207], v[36:39]
  v_mfma_f32_16x16x32_bf16 v[40:43], v[240:243], v[204:207], v[40:43]
  v_mfma_f32_16x16x32_bf16 v[56:59], v[232:235], v[208:211], v[56:59]
  v_mfma_f32_16x16x32_bf16 v[60:63], v[236:239], v[208:211], v[60:63]
  v_mfma_f32_16x16x32_bf16 v[64:67], v[240:243], v[208:211], v[64:67]
  v_mfma_f32_16x16x32_bf16 v[80:83], v[232:235], v[212:215], v[80:83]
  v_mfma_f32_16x16x32_bf16 v[84:87], v[236:239], v[212:215], v[84:87]
  v_mfma_f32_16x16x32_bf16 v[88:91], v[240:243], v[212:215], v[88:91]
  s_waitcnt lgkmcnt(8)
  v_mfma_f32_16x16x32_bf16 v[20:23], v[244:247], v[200:203], v[20:23]
  s_waitcnt lgkmcnt(6)
  v_mfma_f32_16x16x32_bf16 v[24:27], v[200:203], v[248:251], v[24:27]
  s_waitcnt lgkmcnt(0)
  v_mfma_f32_16x16x32_bf16 v[28:31], v[200:203], v[252:255], v[28:31]
  ds_read_b128 v[200:203], v2 offset:0
  v_mfma_f32_16x16x32_bf16 v[44:47], v[244:247], v[204:207], v[44:47]
  v_mfma_f32_16x16x32_bf16 v[48:51], v[204:207], v[248:251], v[48:51]
  v_mfma_f32_16x16x32_bf16 v[52:55], v[204:207], v[252:255], v[52:55]
  ds_read_b128 v[204:207], v2 offset:2048
  v_mfma_f32_16x16x32_bf16 v[68:71], v[244:247], v[208:211], v[68:71]
  v_mfma_f32_16x16x32_bf16 v[72:75], v[208:211], v[248:251], v[72:75]
  v_mfma_f32_16x16x32_bf16 v[76:79], v[208:211], v[252:255], v[76:79]
  ds_read_b128 v[208:211], v2 offset:4096
  v_mfma_f32_16x16x32_bf16 v[92:95], v[244:247], v[212:215], v[92:95]
  v_mfma_f32_16x16x32_bf16 v[96:99], v[212:215], v[248:251], v[96:99]
  v_mfma_f32_16x16x32_bf16 v[100:103], v[212:215], v[252:255], v[100:103]
  ds_read_b128 v[212:215], v2 offset:6144
  v_mfma_f32_16x16x32_bf16 v[116:119], v[244:247], v[216:219], v[116:119]
  v_mfma_f32_16x16x32_bf16 v[140:143], v[244:247], v[220:223], v[140:143]
  v_mfma_f32_16x16x32_bf16 v[164:167], v[244:247], v[224:227], v[164:167]
  v_mfma_f32_16x16x32_bf16 v[188:191], v[244:247], v[228:231], v[188:191]
  ds_read_b64_tr_b16 v[244:245], v6 offset:2048
  ds_read_b64_tr_b16 v[246:247], v6 offset:2560
  v_mfma_f32_16x16x32_bf16 v[120:123], v[216:219], v[248:251], v[120:123]
  v_mfma_f32_16x16x32_bf16 v[144:147], v[220:223], v[248:251], v[144:147]
  v_mfma_f32_16x16x32_bf16 v[168:171], v[224:227], v[248:251], v[168:171]
  v_mfma_f32_16x16x32_bf16 v[192:195], v[228:231], v[248:251], v[192:195]
  ds_read_b64_tr_b16 v[248:249], v5 offset:4096
  ds_read_b64_tr_b16 v[250:251], v5 offset:4608
  v_mfma_f32_16x16x32_bf16 v[124:127], v[216:219], v[252:255], v[124:127]
  v_mfma_f32_16x16x32_bf16 v[148:151], v[220:223], v[252:255], v[148:151]
  v_mfma_f32_16x16x32_bf16 v[172:175], v[224:227], v[252:255], v[172:175]
  v_mfma_f32_16x16x32_bf16 v[196:199], v[228:231], v[252:255], v[196:199]
  ds_read_b64_tr_b16 v[252:253], v6 offset:4096
  ds_read_b64_tr_b16 v[254:255], v6 offset:4608
  v_mfma_f32_16x16x32_bf16 v[104:107], v[232:235], v[216:219], v[104:107]
  v_mfma_f32_16x16x32_bf16 v[128:131], v[232:235], v[220:223], v[128:131]
  v_mfma_f32_16x16x32_bf16 v[152:155], v[232:235], v[224:227], v[152:155]
  v_mfma_f32_16x16x32_bf16 v[176:179], v[232:235], v[228:231], v[176:179]
  ds_read_b64_tr_b16 v[232:233], v5 offset:0
  ds_read_b64_tr_b16 v[234:235], v5 offset:512
  v_mfma_f32_16x16x32_bf16 v[108:111], v[236:239], v[216:219], v[108:111]
  v_mfma_f32_16x16x32_bf16 v[132:135], v[236:239], v[220:223], v[132:135]
  v_mfma_f32_16x16x32_bf16 v[156:159], v[236:239], v[224:227], v[156:159]
  v_mfma_f32_16x16x32_bf16 v[180:183], v[236:239], v[228:231], v[180:183]
  ds_read_b64_tr_b16 v[236:237], v6 offset:0
  ds_read_b64_tr_b16 v[238:239], v6 offset:512
  v_mfma_f32_16x16x32_bf16 v[112:115], v[240:243], v[216:219], v[112:115]
  ds_read_b128 v[216:219], v2 offset:8192
  v_mfma_f32_16x16x32_bf16 v[136:139], v[240:243], v[220:223], v[136:139]
  ds_read_b128 v[220:223], v2 offset:10240
  v_mfma_f32_16x16x32_bf16 v[160:163], v[240:243], v[224:227], v[160:163]
  ds_read_b128 v[224:227], v2 offset:12288
  v_mfma_f32_16x16x32_bf16 v[184:187], v[240:243], v[228:231], v[184:187]
  ds_read_b128 v[228:231], v2 offset:14336
  ds_read_b64_tr_b16 v[240:241], v5 offset:2048
  ds_read_b64_tr_b16 v[242:243], v5 offset:2560
  s_waitcnt lgkmcnt(14)
  v_mfma_f32_16x16x32_bf16 v[20:23], v[244:247], v[200:203], v[20:23]
  s_waitcnt lgkmcnt(12)
  v_mfma_f32_16x16x32_bf16 v[24:27], v[200:203], v[248:251], v[24:27]
  s_waitcnt lgkmcnt(10)
  v_mfma_f32_16x16x32_bf16 v[28:31], v[200:203], v[252:255], v[28:31]
  v_mfma_f32_16x16x32_bf16 v[44:47], v[244:247], v[204:207], v[44:47]
  v_mfma_f32_16x16x32_bf16 v[48:51], v[204:207], v[248:251], v[48:51]
  v_mfma_f32_16x16x32_bf16 v[52:55], v[204:207], v[252:255], v[52:55]
  v_mfma_f32_16x16x32_bf16 v[68:71], v[244:247], v[208:211], v[68:71]
  v_mfma_f32_16x16x32_bf16 v[72:75], v[208:211], v[248:251], v[72:75]
  v_mfma_f32_16x16x32_bf16 v[76:79], v[208:211], v[252:255], v[76:79]
  v_mfma_f32_16x16x32_bf16 v[92:95], v[244:247], v[212:215], v[92:95]
  v_mfma_f32_16x16x32_bf16 v[96:99], v[212:215], v[248:251], v[96:99]
  v_mfma_f32_16x16x32_bf16 v[100:103], v[212:215], v[252:255], v[100:103]
  s_waitcnt lgkmcnt(8)
  v_mfma_f32_16x16x32_bf16 v[8:11], v[232:235], v[200:203], v[8:11]
  s_waitcnt lgkmcnt(6)
  v_mfma_f32_16x16x32_bf16 v[12:15], v[236:239], v[200:203], v[12:15]
  s_waitcnt lgkmcnt(0)
  v_mfma_f32_16x16x32_bf16 v[16:19], v[240:243], v[200:203], v[16:19]
  s_waitcnt lgkmcnt(0)
  s_barrier
  ds_read_b128 v[200:203], v1 offset:32768
  v_mfma_f32_16x16x32_bf16 v[32:35], v[232:235], v[204:207], v[32:35]
  v_mfma_f32_16x16x32_bf16 v[36:39], v[236:239], v[204:207], v[36:39]
  v_mfma_f32_16x16x32_bf16 v[40:43], v[240:243], v[204:207], v[40:43]
  ds_read_b128 v[204:207], v1 offset:34816
  v_mfma_f32_16x16x32_bf16 v[56:59], v[232:235], v[208:211], v[56:59]
  v_mfma_f32_16x16x32_bf16 v[60:63], v[236:239], v[208:211], v[60:63]
  v_mfma_f32_16x16x32_bf16 v[64:67], v[240:243], v[208:211], v[64:67]
  ds_read_b128 v[208:211], v1 offset:36864
  v_mfma_f32_16x16x32_bf16 v[80:83], v[232:235], v[212:215], v[80:83]
  v_mfma_f32_16x16x32_bf16 v[84:87], v[236:239], v[212:215], v[84:87]
  v_mfma_f32_16x16x32_bf16 v[88:91], v[240:243], v[212:215], v[88:91]
  ds_read_b128 v[212:215], v1 offset:38912
  v_mfma_f32_16x16x32_bf16 v[104:107], v[232:235], v[216:219], v[104:107]
  v_mfma_f32_16x16x32_bf16 v[128:131], v[232:235], v[220:223], v[128:131]
  v_mfma_f32_16x16x32_bf16 v[152:155], v[232:235], v[224:227], v[152:155]
  v_mfma_f32_16x16x32_bf16 v[176:179], v[232:235], v[228:231], v[176:179]
  ds_read_b64_tr_b16 v[232:233], v5 offset:12288
  ds_read_b64_tr_b16 v[234:235], v5 offset:12800
  v_mfma_f32_16x16x32_bf16 v[108:111], v[236:239], v[216:219], v[108:111]
  v_mfma_f32_16x16x32_bf16 v[132:135], v[236:239], v[220:223], v[132:135]
  v_mfma_f32_16x16x32_bf16 v[156:159], v[236:239], v[224:227], v[156:159]
  v_mfma_f32_16x16x32_bf16 v[180:183], v[236:239], v[228:231], v[180:183]
  ds_read_b64_tr_b16 v[236:237], v6 offset:12288
  ds_read_b64_tr_b16 v[238:239], v6 offset:12800
  v_mfma_f32_16x16x32_bf16 v[112:115], v[240:243], v[216:219], v[112:115]
  v_mfma_f32_16x16x32_bf16 v[136:139], v[240:243], v[220:223], v[136:139]
  v_mfma_f32_16x16x32_bf16 v[160:163], v[240:243], v[224:227], v[160:163]
  v_mfma_f32_16x16x32_bf16 v[184:187], v[240:243], v[228:231], v[184:187]
  ds_read_b64_tr_b16 v[240:241], v5 offset:14336
  ds_read_b64_tr_b16 v[242:243], v5 offset:14848
  v_mfma_f32_16x16x32_bf16 v[116:119], v[244:247], v[216:219], v[116:119]
  v_mfma_f32_16x16x32_bf16 v[140:143], v[244:247], v[220:223], v[140:143]
  v_mfma_f32_16x16x32_bf16 v[164:167], v[244:247], v[224:227], v[164:167]
  v_mfma_f32_16x16x32_bf16 v[188:191], v[244:247], v[228:231], v[188:191]
  ds_read_b64_tr_b16 v[244:245], v6 offset:14336
  ds_read_b64_tr_b16 v[246:247], v6 offset:14848
  v_mfma_f32_16x16x32_bf16 v[120:123], v[216:219], v[248:251], v[120:123]
  v_mfma_f32_16x16x32_bf16 v[144:147], v[220:223], v[248:251], v[144:147]
  v_mfma_f32_16x16x32_bf16 v[168:171], v[224:227], v[248:251], v[168:171]
  v_mfma_f32_16x16x32_bf16 v[192:195], v[228:231], v[248:251], v[192:195]
  ds_read_b64_tr_b16 v[248:249], v5 offset:16384
  ds_read_b64_tr_b16 v[250:251], v5 offset:16896
  v_mfma_f32_16x16x32_bf16 v[124:127], v[216:219], v[252:255], v[124:127]
  ds_read_b128 v[216:219], v1 offset:40960
  v_mfma_f32_16x16x32_bf16 v[148:151], v[220:223], v[252:255], v[148:151]
  ds_read_b128 v[220:223], v1 offset:43008
  v_mfma_f32_16x16x32_bf16 v[172:175], v[224:227], v[252:255], v[172:175]
  ds_read_b128 v[224:227], v1 offset:45056
  v_mfma_f32_16x16x32_bf16 v[196:199], v[228:231], v[252:255], v[196:199]
  ds_read_b128 v[228:231], v1 offset:47104
  ds_read_b64_tr_b16 v[252:253], v6 offset:16384
  ds_read_b64_tr_b16 v[254:255], v6 offset:16896
  s_waitcnt lgkmcnt(14)
  v_mfma_f32_16x16x32_bf16 v[8:11], v[232:235], v[200:203], v[8:11]
  s_waitcnt lgkmcnt(12)
  v_mfma_f32_16x16x32_bf16 v[12:15], v[236:239], v[200:203], v[12:15]
  s_waitcnt lgkmcnt(10)
  v_mfma_f32_16x16x32_bf16 v[16:19], v[240:243], v[200:203], v[16:19]
  v_mfma_f32_16x16x32_bf16 v[32:35], v[232:235], v[204:207], v[32:35]
  v_mfma_f32_16x16x32_bf16 v[36:39], v[236:239], v[204:207], v[36:39]
  v_mfma_f32_16x16x32_bf16 v[40:43], v[240:243], v[204:207], v[40:43]
  v_mfma_f32_16x16x32_bf16 v[56:59], v[232:235], v[208:211], v[56:59]
  v_mfma_f32_16x16x32_bf16 v[60:63], v[236:239], v[208:211], v[60:63]
  v_mfma_f32_16x16x32_bf16 v[64:67], v[240:243], v[208:211], v[64:67]
  v_mfma_f32_16x16x32_bf16 v[80:83], v[232:235], v[212:215], v[80:83]
  v_mfma_f32_16x16x32_bf16 v[84:87], v[236:239], v[212:215], v[84:87]
  v_mfma_f32_16x16x32_bf16 v[88:91], v[240:243], v[212:215], v[88:91]
  s_waitcnt lgkmcnt(8)
  v_mfma_f32_16x16x32_bf16 v[20:23], v[244:247], v[200:203], v[20:23]
  s_waitcnt lgkmcnt(6)
  v_mfma_f32_16x16x32_bf16 v[24:27], v[200:203], v[248:251], v[24:27]
  s_waitcnt lgkmcnt(0)
  v_mfma_f32_16x16x32_bf16 v[28:31], v[200:203], v[252:255], v[28:31]
  ds_read_b128 v[200:203], v2 offset:32768
  v_mfma_f32_16x16x32_bf16 v[44:47], v[244:247], v[204:207], v[44:47]
  v_mfma_f32_16x16x32_bf16 v[48:51], v[204:207], v[248:251], v[48:51]
  v_mfma_f32_16x16x32_bf16 v[52:55], v[204:207], v[252:255], v[52:55]
  ds_read_b128 v[204:207], v2 offset:34816
  v_mfma_f32_16x16x32_bf16 v[68:71], v[244:247], v[208:211], v[68:71]
  v_mfma_f32_16x16x32_bf16 v[72:75], v[208:211], v[248:251], v[72:75]
  v_mfma_f32_16x16x32_bf16 v[76:79], v[208:211], v[252:255], v[76:79]
  ds_read_b128 v[208:211], v2 offset:36864
  v_mfma_f32_16x16x32_bf16 v[92:95], v[244:247], v[212:215], v[92:95]
  v_mfma_f32_16x16x32_bf16 v[96:99], v[212:215], v[248:251], v[96:99]
  v_mfma_f32_16x16x32_bf16 v[100:103], v[212:215], v[252:255], v[100:103]
  ds_read_b128 v[212:215], v2 offset:38912
  v_mfma_f32_16x16x32_bf16 v[116:119], v[244:247], v[216:219], v[116:119]
  v_mfma_f32_16x16x32_bf16 v[140:143], v[244:247], v[220:223], v[140:143]
  v_mfma_f32_16x16x32_bf16 v[164:167], v[244:247], v[224:227], v[164:167]
  v_mfma_f32_16x16x32_bf16 v[188:191], v[244:247], v[228:231], v[188:191]
  ds_read_b64_tr_b16 v[244:245], v6 offset:26624
  ds_read_b64_tr_b16 v[246:247], v6 offset:27136
  v_mfma_f32_16x16x32_bf16 v[120:123], v[216:219], v[248:251], v[120:123]
  v_mfma_f32_16x16x32_bf16 v[144:147], v[220:223], v[248:251], v[144:147]
  v_mfma_f32_16x16x32_bf16 v[168:171], v[224:227], v[248:251], v[168:171]
  v_mfma_f32_16x16x32_bf16 v[192:195], v[228:231], v[248:251], v[192:195]
  ds_read_b64_tr_b16 v[248:249], v5 offset:28672
  ds_read_b64_tr_b16 v[250:251], v5 offset:29184
  v_mfma_f32_16x16x32_bf16 v[124:127], v[216:219], v[252:255], v[124:127]
  v_mfma_f32_16x16x32_bf16 v[148:151], v[220:223], v[252:255], v[148:151]
  v_mfma_f32_16x16x32_bf16 v[172:175], v[224:227], v[252:255], v[172:175]
  v_mfma_f32_16x16x32_bf16 v[196:199], v[228:231], v[252:255], v[196:199]
  ds_read_b64_tr_b16 v[252:253], v6 offset:28672
  ds_read_b64_tr_b16 v[254:255], v6 offset:29184
  v_mfma_f32_16x16x32_bf16 v[104:107], v[232:235], v[216:219], v[104:107]
  v_mfma_f32_16x16x32_bf16 v[128:131], v[232:235], v[220:223], v[128:131]
  v_mfma_f32_16x16x32_bf16 v[152:155], v[232:235], v[224:227], v[152:155]
  v_mfma_f32_16x16x32_bf16 v[176:179], v[232:235], v[228:231], v[176:179]
  ds_read_b64_tr_b16 v[232:233], v5 offset:24576
  ds_read_b64_tr_b16 v[234:235], v5 offset:25088
  v_mfma_f32_16x16x32_bf16 v[108:111], v[236:239], v[216:219], v[108:111]
  v_mfma_f32_16x16x32_bf16 v[132:135], v[236:239], v[220:223], v[132:135]
  v_mfma_f32_16x16x32_bf16 v[156:159], v[236:239], v[224:227], v[156:159]
  v_mfma_f32_16x16x32_bf16 v[180:183], v[236:239], v[228:231], v[180:183]
  ds_read_b64_tr_b16 v[236:237], v6 offset:24576
  ds_read_b64_tr_b16 v[238:239], v6 offset:25088
  v_mfma_f32_16x16x32_bf16 v[112:115], v[240:243], v[216:219], v[112:115]
  ds_read_b128 v[216:219], v2 offset:40960
  v_mfma_f32_16x16x32_bf16 v[136:139], v[240:243], v[220:223], v[136:139]
  ds_read_b128 v[220:223], v2 offset:43008
  v_mfma_f32_16x16x32_bf16 v[160:163], v[240:243], v[224:227], v[160:163]
  ds_read_b128 v[224:227], v2 offset:45056
  v_mfma_f32_16x16x32_bf16 v[184:187], v[240:243], v[228:231], v[184:187]
  ds_read_b128 v[228:231], v2 offset:47104
  ds_read_b64_tr_b16 v[240:241], v5 offset:26624
  ds_read_b64_tr_b16 v[242:243], v5 offset:27136
  s_waitcnt lgkmcnt(14)
  v_mfma_f32_16x16x32_bf16 v[20:23], v[244:247], v[200:203], v[20:23]
  s_waitcnt lgkmcnt(12)
  v_mfma_f32_16x16x32_bf16 v[24:27], v[200:203], v[248:251], v[24:27]
  s_waitcnt lgkmcnt(10)
  v_mfma_f32_16x16x32_bf16 v[28:31], v[200:203], v[252:255], v[28:31]
  v_mfma_f32_16x16x32_bf16 v[44:47], v[244:247], v[204:207], v[44:47]
  v_mfma_f32_16x16x32_bf16 v[48:51], v[204:207], v[248:251], v[48:51]
  v_mfma_f32_16x16x32_bf16 v[52:55], v[204:207], v[252:255], v[52:55]
  v_mfma_f32_16x16x32_bf16 v[68:71], v[244:247], v[208:211], v[68:71]
  v_mfma_f32_16x16x32_bf16 v[72:75], v[208:211], v[248:251], v[72:75]
  v_mfma_f32_16x16x32_bf16 v[76:79], v[208:211], v[252:255], v[76:79]
  v_mfma_f32_16x16x32_bf16 v[92:95], v[244:247], v[212:215], v[92:95]
  v_mfma_f32_16x16x32_bf16 v[96:99], v[212:215], v[248:251], v[96:99]
  v_mfma_f32_16x16x32_bf16 v[100:103], v[212:215], v[252:255], v[100:103]
  s_waitcnt lgkmcnt(8)
  v_mfma_f32_16x16x32_bf16 v[8:11], v[232:235], v[200:203], v[8:11]
  s_waitcnt lgkmcnt(6)
  v_mfma_f32_16x16x32_bf16 v[12:15], v[236:239], v[200:203], v[12:15]
  s_waitcnt lgkmcnt(0)
  v_mfma_f32_16x16x32_bf16 v[16:19], v[240:243], v[200:203], v[16:19]
  s_waitcnt lgkmcnt(0)
  s_barrier
  ds_read_b128 v[200:203], v3 offset:0
  v_mfma_f32_16x16x32_bf16 v[32:35], v[232:235], v[204:207], v[32:35]
  v_mfma_f32_16x16x32_bf16 v[36:39], v[236:239], v[204:207], v[36:39]
  v_mfma_f32_16x16x32_bf16 v[40:43], v[240:243], v[204:207], v[40:43]
  ds_read_b128 v[204:207], v3 offset:2048
  v_mfma_f32_16x16x32_bf16 v[56:59], v[232:235], v[208:211], v[56:59]
  v_mfma_f32_16x16x32_bf16 v[60:63], v[236:239], v[208:211], v[60:63]
  v_mfma_f32_16x16x32_bf16 v[64:67], v[240:243], v[208:211], v[64:67]
  ds_read_b128 v[208:211], v3 offset:4096
  v_mfma_f32_16x16x32_bf16 v[80:83], v[232:235], v[212:215], v[80:83]
  v_mfma_f32_16x16x32_bf16 v[84:87], v[236:239], v[212:215], v[84:87]
  v_mfma_f32_16x16x32_bf16 v[88:91], v[240:243], v[212:215], v[88:91]
  ds_read_b128 v[212:215], v3 offset:6144
  v_mfma_f32_16x16x32_bf16 v[104:107], v[232:235], v[216:219], v[104:107]
  v_mfma_f32_16x16x32_bf16 v[128:131], v[232:235], v[220:223], v[128:131]
  v_mfma_f32_16x16x32_bf16 v[152:155], v[232:235], v[224:227], v[152:155]
  v_mfma_f32_16x16x32_bf16 v[176:179], v[232:235], v[228:231], v[176:179]
  ds_read_b64_tr_b16 v[232:233], v5 offset:36864
  ds_read_b64_tr_b16 v[234:235], v5 offset:37376
  v_mfma_f32_16x16x32_bf16 v[108:111], v[236:239], v[216:219], v[108:111]
  v_mfma_f32_16x16x32_bf16 v[132:135], v[236:239], v[220:223], v[132:135]
  v_mfma_f32_16x16x32_bf16 v[156:159], v[236:239], v[224:227], v[156:159]
  v_mfma_f32_16x16x32_bf16 v[180:183], v[236:239], v[228:231], v[180:183]
  ds_read_b64_tr_b16 v[236:237], v6 offset:36864
  ds_read_b64_tr_b16 v[238:239], v6 offset:37376
  v_mfma_f32_16x16x32_bf16 v[112:115], v[240:243], v[216:219], v[112:115]
  v_mfma_f32_16x16x32_bf16 v[136:139], v[240:243], v[220:223], v[136:139]
  v_mfma_f32_16x16x32_bf16 v[160:163], v[240:243], v[224:227], v[160:163]
  v_mfma_f32_16x16x32_bf16 v[184:187], v[240:243], v[228:231], v[184:187]
  ds_read_b64_tr_b16 v[240:241], v5 offset:38912
  ds_read_b64_tr_b16 v[242:243], v5 offset:39424
  v_mfma_f32_16x16x32_bf16 v[116:119], v[244:247], v[216:219], v[116:119]
  v_mfma_f32_16x16x32_bf16 v[140:143], v[244:247], v[220:223], v[140:143]
  v_mfma_f32_16x16x32_bf16 v[164:167], v[244:247], v[224:227], v[164:167]
  v_mfma_f32_16x16x32_bf16 v[188:191], v[244:247], v[228:231], v[188:191]
  ds_read_b64_tr_b16 v[244:245], v6 offset:38912
  ds_read_b64_tr_b16 v[246:247], v6 offset:39424
  v_mfma_f32_16x16x32_bf16 v[120:123], v[216:219], v[248:251], v[120:123]
  v_mfma_f32_16x16x32_bf16 v[144:147], v[220:223], v[248:251], v[144:147]
  v_mfma_f32_16x16x32_bf16 v[168:171], v[224:227], v[248:251], v[168:171]
  v_mfma_f32_16x16x32_bf16 v[192:195], v[228:231], v[248:251], v[192:195]
  ds_read_b64_tr_b16 v[248:249], v5 offset:40960
  ds_read_b64_tr_b16 v[250:251], v5 offset:41472
  v_mfma_f32_16x16x32_bf16 v[124:127], v[216:219], v[252:255], v[124:127]
  ds_read_b128 v[216:219], v3 offset:8192
  v_mfma_f32_16x16x32_bf16 v[148:151], v[220:223], v[252:255], v[148:151]
  ds_read_b128 v[220:223], v3 offset:10240
  v_mfma_f32_16x16x32_bf16 v[172:175], v[224:227], v[252:255], v[172:175]
  ds_read_b128 v[224:227], v3 offset:12288
  v_mfma_f32_16x16x32_bf16 v[196:199], v[228:231], v[252:255], v[196:199]
  ds_read_b128 v[228:231], v3 offset:14336
  ds_read_b64_tr_b16 v[252:253], v6 offset:40960
  ds_read_b64_tr_b16 v[254:255], v6 offset:41472
  s_waitcnt lgkmcnt(14)
  v_mfma_f32_16x16x32_bf16 v[8:11], v[232:235], v[200:203], v[8:11]
  s_waitcnt lgkmcnt(12)
  v_mfma_f32_16x16x32_bf16 v[12:15], v[236:239], v[200:203], v[12:15]
  s_waitcnt lgkmcnt(10)
  v_mfma_f32_16x16x32_bf16 v[16:19], v[240:243], v[200:203], v[16:19]
  v_mfma_f32_16x16x32_bf16 v[32:35], v[232:235], v[204:207], v[32:35]
  v_mfma_f32_16x16x32_bf16 v[36:39], v[236:239], v[204:207], v[36:39]
  v_mfma_f32_16x16x32_bf16 v[40:43], v[240:243], v[204:207], v[40:43]
  v_mfma_f32_16x16x32_bf16 v[56:59], v[232:235], v[208:211], v[56:59]
  v_mfma_f32_16x16x32_bf16 v[60:63], v[236:239], v[208:211], v[60:63]
  v_mfma_f32_16x16x32_bf16 v[64:67], v[240:243], v[208:211], v[64:67]
  v_mfma_f32_16x16x32_bf16 v[80:83], v[232:235], v[212:215], v[80:83]
  v_mfma_f32_16x16x32_bf16 v[84:87], v[236:239], v[212:215], v[84:87]
  v_mfma_f32_16x16x32_bf16 v[88:91], v[240:243], v[212:215], v[88:91]
  s_waitcnt lgkmcnt(8)
  v_mfma_f32_16x16x32_bf16 v[20:23], v[244:247], v[200:203], v[20:23]
  s_waitcnt lgkmcnt(6)
  v_mfma_f32_16x16x32_bf16 v[24:27], v[200:203], v[248:251], v[24:27]
  s_waitcnt lgkmcnt(0)
  v_mfma_f32_16x16x32_bf16 v[28:31], v[200:203], v[252:255], v[28:31]
  ds_read_b128 v[200:203], v4 offset:0
  v_mfma_f32_16x16x32_bf16 v[44:47], v[244:247], v[204:207], v[44:47]
  v_mfma_f32_16x16x32_bf16 v[48:51], v[204:207], v[248:251], v[48:51]
  v_mfma_f32_16x16x32_bf16 v[52:55], v[204:207], v[252:255], v[52:55]
  ds_read_b128 v[204:207], v4 offset:2048
  v_mfma_f32_16x16x32_bf16 v[68:71], v[244:247], v[208:211], v[68:71]
  v_mfma_f32_16x16x32_bf16 v[72:75], v[208:211], v[248:251], v[72:75]
  v_mfma_f32_16x16x32_bf16 v[76:79], v[208:211], v[252:255], v[76:79]
  ds_read_b128 v[208:211], v4 offset:4096
  v_mfma_f32_16x16x32_bf16 v[92:95], v[244:247], v[212:215], v[92:95]
  v_mfma_f32_16x16x32_bf16 v[96:99], v[212:215], v[248:251], v[96:99]
  v_mfma_f32_16x16x32_bf16 v[100:103], v[212:215], v[252:255], v[100:103]
  ds_read_b128 v[212:215], v4 offset:6144
  v_mfma_f32_16x16x32_bf16 v[116:119], v[244:247], v[216:219], v[116:119]
  v_mfma_f32_16x16x32_bf16 v[140:143], v[244:247], v[220:223], v[140:143]
  v_mfma_f32_16x16x32_bf16 v[164:167], v[244:247], v[224:227], v[164:167]
  v_mfma_f32_16x16x32_bf16 v[188:191], v[244:247], v[228:231], v[188:191]
  ds_read_b64_tr_b16 v[244:245], v6 offset:51200
  ds_read_b64_tr_b16 v[246:247], v6 offset:51712
  v_mfma_f32_16x16x32_bf16 v[120:123], v[216:219], v[248:251], v[120:123]
  v_mfma_f32_16x16x32_bf16 v[144:147], v[220:223], v[248:251], v[144:147]
  v_mfma_f32_16x16x32_bf16 v[168:171], v[224:227], v[248:251], v[168:171]
  v_mfma_f32_16x16x32_bf16 v[192:195], v[228:231], v[248:251], v[192:195]
  ds_read_b64_tr_b16 v[248:249], v5 offset:53248
  ds_read_b64_tr_b16 v[250:251], v5 offset:53760
  v_mfma_f32_16x16x32_bf16 v[124:127], v[216:219], v[252:255], v[124:127]
  v_mfma_f32_16x16x32_bf16 v[148:151], v[220:223], v[252:255], v[148:151]
  v_mfma_f32_16x16x32_bf16 v[172:175], v[224:227], v[252:255], v[172:175]
  v_mfma_f32_16x16x32_bf16 v[196:199], v[228:231], v[252:255], v[196:199]
  ds_read_b64_tr_b16 v[252:253], v6 offset:53248
  ds_read_b64_tr_b16 v[254:255], v6 offset:53760
  v_mfma_f32_16x16x32_bf16 v[104:107], v[232:235], v[216:219], v[104:107]
  v_mfma_f32_16x16x32_bf16 v[128:131], v[232:235], v[220:223], v[128:131]
  v_mfma_f32_16x16x32_bf16 v[152:155], v[232:235], v[224:227], v[152:155]
  v_mfma_f32_16x16x32_bf16 v[176:179], v[232:235], v[228:231], v[176:179]
  ds_read_b64_tr_b16 v[232:233], v5 offset:49152
  ds_read_b64_tr_b16 v[234:235], v5 offset:49664
  v_mfma_f32_16x16x32_bf16 v[108:111], v[236:239], v[216:219], v[108:111]
  v_mfma_f32_16x16x32_bf16 v[132:135], v[236:239], v[220:223], v[132:135]
  v_mfma_f32_16x16x32_bf16 v[156:159], v[236:239], v[224:227], v[156:159]
  v_mfma_f32_16x16x32_bf16 v[180:183], v[236:239], v[228:231], v[180:183]
  ds_read_b64_tr_b16 v[236:237], v6 offset:49152
  ds_read_b64_tr_b16 v[238:239], v6 offset:49664
  v_mfma_f32_16x16x32_bf16 v[112:115], v[240:243], v[216:219], v[112:115]
  ds_read_b128 v[216:219], v4 offset:8192
  v_mfma_f32_16x16x32_bf16 v[136:139], v[240:243], v[220:223], v[136:139]
  ds_read_b128 v[220:223], v4 offset:10240
  v_mfma_f32_16x16x32_bf16 v[160:163], v[240:243], v[224:227], v[160:163]
  ds_read_b128 v[224:227], v4 offset:12288
  v_mfma_f32_16x16x32_bf16 v[184:187], v[240:243], v[228:231], v[184:187]
  ds_read_b128 v[228:231], v4 offset:14336
  ds_read_b64_tr_b16 v[240:241], v5 offset:51200
  ds_read_b64_tr_b16 v[242:243], v5 offset:51712
  s_waitcnt lgkmcnt(14)
  v_mfma_f32_16x16x32_bf16 v[20:23], v[244:247], v[200:203], v[20:23]
  s_waitcnt lgkmcnt(12)
  v_mfma_f32_16x16x32_bf16 v[24:27], v[200:203], v[248:251], v[24:27]
  s_waitcnt lgkmcnt(10)
  v_mfma_f32_16x16x32_bf16 v[28:31], v[200:203], v[252:255], v[28:31]
  v_mfma_f32_16x16x32_bf16 v[44:47], v[244:247], v[204:207], v[44:47]
  v_mfma_f32_16x16x32_bf16 v[48:51], v[204:207], v[248:251], v[48:51]
  v_mfma_f32_16x16x32_bf16 v[52:55], v[204:207], v[252:255], v[52:55]
  v_mfma_f32_16x16x32_bf16 v[68:71], v[244:247], v[208:211], v[68:71]
  v_mfma_f32_16x16x32_bf16 v[72:75], v[208:211], v[248:251], v[72:75]
  v_mfma_f32_16x16x32_bf16 v[76:79], v[208:211], v[252:255], v[76:79]
  v_mfma_f32_16x16x32_bf16 v[92:95], v[244:247], v[212:215], v[92:95]
  v_mfma_f32_16x16x32_bf16 v[96:99], v[212:215], v[248:251], v[96:99]
  v_mfma_f32_16x16x32_bf16 v[100:103], v[212:215], v[252:255], v[100:103]
  s_waitcnt lgkmcnt(8)
  v_mfma_f32_16x16x32_bf16 v[8:11], v[232:235], v[200:203], v[8:11]
  s_waitcnt lgkmcnt(6)
  v_mfma_f32_16x16x32_bf16 v[12:15], v[236:239], v[200:203], v[12:15]
  s_waitcnt lgkmcnt(0)
  v_mfma_f32_16x16x32_bf16 v[16:19], v[240:243], v[200:203], v[16:19]
  s_waitcnt lgkmcnt(0)
  s_barrier
  ds_read_b128 v[200:203], v1 offset:0
  v_mfma_f32_16x16x32_bf16 v[32:35], v[232:235], v[204:207], v[32:35]
  v_mfma_f32_16x16x32_bf16 v[36:39], v[236:239], v[204:207], v[36:39]
  v_mfma_f32_16x16x32_bf16 v[40:43], v[240:243], v[204:207], v[40:43]
  ds_read_b128 v[204:207], v1 offset:2048
  v_mfma_f32_16x16x32_bf16 v[56:59], v[232:235], v[208:211], v[56:59]
  v_mfma_f32_16x16x32_bf16 v[60:63], v[236:239], v[208:211], v[60:63]
  v_mfma_f32_16x16x32_bf16 v[64:67], v[240:243], v[208:211], v[64:67]
  ds_read_b128 v[208:211], v1 offset:4096
  v_mfma_f32_16x16x32_bf16 v[80:83], v[232:235], v[212:215], v[80:83]
  v_mfma_f32_16x16x32_bf16 v[84:87], v[236:239], v[212:215], v[84:87]
  v_mfma_f32_16x16x32_bf16 v[88:91], v[240:243], v[212:215], v[88:91]
  ds_read_b128 v[212:215], v1 offset:6144
  v_mfma_f32_16x16x32_bf16 v[104:107], v[232:235], v[216:219], v[104:107]
  v_mfma_f32_16x16x32_bf16 v[128:131], v[232:235], v[220:223], v[128:131]
  v_mfma_f32_16x16x32_bf16 v[152:155], v[232:235], v[224:227], v[152:155]
  v_mfma_f32_16x16x32_bf16 v[176:179], v[232:235], v[228:231], v[176:179]
  ds_read_b64_tr_b16 v[232:233], v5 offset:0
  ds_read_b64_tr_b16 v[234:235], v5 offset:512
  v_mfma_f32_16x16x32_bf16 v[108:111], v[236:239], v[216:219], v[108:111]
  v_mfma_f32_16x16x32_bf16 v[132:135], v[236:239], v[220:223], v[132:135]
  v_mfma_f32_16x16x32_bf16 v[156:159], v[236:239], v[224:227], v[156:159]
  v_mfma_f32_16x16x32_bf16 v[180:183], v[236:239], v[228:231], v[180:183]
  ds_read_b64_tr_b16 v[236:237], v6 offset:0
  ds_read_b64_tr_b16 v[238:239], v6 offset:512
  v_mfma_f32_16x16x32_bf16 v[112:115], v[240:243], v[216:219], v[112:115]
  v_mfma_f32_16x16x32_bf16 v[136:139], v[240:243], v[220:223], v[136:139]
  v_mfma_f32_16x16x32_bf16 v[160:163], v[240:243], v[224:227], v[160:163]
  v_mfma_f32_16x16x32_bf16 v[184:187], v[240:243], v[228:231], v[184:187]
  ds_read_b64_tr_b16 v[240:241], v5 offset:2048
  ds_read_b64_tr_b16 v[242:243], v5 offset:2560
  v_mfma_f32_16x16x32_bf16 v[116:119], v[244:247], v[216:219], v[116:119]
  v_mfma_f32_16x16x32_bf16 v[140:143], v[244:247], v[220:223], v[140:143]
  v_mfma_f32_16x16x32_bf16 v[164:167], v[244:247], v[224:227], v[164:167]
  v_mfma_f32_16x16x32_bf16 v[188:191], v[244:247], v[228:231], v[188:191]
  ds_read_b64_tr_b16 v[244:245], v6 offset:2048
  ds_read_b64_tr_b16 v[246:247], v6 offset:2560
  v_mfma_f32_16x16x32_bf16 v[120:123], v[216:219], v[248:251], v[120:123]
  v_mfma_f32_16x16x32_bf16 v[144:147], v[220:223], v[248:251], v[144:147]
  v_mfma_f32_16x16x32_bf16 v[168:171], v[224:227], v[248:251], v[168:171]
  v_mfma_f32_16x16x32_bf16 v[192:195], v[228:231], v[248:251], v[192:195]
  ds_read_b64_tr_b16 v[248:249], v5 offset:4096
  ds_read_b64_tr_b16 v[250:251], v5 offset:4608
  v_mfma_f32_16x16x32_bf16 v[124:127], v[216:219], v[252:255], v[124:127]
  ds_read_b128 v[216:219], v1 offset:8192
  v_mfma_f32_16x16x32_bf16 v[148:151], v[220:223], v[252:255], v[148:151]
  ds_read_b128 v[220:223], v1 offset:10240
  v_mfma_f32_16x16x32_bf16 v[172:175], v[224:227], v[252:255], v[172:175]
  ds_read_b128 v[224:227], v1 offset:12288
  v_mfma_f32_16x16x32_bf16 v[196:199], v[228:231], v[252:255], v[196:199]
  ds_read_b128 v[228:231], v1 offset:14336
  ds_read_b64_tr_b16 v[252:253], v6 offset:4096
  ds_read_b64_tr_b16 v[254:255], v6 offset:4608
  s_waitcnt lgkmcnt(14)
  v_mfma_f32_16x16x32_bf16 v[8:11], v[232:235], v[200:203], v[8:11]
  s_waitcnt lgkmcnt(12)
  v_mfma_f32_16x16x32_bf16 v[12:15], v[236:239], v[200:203], v[12:15]
  s_waitcnt lgkmcnt(10)
  v_mfma_f32_16x16x32_bf16 v[16:19], v[240:243], v[200:203], v[16:19]
  v_mfma_f32_16x16x32_bf16 v[32:35], v[232:235], v[204:207], v[32:35]
  v_mfma_f32_16x16x32_bf16 v[36:39], v[236:239], v[204:207], v[36:39]
  v_mfma_f32_16x16x32_bf16 v[40:43], v[240:243], v[204:207], v[40:43]
  v_mfma_f32_16x16x32_bf16 v[56:59], v[232:235], v[208:211], v[56:59]
  v_mfma_f32_16x16x32_bf16 v[60:63], v[236:239], v[208:211], v[60:63]
  v_mfma_f32_16x16x32_bf16 v[64:67], v[240:243], v[208:211], v[64:67]
  v_mfma_f32_16x16x32_bf16 v[80:83], v[232:235], v[212:215], v[80:83]
  v_mfma_f32_16x16x32_bf16 v[84:87], v[236:239], v[212:215], v[84:87]
  v_mfma_f32_16x16x32_bf16 v[88:91], v[240:243], v[212:215], v[88:91]
  s_waitcnt lgkmcnt(8)
  v_mfma_f32_16x16x32_bf16 v[20:23], v[244:247], v[200:203], v[20:23]
  s_waitcnt lgkmcnt(6)
  v_mfma_f32_16x16x32_bf16 v[24:27], v[200:203], v[248:251], v[24:27]
  s_waitcnt lgkmcnt(0)
  v_mfma_f32_16x16x32_bf16 v[28:31], v[200:203], v[252:255], v[28:31]
  ds_read_b128 v[200:203], v2 offset:0
  v_mfma_f32_16x16x32_bf16 v[44:47], v[244:247], v[204:207], v[44:47]
  v_mfma_f32_16x16x32_bf16 v[48:51], v[204:207], v[248:251], v[48:51]
  v_mfma_f32_16x16x32_bf16 v[52:55], v[204:207], v[252:255], v[52:55]
  ds_read_b128 v[204:207], v2 offset:2048
  v_mfma_f32_16x16x32_bf16 v[68:71], v[244:247], v[208:211], v[68:71]
  v_mfma_f32_16x16x32_bf16 v[72:75], v[208:211], v[248:251], v[72:75]
  v_mfma_f32_16x16x32_bf16 v[76:79], v[208:211], v[252:255], v[76:79]
  ds_read_b128 v[208:211], v2 offset:4096
  v_mfma_f32_16x16x32_bf16 v[92:95], v[244:247], v[212:215], v[92:95]
  v_mfma_f32_16x16x32_bf16 v[96:99], v[212:215], v[248:251], v[96:99]
  v_mfma_f32_16x16x32_bf16 v[100:103], v[212:215], v[252:255], v[100:103]
  ds_read_b128 v[212:215], v2 offset:6144
  v_mfma_f32_16x16x32_bf16 v[116:119], v[244:247], v[216:219], v[116:119]
  v_mfma_f32_16x16x32_bf16 v[140:143], v[244:247], v[220:223], v[140:143]
  v_mfma_f32_16x16x32_bf16 v[164:167], v[244:247], v[224:227], v[164:167]
  v_mfma_f32_16x16x32_bf16 v[188:191], v[244:247], v[228:231], v[188:191]
  ds_read_b64_tr_b16 v[244:245], v6 offset:14336
  ds_read_b64_tr_b16 v[246:247], v6 offset:14848
  v_mfma_f32_16x16x32_bf16 v[120:123], v[216:219], v[248:251], v[120:123]
  v_mfma_f32_16x16x32_bf16 v[144:147], v[220:223], v[248:251], v[144:147]
  v_mfma_f32_16x16x32_bf16 v[168:171], v[224:227], v[248:251], v[168:171]
  v_mfma_f32_16x16x32_bf16 v[192:195], v[228:231], v[248:251], v[192:195]
  ds_read_b64_tr_b16 v[248:249], v5 offset:16384
  ds_read_b64_tr_b16 v[250:251], v5 offset:16896
  v_mfma_f32_16x16x32_bf16 v[124:127], v[216:219], v[252:255], v[124:127]
  v_mfma_f32_16x16x32_bf16 v[148:151], v[220:223], v[252:255], v[148:151]
  v_mfma_f32_16x16x32_bf16 v[172:175], v[224:227], v[252:255], v[172:175]
  v_mfma_f32_16x16x32_bf16 v[196:199], v[228:231], v[252:255], v[196:199]
  ds_read_b64_tr_b16 v[252:253], v6 offset:16384
  ds_read_b64_tr_b16 v[254:255], v6 offset:16896
  v_mfma_f32_16x16x32_bf16 v[104:107], v[232:235], v[216:219], v[104:107]
  v_mfma_f32_16x16x32_bf16 v[128:131], v[232:235], v[220:223], v[128:131]
  v_mfma_f32_16x16x32_bf16 v[152:155], v[232:235], v[224:227], v[152:155]
  v_mfma_f32_16x16x32_bf16 v[176:179], v[232:235], v[228:231], v[176:179]
  ds_read_b64_tr_b16 v[232:233], v5 offset:12288
  ds_read_b64_tr_b16 v[234:235], v5 offset:12800
  v_mfma_f32_16x16x32_bf16 v[108:111], v[236:239], v[216:219], v[108:111]
  v_mfma_f32_16x16x32_bf16 v[132:135], v[236:239], v[220:223], v[132:135]
  v_mfma_f32_16x16x32_bf16 v[156:159], v[236:239], v[224:227], v[156:159]
  v_mfma_f32_16x16x32_bf16 v[180:183], v[236:239], v[228:231], v[180:183]
  ds_read_b64_tr_b16 v[236:237], v6 offset:12288
  ds_read_b64_tr_b16 v[238:239], v6 offset:12800
  v_mfma_f32_16x16x32_bf16 v[112:115], v[240:243], v[216:219], v[112:115]
  ds_read_b128 v[216:219], v2 offset:8192
  v_mfma_f32_16x16x32_bf16 v[136:139], v[240:243], v[220:223], v[136:139]
  ds_read_b128 v[220:223], v2 offset:10240
  v_mfma_f32_16x16x32_bf16 v[160:163], v[240:243], v[224:227], v[160:163]
  ds_read_b128 v[224:227], v2 offset:12288
  v_mfma_f32_16x16x32_bf16 v[184:187], v[240:243], v[228:231], v[184:187]
  ds_read_b128 v[228:231], v2 offset:14336
  ds_read_b64_tr_b16 v[240:241], v5 offset:14336
  ds_read_b64_tr_b16 v[242:243], v5 offset:14848
  s_waitcnt lgkmcnt(14)
  v_mfma_f32_16x16x32_bf16 v[20:23], v[244:247], v[200:203], v[20:23]
  s_waitcnt lgkmcnt(12)
  v_mfma_f32_16x16x32_bf16 v[24:27], v[200:203], v[248:251], v[24:27]
  s_waitcnt lgkmcnt(10)
  v_mfma_f32_16x16x32_bf16 v[28:31], v[200:203], v[252:255], v[28:31]
  v_mfma_f32_16x16x32_bf16 v[44:47], v[244:247], v[204:207], v[44:47]
  v_mfma_f32_16x16x32_bf16 v[48:51], v[204:207], v[248:251], v[48:51]
  v_mfma_f32_16x16x32_bf16 v[52:55], v[204:207], v[252:255], v[52:55]
  v_mfma_f32_16x16x32_bf16 v[68:71], v[244:247], v[208:211], v[68:71]
  v_mfma_f32_16x16x32_bf16 v[72:75], v[208:211], v[248:251], v[72:75]
  v_mfma_f32_16x16x32_bf16 v[76:79], v[208:211], v[252:255], v[76:79]
  v_mfma_f32_16x16x32_bf16 v[92:95], v[244:247], v[212:215], v[92:95]
  v_mfma_f32_16x16x32_bf16 v[96:99], v[212:215], v[248:251], v[96:99]
  v_mfma_f32_16x16x32_bf16 v[100:103], v[212:215], v[252:255], v[100:103]
  s_waitcnt lgkmcnt(0)
  s_waitcnt vmcnt(0)
  s_lshl_b32 s8, s13, 15
  s_lshl_b32 s9, s14, 14
  s_add_u32 s8, s8, s9
  s_lshr_b32 s10, s8, 1
  s_add_u32 s10, s10, 131072
  s_lshl_b32 s9, s7, 16
  s_add_u32 s9, s9, 8388608
  s_add_u32 s9, s9, s8
  s_add_u32 s8, s8, 32768
  s_mov_b32 s92, s44
  s_mov_b32 s93, s45
  s_cmp_eq_u32 s5, 7
  s_cselect_b32 s94, 0, s46
  s_mov_b32 s95, 0x20000
  s_cselect_b32 s34, 0, 1
  s_mov_b32 s33, 0
  v_mfma_f32_16x16x32_bf16 v[16:19], v[240:243], v[200:203], v[16:19]
  v_and_b32 v1, 15, v0
  v_lshlrev_b32 v1, 4, v1
  v_mfma_f32_16x16x32_bf16 v[40:43], v[240:243], v[204:207], v[40:43]
  v_lshrrev_b32 v2, 4, v0
  v_lshl_add_u32 v3, v2, 9, v1
  v_mfma_f32_16x16x32_bf16 v[64:67], v[240:243], v[208:211], v[64:67]
  v_and_b32 v2, 1, v2
  s_nop 0
  v_cvt_pk_bf16_f32 v16, v16, v17
  v_mfma_f32_16x16x32_bf16 v[88:91], v[240:243], v[212:215], v[88:91]
  v_cvt_pk_bf16_f32 v17, v18, v19
  v_lshl_add_u32 v4, v2, 9, v1
  v_mfma_f32_16x16x32_bf16 v[112:115], v[240:243], v[216:219], v[112:115]
  v_cvt_pk_bf16_f32 v18, v20, v21
  v_cvt_pk_bf16_f32 v19, v22, v23
  v_mfma_f32_16x16x32_bf16 v[116:119], v[244:247], v[216:219], v[116:119]
  v_add_u32 v1, s9, v3
  buffer_store_dwordx4 v[16:19], v1, s[92:95], 0 offen offset:0 sc1
  v_mfma_f32_16x16x32_bf16 v[136:139], v[240:243], v[220:223], v[136:139]
  v_cvt_pk_bf16_f32 v40, v40, v41
  v_cvt_pk_bf16_f32 v41, v42, v43
  v_mfma_f32_16x16x32_bf16 v[140:143], v[244:247], v[220:223], v[140:143]
  v_cvt_pk_bf16_f32 v42, v44, v45
  v_cvt_pk_bf16_f32 v43, v46, v47
  v_mfma_f32_16x16x32_bf16 v[160:163], v[240:243], v[224:227], v[160:163]
  v_mov_b32 v7, 122880
  ds_read_b32 v6, v7
  v_mfma_f32_16x16x32_bf16 v[164:167], v[244:247], v[224:227], v[164:167]
  buffer_store_dwordx4 v[40:43], v1, s[92:95], 0 offen offset:256 sc1
  v_add_u32 v5, s10, v3
  v_mfma_f32_16x16x32_bf16 v[184:187], v[240:243], v[228:231], v[184:187]
  v_add_u32 v3, s8, v3
  ds_write_b128 v3, v[16:19] offset:0
  v_mfma_f32_16x16x32_bf16 v[188:191], v[244:247], v[228:231], v[188:191]
  v_cvt_pk_bf16_f32 v64, v64, v65
  ds_write_b128 v3, v[40:43] offset:256
  v_mfma_f32_16x16x32_bf16 v[120:123], v[216:219], v[248:251], v[120:123]
  v_cvt_pk_bf16_f32 v65, v66, v67
  v_cvt_pk_bf16_f32 v66, v68, v69
  v_mfma_f32_16x16x32_bf16 v[124:127], v[216:219], v[252:255], v[124:127]
  v_cvt_pk_bf16_f32 v67, v70, v71
  ds_write_b128 v3, v[64:67] offset:4096
  v_mfma_f32_16x16x32_bf16 v[144:147], v[220:223], v[248:251], v[144:147]
  v_cvt_pk_bf16_f32 v88, v88, v89
  v_cvt_pk_bf16_f32 v89, v90, v91
  v_mfma_f32_16x16x32_bf16 v[148:151], v[220:223], v[252:255], v[148:151]
  v_cvt_pk_bf16_f32 v90, v92, v93
  v_cvt_pk_bf16_f32 v91, v94, v95
  ds_write_b128 v3, v[88:91] offset:4352
  v_mfma_f32_16x16x32_bf16 v[168:171], v[224:227], v[248:251], v[168:171]
  buffer_store_dwordx4 v[64:67], v1, s[92:95], s56 offen offset:0 sc1
  v_cvt_pk_bf16_f32 v112, v112, v113
  v_mfma_f32_16x16x32_bf16 v[172:175], v[224:227], v[252:255], v[172:175]
  v_cvt_pk_bf16_f32 v113, v114, v115
  v_cvt_pk_bf16_f32 v114, v116, v117
  v_mfma_f32_16x16x32_bf16 v[192:195], v[228:231], v[248:251], v[192:195]
  v_cvt_pk_bf16_f32 v115, v118, v119
  ds_write_b128 v3, v[112:115] offset:8192
  v_mfma_f32_16x16x32_bf16 v[196:199], v[228:231], v[252:255], v[196:199]
  v_cvt_pk_bf16_f32 v136, v136, v137
  v_cvt_pk_bf16_f32 v137, v138, v139
  v_mfma_f32_16x16x32_bf16 v[8:11], v[232:235], v[200:203], v[8:11]
  v_cvt_pk_bf16_f32 v138, v140, v141
  v_cvt_pk_bf16_f32 v139, v142, v143
  ds_write_b128 v3, v[136:139] offset:8448
  v_mfma_f32_16x16x32_bf16 v[12:15], v[236:239], v[200:203], v[12:15]
  v_cvt_pk_bf16_f32 v160, v160, v161
  v_cvt_pk_bf16_f32 v161, v162, v163
  v_mfma_f32_16x16x32_bf16 v[32:35], v[232:235], v[204:207], v[32:35]
  v_cvt_pk_bf16_f32 v162, v164, v165
  v_cvt_pk_bf16_f32 v163, v166, v167
  ds_write_b128 v3, v[160:163] offset:12288
  v_mfma_f32_16x16x32_bf16 v[36:39], v[236:239], v[204:207], v[36:39]
  v_cvt_pk_bf16_f32 v184, v184, v185
  v_cvt_pk_bf16_f32 v185, v186, v187
  v_mfma_f32_16x16x32_bf16 v[56:59], v[232:235], v[208:211], v[56:59]
  v_cvt_pk_bf16_f32 v24, v24, v25
  v_cvt_pk_bf16_f32 v186, v188, v189
  v_mfma_f32_16x16x32_bf16 v[60:63], v[236:239], v[208:211], v[60:63]
  v_cvt_pk_bf16_f32 v187, v190, v191
  ds_write_b128 v3, v[184:187] offset:12544
  v_mfma_f32_16x16x32_bf16 v[80:83], v[232:235], v[212:215], v[80:83]
  v_cvt_pk_bf16_f32 v25, v26, v27
  v_lshrrev_b32 v2, 5, v0
  v_mfma_f32_16x16x32_bf16 v[84:87], v[236:239], v[212:215], v[84:87]
  buffer_store_dwordx4 v[88:91], v1, s[92:95], s56 offen offset:256 sc1
  v_cvt_pk_bf16_f32 v26, v28, v29
  v_mfma_f32_16x16x32_bf16 v[104:107], v[232:235], v[216:219], v[104:107]
  v_cvt_pk_bf16_f32 v27, v30, v31
  v_lshl_add_u32 v4, v2, 8, v4
  v_mfma_f32_16x16x32_bf16 v[108:111], v[236:239], v[216:219], v[108:111]
  v_cvt_pk_bf16_f32 v48, v48, v49
  v_add_u32 v2, s9, v4
  v_mfma_f32_16x16x32_bf16 v[128:131], v[232:235], v[220:223], v[128:131]
  v_cvt_pk_bf16_f32 v49, v50, v51
  v_add_u32 v4, s8, v4
  v_mfma_f32_16x16x32_bf16 v[132:135], v[236:239], v[220:223], v[132:135]
  v_permlane32_swap_b32 v24, v26
  v_permlane32_swap_b32 v25, v27
  ds_write_b128 v4, v[24:27] offset:2048
  v_mfma_f32_16x16x32_bf16 v[152:155], v[232:235], v[224:227], v[152:155]
  v_cvt_pk_bf16_f32 v50, v52, v53
  v_cvt_pk_bf16_f32 v51, v54, v55
  v_mfma_f32_16x16x32_bf16 v[156:159], v[236:239], v[224:227], v[156:159]
  v_cvt_pk_bf16_f32 v72, v72, v73
  v_cvt_pk_bf16_f32 v73, v74, v75
  v_mfma_f32_16x16x32_bf16 v[176:179], v[232:235], v[228:231], v[176:179]
  v_permlane32_swap_b32 v48, v50
  v_permlane32_swap_b32 v49, v51
  ds_write_b128 v4, v[48:51] offset:3072
  v_mfma_f32_16x16x32_bf16 v[180:183], v[236:239], v[228:231], v[180:183]
  v_cvt_pk_bf16_f32 v74, v76, v77
  v_cvt_pk_bf16_f32 v75, v78, v79
  v_cvt_pk_bf16_f32 v96, v96, v97
  v_cvt_pk_bf16_f32 v97, v98, v99
  v_permlane32_swap_b32 v72, v74
  v_permlane32_swap_b32 v73, v75
  ds_write_b128 v4, v[72:75] offset:6144
  v_cvt_pk_bf16_f32 v98, v100, v101
  v_cvt_pk_bf16_f32 v99, v102, v103
  v_cvt_pk_bf16_f32 v120, v120, v121
  v_cvt_pk_bf16_f32 v121, v122, v123
  v_permlane32_swap_b32 v96, v98
  v_permlane32_swap_b32 v97, v99
  ds_write_b128 v4, v[96:99] offset:7168
  buffer_store_dwordx4 v[112:115], v1, s[92:95], s57 offen offset:0 sc1
  v_cvt_pk_bf16_f32 v122, v124, v125
  v_cvt_pk_bf16_f32 v123, v126, v127
  v_cvt_pk_bf16_f32 v144, v144, v145
  v_cvt_pk_bf16_f32 v145, v146, v147
  v_permlane32_swap_b32 v120, v122
  v_permlane32_swap_b32 v121, v123
  ds_write_b128 v4, v[120:123] offset:10240
  v_cvt_pk_bf16_f32 v146, v148, v149
  v_cvt_pk_bf16_f32 v147, v150, v151
  v_cvt_pk_bf16_f32 v168, v168, v169
  v_cvt_pk_bf16_f32 v169, v170, v171
  v_permlane32_swap_b32 v144, v146
  v_permlane32_swap_b32 v145, v147
  s_waitcnt lgkmcnt(13)
  ds_write_b128 v4, v[144:147] offset:11264
  v_cvt_pk_bf16_f32 v170, v172, v173
  v_cvt_pk_bf16_f32 v171, v174, v175
  v_cvt_pk_bf16_f32 v192, v192, v193
  v_cvt_pk_bf16_f32 v193, v194, v195
  v_permlane32_swap_b32 v168, v170
  v_permlane32_swap_b32 v169, v171
  s_waitcnt lgkmcnt(13)
  ds_write_b128 v4, v[168:171] offset:14336
  v_cvt_pk_bf16_f32 v194, v196, v197
  v_cvt_pk_bf16_f32 v195, v198, v199
  v_mul_f32 v8, s15, v8
  v_permlane32_swap_b32 v192, v194
  v_permlane32_swap_b32 v193, v195
  s_waitcnt lgkmcnt(13)
  ds_write_b128 v4, v[192:195] offset:15360
  v_mul_f32 v9, s15, v9
  buffer_store_dwordx4 v[136:139], v1, s[92:95], s57 offen offset:256 sc1
  v_cvt_pk_bf16_f32 v8, v8, v9
  v_mul_f32 v10, s15, v10
  v_mul_f32 v11, s15, v11
  v_cvt_pk_bf16_f32 v9, v10, v11
  v_mul_f32 v12, s15, v12
  v_mul_f32 v13, s15, v13
  v_mul_f32 v14, s15, v14
  v_mul_f32 v15, s15, v15
  v_cvt_pk_bf16_f32 v10, v12, v13
  v_cvt_pk_bf16_f32 v11, v14, v15
  s_waitcnt lgkmcnt(13)
  ds_write_b128 v5, v[8:11] offset:0
  v_mul_f32 v32, s15, v32
  v_mul_f32 v33, s15, v33
  v_cvt_pk_bf16_f32 v32, v32, v33
  v_mul_f32 v34, s15, v34
  v_mul_f32 v35, s15, v35
  v_cvt_pk_bf16_f32 v33, v34, v35
  v_mul_f32 v36, s15, v36
  v_mul_f32 v37, s15, v37
  v_mul_f32 v38, s15, v38
  v_mul_f32 v39, s15, v39
  v_cvt_pk_bf16_f32 v34, v36, v37
  v_cvt_pk_bf16_f32 v35, v38, v39
  s_waitcnt lgkmcnt(13)
  ds_write_b128 v5, v[32:35] offset:256
  v_mul_f32 v56, s15, v56
  v_mul_f32 v57, s15, v57
  v_cvt_pk_bf16_f32 v56, v56, v57
  v_mul_f32 v58, s15, v58
  v_mul_f32 v59, s15, v59
  v_cvt_pk_bf16_f32 v57, v58, v59
  v_mul_f32 v60, s15, v60
  v_mul_f32 v61, s15, v61
  v_mul_f32 v62, s15, v62
  v_mul_f32 v63, s15, v63
  v_cvt_pk_bf16_f32 v58, v60, v61
  v_cvt_pk_bf16_f32 v59, v62, v63
  s_waitcnt lgkmcnt(13)
  ds_write_b128 v5, v[56:59] offset:2048
  v_mul_f32 v80, s15, v80
  v_mul_f32 v81, s15, v81
  v_cvt_pk_bf16_f32 v80, v80, v81
  v_mul_f32 v82, s15, v82
  v_mul_f32 v83, s15, v83
  v_cvt_pk_bf16_f32 v81, v82, v83
  v_mul_f32 v84, s15, v84
  v_mul_f32 v85, s15, v85
  v_mul_f32 v86, s15, v86
  v_mul_f32 v87, s15, v87
  v_cvt_pk_bf16_f32 v82, v84, v85
  v_cvt_pk_bf16_f32 v83, v86, v87
  s_waitcnt lgkmcnt(13)
  ds_write_b128 v5, v[80:83] offset:2304
  v_mul_f32 v104, s15, v104
  v_mul_f32 v105, s15, v105
  buffer_store_dwordx4 v[160:163], v1, s[92:95], s58 offen offset:0 sc1
  v_cvt_pk_bf16_f32 v104, v104, v105
  v_mul_f32 v106, s15, v106
  v_mul_f32 v107, s15, v107
  v_cvt_pk_bf16_f32 v105, v106, v107
  v_mul_f32 v108, s15, v108
  v_mul_f32 v109, s15, v109
  v_mul_f32 v110, s15, v110
  v_mul_f32 v111, s15, v111
  v_cvt_pk_bf16_f32 v106, v108, v109
  v_cvt_pk_bf16_f32 v107, v110, v111
  s_waitcnt lgkmcnt(13)
  ds_write_b128 v5, v[104:107] offset:4096
  v_mul_f32 v128, s15, v128
  v_mul_f32 v129, s15, v129
  v_cvt_pk_bf16_f32 v128, v128, v129
  v_mul_f32 v130, s15, v130
  v_mul_f32 v131, s15, v131
  v_cvt_pk_bf16_f32 v129, v130, v131
  v_mul_f32 v132, s15, v132
  v_mul_f32 v133, s15, v133
  v_mul_f32 v134, s15, v134
  v_mul_f32 v135, s15, v135
  v_cvt_pk_bf16_f32 v130, v132, v133
  v_cvt_pk_bf16_f32 v131, v134, v135
  s_waitcnt lgkmcnt(13)
  ds_write_b128 v5, v[128:131] offset:4352
  v_mul_f32 v152, s15, v152
  v_mul_f32 v153, s15, v153
  v_cvt_pk_bf16_f32 v152, v152, v153
  v_mul_f32 v154, s15, v154
  v_mul_f32 v155, s15, v155
  v_cvt_pk_bf16_f32 v153, v154, v155
  v_mul_f32 v156, s15, v156
  v_mul_f32 v157, s15, v157
  v_mul_f32 v158, s15, v158
  v_mul_f32 v159, s15, v159
  v_cvt_pk_bf16_f32 v154, v156, v157
  v_cvt_pk_bf16_f32 v155, v158, v159
  s_waitcnt lgkmcnt(13)
  ds_write_b128 v5, v[152:155] offset:6144
  v_mul_f32 v176, s15, v176
  v_mul_f32 v177, s15, v177
  v_cvt_pk_bf16_f32 v176, v176, v177
  v_mul_f32 v178, s15, v178
  v_mul_f32 v179, s15, v179
  v_cvt_pk_bf16_f32 v177, v178, v179
  v_mul_f32 v180, s15, v180
  v_mul_f32 v181, s15, v181
  v_mul_f32 v182, s15, v182
  v_mul_f32 v183, s15, v183
  v_cvt_pk_bf16_f32 v178, v180, v181
  v_cvt_pk_bf16_f32 v179, v182, v183
  s_waitcnt lgkmcnt(13)
  ds_write_b128 v5, v[176:179] offset:6400
  buffer_store_dwordx4 v[184:187], v1, s[92:95], s58 offen offset:256 sc1
  s_waitcnt lgkmcnt(0)
  s_barrier
  v_mov_b32 v14, v6
  v_lshlrev_b32 v12, 4, v0
  v_add_u32 v12, s10, v12
  buffer_store_dwordx4 v[24:27], v2, s[92:95], 0 offen offset:2048 sc1
  buffer_store_dwordx4 v[48:51], v2, s[92:95], 0 offen offset:3072 sc1
  buffer_store_dwordx4 v[72:75], v2, s[92:95], s56 offen offset:2048 sc1
  buffer_store_dwordx4 v[96:99], v2, s[92:95], s56 offen offset:3072 sc1
  buffer_store_dwordx4 v[120:123], v2, s[92:95], s57 offen offset:2048 sc1
  buffer_store_dwordx4 v[144:147], v2, s[92:95], s57 offen offset:3072 sc1
  buffer_store_dwordx4 v[168:171], v2, s[92:95], s58 offen offset:2048 sc1
  buffer_store_dwordx4 v[192:195], v2, s[92:95], s58 offen offset:3072 sc1
  s_nop 1
  ds_read_b128 v[192:195], v12
  ds_read_b128 v[196:199], v12 offset:1024
  ds_read_b128 v[200:203], v12 offset:2048
  ds_read_b128 v[204:207], v12 offset:3072
  s_lshl_b32 s14, s14, 1
  s_mov_b32 s12, 1
  s_cmp_eq_u32 s5, 0
  s_cselect_b32 s12, 1, 0
K1_ATT:
  v_lshlrev_b32 v3, 4, v0
  s_lshl_b32 s8, s13, 15
  s_add_u32 s8, s8, 32768
  v_add_u32 v1, s8, v3
  s_mul_i32 s8, s13, 98304
  v_add_u32 v2, s8, v3
  s_lshl_b32 s8, s4, 6
  s_lshl_b32 s9, s5, 3
  s_add_u32 s8, s8, s9
  s_lshl_b32 s8, s8, 16
  s_lshl_b32 s9, s6, 1
  s_add_u32 s9, s9, s13
  s_lshl_b32 s9, s9, 11
  s_add_u32 s8, s8, s9
  v_add_u32 v4, s8, v3
  s_lshl_b32 s56, s14, 16
  s_sub_u32 s57, 458752, s56
  s_sub_u32 s8, s7, 16
  s_lshl_b32 s9, s8, 7
  s_add_u32 s9, s9, 25165824
  s_bfe_u32 s10, s3, 0x10001
  s_lshl_b32 s10, s10, 3
  s_add_u32 s9, s9, s10
  s_and_b32 s10, s3, 1
  s_lshl_b32 s10, s10, 4
  s_add_u32 s9, s9, s10
  v_mov_b32 v13, s9
  s_lshl_b32 s8, s8, 16
  s_add_u32 s8, s8, 8388608
  s_and_b32 s10, s3, 3
  s_lshl_b32 s9, s10, 14
  s_add_u32 s58, s8, s9
  s_lshr_b32 s10, s10, 1
  s_mul_i32 s10, s10, 65536
  s_add_u32 s15, s9, s10
  s_lshl_b32 s8, s7, 7
  s_lshl_b32 s9, s3, 3
  s_add_u32 s8, s8, s9
  s_add_u32 s11, s8, 25165824
  s_mov_b32 s59, 0
  s_waitcnt lgkmcnt(0)
  v_readfirstlane_b32 s35, v14
  s_cmp_eq_u32 s14, 1
  s_nop 2
  s_cbranch_scc1 K1_P1_1
  s_cmp_eq_u32 s14, 2
  s_cbranch_scc1 K1_P1_2
  s_cmp_eq_u32 s14, 3
  s_cbranch_scc1 K1_P1_3
K1_P1_0:
  ds_read_b128 v[208:211], v1 offset:0
  ds_read_b128 v[212:215], v1 offset:1024
  ds_read_b128 v[224:227], v1 offset:2048
  ds_read_b128 v[228:231], v1 offset:3072
  ds_read_b128 v[216:219], v1 offset:8192
  ds_read_b128 v[220:223], v1 offset:9216
  ds_read_b128 v[232:235], v1 offset:10240
  ds_read_b128 v[236:239], v1 offset:11264
  v_lshrrev_b32 v155, 5, v0
  v_and_b32 v154, 31, v0
  v_lshlrev_b32 v155, 2, v155
  v_sub_u32 v154, v154, v155
  v_mov_b32 v155, 0
  v_mov_b32 v156, 0xf149f2ca
  v_cmp_le_i32 s[80:81], 0, v154
  v_cmp_le_i32 s[82:83], 1, v154
  v_cmp_le_i32 s[84:85], 2, v154
  v_cmp_le_i32 s[86:87], 3, v154
  s_cmp_eq_u32 s34, 0
  s_nop 2
  s_cbranch_scc1 K1_CPA1
  v_mov_b32 v150, s35
  v_mov_b32 v151, s11
  s_waitcnt vmcnt(8)
  s_mov_b64 exec, 1
  buffer_store_dword v150, v151, s[44:47], 0 offen offset:0 sc1
  s_mov_b64 exec, -1
K1_CPA1:
  v_cndmask_b32 v240, v156, v155, s[80:81]
  v_cndmask_b32 v241, v156, v155, s[82:83]
  v_cndmask_b32 v242, v156, v155, s[84:85]
  v_cndmask_b32 v243, v156, v155, s[86:87]
  v_cmp_le_i32 s[80:81], 8, v154
  v_cmp_le_i32 s[82:83], 9, v154
  v_cmp_le_i32 s[84:85], 10, v154
  v_cmp_le_i32 s[86:87], 11, v154
  v_cndmask_b32 v244, v156, v155, s[80:81]
  v_cndmask_b32 v245, v156, v155, s[82:83]
  v_cndmask_b32 v246, v156, v155, s[84:85]
  v_cndmask_b32 v247, v156, v155, s[86:87]
  v_cmp_le_i32 s[80:81], 16, v154
  v_cmp_le_i32 s[82:83], 17, v154
  v_cmp_le_i32 s[84:85], 18, v154
  v_cmp_le_i32 s[86:87], 19, v154
  v_cndmask_b32 v248, v156, v155, s[80:81]
  v_cndmask_b32 v249, v156, v155, s[82:83]
  v_cndmask_b32 v250, v156, v155, s[84:85]
  v_cndmask_b32 v251, v156, v155, s[86:87]
  v_cmp_le_i32 s[80:81], 24, v154
  v_cmp_le_i32 s[82:83], 25, v154
  s_waitcnt lgkmcnt(7)
  v_mfma_f32_32x32x16_bf16 v[16:31], v[208:211], v[200:203], 0
  v_cmp_le_i32 s[84:85], 26, v154
  v_cmp_le_i32 s[86:87], 27, v154
  v_cndmask_b32 v252, v156, v155, s[80:81]
  v_cndmask_b32 v253, v156, v155, s[82:83]
  v_cndmask_b32 v254, v156, v155, s[84:85]
  v_cndmask_b32 v255, v156, v155, s[86:87]
  s_waitcnt lgkmcnt(6)
  v_mfma_f32_32x32x16_bf16 v[16:31], v[212:215], v[204:207], v[16:31]
  v_mov_b32 v128, 0x3f803f80
  v_mov_b32 v129, 0x3f803f80
  v_mov_b32 v130, 0x3f803f80
  v_mov_b32 v131, 0x3f803f80
  v_mfma_f32_32x32x16_bf16 v[32:47], v[208:211], v[192:195], v[240:255]
  ds_read_b128 v[208:211], v1 offset:16384
  v_mfma_f32_32x32x16_bf16 v[32:47], v[212:215], v[196:199], v[32:47]
  ds_read_b128 v[212:215], v1 offset:17408
  s_nop 3
  v_exp_f32 v16, v16
  v_exp_f32 v17, v17
  v_exp_f32 v18, v18
  s_waitcnt lgkmcnt(5)
  v_mfma_f32_32x32x16_bf16 v[48:63], v[216:219], v[200:203], 0
  v_exp_f32 v19, v19
  v_exp_f32 v20, v20
  v_exp_f32 v21, v21
  s_waitcnt lgkmcnt(4)
  v_mfma_f32_32x32x16_bf16 v[48:63], v[220:223], v[204:207], v[48:63]
  v_exp_f32 v32, v32
  v_exp_f32 v33, v33
  v_exp_f32 v34, v34
  v_exp_f32 v35, v35
  v_exp_f32 v22, v22
  v_exp_f32 v23, v23
  v_exp_f32 v36, v36
  v_exp_f32 v37, v37
  s_waitcnt lgkmcnt(1)
  v_mfma_f32_32x32x16_bf16 v[64:79], v[208:211], v[200:203], 0
  v_exp_f32 v38, v38
  v_exp_f32 v39, v39
  v_cvt_pk_bf16_f32 v16, v16, v17
  v_cvt_pk_bf16_f32 v32, v32, v33
  s_waitcnt lgkmcnt(0)
  v_mfma_f32_32x32x16_bf16 v[64:79], v[212:215], v[204:207], v[64:79]
  v_cvt_pk_bf16_f32 v17, v18, v19
  v_cvt_pk_bf16_f32 v33, v34, v35
  v_cvt_pk_bf16_f32 v18, v20, v21
  v_cvt_pk_bf16_f32 v19, v22, v23
  v_cvt_pk_bf16_f32 v34, v36, v37
  v_cvt_pk_bf16_f32 v35, v38, v39
  v_mfma_f32_32x32x16_bf16 v[176:191], v[224:227], v[16:19], 0
  v_exp_f32 v24, v24
  v_exp_f32 v25, v25
  v_exp_f32 v40, v40
  v_mfma_f32_32x32x16_bf16 v[160:175], v[224:227], v[32:35], 0
  ds_read_b128 v[224:227], v1 offset:18432
  v_exp_f32 v41, v41
  v_exp_f32 v26, v26
  v_exp_f32 v27, v27
  v_mfma_f32_32x32x16_bf16 v[112:127], v[128:131], v[16:19], 0
  v_exp_f32 v42, v42
  v_exp_f32 v43, v43
  v_exp_f32 v28, v28
  v_mfma_f32_32x32x16_bf16 v[96:111], v[128:131], v[32:35], 0
  v_exp_f32 v29, v29
  v_exp_f32 v30, v30
  v_exp_f32 v31, v31
  v_exp_f32 v44, v44
  v_exp_f32 v45, v45
  v_exp_f32 v46, v46
  v_exp_f32 v47, v47
  v_cvt_pk_bf16_f32 v24, v24, v25
  v_cvt_pk_bf16_f32 v40, v40, v41
  v_cvt_pk_bf16_f32 v25, v26, v27
  v_cvt_pk_bf16_f32 v41, v42, v43
  v_cvt_pk_bf16_f32 v26, v28, v29
  v_cvt_pk_bf16_f32 v27, v30, v31
  v_cvt_pk_bf16_f32 v42, v44, v45
  v_cvt_pk_bf16_f32 v43, v46, v47
  v_mfma_f32_32x32x16_bf16 v[176:191], v[228:231], v[24:27], v[176:191]
  v_exp_f32 v48, v48
  v_exp_f32 v49, v49
  v_exp_f32 v50, v50
  v_mfma_f32_32x32x16_bf16 v[160:175], v[228:231], v[40:43], v[160:175]
  ds_read_b128 v[228:231], v1 offset:19456
  ds_read_b128 v[216:219], v1 offset:24576
  ds_read_b128 v[220:223], v1 offset:25600
  v_exp_f32 v51, v51
  v_exp_f32 v52, v52
  v_mfma_f32_32x32x16_bf16 v[112:127], v[128:131], v[24:27], v[112:127]
  v_exp_f32 v53, v53
  v_exp_f32 v54, v54
  v_exp_f32 v55, v55
  v_mfma_f32_32x32x16_bf16 v[96:111], v[128:131], v[40:43], v[96:111]
  v_cvt_pk_bf16_f32 v48, v48, v49
  v_cvt_pk_bf16_f32 v49, v50, v51
  v_cvt_pk_bf16_f32 v50, v52, v53
  v_cvt_pk_bf16_f32 v51, v54, v55
  v_exp_f32 v56, v56
  s_nop 0
  v_mfma_f32_32x32x16_bf16 v[176:191], v[232:235], v[48:51], v[176:191]
  ds_read_b128 v[232:235], v1 offset:26624
  v_exp_f32 v57, v57
  v_exp_f32 v58, v58
  v_exp_f32 v59, v59
  v_mfma_f32_32x32x16_bf16 v[112:127], v[128:131], v[48:51], v[112:127]
  v_exp_f32 v60, v60
  v_exp_f32 v61, v61
  v_exp_f32 v62, v62
  s_waitcnt lgkmcnt(2)
  v_mfma_f32_32x32x16_bf16 v[80:95], v[216:219], v[200:203], 0
  v_exp_f32 v63, v63
  v_cvt_pk_bf16_f32 v56, v56, v57
  v_cvt_pk_bf16_f32 v57, v58, v59
  v_cvt_pk_bf16_f32 v58, v60, v61
  v_cvt_pk_bf16_f32 v59, v62, v63
  s_waitcnt lgkmcnt(1)
  v_mfma_f32_32x32x16_bf16 v[80:95], v[220:223], v[204:207], v[80:95]
  v_exp_f32 v64, v64
  v_exp_f32 v65, v65
  v_exp_f32 v66, v66
  v_mfma_f32_32x32x16_bf16 v[176:191], v[236:239], v[56:59], v[176:191]
  ds_read_b128 v[236:239], v1 offset:27648
  ds_read_b128 v[208:211], v1 offset:28672
  s_cmp_eq_u32 s34, 0
  s_nop 7
  s_cbranch_scc1 K1_CPA2
  v_mov_b32 v150, s35
  v_mov_b32 v151, s11
  s_waitcnt vmcnt(1)
  s_mov_b64 exec, 1
  buffer_store_dword v150, v151, s[44:47], 0 offen offset:4 sc1
  s_mov_b64 exec, -1
K1_CPA2:
  ds_read_b128 v[212:215], v1 offset:29696
  v_exp_f32 v67, v67
  v_exp_f32 v68, v68
  v_mfma_f32_32x32x16_bf16 v[112:127], v[128:131], v[56:59], v[112:127]
  v_exp_f32 v69, v69
  v_exp_f32 v70, v70
  v_exp_f32 v71, v71
  v_cvt_pk_bf16_f32 v64, v64, v65
  v_cvt_pk_bf16_f32 v65, v66, v67
  v_cvt_pk_bf16_f32 v66, v68, v69
  v_cvt_pk_bf16_f32 v67, v70, v71
  v_exp_f32 v72, v72
  s_nop 0
  v_mfma_f32_32x32x16_bf16 v[176:191], v[224:227], v[64:67], v[176:191]
  ds_read_b128 v[224:227], v1 offset:30720
  v_exp_f32 v73, v73
  v_exp_f32 v74, v74
  v_exp_f32 v75, v75
  v_mfma_f32_32x32x16_bf16 v[112:127], v[128:131], v[64:67], v[112:127]
  v_exp_f32 v76, v76
  v_exp_f32 v77, v77
  v_exp_f32 v78, v78
  v_exp_f32 v79, v79
  s_waitcnt lgkmcnt(2)
  v_mfma_f32_32x32x16_bf16 v[16:31], v[208:211], v[200:203], 0
  v_cvt_pk_bf16_f32 v72, v72, v73
  v_cvt_pk_bf16_f32 v73, v74, v75
  v_cvt_pk_bf16_f32 v74, v76, v77
  v_cvt_pk_bf16_f32 v75, v78, v79
  v_exp_f32 v80, v80
  s_nop 0
  v_mfma_f32_32x32x16_bf16 v[176:191], v[228:231], v[72:75], v[176:191]
  ds_read_b128 v[228:231], v1 offset:31744
  ds_read_b128 v[216:219], v1 offset:20480
  ds_read_b128 v[220:223], v1 offset:21504
  v_exp_f32 v81, v81
  v_exp_f32 v82, v82
  s_waitcnt lgkmcnt(4)
  v_mfma_f32_32x32x16_bf16 v[16:31], v[212:215], v[204:207], v[16:31]
  v_exp_f32 v83, v83
  v_exp_f32 v84, v84
  v_exp_f32 v85, v85
  v_mfma_f32_32x32x16_bf16 v[112:127], v[128:131], v[72:75], v[112:127]
  v_exp_f32 v86, v86
  v_exp_f32 v87, v87
  v_cvt_pk_bf16_f32 v80, v80, v81
  v_cvt_pk_bf16_f32 v81, v82, v83
  v_cvt_pk_bf16_f32 v82, v84, v85
  v_cvt_pk_bf16_f32 v83, v86, v87
  v_exp_f32 v88, v88
  s_nop 0
  v_mfma_f32_32x32x16_bf16 v[176:191], v[232:235], v[80:83], v[176:191]
  ds_read_b128 v[232:235], v1 offset:22528
  v_exp_f32 v89, v89
  v_exp_f32 v90, v90
  v_exp_f32 v91, v91
  v_mfma_f32_32x32x16_bf16 v[112:127], v[128:131], v[80:83], v[112:127]
  s_cmp_eq_u32 s12, 1
  s_nop 9
  s_cbranch_scc1 K1_CPB3
  buffer_load_dwordx2 v[150:151], v13, s[44:47], 0 offen sc1
K1_CPB3:
  v_exp_f32 v92, v92
  v_exp_f32 v93, v93
  v_exp_f32 v94, v94
  s_waitcnt lgkmcnt(2)
  v_mfma_f32_32x32x16_bf16 v[32:47], v[216:219], v[200:203], 0
  v_exp_f32 v95, v95
  v_cvt_pk_bf16_f32 v88, v88, v89
  v_cvt_pk_bf16_f32 v89, v90, v91
  v_cvt_pk_bf16_f32 v90, v92, v93
  v_cvt_pk_bf16_f32 v91, v94, v95
  s_waitcnt lgkmcnt(1)
  v_mfma_f32_32x32x16_bf16 v[32:47], v[220:223], v[204:207], v[32:47]
  v_exp_f32 v16, v16
  v_exp_f32 v17, v17
  v_exp_f32 v18, v18
  v_mfma_f32_32x32x16_bf16 v[176:191], v[236:239], v[88:91], v[176:191]
  ds_read_b128 v[236:239], v1 offset:23552
  ds_read_b128 v[208:211], v1 offset:12288
  ds_read_b128 v[212:215], v1 offset:13312
  v_exp_f32 v19, v19
  v_exp_f32 v20, v20
  v_mfma_f32_32x32x16_bf16 v[112:127], v[128:131], v[88:91], v[112:127]
  v_exp_f32 v21, v21
  v_exp_f32 v22, v22
  v_exp_f32 v23, v23
  v_cvt_pk_bf16_f32 v16, v16, v17
  v_cvt_pk_bf16_f32 v17, v18, v19
  v_cvt_pk_bf16_f32 v18, v20, v21
  v_cvt_pk_bf16_f32 v19, v22, v23
  v_exp_f32 v24, v24
  s_nop 0
  v_mfma_f32_32x32x16_bf16 v[176:191], v[224:227], v[16:19], v[176:191]
  ds_read_b128 v[224:227], v1 offset:14336
  v_exp_f32 v25, v25
  v_exp_f32 v26, v26
  v_exp_f32 v27, v27
  v_mfma_f32_32x32x16_bf16 v[112:127], v[128:131], v[16:19], v[112:127]
  v_exp_f32 v28, v28
  v_exp_f32 v29, v29
  v_exp_f32 v30, v30
  v_exp_f32 v31, v31
  s_waitcnt lgkmcnt(2)
  v_mfma_f32_32x32x16_bf16 v[48:63], v[208:211], v[200:203], 0
  v_cvt_pk_bf16_f32 v24, v24, v25
  v_cvt_pk_bf16_f32 v25, v26, v27
  v_cvt_pk_bf16_f32 v26, v28, v29
  v_cvt_pk_bf16_f32 v27, v30, v31
  v_exp_f32 v32, v32
  s_nop 0
  v_mfma_f32_32x32x16_bf16 v[176:191], v[228:231], v[24:27], v[176:191]
  ds_read_b128 v[228:231], v1 offset:15360
  ds_read_b128 v[216:219], v1 offset:4096
  ds_read_b128 v[220:223], v1 offset:5120
  v_exp_f32 v33, v33
  v_exp_f32 v34, v34
  s_waitcnt lgkmcnt(4)
  v_mfma_f32_32x32x16_bf16 v[48:63], v[212:215], v[204:207], v[48:63]
  v_exp_f32 v35, v35
  v_exp_f32 v36, v36
  v_exp_f32 v37, v37
  v_mfma_f32_32x32x16_bf16 v[112:127], v[128:131], v[24:27], v[112:127]
  v_exp_f32 v38, v38
  v_exp_f32 v39, v39
  v_cvt_pk_bf16_f32 v32, v32, v33
  v_cvt_pk_bf16_f32 v33, v34, v35
  v_cvt_pk_bf16_f32 v34, v36, v37
  v_cvt_pk_bf16_f32 v35, v38, v39
  v_exp_f32 v40, v40
  s_nop 0
  v_mfma_f32_32x32x16_bf16 v[176:191], v[232:235], v[32:35], v[176:191]
  ds_read_b128 v[232:235], v1 offset:6144
  v_exp_f32 v41, v41
  v_exp_f32 v42, v42
  v_exp_f32 v43, v43
  v_mfma_f32_32x32x16_bf16 v[112:127], v[128:131], v[32:35], v[112:127]
  v_exp_f32 v44, v44
  s_cmp_eq_u32 s12, 1
  s_nop 8
  s_cbranch_scc1 K1_TKD4
  s_waitcnt vmcnt(0)
  v_readfirstlane_b32 s8, v150
  v_readfirstlane_b32 s9, v151
  s_cmp_eq_u32 s12, 2
  s_nop 2
  s_cbranch_scc1 K1_TKB4
  s_cmp_lg_u32 s8, s35
  s_cbranch_scc1 K1_TKC4
  s_add_u32 m0, s15, 0
  s_add_u32 s8, s58, 0
  buffer_load_dwordx4 v3, s[44:47], s8 offen offset:0 sc1 lds
  buffer_load_dwordx4 v3, s[44:47], s8 offen offset:1024 sc1 lds
  s_add_u32 m0, s15, 4096
  s_add_u32 s8, s58, 4096
  buffer_load_dwordx4 v3, s[44:47], s8 offen offset:0 sc1 lds
  buffer_load_dwordx4 v3, s[44:47], s8 offen offset:1024 sc1 lds
  s_add_u32 m0, s15, 8192
  s_add_u32 s8, s58, 8192
  buffer_load_dwordx4 v3, s[44:47], s8 offen offset:0 sc1 lds
  buffer_load_dwordx4 v3, s[44:47], s8 offen offset:1024 sc1 lds
  s_add_u32 m0, s15, 12288
  s_add_u32 s8, s58, 12288
  buffer_load_dwordx4 v3, s[44:47], s8 offen offset:0 sc1 lds
  buffer_load_dwordx4 v3, s[44:47], s8 offen offset:1024 sc1 lds
  s_mov_b32 s12, 2
K1_TKB4:
  s_cmp_lg_u32 s9, s35
  s_cbranch_scc1 K1_TKC4
  s_add_u32 m0, s15, 0
  s_add_u32 s8, s58, 0
  buffer_load_dwordx4 v3, s[44:47], s8 offen offset:2048 sc1 lds
  buffer_load_dwordx4 v3, s[44:47], s8 offen offset:3072 sc1 lds
  s_add_u32 m0, s15, 4096
  s_add_u32 s8, s58, 4096
  buffer_load_dwordx4 v3, s[44:47], s8 offen offset:2048 sc1 lds
  buffer_load_dwordx4 v3, s[44:47], s8 offen offset:3072 sc1 lds
  s_add_u32 m0, s15, 8192
  s_add_u32 s8, s58, 8192
  buffer_load_dwordx4 v3, s[44:47], s8 offen offset:2048 sc1 lds
  buffer_load_dwordx4 v3, s[44:47], s8 offen offset:3072 sc1 lds
  s_add_u32 m0, s15, 12288
  s_add_u32 s8, s58, 12288
  buffer_load_dwordx4 v3, s[44:47], s8 offen offset:2048 sc1 lds
  buffer_load_dwordx4 v3, s[44:47], s8 offen offset:3072 sc1 lds
  s_mov_b32 s12, 1
  s_branch K1_TKD4
K1_TKC4:
  buffer_load_dwordx2 v[150:151], v13, s[44:47], 0 offen sc1
K1_TKD4:
  v_exp_f32 v45, v45
  v_exp_f32 v46, v46
  s_waitcnt lgkmcnt(2)
  v_mfma_f32_32x32x16_bf16 v[64:79], v[216:219], v[200:203], v[240:255]
  v_exp_f32 v47, v47
  v_cvt_pk_bf16_f32 v40, v40, v41
  v_cvt_pk_bf16_f32 v41, v42, v43
  v_cvt_pk_bf16_f32 v42, v44, v45
  v_cvt_pk_bf16_f32 v43, v46, v47
  s_waitcnt lgkmcnt(1)
  v_mfma_f32_32x32x16_bf16 v[64:79], v[220:223], v[204:207], v[64:79]
  v_exp_f32 v48, v48
  v_exp_f32 v49, v49
  v_exp_f32 v50, v50
  v_mfma_f32_32x32x16_bf16 v[176:191], v[236:239], v[40:43], v[176:191]
  ds_read_b128 v[236:239], v1 offset:7168
  v_exp_f32 v51, v51
  v_exp_f32 v52, v52
  v_exp_f32 v53, v53
  v_mfma_f32_32x32x16_bf16 v[112:127], v[128:131], v[40:43], v[112:127]
  v_exp_f32 v54, v54
  v_exp_f32 v55, v55
  v_cvt_pk_bf16_f32 v48, v48, v49
  v_cvt_pk_bf16_f32 v49, v50, v51
  v_cvt_pk_bf16_f32 v50, v52, v53
  v_cvt_pk_bf16_f32 v51, v54, v55
  v_exp_f32 v56, v56
  s_nop 0
  v_mfma_f32_32x32x16_bf16 v[176:191], v[224:227], v[48:51], v[176:191]
  v_exp_f32 v57, v57
  v_exp_f32 v58, v58
  v_exp_f32 v59, v59
  v_mfma_f32_32x32x16_bf16 v[112:127], v[128:131], v[48:51], v[112:127]
  v_exp_f32 v60, v60
  v_exp_f32 v61, v61
  v_exp_f32 v62, v62
  v_exp_f32 v63, v63
  v_cvt_pk_bf16_f32 v56, v56, v57
  v_cvt_pk_bf16_f32 v57, v58, v59
  v_cvt_pk_bf16_f32 v58, v60, v61
  v_cvt_pk_bf16_f32 v59, v62, v63
  v_exp_f32 v64, v64
  s_nop 0
  v_mfma_f32_32x32x16_bf16 v[176:191], v[228:231], v[56:59], v[176:191]
  v_exp_f32 v65, v65
  v_exp_f32 v66, v66
  v_exp_f32 v67, v67
  v_mfma_f32_32x32x16_bf16 v[112:127], v[128:131], v[56:59], v[112:127]
  v_exp_f32 v68, v68
  v_exp_f32 v69, v69
  v_exp_f32 v70, v70
  v_exp_f32 v71, v71
  v_cvt_pk_bf16_f32 v64, v64, v65
  v_cvt_pk_bf16_f32 v65, v66, v67
  v_cvt_pk_bf16_f32 v66, v68, v69
  v_cvt_pk_bf16_f32 v67, v70, v71
  v_exp_f32 v72, v72
  s_waitcnt lgkmcnt(1)
  v_mfma_f32_32x32x16_bf16 v[176:191], v[232:235], v[64:67], v[176:191]
  v_exp_f32 v73, v73
  v_exp_f32 v74, v74
  v_exp_f32 v75, v75
  v_mfma_f32_32x32x16_bf16 v[112:127], v[128:131], v[64:67], v[112:127]
  v_exp_f32 v76, v76
  v_exp_f32 v77, v77
  v_exp_f32 v78, v78
  v_exp_f32 v79, v79
  v_cvt_pk_bf16_f32 v72, v72, v73
  v_cvt_pk_bf16_f32 v73, v74, v75
  v_cvt_pk_bf16_f32 v74, v76, v77
  v_cvt_pk_bf16_f32 v75, v78, v79
  s_waitcnt lgkmcnt(0)
  s_nop 0
  v_mfma_f32_32x32x16_bf16 v[176:191], v[236:239], v[72:75], v[176:191]
  v_mfma_f32_32x32x16_bf16 v[112:127], v[128:131], v[72:75], v[112:127]
  s_nop 10
  s_branch K1_MID
K1_P1_1:
  ds_read_b128 v[208:211], v1 offset:0
  ds_read_b128 v[212:215], v1 offset:1024
  ds_read_b128 v[224:227], v1 offset:2048
  ds_read_b128 v[228:231], v1 offset:3072
  ds_read_b128 v[216:219], v1 offset:8192
  ds_read_b128 v[220:223], v1 offset:9216
  ds_read_b128 v[232:235], v1 offset:10240
  ds_read_b128 v[236:239], v1 offset:11264
  v_lshrrev_b32 v155, 5, v0
  v_and_b32 v154, 31, v0
  v_lshlrev_b32 v155, 2, v155
  v_sub_u32 v154, v154, v155
  v_mov_b32 v155, 0
  v_mov_b32 v156, 0xf149f2ca
  v_cmp_le_i32 s[80:81], 0, v154
  v_cmp_le_i32 s[82:83], 1, v154
  v_cmp_le_i32 s[84:85], 2, v154
  s_cmp_eq_u32 s34, 0
  s_nop 2
  s_cbranch_scc1 K1_CPA5
  v_mov_b32 v150, s35
  v_mov_b32 v151, s11
  s_waitcnt vmcnt(8)
  s_mov_b64 exec, 1
  buffer_store_dword v150, v151, s[44:47], 0 offen offset:0 sc1
  s_mov_b64 exec, -1
K1_CPA5:
  v_cmp_le_i32 s[86:87], 3, v154
  v_cndmask_b32 v240, v156, v155, s[80:81]
  v_cndmask_b32 v241, v156, v155, s[82:83]
  v_cndmask_b32 v242, v156, v155, s[84:85]
  v_cndmask_b32 v243, v156, v155, s[86:87]
  v_cmp_le_i32 s[80:81], 8, v154
  v_cmp_le_i32 s[82:83], 9, v154
  v_cmp_le_i32 s[84:85], 10, v154
  v_cmp_le_i32 s[86:87], 11, v154
  v_cndmask_b32 v244, v156, v155, s[80:81]
  v_cndmask_b32 v245, v156, v155, s[82:83]
  v_cndmask_b32 v246, v156, v155, s[84:85]
  v_cndmask_b32 v247, v156, v155, s[86:87]
  v_cmp_le_i32 s[80:81], 16, v154
  v_cmp_le_i32 s[82:83], 17, v154
  v_cmp_le_i32 s[84:85], 18, v154
  v_cmp_le_i32 s[86:87], 19, v154
  v_cndmask_b32 v248, v156, v155, s[80:81]
  v_cndmask_b32 v249, v156, v155, s[82:83]
  v_cndmask_b32 v250, v156, v155, s[84:85]
  v_cndmask_b32 v251, v156, v155, s[86:87]
  v_cmp_le_i32 s[80:81], 24, v154
  v_cmp_le_i32 s[82:83], 25, v154
  s_waitcnt lgkmcnt(7)
  v_mfma_f32_32x32x16_bf16 v[16:31], v[208:211], v[200:203], 0
  v_cmp_le_i32 s[84:85], 26, v154
  v_cmp_le_i32 s[86:87], 27, v154
  v_cndmask_b32 v252, v156, v155, s[80:81]
  v_cndmask_b32 v253, v156, v155, s[82:83]
  v_cndmask_b32 v254, v156, v155, s[84:85]
  v_cndmask_b32 v255, v156, v155, s[86:87]
  v_mfma_f32_32x32x16_bf16 v[32:47], v[208:211], v[192:195], 0
  ds_read_b128 v[208:211], v1 offset:16384
  v_mov_b32 v128, 0x3f803f80
  v_mov_b32 v129, 0x3f803f80
  v_mov_b32 v130, 0x3f803f80
  v_mov_b32 v131, 0x3f803f80
  s_waitcnt lgkmcnt(7)
  v_mfma_f32_32x32x16_bf16 v[16:31], v[212:215], v[204:207], v[16:31]
  v_mfma_f32_32x32x16_bf16 v[32:47], v[212:215], v[196:199], v[32:47]
  ds_read_b128 v[212:215], v1 offset:17408
  s_waitcnt lgkmcnt(5)
  v_mfma_f32_32x32x16_bf16 v[48:63], v[216:219], v[200:203], 0
  s_nop 7
  v_exp_f32 v16, v16
  v_exp_f32 v17, v17
  v_exp_f32 v18, v18
  v_mfma_f32_32x32x16_bf16 v[64:79], v[216:219], v[192:195], v[240:255]
  v_exp_f32 v32, v32
  v_exp_f32 v33, v33
  v_exp_f32 v19, v19
  s_waitcnt lgkmcnt(4)
  v_mfma_f32_32x32x16_bf16 v[48:63], v[220:223], v[204:207], v[48:63]
  v_exp_f32 v34, v34
  v_exp_f32 v35, v35
  v_exp_f32 v20, v20
  v_mfma_f32_32x32x16_bf16 v[64:79], v[220:223], v[196:199], v[64:79]
  v_exp_f32 v21, v21
  v_exp_f32 v22, v22
  v_exp_f32 v23, v23
  s_waitcnt lgkmcnt(1)
  v_mfma_f32_32x32x16_bf16 v[80:95], v[208:211], v[200:203], 0
  v_exp_f32 v36, v36
  v_exp_f32 v37, v37
  v_exp_f32 v38, v38
  s_waitcnt lgkmcnt(0)
  v_mfma_f32_32x32x16_bf16 v[80:95], v[212:215], v[204:207], v[80:95]
  v_exp_f32 v39, v39
  v_cvt_pk_bf16_f32 v16, v16, v17
  v_cvt_pk_bf16_f32 v32, v32, v33
  v_cvt_pk_bf16_f32 v17, v18, v19
  v_cvt_pk_bf16_f32 v33, v34, v35
  v_cvt_pk_bf16_f32 v18, v20, v21
  v_cvt_pk_bf16_f32 v19, v22, v23
  v_cvt_pk_bf16_f32 v34, v36, v37
  v_cvt_pk_bf16_f32 v35, v38, v39
  v_mfma_f32_32x32x16_bf16 v[176:191], v[224:227], v[16:19], 0
  v_exp_f32 v24, v24
  v_exp_f32 v25, v25
  v_exp_f32 v40, v40
  v_mfma_f32_32x32x16_bf16 v[160:175], v[224:227], v[32:35], 0
  ds_read_b128 v[224:227], v1 offset:18432
  v_exp_f32 v41, v41
  v_exp_f32 v26, v26
  v_exp_f32 v27, v27
  v_mfma_f32_32x32x16_bf16 v[112:127], v[128:131], v[16:19], 0
  v_exp_f32 v42, v42
  v_exp_f32 v43, v43
  v_exp_f32 v28, v28
  v_mfma_f32_32x32x16_bf16 v[96:111], v[128:131], v[32:35], 0
  v_exp_f32 v29, v29
  v_exp_f32 v30, v30
  v_exp_f32 v31, v31
  v_exp_f32 v44, v44
  v_exp_f32 v45, v45
  v_exp_f32 v46, v46
  v_exp_f32 v47, v47
  v_cvt_pk_bf16_f32 v24, v24, v25
  v_cvt_pk_bf16_f32 v40, v40, v41
  v_cvt_pk_bf16_f32 v25, v26, v27
  v_cvt_pk_bf16_f32 v41, v42, v43
  v_cvt_pk_bf16_f32 v26, v28, v29
  v_cvt_pk_bf16_f32 v27, v30, v31
  v_cvt_pk_bf16_f32 v42, v44, v45
  v_cvt_pk_bf16_f32 v43, v46, v47
  v_mfma_f32_32x32x16_bf16 v[176:191], v[228:231], v[24:27], v[176:191]
  v_exp_f32 v48, v48
  v_exp_f32 v49, v49
  v_exp_f32 v64, v64
  v_mfma_f32_32x32x16_bf16 v[160:175], v[228:231], v[40:43], v[160:175]
  ds_read_b128 v[228:231], v1 offset:19456
  ds_read_b128 v[216:219], v1 offset:24576
  ds_read_b128 v[220:223], v1 offset:25600
  v_exp_f32 v65, v65
  v_exp_f32 v50, v50
  v_mfma_f32_32x32x16_bf16 v[112:127], v[128:131], v[24:27], v[112:127]
  v_exp_f32 v51, v51
  v_exp_f32 v66, v66
  v_exp_f32 v67, v67
  v_mfma_f32_32x32x16_bf16 v[96:111], v[128:131], v[40:43], v[96:111]
  v_exp_f32 v52, v52
  v_exp_f32 v53, v53
  v_exp_f32 v54, v54
  v_exp_f32 v55, v55
  v_exp_f32 v68, v68
  v_exp_f32 v69, v69
  v_exp_f32 v70, v70
  v_exp_f32 v71, v71
  v_cvt_pk_bf16_f32 v48, v48, v49
  v_cvt_pk_bf16_f32 v64, v64, v65
  v_cvt_pk_bf16_f32 v49, v50, v51
  v_cvt_pk_bf16_f32 v65, v66, v67
  v_cvt_pk_bf16_f32 v50, v52, v53
  v_cvt_pk_bf16_f32 v51, v54, v55
  v_cvt_pk_bf16_f32 v66, v68, v69
  s_waitcnt lgkmcnt(1)
  v_mfma_f32_32x32x16_bf16 v[16:31], v[216:219], v[200:203], 0
  v_cvt_pk_bf16_f32 v67, v70, v71
  v_exp_f32 v56, v56
  v_exp_f32 v57, v57
  v_exp_f32 v72, v72
  v_mfma_f32_32x32x16_bf16 v[176:191], v[232:235], v[48:51], v[176:191]
  v_exp_f32 v73, v73
  v_exp_f32 v58, v58
  s_cmp_eq_u32 s34, 0
  s_nop 7
  s_cbranch_scc1 K1_CPA6
  v_mov_b32 v150, s35
  v_mov_b32 v151, s11
  s_waitcnt vmcnt(1)
  s_mov_b64 exec, 1
  buffer_store_dword v150, v151, s[44:47], 0 offen offset:4 sc1
  s_mov_b64 exec, -1
K1_CPA6:
  v_exp_f32 v59, v59
  v_mfma_f32_32x32x16_bf16 v[160:175], v[232:235], v[64:67], v[160:175]
  ds_read_b128 v[232:235], v1 offset:26624
  v_exp_f32 v74, v74
  v_exp_f32 v75, v75
  v_exp_f32 v60, v60
  s_waitcnt lgkmcnt(1)
  v_mfma_f32_32x32x16_bf16 v[16:31], v[220:223], v[204:207], v[16:31]
  v_exp_f32 v61, v61
  v_exp_f32 v62, v62
  v_exp_f32 v63, v63
  v_mfma_f32_32x32x16_bf16 v[112:127], v[128:131], v[48:51], v[112:127]
  v_exp_f32 v76, v76
  v_exp_f32 v77, v77
  v_exp_f32 v78, v78
  v_mfma_f32_32x32x16_bf16 v[96:111], v[128:131], v[64:67], v[96:111]
  v_exp_f32 v79, v79
  v_cvt_pk_bf16_f32 v56, v56, v57
  v_cvt_pk_bf16_f32 v72, v72, v73
  v_cvt_pk_bf16_f32 v57, v58, v59
  v_cvt_pk_bf16_f32 v73, v74, v75
  v_cvt_pk_bf16_f32 v58, v60, v61
  v_cvt_pk_bf16_f32 v59, v62, v63
  v_cvt_pk_bf16_f32 v74, v76, v77
  v_cvt_pk_bf16_f32 v75, v78, v79
  v_mfma_f32_32x32x16_bf16 v[176:191], v[236:239], v[56:59], v[176:191]
  v_exp_f32 v80, v80
  v_exp_f32 v81, v81
  v_exp_f32 v82, v82
  v_mfma_f32_32x32x16_bf16 v[160:175], v[236:239], v[72:75], v[160:175]
  ds_read_b128 v[236:239], v1 offset:27648
  ds_read_b128 v[208:211], v1 offset:28672
  ds_read_b128 v[212:215], v1 offset:29696
  v_exp_f32 v83, v83
  v_exp_f32 v84, v84
  v_mfma_f32_32x32x16_bf16 v[112:127], v[128:131], v[56:59], v[112:127]
  v_exp_f32 v85, v85
  v_exp_f32 v86, v86
  v_exp_f32 v87, v87
  v_mfma_f32_32x32x16_bf16 v[96:111], v[128:131], v[72:75], v[96:111]
  v_cvt_pk_bf16_f32 v80, v80, v81
  v_cvt_pk_bf16_f32 v81, v82, v83
  v_cvt_pk_bf16_f32 v82, v84, v85
  v_cvt_pk_bf16_f32 v83, v86, v87
  v_exp_f32 v88, v88
  s_nop 0
  v_mfma_f32_32x32x16_bf16 v[176:191], v[224:227], v[80:83], v[176:191]
  ds_read_b128 v[224:227], v1 offset:30720
  v_exp_f32 v89, v89
  v_exp_f32 v90, v90
  v_exp_f32 v91, v91
  v_mfma_f32_32x32x16_bf16 v[112:127], v[128:131], v[80:83], v[112:127]
  v_exp_f32 v92, v92
  s_cmp_eq_u32 s12, 1
  s_nop 8
  s_cbranch_scc1 K1_CPB7
  buffer_load_dwordx2 v[150:151], v13, s[44:47], 0 offen sc1
K1_CPB7:
  v_exp_f32 v93, v93
  v_exp_f32 v94, v94
  s_waitcnt lgkmcnt(2)
  v_mfma_f32_32x32x16_bf16 v[32:47], v[208:211], v[200:203], 0
  v_exp_f32 v95, v95
  v_cvt_pk_bf16_f32 v88, v88, v89
  v_cvt_pk_bf16_f32 v89, v90, v91
  v_cvt_pk_bf16_f32 v90, v92, v93
  v_cvt_pk_bf16_f32 v91, v94, v95
  s_waitcnt lgkmcnt(1)
  v_mfma_f32_32x32x16_bf16 v[32:47], v[212:215], v[204:207], v[32:47]
  v_exp_f32 v16, v16
  v_exp_f32 v17, v17
  v_exp_f32 v18, v18
  v_mfma_f32_32x32x16_bf16 v[176:191], v[228:231], v[88:91], v[176:191]
  ds_read_b128 v[228:231], v1 offset:31744
  ds_read_b128 v[216:219], v1 offset:20480
  ds_read_b128 v[220:223], v1 offset:21504
  v_exp_f32 v19, v19
  v_exp_f32 v20, v20
  v_mfma_f32_32x32x16_bf16 v[112:127], v[128:131], v[88:91], v[112:127]
  v_exp_f32 v21, v21
  v_exp_f32 v22, v22
  v_exp_f32 v23, v23
  v_cvt_pk_bf16_f32 v16, v16, v17
  v_cvt_pk_bf16_f32 v17, v18, v19
  v_cvt_pk_bf16_f32 v18, v20, v21
  v_cvt_pk_bf16_f32 v19, v22, v23
  v_exp_f32 v24, v24
  s_nop 0
  v_mfma_f32_32x32x16_bf16 v[176:191], v[232:235], v[16:19], v[176:191]
  ds_read_b128 v[232:235], v1 offset:22528
  v_exp_f32 v25, v25
  v_exp_f32 v26, v26
  v_exp_f32 v27, v27
  v_mfma_f32_32x32x16_bf16 v[112:127], v[128:131], v[16:19], v[112:127]
  v_exp_f32 v28, v28
  v_exp_f32 v29, v29
  v_exp_f32 v30, v30
  v_exp_f32 v31, v31
  s_waitcnt lgkmcnt(2)
  v_mfma_f32_32x32x16_bf16 v[48:63], v[216:219], v[200:203], 0
  v_cvt_pk_bf16_f32 v24, v24, v25
  v_cvt_pk_bf16_f32 v25, v26, v27
  v_cvt_pk_bf16_f32 v26, v28, v29
  v_cvt_pk_bf16_f32 v27, v30, v31
  v_exp_f32 v32, v32
  s_nop 0
  v_mfma_f32_32x32x16_bf16 v[176:191], v[236:239], v[24:27], v[176:191]
  ds_read_b128 v[236:239], v1 offset:23552
  ds_read_b128 v[208:211], v1 offset:12288
  ds_read_b128 v[212:215], v1 offset:13312
  v_exp_f32 v33, v33
  v_exp_f32 v34, v34
  s_waitcnt lgkmcnt(4)
  v_mfma_f32_32x32x16_bf16 v[48:63], v[220:223], v[204:207], v[48:63]
  v_exp_f32 v35, v35
  v_exp_f32 v36, v36
  v_exp_f32 v37, v37
  v_mfma_f32_32x32x16_bf16 v[112:127], v[128:131], v[24:27], v[112:127]
  v_exp_f32 v38, v38
  v_exp_f32 v39, v39
  v_cvt_pk_bf16_f32 v32, v32, v33
  v_cvt_pk_bf16_f32 v33, v34, v35
  v_cvt_pk_bf16_f32 v34, v36, v37
  v_cvt_pk_bf16_f32 v35, v38, v39
  v_exp_f32 v40, v40
  s_nop 0
  v_mfma_f32_32x32x16_bf16 v[176:191], v[224:227], v[32:35], v[176:191]
  ds_read_b128 v[224:227], v1 offset:14336
  v_exp_f32 v41, v41
  v_exp_f32 v42, v42
  v_exp_f32 v43, v43
  v_mfma_f32_32x32x16_bf16 v[112:127], v[128:131], v[32:35], v[112:127]
  v_exp_f32 v44, v44
  s_cmp_eq_u32 s12, 1
  s_nop 8
  s_cbranch_scc1 K1_TKD8
  s_waitcnt vmcnt(0)
  v_readfirstlane_b32 s8, v150
  v_readfirstlane_b32 s9, v151
  s_cmp_eq_u32 s12, 2
  s_nop 2
  s_cbranch_scc1 K1_TKB8
  s_cmp_lg_u32 s8, s35
  s_cbranch_scc1 K1_TKC8
  s_add_u32 m0, s15, 0
  s_add_u32 s8, s58, 0
  buffer_load_dwordx4 v3, s[44:47], s8 offen offset:0 sc1 lds
  buffer_load_dwordx4 v3, s[44:47], s8 offen offset:1024 sc1 lds
  s_add_u32 m0, s15, 4096
  s_add_u32 s8, s58, 4096
  buffer_load_dwordx4 v3, s[44:47], s8 offen offset:0 sc1 lds
  buffer_load_dwordx4 v3, s[44:47], s8 offen offset:1024 sc1 lds
  s_add_u32 m0, s15, 8192
  s_add_u32 s8, s58, 8192
  buffer_load_dwordx4 v3, s[44:47], s8 offen offset:0 sc1 lds
  buffer_load_dwordx4 v3, s[44:47], s8 offen offset:1024 sc1 lds
  s_add_u32 m0, s15, 12288
  s_add_u32 s8, s58, 12288
  buffer_load_dwordx4 v3, s[44:47], s8 offen offset:0 sc1 lds
  buffer_load_dwordx4 v3, s[44:47], s8 offen offset:1024 sc1 lds
  s_mov_b32 s12, 2
K1_TKB8:
  s_cmp_lg_u32 s9, s35
  s_cbranch_scc1 K1_TKC8
  s_add_u32 m0, s15, 0
  s_add_u32 s8, s58, 0
  buffer_load_dwordx4 v3, s[44:47], s8 offen offset:2048 sc1 lds
  buffer_load_dwordx4 v3, s[44:47], s8 offen offset:3072 sc1 lds
  s_add_u32 m0, s15, 4096
  s_add_u32 s8, s58, 4096
  buffer_load_dwordx4 v3, s[44:47], s8 offen offset:2048 sc1 lds
  buffer_load_dwordx4 v3, s[44:47], s8 offen offset:3072 sc1 lds
  s_add_u32 m0, s15, 8192
  s_add_u32 s8, s58, 8192
  buffer_load_dwordx4 v3, s[44:47], s8 offen offset:2048 sc1 lds
  buffer_load_dwordx4 v3, s[44:47], s8 offen offset:3072 sc1 lds
  s_add_u32 m0, s15, 12288
  s_add_u32 s8, s58, 12288
  buffer_load_dwordx4 v3, s[44:47], s8 offen offset:2048 sc1 lds
  buffer_load_dwordx4 v3, s[44:47], s8 offen offset:3072 sc1 lds
  s_mov_b32 s12, 1
  s_branch K1_TKD8
K1_TKC8:
  buffer_load_dwordx2 v[150:151], v13, s[44:47], 0 offen sc1
K1_TKD8:
  v_exp_f32 v45, v45
  v_exp_f32 v46, v46
  s_waitcnt lgkmcnt(2)
  v_mfma_f32_32x32x16_bf16 v[64:79], v[208:211], v[200:203], v[240:255]
  v_exp_f32 v47, v47
  v_cvt_pk_bf16_f32 v40, v40, v41
  v_cvt_pk_bf16_f32 v41, v42, v43
  v_cvt_pk_bf16_f32 v42, v44, v45
  v_cvt_pk_bf16_f32 v43, v46, v47
  s_waitcnt lgkmcnt(1)
  v_mfma_f32_32x32x16_bf16 v[64:79], v[212:215], v[204:207], v[64:79]
  v_exp_f32 v48, v48
  v_exp_f32 v49, v49
  v_exp_f32 v50, v50
  v_mfma_f32_32x32x16_bf16 v[176:191], v[228:231], v[40:43], v[176:191]
  ds_read_b128 v[228:231], v1 offset:15360
  v_exp_f32 v51, v51
  v_exp_f32 v52, v52
  v_exp_f32 v53, v53
  v_mfma_f32_32x32x16_bf16 v[112:127], v[128:131], v[40:43], v[112:127]
  v_exp_f32 v54, v54
  v_exp_f32 v55, v55
  v_cvt_pk_bf16_f32 v48, v48, v49
  v_cvt_pk_bf16_f32 v49, v50, v51
  v_cvt_pk_bf16_f32 v50, v52, v53
  v_cvt_pk_bf16_f32 v51, v54, v55
  v_exp_f32 v56, v56
  s_nop 0
  v_mfma_f32_32x32x16_bf16 v[176:191], v[232:235], v[48:51], v[176:191]
  v_exp_f32 v57, v57
  v_exp_f32 v58, v58
  v_exp_f32 v59, v59
  v_mfma_f32_32x32x16_bf16 v[112:127], v[128:131], v[48:51], v[112:127]
  v_exp_f32 v60, v60
  v_exp_f32 v61, v61
  v_exp_f32 v62, v62
  v_exp_f32 v63, v63
  v_cvt_pk_bf16_f32 v56, v56, v57
  v_cvt_pk_bf16_f32 v57, v58, v59
  v_cvt_pk_bf16_f32 v58, v60, v61
  v_cvt_pk_bf16_f32 v59, v62, v63
  v_exp_f32 v64, v64
  s_nop 0
  v_mfma_f32_32x32x16_bf16 v[176:191], v[236:239], v[56:59], v[176:191]
  v_exp_f32 v65, v65
  v_exp_f32 v66, v66
  v_exp_f32 v67, v67
  v_mfma_f32_32x32x16_bf16 v[112:127], v[128:131], v[56:59], v[112:127]
  v_exp_f32 v68, v68
  v_exp_f32 v69, v69
  v_exp_f32 v70, v70
  v_exp_f32 v71, v71
  v_cvt_pk_bf16_f32 v64, v64, v65
  v_cvt_pk_bf16_f32 v65, v66, v67
  v_cvt_pk_bf16_f32 v66, v68, v69
  v_cvt_pk_bf16_f32 v67, v70, v71
  v_exp_f32 v72, v72
  s_waitcnt lgkmcnt(1)
  v_mfma_f32_32x32x16_bf16 v[176:191], v[224:227], v[64:67], v[176:191]
  v_exp_f32 v73, v73
  v_exp_f32 v74, v74
  v_exp_f32 v75, v75
  v_mfma_f32_32x32x16_bf16 v[112:127], v[128:131], v[64:67], v[112:127]
  v_exp_f32 v76, v76
  v_exp_f32 v77, v77
  v_exp_f32 v78, v78
  v_exp_f32 v79, v79
  v_cvt_pk_bf16_f32 v72, v72, v73
  v_cvt_pk_bf16_f32 v73, v74, v75
  v_cvt_pk_bf16_f32 v74, v76, v77
  v_cvt_pk_bf16_f32 v75, v78, v79
  s_waitcnt lgkmcnt(0)
  s_nop 0
  v_mfma_f32_32x32x16_bf16 v[176:191], v[228:231], v[72:75], v[176:191]
  v_mfma_f32_32x32x16_bf16 v[112:127], v[128:131], v[72:75], v[112:127]
  s_nop 10
  s_branch K1_MID
K1_P1_2:
  ds_read_b128 v[208:211], v1 offset:0
  ds_read_b128 v[212:215], v1 offset:1024
  ds_read_b128 v[224:227], v1 offset:2048
  ds_read_b128 v[228:231], v1 offset:3072
  ds_read_b128 v[216:219], v1 offset:8192
  ds_read_b128 v[220:223], v1 offset:9216
  ds_read_b128 v[232:235], v1 offset:10240
  ds_read_b128 v[236:239], v1 offset:11264
  v_mov_b32 v128, 0x3f803f80
  v_mov_b32 v129, 0x3f803f80
  v_mov_b32 v130, 0x3f803f80
  v_mov_b32 v131, 0x3f803f80
  v_lshrrev_b32 v155, 5, v0
  v_and_b32 v154, 31, v0
  v_lshlrev_b32 v155, 2, v155
  v_sub_u32 v154, v154, v155
  v_mov_b32 v155, 0
  s_cmp_eq_u32 s34, 0
  s_cbranch_scc1 K1_CPA9
  v_mov_b32 v150, s35
  v_mov_b32 v151, s11
  s_waitcnt vmcnt(8)
  s_mov_b64 exec, 1
  buffer_store_dword v150, v151, s[44:47], 0 offen offset:0 sc1
  s_mov_b64 exec, -1
K1_CPA9:
  v_mov_b32 v156, 0xf149f2ca
  v_cmp_le_i32 s[80:81], 0, v154
  v_cmp_le_i32 s[82:83], 1, v154
  v_cmp_le_i32 s[84:85], 2, v154
  v_cmp_le_i32 s[86:87], 3, v154
  v_cndmask_b32 v240, v156, v155, s[80:81]
  v_cndmask_b32 v241, v156, v155, s[82:83]
  v_cndmask_b32 v242, v156, v155, s[84:85]
  v_cndmask_b32 v243, v156, v155, s[86:87]
  v_cmp_le_i32 s[80:81], 8, v154
  v_cmp_le_i32 s[82:83], 9, v154
  v_cmp_le_i32 s[84:85], 10, v154
  v_cmp_le_i32 s[86:87], 11, v154
  v_cndmask_b32 v244, v156, v155, s[80:81]
  v_cndmask_b32 v245, v156, v155, s[82:83]
  v_cndmask_b32 v246, v156, v155, s[84:85]
  v_cndmask_b32 v247, v156, v155, s[86:87]
  v_cmp_le_i32 s[80:81], 16, v154
  v_cmp_le_i32 s[82:83], 17, v154
  v_cmp_le_i32 s[84:85], 18, v154
  v_cmp_le_i32 s[86:87], 19, v154
  v_cndmask_b32 v248, v156, v155, s[80:81]
  v_cndmask_b32 v249, v156, v155, s[82:83]
  s_waitcnt lgkmcnt(7)
  v_mfma_f32_32x32x16_bf16 v[16:31], v[208:211], v[200:203], 0
  v_cndmask_b32 v250, v156, v155, s[84:85]
  v_cndmask_b32 v251, v156, v155, s[86:87]
  v_cmp_le_i32 s[80:81], 24, v154
  v_cmp_le_i32 s[82:83], 25, v154
  v_cmp_le_i32 s[84:85], 26, v154
  v_cmp_le_i32 s[86:87], 27, v154
  v_mfma_f32_32x32x16_bf16 v[32:47], v[208:211], v[192:195], 0
  ds_read_b128 v[208:211], v1 offset:16384
  v_cndmask_b32 v252, v156, v155, s[80:81]
  v_cndmask_b32 v253, v156, v155, s[82:83]
  v_cndmask_b32 v254, v156, v155, s[84:85]
  v_cndmask_b32 v255, v156, v155, s[86:87]
  s_waitcnt lgkmcnt(7)
  v_mfma_f32_32x32x16_bf16 v[16:31], v[212:215], v[204:207], v[16:31]
  v_mfma_f32_32x32x16_bf16 v[32:47], v[212:215], v[196:199], v[32:47]
  ds_read_b128 v[212:215], v1 offset:17408
  s_waitcnt lgkmcnt(5)
  v_mfma_f32_32x32x16_bf16 v[48:63], v[216:219], v[200:203], 0
  s_nop 7
  v_exp_f32 v16, v16
  v_exp_f32 v17, v17
  v_exp_f32 v18, v18
  v_mfma_f32_32x32x16_bf16 v[64:79], v[216:219], v[192:195], 0
  v_exp_f32 v19, v19
  v_exp_f32 v20, v20
  v_exp_f32 v21, v21
  s_waitcnt lgkmcnt(4)
  v_mfma_f32_32x32x16_bf16 v[48:63], v[220:223], v[204:207], v[48:63]
  v_exp_f32 v22, v22
  v_exp_f32 v23, v23
  v_exp_f32 v32, v32
  v_mfma_f32_32x32x16_bf16 v[64:79], v[220:223], v[196:199], v[64:79]
  v_exp_f32 v33, v33
  v_cvt_pk_bf16_f32 v16, v16, v17
  v_exp_f32 v34, v34
  v_exp_f32 v35, v35
  s_waitcnt lgkmcnt(1)
  v_mfma_f32_32x32x16_bf16 v[80:95], v[208:211], v[200:203], 0
  v_cvt_pk_bf16_f32 v17, v18, v19
  v_exp_f32 v36, v36
  v_exp_f32 v37, v37
  v_exp_f32 v38, v38
  s_waitcnt lgkmcnt(0)
  v_mfma_f32_32x32x16_bf16 v[80:95], v[212:215], v[204:207], v[80:95]
  v_exp_f32 v39, v39
  v_cvt_pk_bf16_f32 v18, v20, v21
  v_cvt_pk_bf16_f32 v19, v22, v23
  v_cvt_pk_bf16_f32 v32, v32, v33
  v_cvt_pk_bf16_f32 v33, v34, v35
  v_mfma_f32_32x32x16_bf16 v[176:191], v[224:227], v[16:19], 0
  v_exp_f32 v24, v24
  v_exp_f32 v25, v25
  v_cvt_pk_bf16_f32 v34, v36, v37
  v_cvt_pk_bf16_f32 v35, v38, v39
  v_mfma_f32_32x32x16_bf16 v[112:127], v[128:131], v[16:19], 0
  v_exp_f32 v26, v26
  v_exp_f32 v27, v27
  v_exp_f32 v28, v28
  v_mfma_f32_32x32x16_bf16 v[160:175], v[224:227], v[32:35], 0
  ds_read_b128 v[224:227], v1 offset:18432
  v_exp_f32 v29, v29
  v_exp_f32 v30, v30
  v_exp_f32 v31, v31
  v_mfma_f32_32x32x16_bf16 v[96:111], v[128:131], v[32:35], 0
  v_exp_f32 v40, v40
  v_exp_f32 v41, v41
  v_cvt_pk_bf16_f32 v24, v24, v25
  v_exp_f32 v42, v42
  v_exp_f32 v43, v43
  v_cvt_pk_bf16_f32 v25, v26, v27
  v_exp_f32 v44, v44
  v_exp_f32 v45, v45
  v_exp_f32 v46, v46
  v_exp_f32 v47, v47
  v_cvt_pk_bf16_f32 v26, v28, v29
  v_cvt_pk_bf16_f32 v27, v30, v31
  v_cvt_pk_bf16_f32 v40, v40, v41
  v_cvt_pk_bf16_f32 v41, v42, v43
  v_mfma_f32_32x32x16_bf16 v[176:191], v[228:231], v[24:27], v[176:191]
  v_cvt_pk_bf16_f32 v42, v44, v45
  v_cvt_pk_bf16_f32 v43, v46, v47
  v_exp_f32 v48, v48
  v_exp_f32 v49, v49
  v_mfma_f32_32x32x16_bf16 v[112:127], v[128:131], v[24:27], v[112:127]
  v_exp_f32 v64, v64
  v_exp_f32 v65, v65
  v_exp_f32 v50, v50
  v_mfma_f32_32x32x16_bf16 v[16:31], v[208:211], v[192:195], v[240:255]
  v_exp_f32 v51, v51
  v_exp_f32 v66, v66
  v_exp_f32 v67, v67
  v_mfma_f32_32x32x16_bf16 v[160:175], v[228:231], v[40:43], v[160:175]
  ds_read_b128 v[228:231], v1 offset:19456
  ds_read_b128 v[216:219], v1 offset:24576
  ds_read_b128 v[220:223], v1 offset:25600
  v_exp_f32 v52, v52
  v_exp_f32 v53, v53
  v_mfma_f32_32x32x16_bf16 v[16:31], v[212:215], v[196:199], v[16:31]
  v_exp_f32 v54, v54
  v_exp_f32 v55, v55
  v_exp_f32 v68, v68
  v_mfma_f32_32x32x16_bf16 v[96:111], v[128:131], v[40:43], v[96:111]
  v_exp_f32 v69, v69
  v_exp_f32 v70, v70
  v_exp_f32 v71, v71
  v_cvt_pk_bf16_f32 v48, v48, v49
  v_cvt_pk_bf16_f32 v64, v64, v65
  v_cvt_pk_bf16_f32 v49, v50, v51
  v_cvt_pk_bf16_f32 v65, v66, v67
  v_cvt_pk_bf16_f32 v50, v52, v53
  v_cvt_pk_bf16_f32 v51, v54, v55
  v_cvt_pk_bf16_f32 v66, v68, v69
  v_cvt_pk_bf16_f32 v67, v70, v71
  v_mfma_f32_32x32x16_bf16 v[176:191], v[232:235], v[48:51], v[176:191]
  v_exp_f32 v56, v56
  v_exp_f32 v57, v57
  v_exp_f32 v72, v72
  s_cmp_eq_u32 s34, 0
  s_nop 6
  s_cbranch_scc1 K1_CPA10
  v_mov_b32 v150, s35
  v_mov_b32 v151, s11
  s_waitcnt vmcnt(1)
  s_mov_b64 exec, 1
  buffer_store_dword v150, v151, s[44:47], 0 offen offset:4 sc1
  s_mov_b64 exec, -1
K1_CPA10:
  v_mfma_f32_32x32x16_bf16 v[160:175], v[232:235], v[64:67], v[160:175]
  ds_read_b128 v[232:235], v1 offset:26624
  v_exp_f32 v73, v73
  v_exp_f32 v58, v58
  v_exp_f32 v59, v59
  s_waitcnt lgkmcnt(2)
  v_mfma_f32_32x32x16_bf16 v[32:47], v[216:219], v[200:203], 0
  v_exp_f32 v74, v74
  v_exp_f32 v75, v75
  v_exp_f32 v60, v60
  s_waitcnt lgkmcnt(1)
  v_mfma_f32_32x32x16_bf16 v[32:47], v[220:223], v[204:207], v[32:47]
  v_exp_f32 v61, v61
  v_exp_f32 v62, v62
  v_exp_f32 v63, v63
  v_mfma_f32_32x32x16_bf16 v[112:127], v[128:131], v[48:51], v[112:127]
  v_exp_f32 v76, v76
  v_exp_f32 v77, v77
  v_exp_f32 v78, v78
  v_mfma_f32_32x32x16_bf16 v[96:111], v[128:131], v[64:67], v[96:111]
  v_exp_f32 v79, v79
  v_cvt_pk_bf16_f32 v56, v56, v57
  v_cvt_pk_bf16_f32 v72, v72, v73
  v_cvt_pk_bf16_f32 v57, v58, v59
  v_cvt_pk_bf16_f32 v73, v74, v75
  v_cvt_pk_bf16_f32 v58, v60, v61
  v_cvt_pk_bf16_f32 v59, v62, v63
  v_cvt_pk_bf16_f32 v74, v76, v77
  v_cvt_pk_bf16_f32 v75, v78, v79
  v_mfma_f32_32x32x16_bf16 v[176:191], v[236:239], v[56:59], v[176:191]
  v_exp_f32 v80, v80
  v_exp_f32 v81, v81
  v_exp_f32 v16, v16
  v_mfma_f32_32x32x16_bf16 v[160:175], v[236:239], v[72:75], v[160:175]
  ds_read_b128 v[236:239], v1 offset:27648
  ds_read_b128 v[208:211], v1 offset:28672
  ds_read_b128 v[212:215], v1 offset:29696
  v_exp_f32 v17, v17
  v_exp_f32 v82, v82
  v_mfma_f32_32x32x16_bf16 v[112:127], v[128:131], v[56:59], v[112:127]
  v_exp_f32 v83, v83
  v_exp_f32 v18, v18
  v_exp_f32 v19, v19
  v_mfma_f32_32x32x16_bf16 v[96:111], v[128:131], v[72:75], v[96:111]
  v_exp_f32 v84, v84
  v_exp_f32 v85, v85
  v_exp_f32 v86, v86
  v_exp_f32 v87, v87
  v_exp_f32 v20, v20
  v_exp_f32 v21, v21
  v_exp_f32 v22, v22
  v_exp_f32 v23, v23
  s_cmp_eq_u32 s12, 1
  s_nop 1
  s_cbranch_scc1 K1_CPB11
  buffer_load_dwordx2 v[150:151], v13, s[44:47], 0 offen sc1
K1_CPB11:
  v_cvt_pk_bf16_f32 v80, v80, v81
  v_cvt_pk_bf16_f32 v16, v16, v17
  v_cvt_pk_bf16_f32 v81, v82, v83
  v_cvt_pk_bf16_f32 v17, v18, v19
  v_cvt_pk_bf16_f32 v82, v84, v85
  v_cvt_pk_bf16_f32 v83, v86, v87
  v_cvt_pk_bf16_f32 v18, v20, v21
  s_waitcnt lgkmcnt(1)
  v_mfma_f32_32x32x16_bf16 v[48:63], v[208:211], v[200:203], 0
  v_cvt_pk_bf16_f32 v19, v22, v23
  v_exp_f32 v88, v88
  v_exp_f32 v89, v89
  v_exp_f32 v24, v24
  v_mfma_f32_32x32x16_bf16 v[176:191], v[224:227], v[80:83], v[176:191]
  v_exp_f32 v25, v25
  v_exp_f32 v90, v90
  v_exp_f32 v91, v91
  v_mfma_f32_32x32x16_bf16 v[160:175], v[224:227], v[16:19], v[160:175]
  ds_read_b128 v[224:227], v1 offset:30720
  v_exp_f32 v26, v26
  v_exp_f32 v27, v27
  v_exp_f32 v92, v92
  v_mfma_f32_32x32x16_bf16 v[112:127], v[128:131], v[80:83], v[112:127]
  v_exp_f32 v93, v93
  v_exp_f32 v94, v94
  v_exp_f32 v95, v95
  s_waitcnt lgkmcnt(1)
  v_mfma_f32_32x32x16_bf16 v[48:63], v[212:215], v[204:207], v[48:63]
  v_exp_f32 v28, v28
  v_exp_f32 v29, v29
  v_exp_f32 v30, v30
  v_mfma_f32_32x32x16_bf16 v[96:111], v[128:131], v[16:19], v[96:111]
  v_exp_f32 v31, v31
  v_cvt_pk_bf16_f32 v88, v88, v89
  v_cvt_pk_bf16_f32 v24, v24, v25
  v_cvt_pk_bf16_f32 v89, v90, v91
  v_cvt_pk_bf16_f32 v25, v26, v27
  v_cvt_pk_bf16_f32 v90, v92, v93
  v_cvt_pk_bf16_f32 v91, v94, v95
  v_cvt_pk_bf16_f32 v26, v28, v29
  v_cvt_pk_bf16_f32 v27, v30, v31
  v_mfma_f32_32x32x16_bf16 v[176:191], v[228:231], v[88:91], v[176:191]
  v_exp_f32 v32, v32
  v_exp_f32 v33, v33
  v_exp_f32 v34, v34
  v_mfma_f32_32x32x16_bf16 v[160:175], v[228:231], v[24:27], v[160:175]
  ds_read_b128 v[228:231], v1 offset:31744
  ds_read_b128 v[216:219], v1 offset:20480
  ds_read_b128 v[220:223], v1 offset:21504
  v_exp_f32 v35, v35
  v_exp_f32 v36, v36
  v_mfma_f32_32x32x16_bf16 v[112:127], v[128:131], v[88:91], v[112:127]
  v_exp_f32 v37, v37
  v_exp_f32 v38, v38
  v_exp_f32 v39, v39
  v_mfma_f32_32x32x16_bf16 v[96:111], v[128:131], v[24:27], v[96:111]
  v_cvt_pk_bf16_f32 v32, v32, v33
  v_cvt_pk_bf16_f32 v33, v34, v35
  v_cvt_pk_bf16_f32 v34, v36, v37
  v_cvt_pk_bf16_f32 v35, v38, v39
  v_exp_f32 v40, v40
  s_nop 0
  v_mfma_f32_32x32x16_bf16 v[176:191], v[232:235], v[32:35], v[176:191]
  ds_read_b128 v[232:235], v1 offset:22528
  v_exp_f32 v41, v41
  v_exp_f32 v42, v42
  v_exp_f32 v43, v43
  v_mfma_f32_32x32x16_bf16 v[112:127], v[128:131], v[32:35], v[112:127]
  v_exp_f32 v44, v44
  v_exp_f32 v45, v45
  s_cmp_eq_u32 s12, 1
  s_nop 7
  s_cbranch_scc1 K1_TKD12
  s_waitcnt vmcnt(0)
  v_readfirstlane_b32 s8, v150
  v_readfirstlane_b32 s9, v151
  s_cmp_eq_u32 s12, 2
  s_nop 2
  s_cbranch_scc1 K1_TKB12
  s_cmp_lg_u32 s8, s35
  s_cbranch_scc1 K1_TKC12
  s_add_u32 m0, s15, 0
  s_add_u32 s8, s58, 0
  buffer_load_dwordx4 v3, s[44:47], s8 offen offset:0 sc1 lds
  buffer_load_dwordx4 v3, s[44:47], s8 offen offset:1024 sc1 lds
  s_add_u32 m0, s15, 4096
  s_add_u32 s8, s58, 4096
  buffer_load_dwordx4 v3, s[44:47], s8 offen offset:0 sc1 lds
  buffer_load_dwordx4 v3, s[44:47], s8 offen offset:1024 sc1 lds
  s_add_u32 m0, s15, 8192
  s_add_u32 s8, s58, 8192
  buffer_load_dwordx4 v3, s[44:47], s8 offen offset:0 sc1 lds
  buffer_load_dwordx4 v3, s[44:47], s8 offen offset:1024 sc1 lds
  s_add_u32 m0, s15, 12288
  s_add_u32 s8, s58, 12288
  buffer_load_dwordx4 v3, s[44:47], s8 offen offset:0 sc1 lds
  buffer_load_dwordx4 v3, s[44:47], s8 offen offset:1024 sc1 lds
  s_mov_b32 s12, 2
K1_TKB12:
  s_cmp_lg_u32 s9, s35
  s_cbranch_scc1 K1_TKC12
  s_add_u32 m0, s15, 0
  s_add_u32 s8, s58, 0
  buffer_load_dwordx4 v3, s[44:47], s8 offen offset:2048 sc1 lds
  buffer_load_dwordx4 v3, s[44:47], s8 offen offset:3072 sc1 lds
  s_add_u32 m0, s15, 4096
  s_add_u32 s8, s58, 4096
  buffer_load_dwordx4 v3, s[44:47], s8 offen offset:2048 sc1 lds
  buffer_load_dwordx4 v3, s[44:47], s8 offen offset:3072 sc1 lds
  s_add_u32 m0, s15, 8192
  s_add_u32 s8, s58, 8192
  buffer_load_dwordx4 v3, s[44:47], s8 offen offset:2048 sc1 lds
  buffer_load_dwordx4 v3, s[44:47], s8 offen offset:3072 sc1 lds
  s_add_u32 m0, s15, 12288
  s_add_u32 s8, s58, 12288
  buffer_load_dwordx4 v3, s[44:47], s8 offen offset:2048 sc1 lds
  buffer_load_dwordx4 v3, s[44:47], s8 offen offset:3072 sc1 lds
  s_mov_b32 s12, 1
  s_branch K1_TKD12
K1_TKC12:
  buffer_load_dwordx2 v[150:151], v13, s[44:47], 0 offen sc1
K1_TKD12:
  v_exp_f32 v46, v46
  s_waitcnt lgkmcnt(2)
  v_mfma_f32_32x32x16_bf16 v[64:79], v[216:219], v[200:203], v[240:255]
  v_exp_f32 v47, v47
  v_cvt_pk_bf16_f32 v40, v40, v41
  v_cvt_pk_bf16_f32 v41, v42, v43
  v_cvt_pk_bf16_f32 v42, v44, v45
  v_cvt_pk_bf16_f32 v43, v46, v47
  s_waitcnt lgkmcnt(1)
  v_mfma_f32_32x32x16_bf16 v[64:79], v[220:223], v[204:207], v[64:79]
  v_exp_f32 v48, v48
  v_exp_f32 v49, v49
  v_exp_f32 v50, v50
  v_mfma_f32_32x32x16_bf16 v[176:191], v[236:239], v[40:43], v[176:191]
  ds_read_b128 v[236:239], v1 offset:23552
  v_exp_f32 v51, v51
  v_exp_f32 v52, v52
  v_exp_f32 v53, v53
  v_mfma_f32_32x32x16_bf16 v[112:127], v[128:131], v[40:43], v[112:127]
  v_exp_f32 v54, v54
  v_exp_f32 v55, v55
  v_cvt_pk_bf16_f32 v48, v48, v49
  v_cvt_pk_bf16_f32 v49, v50, v51
  v_cvt_pk_bf16_f32 v50, v52, v53
  v_cvt_pk_bf16_f32 v51, v54, v55
  v_exp_f32 v56, v56
  s_nop 0
  v_mfma_f32_32x32x16_bf16 v[176:191], v[224:227], v[48:51], v[176:191]
  v_exp_f32 v57, v57
  v_exp_f32 v58, v58
  v_exp_f32 v59, v59
  v_mfma_f32_32x32x16_bf16 v[112:127], v[128:131], v[48:51], v[112:127]
  v_exp_f32 v60, v60
  v_exp_f32 v61, v61
  v_exp_f32 v62, v62
  v_exp_f32 v63, v63
  v_cvt_pk_bf16_f32 v56, v56, v57
  v_cvt_pk_bf16_f32 v57, v58, v59
  v_cvt_pk_bf16_f32 v58, v60, v61
  v_cvt_pk_bf16_f32 v59, v62, v63
  v_exp_f32 v64, v64
  s_nop 0
  v_mfma_f32_32x32x16_bf16 v[176:191], v[228:231], v[56:59], v[176:191]
  v_exp_f32 v65, v65
  v_exp_f32 v66, v66
  v_exp_f32 v67, v67
  v_mfma_f32_32x32x16_bf16 v[112:127], v[128:131], v[56:59], v[112:127]
  v_exp_f32 v68, v68
  v_exp_f32 v69, v69
  v_exp_f32 v70, v70
  v_exp_f32 v71, v71
  v_cvt_pk_bf16_f32 v64, v64, v65
  v_cvt_pk_bf16_f32 v65, v66, v67
  v_cvt_pk_bf16_f32 v66, v68, v69
  v_cvt_pk_bf16_f32 v67, v70, v71
  v_exp_f32 v72, v72
  s_waitcnt lgkmcnt(1)
  v_mfma_f32_32x32x16_bf16 v[176:191], v[232:235], v[64:67], v[176:191]
  v_exp_f32 v73, v73
  v_exp_f32 v74, v74
  v_exp_f32 v75, v75
  v_mfma_f32_32x32x16_bf16 v[112:127], v[128:131], v[64:67], v[112:127]
  v_exp_f32 v76, v76
  v_exp_f32 v77, v77
  v_exp_f32 v78, v78
  v_exp_f32 v79, v79
  v_cvt_pk_bf16_f32 v72, v72, v73
  v_cvt_pk_bf16_f32 v73, v74, v75
  v_cvt_pk_bf16_f32 v74, v76, v77
  v_cvt_pk_bf16_f32 v75, v78, v79
  s_waitcnt lgkmcnt(0)
  s_nop 0
  v_mfma_f32_32x32x16_bf16 v[176:191], v[236:239], v[72:75], v[176:191]
  v_mfma_f32_32x32x16_bf16 v[112:127], v[128:131], v[72:75], v[112:127]
  s_nop 10
  s_branch K1_MID
K1_P1_3:
  ds_read_b128 v[208:211], v1 offset:0
  ds_read_b128 v[212:215], v1 offset:1024
  ds_read_b128 v[224:227], v1 offset:2048
  ds_read_b128 v[228:231], v1 offset:3072
  ds_read_b128 v[216:219], v1 offset:8192
  ds_read_b128 v[220:223], v1 offset:9216
  ds_read_b128 v[232:235], v1 offset:10240
  ds_read_b128 v[236:239], v1 offset:11264
  v_mov_b32 v128, 0x3f803f80
  v_mov_b32 v129, 0x3f803f80
  v_mov_b32 v130, 0x3f803f80
  v_mov_b32 v131, 0x3f803f80
  v_lshrrev_b32 v155, 5, v0
  v_and_b32 v154, 31, v0
  v_lshlrev_b32 v155, 2, v155
  v_sub_u32 v154, v154, v155
  v_mov_b32 v155, 0
  s_cmp_eq_u32 s34, 0
  s_cbranch_scc1 K1_CPA13
  v_mov_b32 v150, s35
  v_mov_b32 v151, s11
  s_waitcnt vmcnt(8)
  s_mov_b64 exec, 1
  buffer_store_dword v150, v151, s[44:47], 0 offen offset:0 sc1
  s_mov_b64 exec, -1
K1_CPA13:
  v_mov_b32 v156, 0xf149f2ca
  v_cmp_le_i32 s[80:81], 0, v154
  v_cmp_le_i32 s[82:83], 1, v154
  v_cmp_le_i32 s[84:85], 2, v154
  v_cmp_le_i32 s[86:87], 3, v154
  v_cndmask_b32 v240, v156, v155, s[80:81]
  v_cndmask_b32 v241, v156, v155, s[82:83]
  v_cndmask_b32 v242, v156, v155, s[84:85]
  v_cndmask_b32 v243, v156, v155, s[86:87]
  v_cmp_le_i32 s[80:81], 8, v154
  v_cmp_le_i32 s[82:83], 9, v154
  v_cmp_le_i32 s[84:85], 10, v154
  v_cmp_le_i32 s[86:87], 11, v154
  v_cndmask_b32 v244, v156, v155, s[80:81]
  v_cndmask_b32 v245, v156, v155, s[82:83]
  v_cndmask_b32 v246, v156, v155, s[84:85]
  v_cndmask_b32 v247, v156, v155, s[86:87]
  v_cmp_le_i32 s[80:81], 16, v154
  v_cmp_le_i32 s[82:83], 17, v154
  v_cmp_le_i32 s[84:85], 18, v154
  v_cmp_le_i32 s[86:87], 19, v154
  v_cndmask_b32 v248, v156, v155, s[80:81]
  v_cndmask_b32 v249, v156, v155, s[82:83]
  s_waitcnt lgkmcnt(7)
  v_mfma_f32_32x32x16_bf16 v[16:31], v[208:211], v[200:203], 0
  v_cndmask_b32 v250, v156, v155, s[84:85]
  v_cndmask_b32 v251, v156, v155, s[86:87]
  v_cmp_le_i32 s[80:81], 24, v154
  v_cmp_le_i32 s[82:83], 25, v154
  v_cmp_le_i32 s[84:85], 26, v154
  v_cmp_le_i32 s[86:87], 27, v154
  v_mfma_f32_32x32x16_bf16 v[32:47], v[208:211], v[192:195], 0
  ds_read_b128 v[208:211], v1 offset:16384
  v_cndmask_b32 v252, v156, v155, s[80:81]
  v_cndmask_b32 v253, v156, v155, s[82:83]
  v_cndmask_b32 v254, v156, v155, s[84:85]
  v_cndmask_b32 v255, v156, v155, s[86:87]
  s_waitcnt lgkmcnt(7)
  v_mfma_f32_32x32x16_bf16 v[16:31], v[212:215], v[204:207], v[16:31]
  v_mfma_f32_32x32x16_bf16 v[32:47], v[212:215], v[196:199], v[32:47]
  ds_read_b128 v[212:215], v1 offset:17408
  s_waitcnt lgkmcnt(5)
  v_mfma_f32_32x32x16_bf16 v[48:63], v[216:219], v[200:203], 0
  s_nop 7
  v_exp_f32 v16, v16
  v_exp_f32 v17, v17
  v_exp_f32 v18, v18
  v_mfma_f32_32x32x16_bf16 v[64:79], v[216:219], v[192:195], 0
  v_exp_f32 v32, v32
  v_exp_f32 v33, v33
  v_exp_f32 v19, v19
  s_waitcnt lgkmcnt(4)
  v_mfma_f32_32x32x16_bf16 v[48:63], v[220:223], v[204:207], v[48:63]
  v_exp_f32 v34, v34
  v_exp_f32 v35, v35
  v_exp_f32 v20, v20
  v_mfma_f32_32x32x16_bf16 v[64:79], v[220:223], v[196:199], v[64:79]
  v_exp_f32 v21, v21
  v_exp_f32 v22, v22
  v_exp_f32 v23, v23
  s_waitcnt lgkmcnt(1)
  v_mfma_f32_32x32x16_bf16 v[80:95], v[208:211], v[200:203], 0
  v_exp_f32 v36, v36
  v_exp_f32 v37, v37
  v_exp_f32 v38, v38
  s_waitcnt lgkmcnt(0)
  v_mfma_f32_32x32x16_bf16 v[80:95], v[212:215], v[204:207], v[80:95]
  v_exp_f32 v39, v39
  v_cvt_pk_bf16_f32 v16, v16, v17
  v_cvt_pk_bf16_f32 v32, v32, v33
  v_cvt_pk_bf16_f32 v17, v18, v19
  v_cvt_pk_bf16_f32 v33, v34, v35
  v_cvt_pk_bf16_f32 v18, v20, v21
  v_cvt_pk_bf16_f32 v19, v22, v23
  v_cvt_pk_bf16_f32 v34, v36, v37
  v_cvt_pk_bf16_f32 v35, v38, v39
  v_mfma_f32_32x32x16_bf16 v[176:191], v[224:227], v[16:19], 0
  v_exp_f32 v24, v24
  v_exp_f32 v25, v25
  v_exp_f32 v40, v40
  v_mfma_f32_32x32x16_bf16 v[160:175], v[224:227], v[32:35], 0
  ds_read_b128 v[224:227], v1 offset:18432
  v_exp_f32 v41, v41
  v_exp_f32 v26, v26
  v_exp_f32 v27, v27
  v_mfma_f32_32x32x16_bf16 v[112:127], v[128:131], v[16:19], 0
  v_exp_f32 v42, v42
  v_exp_f32 v43, v43
  v_exp_f32 v28, v28
  v_mfma_f32_32x32x16_bf16 v[96:111], v[128:131], v[32:35], 0
  v_exp_f32 v29, v29
  v_exp_f32 v30, v30
  v_exp_f32 v31, v31
  v_exp_f32 v44, v44
  v_exp_f32 v45, v45
  v_exp_f32 v46, v46
  v_exp_f32 v47, v47
  v_cvt_pk_bf16_f32 v24, v24, v25
  v_cvt_pk_bf16_f32 v40, v40, v41
  v_cvt_pk_bf16_f32 v25, v26, v27
  v_cvt_pk_bf16_f32 v41, v42, v43
  v_cvt_pk_bf16_f32 v26, v28, v29
  v_cvt_pk_bf16_f32 v27, v30, v31
  v_cvt_pk_bf16_f32 v42, v44, v45
  v_cvt_pk_bf16_f32 v43, v46, v47
  v_mfma_f32_32x32x16_bf16 v[176:191], v[228:231], v[24:27], v[176:191]
  v_exp_f32 v48, v48
  v_exp_f32 v49, v49
  v_exp_f32 v64, v64
  v_mfma_f32_32x32x16_bf16 v[160:175], v[228:231], v[40:43], v[160:175]
  ds_read_b128 v[228:231], v1 offset:19456
  ds_read_b128 v[216:219], v1 offset:24576
  ds_read_b128 v[220:223], v1 offset:25600
  v_exp_f32 v65, v65
  v_exp_f32 v50, v50
  v_mfma_f32_32x32x16_bf16 v[112:127], v[128:131], v[24:27], v[112:127]
  v_exp_f32 v51, v51
  v_exp_f32 v66, v66
  v_exp_f32 v67, v67
  v_mfma_f32_32x32x16_bf16 v[16:31], v[208:211], v[192:195], 0
  v_exp_f32 v52, v52
  v_exp_f32 v53, v53
  v_exp_f32 v54, v54
  v_mfma_f32_32x32x16_bf16 v[16:31], v[212:215], v[196:199], v[16:31]
  v_exp_f32 v55, v55
  v_exp_f32 v68, v68
  v_exp_f32 v69, v69
  v_mfma_f32_32x32x16_bf16 v[96:111], v[128:131], v[40:43], v[96:111]
  v_exp_f32 v70, v70
  v_exp_f32 v71, v71
  v_cvt_pk_bf16_f32 v48, v48, v49
  v_cvt_pk_bf16_f32 v64, v64, v65
  v_cvt_pk_bf16_f32 v49, v50, v51
  v_cvt_pk_bf16_f32 v65, v66, v67
  s_waitcnt lgkmcnt(1)
  v_mfma_f32_32x32x16_bf16 v[32:47], v[216:219], v[200:203], 0
  v_cvt_pk_bf16_f32 v50, v52, v53
  v_cvt_pk_bf16_f32 v51, v54, v55
  v_cvt_pk_bf16_f32 v66, v68, v69
  v_cvt_pk_bf16_f32 v67, v70, v71
  v_exp_f32 v56, v56
  s_cmp_eq_u32 s34, 0
  s_nop 4
  s_cbranch_scc1 K1_CPA14
  v_mov_b32 v150, s35
  v_mov_b32 v151, s11
  s_waitcnt vmcnt(1)
  s_mov_b64 exec, 1
  buffer_store_dword v150, v151, s[44:47], 0 offen offset:4 sc1
  s_mov_b64 exec, -1
K1_CPA14:
  v_mfma_f32_32x32x16_bf16 v[176:191], v[232:235], v[48:51], v[176:191]
  v_exp_f32 v57, v57
  v_exp_f32 v72, v72
  v_exp_f32 v73, v73
  v_mfma_f32_32x32x16_bf16 v[160:175], v[232:235], v[64:67], v[160:175]
  ds_read_b128 v[232:235], v1 offset:26624
  v_exp_f32 v58, v58
  v_exp_f32 v59, v59
  v_exp_f32 v74, v74
  v_mfma_f32_32x32x16_bf16 v[112:127], v[128:131], v[48:51], v[112:127]
  v_exp_f32 v75, v75
  v_exp_f32 v60, v60
  v_exp_f32 v61, v61
  v_mfma_f32_32x32x16_bf16 v[96:111], v[128:131], v[64:67], v[96:111]
  v_exp_f32 v62, v62
  v_exp_f32 v63, v63
  v_exp_f32 v76, v76
  s_waitcnt lgkmcnt(1)
  v_mfma_f32_32x32x16_bf16 v[32:47], v[220:223], v[204:207], v[32:47]
  v_exp_f32 v77, v77
  v_exp_f32 v78, v78
  v_exp_f32 v79, v79
  v_cvt_pk_bf16_f32 v56, v56, v57
  v_cvt_pk_bf16_f32 v72, v72, v73
  v_cvt_pk_bf16_f32 v57, v58, v59
  v_cvt_pk_bf16_f32 v73, v74, v75
  v_cvt_pk_bf16_f32 v58, v60, v61
  v_cvt_pk_bf16_f32 v59, v62, v63
  v_cvt_pk_bf16_f32 v74, v76, v77
  v_cvt_pk_bf16_f32 v75, v78, v79
  v_mfma_f32_32x32x16_bf16 v[176:191], v[236:239], v[56:59], v[176:191]
  v_exp_f32 v80, v80
  v_exp_f32 v81, v81
  v_exp_f32 v16, v16
  v_mfma_f32_32x32x16_bf16 v[160:175], v[236:239], v[72:75], v[160:175]
  ds_read_b128 v[236:239], v1 offset:27648
  ds_read_b128 v[208:211], v1 offset:28672
  ds_read_b128 v[212:215], v1 offset:29696
  v_exp_f32 v17, v17
  v_exp_f32 v82, v82
  v_mfma_f32_32x32x16_bf16 v[112:127], v[128:131], v[56:59], v[112:127]
  v_exp_f32 v83, v83
  v_exp_f32 v18, v18
  v_exp_f32 v19, v19
  v_mfma_f32_32x32x16_bf16 v[96:111], v[128:131], v[72:75], v[96:111]
  v_exp_f32 v84, v84
  v_exp_f32 v85, v85
  v_exp_f32 v86, v86
  v_mfma_f32_32x32x16_bf16 v[48:63], v[216:219], v[192:195], v[240:255]
  v_exp_f32 v87, v87
  v_exp_f32 v20, v20
  s_cmp_eq_u32 s12, 1
  s_nop 7
  s_cbranch_scc1 K1_CPB15
  buffer_load_dwordx2 v[150:151], v13, s[44:47], 0 offen sc1
K1_CPB15:
  v_exp_f32 v21, v21
  v_mfma_f32_32x32x16_bf16 v[48:63], v[220:223], v[196:199], v[48:63]
  v_exp_f32 v22, v22
  v_exp_f32 v23, v23
  v_cvt_pk_bf16_f32 v80, v80, v81
  v_cvt_pk_bf16_f32 v16, v16, v17
  v_cvt_pk_bf16_f32 v81, v82, v83
  v_cvt_pk_bf16_f32 v17, v18, v19
  s_waitcnt lgkmcnt(1)
  v_mfma_f32_32x32x16_bf16 v[64:79], v[208:211], v[200:203], v[240:255]
  v_cvt_pk_bf16_f32 v82, v84, v85
  v_cvt_pk_bf16_f32 v83, v86, v87
  v_cvt_pk_bf16_f32 v18, v20, v21
  v_cvt_pk_bf16_f32 v19, v22, v23
  v_exp_f32 v88, v88
  v_mfma_f32_32x32x16_bf16 v[176:191], v[224:227], v[80:83], v[176:191]
  v_exp_f32 v89, v89
  v_exp_f32 v24, v24
  v_exp_f32 v25, v25
  v_mfma_f32_32x32x16_bf16 v[160:175], v[224:227], v[16:19], v[160:175]
  ds_read_b128 v[224:227], v1 offset:30720
  v_exp_f32 v90, v90
  v_exp_f32 v91, v91
  v_exp_f32 v26, v26
  v_mfma_f32_32x32x16_bf16 v[112:127], v[128:131], v[80:83], v[112:127]
  v_exp_f32 v27, v27
  v_exp_f32 v92, v92
  v_exp_f32 v93, v93
  s_waitcnt lgkmcnt(1)
  v_mfma_f32_32x32x16_bf16 v[64:79], v[212:215], v[204:207], v[64:79]
  v_exp_f32 v94, v94
  v_exp_f32 v95, v95
  v_exp_f32 v28, v28
  v_mfma_f32_32x32x16_bf16 v[96:111], v[128:131], v[16:19], v[96:111]
  v_exp_f32 v29, v29
  v_exp_f32 v30, v30
  v_exp_f32 v31, v31
  v_cvt_pk_bf16_f32 v88, v88, v89
  v_cvt_pk_bf16_f32 v24, v24, v25
  v_cvt_pk_bf16_f32 v89, v90, v91
  v_cvt_pk_bf16_f32 v25, v26, v27
  v_cvt_pk_bf16_f32 v90, v92, v93
  v_cvt_pk_bf16_f32 v91, v94, v95
  v_cvt_pk_bf16_f32 v26, v28, v29
  v_cvt_pk_bf16_f32 v27, v30, v31
  v_mfma_f32_32x32x16_bf16 v[176:191], v[228:231], v[88:91], v[176:191]
  v_exp_f32 v32, v32
  v_exp_f32 v33, v33
  v_exp_f32 v34, v34
  v_mfma_f32_32x32x16_bf16 v[160:175], v[228:231], v[24:27], v[160:175]
  ds_read_b128 v[228:231], v1 offset:31744
  v_exp_f32 v35, v35
  v_exp_f32 v36, v36
  v_exp_f32 v37, v37
  v_mfma_f32_32x32x16_bf16 v[112:127], v[128:131], v[88:91], v[112:127]
  v_exp_f32 v38, v38
  v_exp_f32 v39, v39
  v_cvt_pk_bf16_f32 v32, v32, v33
  v_cvt_pk_bf16_f32 v33, v34, v35
  v_mfma_f32_32x32x16_bf16 v[96:111], v[128:131], v[24:27], v[96:111]
  v_cvt_pk_bf16_f32 v34, v36, v37
  v_cvt_pk_bf16_f32 v35, v38, v39
  v_exp_f32 v40, v40
  v_exp_f32 v41, v41
  v_mfma_f32_32x32x16_bf16 v[176:191], v[232:235], v[32:35], v[176:191]
  v_exp_f32 v42, v42
  v_exp_f32 v43, v43
  v_exp_f32 v44, v44
  s_cmp_eq_u32 s12, 1
  s_nop 6
  s_cbranch_scc1 K1_TKD16
  s_waitcnt vmcnt(0)
  v_readfirstlane_b32 s8, v150
  v_readfirstlane_b32 s9, v151
  s_cmp_eq_u32 s12, 2
  s_nop 2
  s_cbranch_scc1 K1_TKB16
  s_cmp_lg_u32 s8, s35
  s_cbranch_scc1 K1_TKC16
  s_add_u32 m0, s15, 0
  s_add_u32 s8, s58, 0
  buffer_load_dwordx4 v3, s[44:47], s8 offen offset:0 sc1 lds
  buffer_load_dwordx4 v3, s[44:47], s8 offen offset:1024 sc1 lds
  s_add_u32 m0, s15, 4096
  s_add_u32 s8, s58, 4096
  buffer_load_dwordx4 v3, s[44:47], s8 offen offset:0 sc1 lds
  buffer_load_dwordx4 v3, s[44:47], s8 offen offset:1024 sc1 lds
  s_add_u32 m0, s15, 8192
  s_add_u32 s8, s58, 8192
  buffer_load_dwordx4 v3, s[44:47], s8 offen offset:0 sc1 lds
  buffer_load_dwordx4 v3, s[44:47], s8 offen offset:1024 sc1 lds
  s_add_u32 m0, s15, 12288
  s_add_u32 s8, s58, 12288
  buffer_load_dwordx4 v3, s[44:47], s8 offen offset:0 sc1 lds
  buffer_load_dwordx4 v3, s[44:47], s8 offen offset:1024 sc1 lds
  s_mov_b32 s12, 2
K1_TKB16:
  s_cmp_lg_u32 s9, s35
  s_cbranch_scc1 K1_TKC16
  s_add_u32 m0, s15, 0
  s_add_u32 s8, s58, 0
  buffer_load_dwordx4 v3, s[44:47], s8 offen offset:2048 sc1 lds
  buffer_load_dwordx4 v3, s[44:47], s8 offen offset:3072 sc1 lds
  s_add_u32 m0, s15, 4096
  s_add_u32 s8, s58, 4096
  buffer_load_dwordx4 v3, s[44:47], s8 offen offset:2048 sc1 lds
  buffer_load_dwordx4 v3, s[44:47], s8 offen offset:3072 sc1 lds
  s_add_u32 m0, s15, 8192
  s_add_u32 s8, s58, 8192
  buffer_load_dwordx4 v3, s[44:47], s8 offen offset:2048 sc1 lds
  buffer_load_dwordx4 v3, s[44:47], s8 offen offset:3072 sc1 lds
  s_add_u32 m0, s15, 12288
  s_add_u32 s8, s58, 12288
  buffer_load_dwordx4 v3, s[44:47], s8 offen offset:2048 sc1 lds
  buffer_load_dwordx4 v3, s[44:47], s8 offen offset:3072 sc1 lds
  s_mov_b32 s12, 1
  s_branch K1_TKD16
K1_TKC16:
  buffer_load_dwordx2 v[150:151], v13, s[44:47], 0 offen sc1
K1_TKD16:
  v_mfma_f32_32x32x16_bf16 v[112:127], v[128:131], v[32:35], v[112:127]
  v_exp_f32 v45, v45
  v_exp_f32 v46, v46
  v_exp_f32 v47, v47
  v_cvt_pk_bf16_f32 v40, v40, v41
  v_cvt_pk_bf16_f32 v41, v42, v43
  v_cvt_pk_bf16_f32 v42, v44, v45
  v_cvt_pk_bf16_f32 v43, v46, v47
  v_exp_f32 v48, v48
  s_nop 0
  v_mfma_f32_32x32x16_bf16 v[176:191], v[236:239], v[40:43], v[176:191]
  v_exp_f32 v49, v49
  v_exp_f32 v64, v64
  v_exp_f32 v65, v65
  v_mfma_f32_32x32x16_bf16 v[112:127], v[128:131], v[40:43], v[112:127]
  v_exp_f32 v50, v50
  v_exp_f32 v51, v51
  v_exp_f32 v66, v66
  v_exp_f32 v67, v67
  v_exp_f32 v52, v52
  v_exp_f32 v53, v53
  v_exp_f32 v54, v54
  v_exp_f32 v55, v55
  v_exp_f32 v68, v68
  v_exp_f32 v69, v69
  v_exp_f32 v70, v70
  v_exp_f32 v71, v71
  v_cvt_pk_bf16_f32 v48, v48, v49
  v_cvt_pk_bf16_f32 v64, v64, v65
  v_cvt_pk_bf16_f32 v49, v50, v51
  v_cvt_pk_bf16_f32 v65, v66, v67
  v_cvt_pk_bf16_f32 v50, v52, v53
  v_cvt_pk_bf16_f32 v51, v54, v55
  v_cvt_pk_bf16_f32 v66, v68, v69
  v_cvt_pk_bf16_f32 v67, v70, v71
  v_mfma_f32_32x32x16_bf16 v[160:175], v[232:235], v[48:51], v[160:175]
  v_exp_f32 v56, v56
  v_exp_f32 v57, v57
  v_exp_f32 v72, v72
  v_mfma_f32_32x32x16_bf16 v[96:111], v[128:131], v[48:51], v[96:111]
  v_exp_f32 v73, v73
  v_exp_f32 v58, v58
  v_exp_f32 v59, v59
  s_waitcnt lgkmcnt(1)
  v_mfma_f32_32x32x16_bf16 v[176:191], v[224:227], v[64:67], v[176:191]
  v_exp_f32 v74, v74
  v_exp_f32 v75, v75
  v_exp_f32 v60, v60
  v_mfma_f32_32x32x16_bf16 v[112:127], v[128:131], v[64:67], v[112:127]
  v_exp_f32 v61, v61
  v_exp_f32 v62, v62
  v_exp_f32 v63, v63
  v_exp_f32 v76, v76
  v_exp_f32 v77, v77
  v_exp_f32 v78, v78
  v_exp_f32 v79, v79
  v_cvt_pk_bf16_f32 v56, v56, v57
  v_cvt_pk_bf16_f32 v72, v72, v73
  v_cvt_pk_bf16_f32 v57, v58, v59
  v_cvt_pk_bf16_f32 v73, v74, v75
  v_cvt_pk_bf16_f32 v58, v60, v61
  v_cvt_pk_bf16_f32 v59, v62, v63
  v_cvt_pk_bf16_f32 v74, v76, v77
  v_cvt_pk_bf16_f32 v75, v78, v79
  v_mfma_f32_32x32x16_bf16 v[160:175], v[236:239], v[56:59], v[160:175]
  v_mfma_f32_32x32x16_bf16 v[96:111], v[128:131], v[56:59], v[96:111]
  s_waitcnt lgkmcnt(0)
  v_mfma_f32_32x32x16_bf16 v[176:191], v[228:231], v[72:75], v[176:191]
  v_mfma_f32_32x32x16_bf16 v[112:127], v[128:131], v[72:75], v[112:127]
  s_nop 11
K1_MID:
  s_cmp_eq_u32 s5, 0
  s_cbranch_scc1 K1_CHECK
  v_mov_b32 v156, 0xf149f2ca
  v_sub_f32 v240, v156, v240
  v_sub_f32 v241, v156, v241
  v_sub_f32 v242, v156, v242
  v_sub_f32 v243, v156, v243
  v_sub_f32 v244, v156, v244
  v_sub_f32 v245, v156, v245
  v_sub_f32 v246, v156, v246
  v_sub_f32 v247, v156, v247
  v_sub_f32 v248, v156, v248
  v_sub_f32 v249, v156, v249
  v_sub_f32 v250, v156, v250
  v_sub_f32 v251, v156, v251
  v_sub_f32 v252, v156, v252
  v_sub_f32 v253, v156, v253
  v_sub_f32 v254, v156, v254
  v_sub_f32 v255, v156, v255
  s_cmp_eq_u32 s12, 1
  s_cbranch_scc1 K1_W8
  s_cmp_eq_u32 s12, 2
  s_cbranch_scc1 K1_W1
K1_POLL:
  s_waitcnt vmcnt(0)
  v_readfirstlane_b32 s8, v150
  v_readfirstlane_b32 s9, v151
  s_nop 0
  s_cmp_eq_u32 s8, s35
  s_nop 1
  s_cbranch_scc1 K1_GIVEUP
  s_add_u32 s59, s59, 1
  s_cmp_ge_u32 s59, 131072
  s_cbranch_scc1 K1_GIVEUP
  s_sleep 2
  buffer_load_dwordx2 v[150:151], v13, s[44:47], 0 offen sc1
  s_branch K1_POLL
K1_GIVEUP:
  s_add_u32 m0, s15, 0
  s_add_u32 s8, s58, 0
  buffer_load_dwordx4 v3, s[44:47], s8 offen offset:0 sc1 lds
  buffer_load_dwordx4 v3, s[44:47], s8 offen offset:1024 sc1 lds
  s_add_u32 m0, s15, 4096
  s_add_u32 s8, s58, 4096
  buffer_load_dwordx4 v3, s[44:47], s8 offen offset:0 sc1 lds
  buffer_load_dwordx4 v3, s[44:47], s8 offen offset:1024 sc1 lds
  s_add_u32 m0, s15, 8192
  s_add_u32 s8, s58, 8192
  buffer_load_dwordx4 v3, s[44:47], s8 offen offset:0 sc1 lds
  buffer_load_dwordx4 v3, s[44:47], s8 offen offset:1024 sc1 lds
  s_add_u32 m0, s15, 12288
  s_add_u32 s8, s58, 12288
  buffer_load_dwordx4 v3, s[44:47], s8 offen offset:0 sc1 lds
  buffer_load_dwordx4 v3, s[44:47], s8 offen offset:1024 sc1 lds
  s_mov_b32 s12, 2
  s_cmp_eq_u32 s9, s35
  s_cbranch_scc1 K1_BOTH
  buffer_load_dwordx2 v[150:151], v13, s[44:47], 0 offen sc1
K1_W1:
  s_waitcnt vmcnt(1)
  s_branch K1_GOT
K1_BOTH:
  s_add_u32 m0, s15, 0
  s_add_u32 s8, s58, 0
  buffer_load_dwordx4 v3, s[44:47], s8 offen offset:2048 sc1 lds
  buffer_load_dwordx4 v3, s[44:47], s8 offen offset:3072 sc1 lds
  s_add_u32 m0, s15, 4096
  s_add_u32 s8, s58, 4096
  buffer_load_dwordx4 v3, s[44:47], s8 offen offset:2048 sc1 lds
  buffer_load_dwordx4 v3, s[44:47], s8 offen offset:3072 sc1 lds
  s_add_u32 m0, s15, 8192
  s_add_u32 s8, s58, 8192
  buffer_load_dwordx4 v3, s[44:47], s8 offen offset:2048 sc1 lds
  buffer_load_dwordx4 v3, s[44:47], s8 offen offset:3072 sc1 lds
  s_add_u32 m0, s15, 12288
  s_add_u32 s8, s58, 12288
  buffer_load_dwordx4 v3, s[44:47], s8 offen offset:2048 sc1 lds
  buffer_load_dwordx4 v3, s[44:47], s8 offen offset:3072 sc1 lds
  s_mov_b32 s12, 1
K1_W8:
  s_waitcnt vmcnt(8)
K1_GOT:
  s_barrier
  s_cmp_eq_u32 s14, 1
  s_cbranch_scc1 K1_P2_1
  s_cmp_eq_u32 s14, 2
  s_cbranch_scc1 K1_P2_2
  s_cmp_eq_u32 s14, 3
  s_cbranch_scc1 K1_P2_3
K1_P2_0:
  ds_read_b128 v[208:211], v2 offset:8192
  ds_read_b128 v[212:215], v2 offset:9216
  ds_read_b128 v[216:219], v2 offset:16384
  ds_read_b128 v[220:223], v2 offset:17408
  s_waitcnt lgkmcnt(3)
  v_mfma_f32_32x32x16_bf16 v[16:31], v[208:211], v[192:195], 0
  ds_read_b128 v[208:211], v2 offset:24576
  s_waitcnt lgkmcnt(3)
  v_mfma_f32_32x32x16_bf16 v[16:31], v[212:215], v[196:199], v[16:31]
  ds_read_b128 v[212:215], v2 offset:25600
  s_waitcnt lgkmcnt(3)
  v_mfma_f32_32x32x16_bf16 v[32:47], v[216:219], v[192:195], 0
  s_waitcnt lgkmcnt(2)
  v_mfma_f32_32x32x16_bf16 v[32:47], v[220:223], v[196:199], v[32:47]
  s_nop 6
  v_exp_f32 v16, v16
  v_exp_f32 v17, v17
  v_exp_f32 v18, v18
  v_exp_f32 v19, v19
  v_exp_f32 v20, v20
  v_exp_f32 v21, v21
  v_exp_f32 v22, v22
  v_exp_f32 v23, v23
  s_waitcnt lgkmcnt(1)
  v_mfma_f32_32x32x16_bf16 v[48:63], v[208:211], v[192:195], 0
  s_cmp_eq_u32 s12, 1
  s_nop 9
  s_cbranch_scc1 K1_TVD17
K1_TVA17:
  s_waitcnt vmcnt(0)
  v_readfirstlane_b32 s8, v151
  s_nop 1
  s_cmp_eq_u32 s8, s35
  s_nop 0
  s_cbranch_scc1 K1_TVC17
  buffer_load_dwordx2 v[150:151], v13, s[44:47], 0 offen sc1
  s_branch K1_TVD17
K1_TVC17:
  s_add_u32 m0, s15, 0
  s_add_u32 s8, s58, 0
  buffer_load_dwordx4 v3, s[44:47], s8 offen offset:2048 sc1 lds
  buffer_load_dwordx4 v3, s[44:47], s8 offen offset:3072 sc1 lds
  s_add_u32 m0, s15, 4096
  s_add_u32 s8, s58, 4096
  buffer_load_dwordx4 v3, s[44:47], s8 offen offset:2048 sc1 lds
  buffer_load_dwordx4 v3, s[44:47], s8 offen offset:3072 sc1 lds
  s_add_u32 m0, s15, 8192
  s_add_u32 s8, s58, 8192
  buffer_load_dwordx4 v3, s[44:47], s8 offen offset:2048 sc1 lds
  buffer_load_dwordx4 v3, s[44:47], s8 offen offset:3072 sc1 lds
  s_add_u32 m0, s15, 12288
  s_add_u32 s8, s58, 12288
  buffer_load_dwordx4 v3, s[44:47], s8 offen offset:2048 sc1 lds
  buffer_load_dwordx4 v3, s[44:47], s8 offen offset:3072 sc1 lds
  s_mov_b32 s12, 1
K1_TVD17:
  v_cvt_pk_bf16_f32 v16, v16, v17
  v_cvt_pk_bf16_f32 v17, v18, v19
  v_cvt_pk_bf16_f32 v18, v20, v21
  v_cvt_pk_bf16_f32 v19, v22, v23
  v_exp_f32 v24, v24
  s_waitcnt lgkmcnt(0)
  v_mfma_f32_32x32x16_bf16 v[48:63], v[212:215], v[196:199], v[48:63]
  v_exp_f32 v25, v25
  v_exp_f32 v26, v26
  v_exp_f32 v27, v27
  v_mfma_f32_32x32x16_bf16 v[96:111], v[128:131], v[16:19], v[96:111]
  v_exp_f32 v28, v28
  v_exp_f32 v29, v29
  v_exp_f32 v30, v30
  v_exp_f32 v31, v31
  s_nop 3
  v_exp_f32 v48, v48
  v_exp_f32 v49, v49
  v_cvt_pk_bf16_f32 v24, v24, v25
  v_cvt_pk_bf16_f32 v48, v48, v49
  s_cmp_eq_u32 s12, 1
  s_cbranch_scc1 K1_TVD18
K1_TVA18:
  s_waitcnt vmcnt(0)
  v_readfirstlane_b32 s8, v151
  s_nop 1
  s_cmp_eq_u32 s8, s35
  s_nop 0
  s_cbranch_scc1 K1_TVC18
  s_add_u32 s59, s59, 1
  s_cmp_ge_u32 s59, 131072
  s_cbranch_scc1 K1_TVC18
  s_sleep 2
  buffer_load_dwordx2 v[150:151], v13, s[44:47], 0 offen sc1
  s_branch K1_TVA18
K1_TVC18:
  s_add_u32 m0, s15, 0
  s_add_u32 s8, s58, 0
  buffer_load_dwordx4 v3, s[44:47], s8 offen offset:2048 sc1 lds
  buffer_load_dwordx4 v3, s[44:47], s8 offen offset:3072 sc1 lds
  s_add_u32 m0, s15, 4096
  s_add_u32 s8, s58, 4096
  buffer_load_dwordx4 v3, s[44:47], s8 offen offset:2048 sc1 lds
  buffer_load_dwordx4 v3, s[44:47], s8 offen offset:3072 sc1 lds
  s_add_u32 m0, s15, 8192
  s_add_u32 s8, s58, 8192
  buffer_load_dwordx4 v3, s[44:47], s8 offen offset:2048 sc1 lds
  buffer_load_dwordx4 v3, s[44:47], s8 offen offset:3072 sc1 lds
  s_add_u32 m0, s15, 12288
  s_add_u32 s8, s58, 12288
  buffer_load_dwordx4 v3, s[44:47], s8 offen offset:2048 sc1 lds
  buffer_load_dwordx4 v3, s[44:47], s8 offen offset:3072 sc1 lds
  s_mov_b32 s12, 1
K1_TVD18:
  s_waitcnt vmcnt(0)
  s_barrier
  ds_read_b128 v[224:227], v2 offset:10240
  ds_read_b128 v[228:231], v2 offset:11264
  ds_read_b128 v[216:219], v2 offset:28672
  ds_read_b128 v[220:223], v2 offset:29696
  ds_read_b128 v[232:235], v2 offset:18432
  ds_read_b128 v[236:239], v2 offset:19456
  ds_read_b128 v[208:211], v2 offset:20480
  ds_read_b128 v[212:215], v2 offset:21504
  v_cvt_pk_bf16_f32 v25, v26, v27
  v_cvt_pk_bf16_f32 v26, v28, v29
  v_cvt_pk_bf16_f32 v27, v30, v31
  v_exp_f32 v32, v32
  s_nop 0
  v_mfma_f32_32x32x16_bf16 v[96:111], v[128:131], v[24:27], v[96:111]
  v_exp_f32 v33, v33
  v_exp_f32 v34, v34
  v_exp_f32 v35, v35
  v_exp_f32 v36, v36
  v_exp_f32 v37, v37
  v_exp_f32 v38, v38
  v_exp_f32 v39, v39
  v_cvt_pk_bf16_f32 v32, v32, v33
  v_cvt_pk_bf16_f32 v33, v34, v35
  v_cvt_pk_bf16_f32 v34, v36, v37
  v_cvt_pk_bf16_f32 v35, v38, v39
  v_exp_f32 v40, v40
  s_nop 0
  v_mfma_f32_32x32x16_bf16 v[96:111], v[128:131], v[32:35], v[96:111]
  v_exp_f32 v41, v41
  v_exp_f32 v42, v42
  v_exp_f32 v43, v43
  s_waitcnt lgkmcnt(7)
  v_mfma_f32_32x32x16_bf16 v[160:175], v[224:227], v[16:19], v[160:175]
  ds_read_b128 v[224:227], v2 offset:26624
  v_exp_f32 v44, v44
  v_exp_f32 v45, v45
  v_exp_f32 v46, v46
  s_waitcnt lgkmcnt(6)
  v_mfma_f32_32x32x16_bf16 v[64:79], v[216:219], v[192:195], 0
  v_exp_f32 v47, v47
  v_cvt_pk_bf16_f32 v40, v40, v41
  v_cvt_pk_bf16_f32 v41, v42, v43
  v_cvt_pk_bf16_f32 v42, v44, v45
  v_cvt_pk_bf16_f32 v43, v46, v47
  v_mfma_f32_32x32x16_bf16 v[160:175], v[228:231], v[24:27], v[160:175]
  ds_read_b128 v[228:231], v2 offset:27648
  ds_read_b128 v[216:219], v2 offset:12288
  v_exp_f32 v50, v50
  v_exp_f32 v51, v51
  s_waitcnt lgkmcnt(7)
  v_mfma_f32_32x32x16_bf16 v[64:79], v[220:223], v[196:199], v[64:79]
  ds_read_b128 v[220:223], v2 offset:13312
  v_exp_f32 v52, v52
  v_exp_f32 v53, v53
  v_exp_f32 v54, v54
  s_waitcnt lgkmcnt(7)
  v_mfma_f32_32x32x16_bf16 v[160:175], v[232:235], v[32:35], v[160:175]
  ds_read_b128 v[232:235], v2 offset:30720
  v_exp_f32 v55, v55
  v_cvt_pk_bf16_f32 v49, v50, v51
  v_cvt_pk_bf16_f32 v50, v52, v53
  v_cvt_pk_bf16_f32 v51, v54, v55
  s_waitcnt lgkmcnt(7)
  v_mfma_f32_32x32x16_bf16 v[160:175], v[236:239], v[40:43], v[160:175]
  ds_read_b128 v[236:239], v2 offset:31744
  v_exp_f32 v56, v56
  v_exp_f32 v57, v57
  v_exp_f32 v58, v58
  s_waitcnt lgkmcnt(7)
  v_mfma_f32_32x32x16_bf16 v[80:95], v[208:211], v[192:195], 0
  ds_read_b128 v[208:211], v2 offset:4096
  v_exp_f32 v59, v59
  v_exp_f32 v60, v60
  v_exp_f32 v61, v61
  s_waitcnt lgkmcnt(6)
  v_mfma_f32_32x32x16_bf16 v[160:175], v[224:227], v[48:51], v[160:175]
  v_exp_f32 v62, v62
  v_exp_f32 v63, v63
  v_cvt_pk_bf16_f32 v56, v56, v57
  v_cvt_pk_bf16_f32 v57, v58, v59
  v_mfma_f32_32x32x16_bf16 v[80:95], v[212:215], v[196:199], v[80:95]
  ds_read_b128 v[212:215], v2 offset:5120
  ds_read_b128 v[224:227], v2 offset:22528
  v_cvt_pk_bf16_f32 v58, v60, v61
  v_cvt_pk_bf16_f32 v59, v62, v63
  v_exp_f32 v64, v64
  s_waitcnt lgkmcnt(7)
  v_mfma_f32_32x32x16_bf16 v[160:175], v[228:231], v[56:59], v[160:175]
  ds_read_b128 v[228:231], v2 offset:23552
  v_exp_f32 v65, v65
  v_exp_f32 v66, v66
  v_exp_f32 v67, v67
  v_mfma_f32_32x32x16_bf16 v[96:111], v[128:131], v[40:43], v[96:111]
  v_exp_f32 v68, v68
  v_exp_f32 v69, v69
  v_exp_f32 v70, v70
  v_mfma_f32_32x32x16_bf16 v[96:111], v[128:131], v[48:51], v[96:111]
  v_exp_f32 v71, v71
  v_cvt_pk_bf16_f32 v64, v64, v65
  v_cvt_pk_bf16_f32 v65, v66, v67
  v_cvt_pk_bf16_f32 v66, v68, v69
  v_cvt_pk_bf16_f32 v67, v70, v71
  s_waitcnt lgkmcnt(7)
  v_mfma_f32_32x32x16_bf16 v[16:31], v[216:219], v[192:195], 0
  v_exp_f32 v72, v72
  v_exp_f32 v73, v73
  v_exp_f32 v74, v74
  s_waitcnt lgkmcnt(5)
  v_mfma_f32_32x32x16_bf16 v[160:175], v[232:235], v[64:67], v[160:175]
  ds_read_b128 v[232:235], v2 offset:14336
  v_exp_f32 v75, v75
  v_exp_f32 v76, v76
  v_exp_f32 v77, v77
  v_mfma_f32_32x32x16_bf16 v[96:111], v[128:131], v[56:59], v[96:111]
  v_exp_f32 v78, v78
  v_exp_f32 v79, v79
  v_cvt_pk_bf16_f32 v72, v72, v73
  v_cvt_pk_bf16_f32 v73, v74, v75
  v_mfma_f32_32x32x16_bf16 v[16:31], v[220:223], v[196:199], v[16:31]
  v_cvt_pk_bf16_f32 v74, v76, v77
  v_cvt_pk_bf16_f32 v75, v78, v79
  v_exp_f32 v80, v80
  v_exp_f32 v81, v81
  s_waitcnt lgkmcnt(5)
  v_mfma_f32_32x32x16_bf16 v[160:175], v[236:239], v[72:75], v[160:175]
  ds_read_b128 v[236:239], v2 offset:15360
  ds_read_b128 v[216:219], v2 offset:0
  ds_read_b128 v[220:223], v2 offset:1024
  v_exp_f32 v82, v82
  v_exp_f32 v83, v83
  v_mfma_f32_32x32x16_bf16 v[96:111], v[128:131], v[64:67], v[96:111]
  v_exp_f32 v84, v84
  v_exp_f32 v85, v85
  v_exp_f32 v86, v86
  v_mfma_f32_32x32x16_bf16 v[96:111], v[128:131], v[72:75], v[96:111]
  v_exp_f32 v87, v87
  v_cvt_pk_bf16_f32 v80, v80, v81
  v_cvt_pk_bf16_f32 v81, v82, v83
  v_cvt_pk_bf16_f32 v82, v84, v85
  v_cvt_pk_bf16_f32 v83, v86, v87
  s_waitcnt lgkmcnt(7)
  v_mfma_f32_32x32x16_bf16 v[32:47], v[208:211], v[192:195], 0
  v_exp_f32 v88, v88
  v_exp_f32 v89, v89
  v_exp_f32 v90, v90
  s_waitcnt lgkmcnt(5)
  v_mfma_f32_32x32x16_bf16 v[160:175], v[224:227], v[80:83], v[160:175]
  ds_read_b128 v[224:227], v2 offset:6144
  v_exp_f32 v91, v91
  v_exp_f32 v92, v92
  v_exp_f32 v93, v93
  v_mfma_f32_32x32x16_bf16 v[96:111], v[128:131], v[80:83], v[96:111]
  v_exp_f32 v94, v94
  v_exp_f32 v95, v95
  v_cvt_pk_bf16_f32 v88, v88, v89
  v_cvt_pk_bf16_f32 v89, v90, v91
  v_mfma_f32_32x32x16_bf16 v[32:47], v[212:215], v[196:199], v[32:47]
  v_cvt_pk_bf16_f32 v90, v92, v93
  v_cvt_pk_bf16_f32 v91, v94, v95
  v_exp_f32 v16, v16
  v_exp_f32 v17, v17
  s_waitcnt lgkmcnt(5)
  v_mfma_f32_32x32x16_bf16 v[160:175], v[228:231], v[88:91], v[160:175]
  ds_read_b128 v[228:231], v2 offset:7168
  v_exp_f32 v18, v18
  v_exp_f32 v19, v19
  v_exp_f32 v20, v20
  v_mfma_f32_32x32x16_bf16 v[96:111], v[128:131], v[88:91], v[96:111]
  v_exp_f32 v21, v21
  v_exp_f32 v22, v22
  v_exp_f32 v23, v23
  v_mfma_f32_32x32x16_bf16 v[48:63], v[208:211], v[200:203], v[240:255]
  v_cvt_pk_bf16_f32 v16, v16, v17
  v_cvt_pk_bf16_f32 v17, v18, v19
  v_cvt_pk_bf16_f32 v18, v20, v21
  v_cvt_pk_bf16_f32 v19, v22, v23
  v_exp_f32 v24, v24
  s_waitcnt lgkmcnt(5)
  v_mfma_f32_32x32x16_bf16 v[160:175], v[232:235], v[16:19], v[160:175]
  ds_read_b128 v[232:235], v2 offset:2048
  v_exp_f32 v25, v25
  v_exp_f32 v26, v26
  v_exp_f32 v27, v27
  s_waitcnt lgkmcnt(4)
  v_mfma_f32_32x32x16_bf16 v[64:79], v[216:219], v[192:195], v[240:255]
  v_exp_f32 v28, v28
  v_exp_f32 v29, v29
  v_exp_f32 v30, v30
  v_mfma_f32_32x32x16_bf16 v[96:111], v[128:131], v[16:19], v[96:111]
  v_exp_f32 v31, v31
  v_cvt_pk_bf16_f32 v24, v24, v25
  v_cvt_pk_bf16_f32 v25, v26, v27
  v_cvt_pk_bf16_f32 v26, v28, v29
  v_cvt_pk_bf16_f32 v27, v30, v31
  v_mfma_f32_32x32x16_bf16 v[48:63], v[212:215], v[204:207], v[48:63]
  v_exp_f32 v32, v32
  v_exp_f32 v33, v33
  v_exp_f32 v34, v34
  v_mfma_f32_32x32x16_bf16 v[160:175], v[236:239], v[24:27], v[160:175]
  ds_read_b128 v[236:239], v2 offset:3072
  v_exp_f32 v35, v35
  v_exp_f32 v36, v36
  v_exp_f32 v37, v37
  s_waitcnt lgkmcnt(4)
  v_mfma_f32_32x32x16_bf16 v[64:79], v[220:223], v[196:199], v[64:79]
  v_exp_f32 v38, v38
  v_exp_f32 v39, v39
  v_cvt_pk_bf16_f32 v32, v32, v33
  v_cvt_pk_bf16_f32 v33, v34, v35
  v_mfma_f32_32x32x16_bf16 v[96:111], v[128:131], v[24:27], v[96:111]
  v_cvt_pk_bf16_f32 v34, v36, v37
  v_cvt_pk_bf16_f32 v35, v38, v39
  v_exp_f32 v40, v40
  v_exp_f32 v41, v41
  s_waitcnt lgkmcnt(3)
  v_mfma_f32_32x32x16_bf16 v[160:175], v[224:227], v[32:35], v[160:175]
  v_exp_f32 v42, v42
  v_exp_f32 v43, v43
  v_exp_f32 v44, v44
  v_mfma_f32_32x32x16_bf16 v[96:111], v[128:131], v[32:35], v[96:111]
  v_exp_f32 v45, v45
  v_exp_f32 v46, v46
  v_exp_f32 v47, v47
  v_cvt_pk_bf16_f32 v40, v40, v41
  v_cvt_pk_bf16_f32 v41, v42, v43
  v_cvt_pk_bf16_f32 v42, v44, v45
  v_cvt_pk_bf16_f32 v43, v46, v47
  v_exp_f32 v48, v48
  s_waitcnt lgkmcnt(2)
  v_mfma_f32_32x32x16_bf16 v[160:175], v[228:231], v[40:43], v[160:175]
  v_exp_f32 v49, v49
  v_exp_f32 v64, v64
  v_exp_f32 v65, v65
  v_mfma_f32_32x32x16_bf16 v[96:111], v[128:131], v[40:43], v[96:111]
  v_exp_f32 v50, v50
  v_exp_f32 v51, v51
  v_exp_f32 v66, v66
  v_exp_f32 v67, v67
  v_exp_f32 v52, v52
  v_exp_f32 v53, v53
  v_exp_f32 v54, v54
  v_exp_f32 v55, v55
  v_exp_f32 v68, v68
  v_exp_f32 v69, v69
  v_exp_f32 v70, v70
  v_exp_f32 v71, v71
  v_cvt_pk_bf16_f32 v48, v48, v49
  v_cvt_pk_bf16_f32 v64, v64, v65
  v_cvt_pk_bf16_f32 v49, v50, v51
  v_cvt_pk_bf16_f32 v65, v66, v67
  v_cvt_pk_bf16_f32 v50, v52, v53
  v_cvt_pk_bf16_f32 v51, v54, v55
  v_cvt_pk_bf16_f32 v66, v68, v69
  v_cvt_pk_bf16_f32 v67, v70, v71
  v_mfma_f32_32x32x16_bf16 v[176:191], v[224:227], v[48:51], v[176:191]
  v_exp_f32 v56, v56
  v_exp_f32 v57, v57
  v_exp_f32 v72, v72
  v_mfma_f32_32x32x16_bf16 v[112:127], v[128:131], v[48:51], v[112:127]
  v_exp_f32 v73, v73
  v_exp_f32 v58, v58
  v_exp_f32 v59, v59
  s_waitcnt lgkmcnt(1)
  v_mfma_f32_32x32x16_bf16 v[160:175], v[232:235], v[64:67], v[160:175]
  v_exp_f32 v74, v74
  v_exp_f32 v75, v75
  v_exp_f32 v60, v60
  v_mfma_f32_32x32x16_bf16 v[96:111], v[128:131], v[64:67], v[96:111]
  v_exp_f32 v61, v61
  v_exp_f32 v62, v62
  v_exp_f32 v63, v63
  v_exp_f32 v76, v76
  v_exp_f32 v77, v77
  v_exp_f32 v78, v78
  v_exp_f32 v79, v79
  v_cvt_pk_bf16_f32 v56, v56, v57
  v_cvt_pk_bf16_f32 v72, v72, v73
  v_cvt_pk_bf16_f32 v57, v58, v59
  v_cvt_pk_bf16_f32 v73, v74, v75
  v_cvt_pk_bf16_f32 v58, v60, v61
  v_cvt_pk_bf16_f32 v59, v62, v63
  v_cvt_pk_bf16_f32 v74, v76, v77
  v_cvt_pk_bf16_f32 v75, v78, v79
  v_mfma_f32_32x32x16_bf16 v[176:191], v[228:231], v[56:59], v[176:191]
  v_mfma_f32_32x32x16_bf16 v[112:127], v[128:131], v[56:59], v[112:127]
  s_waitcnt lgkmcnt(0)
  v_mfma_f32_32x32x16_bf16 v[160:175], v[236:239], v[72:75], v[160:175]
  v_mfma_f32_32x32x16_bf16 v[96:111], v[128:131], v[72:75], v[96:111]
  s_nop 10
  s_branch K1_CHECK
K1_P2_1:
  ds_read_b128 v[208:211], v2 offset:16384
  ds_read_b128 v[212:215], v2 offset:17408
  ds_read_b128 v[216:219], v2 offset:24576
  ds_read_b128 v[220:223], v2 offset:25600
  s_waitcnt lgkmcnt(3)
  v_mfma_f32_32x32x16_bf16 v[16:31], v[208:211], v[192:195], 0
  ds_read_b128 v[208:211], v2 offset:28672
  s_waitcnt lgkmcnt(3)
  v_mfma_f32_32x32x16_bf16 v[16:31], v[212:215], v[196:199], v[16:31]
  ds_read_b128 v[212:215], v2 offset:29696
  s_waitcnt lgkmcnt(3)
  v_mfma_f32_32x32x16_bf16 v[32:47], v[216:219], v[192:195], 0
  s_waitcnt lgkmcnt(2)
  v_mfma_f32_32x32x16_bf16 v[32:47], v[220:223], v[196:199], v[32:47]
  s_nop 6
  v_exp_f32 v16, v16
  v_exp_f32 v17, v17
  v_exp_f32 v18, v18
  v_exp_f32 v19, v19
  v_exp_f32 v20, v20
  v_exp_f32 v21, v21
  v_exp_f32 v22, v22
  v_exp_f32 v23, v23
  s_cmp_eq_u32 s12, 1
  s_cbranch_scc1 K1_TVD19
K1_TVA19:
  s_waitcnt vmcnt(0)
  v_readfirstlane_b32 s8, v151
  s_nop 1
  s_cmp_eq_u32 s8, s35
  s_nop 0
  s_cbranch_scc1 K1_TVC19
  buffer_load_dwordx2 v[150:151], v13, s[44:47], 0 offen sc1
  s_branch K1_TVD19
K1_TVC19:
  s_add_u32 m0, s15, 0
  s_add_u32 s8, s58, 0
  buffer_load_dwordx4 v3, s[44:47], s8 offen offset:2048 sc1 lds
  buffer_load_dwordx4 v3, s[44:47], s8 offen offset:3072 sc1 lds
  s_add_u32 m0, s15, 4096
  s_add_u32 s8, s58, 4096
  buffer_load_dwordx4 v3, s[44:47], s8 offen offset:2048 sc1 lds
  buffer_load_dwordx4 v3, s[44:47], s8 offen offset:3072 sc1 lds
  s_add_u32 m0, s15, 8192
  s_add_u32 s8, s58, 8192
  buffer_load_dwordx4 v3, s[44:47], s8 offen offset:2048 sc1 lds
  buffer_load_dwordx4 v3, s[44:47], s8 offen offset:3072 sc1 lds
  s_add_u32 m0, s15, 12288
  s_add_u32 s8, s58, 12288
  buffer_load_dwordx4 v3, s[44:47], s8 offen offset:2048 sc1 lds
  buffer_load_dwordx4 v3, s[44:47], s8 offen offset:3072 sc1 lds
  s_mov_b32 s12, 1
K1_TVD19:
  s_waitcnt lgkmcnt(1)
  v_mfma_f32_32x32x16_bf16 v[48:63], v[208:211], v[192:195], 0
  v_cvt_pk_bf16_f32 v16, v16, v17
  v_cvt_pk_bf16_f32 v17, v18, v19
  v_cvt_pk_bf16_f32 v18, v20, v21
  v_cvt_pk_bf16_f32 v19, v22, v23
  v_exp_f32 v24, v24
  s_waitcnt lgkmcnt(0)
  v_mfma_f32_32x32x16_bf16 v[48:63], v[212:215], v[196:199], v[48:63]
  v_exp_f32 v25, v25
  v_exp_f32 v26, v26
  v_exp_f32 v27, v27
  v_mfma_f32_32x32x16_bf16 v[96:111], v[128:131], v[16:19], v[96:111]
  v_exp_f32 v28, v28
  v_exp_f32 v29, v29
  v_exp_f32 v30, v30
  v_exp_f32 v31, v31
  s_nop 3
  v_exp_f32 v48, v48
  v_exp_f32 v49, v49
  v_cvt_pk_bf16_f32 v24, v24, v25
  v_cvt_pk_bf16_f32 v48, v48, v49
  s_cmp_eq_u32 s12, 1
  s_cbranch_scc1 K1_TVD20
K1_TVA20:
  s_waitcnt vmcnt(0)
  v_readfirstlane_b32 s8, v151
  s_nop 1
  s_cmp_eq_u32 s8, s35
  s_nop 0
  s_cbranch_scc1 K1_TVC20
  s_add_u32 s59, s59, 1
  s_cmp_ge_u32 s59, 131072
  s_cbranch_scc1 K1_TVC20
  s_sleep 2
  buffer_load_dwordx2 v[150:151], v13, s[44:47], 0 offen sc1
  s_branch K1_TVA20
K1_TVC20:
  s_add_u32 m0, s15, 0
  s_add_u32 s8, s58, 0
  buffer_load_dwordx4 v3, s[44:47], s8 offen offset:2048 sc1 lds
  buffer_load_dwordx4 v3, s[44:47], s8 offen offset:3072 sc1 lds
  s_add_u32 m0, s15, 4096
  s_add_u32 s8, s58, 4096
  buffer_load_dwordx4 v3, s[44:47], s8 offen offset:2048 sc1 lds
  buffer_load_dwordx4 v3, s[44:47], s8 offen offset:3072 sc1 lds
  s_add_u32 m0, s15, 8192
  s_add_u32 s8, s58, 8192
  buffer_load_dwordx4 v3, s[44:47], s8 offen offset:2048 sc1 lds
  buffer_load_dwordx4 v3, s[44:47], s8 offen offset:3072 sc1 lds
  s_add_u32 m0, s15, 12288
  s_add_u32 s8, s58, 12288
  buffer_load_dwordx4 v3, s[44:47], s8 offen offset:2048 sc1 lds
  buffer_load_dwordx4 v3, s[44:47], s8 offen offset:3072 sc1 lds
  s_mov_b32 s12, 1
K1_TVD20:
  s_waitcnt vmcnt(0)
  s_barrier
  ds_read_b128 v[224:227], v2 offset:18432
  ds_read_b128 v[228:231], v2 offset:19456
  ds_read_b128 v[216:219], v2 offset:20480
  ds_read_b128 v[220:223], v2 offset:21504
  ds_read_b128 v[232:235], v2 offset:26624
  ds_read_b128 v[236:239], v2 offset:27648
  ds_read_b128 v[208:211], v2 offset:12288
  ds_read_b128 v[212:215], v2 offset:13312
  v_cvt_pk_bf16_f32 v25, v26, v27
  v_cvt_pk_bf16_f32 v26, v28, v29
  v_cvt_pk_bf16_f32 v27, v30, v31
  v_exp_f32 v32, v32
  s_nop 0
  v_mfma_f32_32x32x16_bf16 v[96:111], v[128:131], v[24:27], v[96:111]
  v_exp_f32 v33, v33
  v_exp_f32 v34, v34
  v_exp_f32 v35, v35
  v_exp_f32 v36, v36
  v_exp_f32 v37, v37
  v_exp_f32 v38, v38
  v_exp_f32 v39, v39
  v_cvt_pk_bf16_f32 v32, v32, v33
  v_cvt_pk_bf16_f32 v33, v34, v35
  v_cvt_pk_bf16_f32 v34, v36, v37
  v_cvt_pk_bf16_f32 v35, v38, v39
  v_exp_f32 v40, v40
  s_nop 0
  v_mfma_f32_32x32x16_bf16 v[96:111], v[128:131], v[32:35], v[96:111]
  v_exp_f32 v41, v41
  v_exp_f32 v42, v42
  v_exp_f32 v43, v43
  s_waitcnt lgkmcnt(7)
  v_mfma_f32_32x32x16_bf16 v[160:175], v[224:227], v[16:19], v[160:175]
  ds_read_b128 v[224:227], v2 offset:30720
  v_exp_f32 v44, v44
  v_exp_f32 v45, v45
  v_exp_f32 v46, v46
  s_waitcnt lgkmcnt(7)
  v_mfma_f32_32x32x16_bf16 v[160:175], v[228:231], v[24:27], v[160:175]
  ds_read_b128 v[228:231], v2 offset:31744
  v_exp_f32 v47, v47
  v_cvt_pk_bf16_f32 v40, v40, v41
  v_cvt_pk_bf16_f32 v41, v42, v43
  v_cvt_pk_bf16_f32 v42, v44, v45
  s_waitcnt lgkmcnt(5)
  v_mfma_f32_32x32x16_bf16 v[160:175], v[232:235], v[32:35], v[160:175]
  ds_read_b128 v[232:235], v2 offset:22528
  v_cvt_pk_bf16_f32 v43, v46, v47
  v_exp_f32 v50, v50
  v_exp_f32 v51, v51
  s_waitcnt lgkmcnt(5)
  v_mfma_f32_32x32x16_bf16 v[160:175], v[236:239], v[40:43], v[160:175]
  ds_read_b128 v[236:239], v2 offset:23552
  v_exp_f32 v52, v52
  v_exp_f32 v53, v53
  v_exp_f32 v54, v54
  v_mfma_f32_32x32x16_bf16 v[64:79], v[216:219], v[192:195], 0
  ds_read_b128 v[216:219], v2 offset:4096
  v_exp_f32 v55, v55
  v_cvt_pk_bf16_f32 v49, v50, v51
  v_cvt_pk_bf16_f32 v50, v52, v53
  v_cvt_pk_bf16_f32 v51, v54, v55
  v_mfma_f32_32x32x16_bf16 v[64:79], v[220:223], v[196:199], v[64:79]
  ds_read_b128 v[220:223], v2 offset:5120
  v_exp_f32 v56, v56
  v_exp_f32 v57, v57
  v_exp_f32 v58, v58
  s_waitcnt lgkmcnt(5)
  v_mfma_f32_32x32x16_bf16 v[160:175], v[224:227], v[48:51], v[160:175]
  ds_read_b128 v[224:227], v2 offset:14336
  v_exp_f32 v59, v59
  v_exp_f32 v60, v60
  v_exp_f32 v61, v61
  v_mfma_f32_32x32x16_bf16 v[80:95], v[208:211], v[192:195], 0
  v_exp_f32 v62, v62
  v_exp_f32 v63, v63
  v_cvt_pk_bf16_f32 v56, v56, v57
  v_cvt_pk_bf16_f32 v57, v58, v59
  v_mfma_f32_32x32x16_bf16 v[16:31], v[208:211], v[200:203], v[240:255]
  v_cvt_pk_bf16_f32 v58, v60, v61
  v_cvt_pk_bf16_f32 v59, v62, v63
  v_exp_f32 v64, v64
  v_exp_f32 v65, v65
  s_waitcnt lgkmcnt(5)
  v_mfma_f32_32x32x16_bf16 v[160:175], v[228:231], v[56:59], v[160:175]
  ds_read_b128 v[228:231], v2 offset:15360
  ds_read_b128 v[208:211], v2 offset:8192
  v_exp_f32 v66, v66
  v_exp_f32 v67, v67
  v_mfma_f32_32x32x16_bf16 v[96:111], v[128:131], v[40:43], v[96:111]
  v_exp_f32 v68, v68
  v_exp_f32 v69, v69
  v_exp_f32 v70, v70
  v_mfma_f32_32x32x16_bf16 v[80:95], v[212:215], v[196:199], v[80:95]
  v_exp_f32 v71, v71
  v_cvt_pk_bf16_f32 v64, v64, v65
  v_cvt_pk_bf16_f32 v65, v66, v67
  v_cvt_pk_bf16_f32 v66, v68, v69
  v_cvt_pk_bf16_f32 v67, v70, v71
  v_mfma_f32_32x32x16_bf16 v[16:31], v[212:215], v[204:207], v[16:31]
  ds_read_b128 v[212:215], v2 offset:9216
  v_exp_f32 v72, v72
  v_exp_f32 v73, v73
  v_exp_f32 v74, v74
  v_mfma_f32_32x32x16_bf16 v[96:111], v[128:131], v[48:51], v[96:111]
  v_exp_f32 v75, v75
  v_exp_f32 v76, v76
  v_exp_f32 v77, v77
  s_waitcnt lgkmcnt(7)
  v_mfma_f32_32x32x16_bf16 v[160:175], v[232:235], v[64:67], v[160:175]
  ds_read_b128 v[232:235], v2 offset:6144
  v_exp_f32 v78, v78
  v_exp_f32 v79, v79
  v_cvt_pk_bf16_f32 v72, v72, v73
  v_mfma_f32_32x32x16_bf16 v[96:111], v[128:131], v[56:59], v[96:111]
  v_cvt_pk_bf16_f32 v73, v74, v75
  v_cvt_pk_bf16_f32 v74, v76, v77
  v_cvt_pk_bf16_f32 v75, v78, v79
  v_exp_f32 v80, v80
  v_exp_f32 v81, v81
  s_waitcnt lgkmcnt(6)
  v_mfma_f32_32x32x16_bf16 v[32:47], v[216:219], v[192:195], 0
  v_exp_f32 v16, v16
  v_exp_f32 v17, v17
  v_exp_f32 v82, v82
  v_mfma_f32_32x32x16_bf16 v[160:175], v[236:239], v[72:75], v[160:175]
  ds_read_b128 v[236:239], v2 offset:7168
  v_exp_f32 v83, v83
  v_exp_f32 v18, v18
  v_exp_f32 v19, v19
  v_mfma_f32_32x32x16_bf16 v[96:111], v[128:131], v[64:67], v[96:111]
  v_exp_f32 v84, v84
  v_exp_f32 v85, v85
  v_exp_f32 v86, v86
  s_waitcnt lgkmcnt(6)
  v_mfma_f32_32x32x16_bf16 v[32:47], v[220:223], v[196:199], v[32:47]
  v_exp_f32 v87, v87
  v_exp_f32 v20, v20
  v_exp_f32 v21, v21
  v_mfma_f32_32x32x16_bf16 v[96:111], v[128:131], v[72:75], v[96:111]
  v_exp_f32 v22, v22
  v_exp_f32 v23, v23
  v_cvt_pk_bf16_f32 v80, v80, v81
  v_cvt_pk_bf16_f32 v16, v16, v17
  v_mfma_f32_32x32x16_bf16 v[48:63], v[216:219], v[200:203], 0
  v_cvt_pk_bf16_f32 v81, v82, v83
  v_cvt_pk_bf16_f32 v17, v18, v19
  v_cvt_pk_bf16_f32 v82, v84, v85
  v_cvt_pk_bf16_f32 v83, v86, v87
  v_cvt_pk_bf16_f32 v18, v20, v21
  s_waitcnt lgkmcnt(3)
  v_mfma_f32_32x32x16_bf16 v[64:79], v[208:211], v[192:195], v[240:255]
  v_cvt_pk_bf16_f32 v19, v22, v23
  v_exp_f32 v88, v88
  v_exp_f32 v89, v89
  v_exp_f32 v24, v24
  v_mfma_f32_32x32x16_bf16 v[160:175], v[224:227], v[80:83], v[160:175]
  v_exp_f32 v25, v25
  v_exp_f32 v90, v90
  v_exp_f32 v91, v91
  v_mfma_f32_32x32x16_bf16 v[176:191], v[224:227], v[16:19], v[176:191]
  ds_read_b128 v[224:227], v2 offset:10240
  v_exp_f32 v26, v26
  v_exp_f32 v27, v27
  v_exp_f32 v92, v92
  v_mfma_f32_32x32x16_bf16 v[96:111], v[128:131], v[80:83], v[96:111]
  v_exp_f32 v93, v93
  v_exp_f32 v94, v94
  v_exp_f32 v95, v95
  v_mfma_f32_32x32x16_bf16 v[48:63], v[220:223], v[204:207], v[48:63]
  v_exp_f32 v28, v28
  v_exp_f32 v29, v29
  v_exp_f32 v30, v30
  s_waitcnt lgkmcnt(3)
  v_mfma_f32_32x32x16_bf16 v[64:79], v[212:215], v[196:199], v[64:79]
  v_exp_f32 v31, v31
  v_cvt_pk_bf16_f32 v88, v88, v89
  v_cvt_pk_bf16_f32 v24, v24, v25
  v_cvt_pk_bf16_f32 v89, v90, v91
  v_cvt_pk_bf16_f32 v25, v26, v27
  v_mfma_f32_32x32x16_bf16 v[112:127], v[128:131], v[16:19], v[112:127]
  v_cvt_pk_bf16_f32 v90, v92, v93
  v_cvt_pk_bf16_f32 v91, v94, v95
  v_cvt_pk_bf16_f32 v26, v28, v29
  v_cvt_pk_bf16_f32 v27, v30, v31
  v_exp_f32 v32, v32
  v_mfma_f32_32x32x16_bf16 v[160:175], v[228:231], v[88:91], v[160:175]
  v_exp_f32 v33, v33
  v_exp_f32 v34, v34
  v_exp_f32 v35, v35
  v_mfma_f32_32x32x16_bf16 v[176:191], v[228:231], v[24:27], v[176:191]
  ds_read_b128 v[228:231], v2 offset:11264
  v_exp_f32 v36, v36
  v_exp_f32 v37, v37
  v_exp_f32 v38, v38
  v_mfma_f32_32x32x16_bf16 v[96:111], v[128:131], v[88:91], v[96:111]
  v_exp_f32 v39, v39
  v_cvt_pk_bf16_f32 v32, v32, v33
  v_cvt_pk_bf16_f32 v33, v34, v35
  v_cvt_pk_bf16_f32 v34, v36, v37
  v_cvt_pk_bf16_f32 v35, v38, v39
  v_mfma_f32_32x32x16_bf16 v[112:127], v[128:131], v[24:27], v[112:127]
  v_exp_f32 v40, v40
  v_exp_f32 v41, v41
  v_exp_f32 v42, v42
  s_waitcnt lgkmcnt(3)
  v_mfma_f32_32x32x16_bf16 v[160:175], v[232:235], v[32:35], v[160:175]
  v_exp_f32 v43, v43
  v_exp_f32 v44, v44
  v_exp_f32 v45, v45
  v_mfma_f32_32x32x16_bf16 v[96:111], v[128:131], v[32:35], v[96:111]
  v_exp_f32 v46, v46
  v_exp_f32 v47, v47
  v_cvt_pk_bf16_f32 v40, v40, v41
  v_cvt_pk_bf16_f32 v41, v42, v43
  v_cvt_pk_bf16_f32 v42, v44, v45
  v_cvt_pk_bf16_f32 v43, v46, v47
  v_exp_f32 v48, v48
  s_waitcnt lgkmcnt(2)
  v_mfma_f32_32x32x16_bf16 v[160:175], v[236:239], v[40:43], v[160:175]
  v_exp_f32 v49, v49
  v_exp_f32 v64, v64
  v_exp_f32 v65, v65
  v_mfma_f32_32x32x16_bf16 v[96:111], v[128:131], v[40:43], v[96:111]
  v_exp_f32 v50, v50
  v_exp_f32 v51, v51
  v_exp_f32 v66, v66
  v_exp_f32 v67, v67
  v_exp_f32 v52, v52
  v_exp_f32 v53, v53
  v_exp_f32 v54, v54
  v_exp_f32 v55, v55
  v_exp_f32 v68, v68
  v_exp_f32 v69, v69
  v_exp_f32 v70, v70
  v_exp_f32 v71, v71
  v_cvt_pk_bf16_f32 v48, v48, v49
  v_cvt_pk_bf16_f32 v64, v64, v65
  v_cvt_pk_bf16_f32 v49, v50, v51
  v_cvt_pk_bf16_f32 v65, v66, v67
  v_cvt_pk_bf16_f32 v50, v52, v53
  v_cvt_pk_bf16_f32 v51, v54, v55
  v_cvt_pk_bf16_f32 v66, v68, v69
  v_cvt_pk_bf16_f32 v67, v70, v71
  v_mfma_f32_32x32x16_bf16 v[176:191], v[232:235], v[48:51], v[176:191]
  v_exp_f32 v56, v56
  v_exp_f32 v57, v57
  v_exp_f32 v72, v72
  v_mfma_f32_32x32x16_bf16 v[112:127], v[128:131], v[48:51], v[112:127]
  v_exp_f32 v73, v73
  v_exp_f32 v58, v58
  v_exp_f32 v59, v59
  s_waitcnt lgkmcnt(1)
  v_mfma_f32_32x32x16_bf16 v[160:175], v[224:227], v[64:67], v[160:175]
  v_exp_f32 v74, v74
  v_exp_f32 v75, v75
  v_exp_f32 v60, v60
  v_mfma_f32_32x32x16_bf16 v[96:111], v[128:131], v[64:67], v[96:111]
  v_exp_f32 v61, v61
  v_exp_f32 v62, v62
  v_exp_f32 v63, v63
  v_exp_f32 v76, v76
  v_exp_f32 v77, v77
  v_exp_f32 v78, v78
  v_exp_f32 v79, v79
  v_cvt_pk_bf16_f32 v56, v56, v57
  v_cvt_pk_bf16_f32 v72, v72, v73
  v_cvt_pk_bf16_f32 v57, v58, v59
  v_cvt_pk_bf16_f32 v73, v74, v75
  v_cvt_pk_bf16_f32 v58, v60, v61
  v_cvt_pk_bf16_f32 v59, v62, v63
  v_cvt_pk_bf16_f32 v74, v76, v77
  v_cvt_pk_bf16_f32 v75, v78, v79
  v_mfma_f32_32x32x16_bf16 v[176:191], v[236:239], v[56:59], v[176:191]
  v_mfma_f32_32x32x16_bf16 v[112:127], v[128:131], v[56:59], v[112:127]
  s_waitcnt lgkmcnt(0)
  v_mfma_f32_32x32x16_bf16 v[160:175], v[228:231], v[72:75], v[160:175]
  v_mfma_f32_32x32x16_bf16 v[96:111], v[128:131], v[72:75], v[96:111]
  s_nop 10
  s_branch K1_CHECK
K1_P2_2:
  ds_read_b128 v[208:211], v2 offset:24576
  ds_read_b128 v[212:215], v2 offset:25600
  ds_read_b128 v[216:219], v2 offset:28672
  ds_read_b128 v[220:223], v2 offset:29696
  s_waitcnt lgkmcnt(3)
  v_mfma_f32_32x32x16_bf16 v[16:31], v[208:211], v[192:195], 0
  ds_read_b128 v[208:211], v2 offset:20480
  s_waitcnt lgkmcnt(3)
  v_mfma_f32_32x32x16_bf16 v[16:31], v[212:215], v[196:199], v[16:31]
  ds_read_b128 v[212:215], v2 offset:21504
  s_waitcnt lgkmcnt(3)
  v_mfma_f32_32x32x16_bf16 v[32:47], v[216:219], v[192:195], 0
  s_waitcnt lgkmcnt(2)
  v_mfma_f32_32x32x16_bf16 v[32:47], v[220:223], v[196:199], v[32:47]
  s_nop 6
  v_exp_f32 v16, v16
  v_exp_f32 v17, v17
  v_exp_f32 v18, v18
  v_exp_f32 v19, v19
  v_exp_f32 v20, v20
  v_exp_f32 v21, v21
  v_exp_f32 v22, v22
  v_exp_f32 v23, v23
  s_cmp_eq_u32 s12, 1
  s_cbranch_scc1 K1_TVD21
K1_TVA21:
  s_waitcnt vmcnt(0)
  v_readfirstlane_b32 s8, v151
  s_nop 1
  s_cmp_eq_u32 s8, s35
  s_nop 0
  s_cbranch_scc1 K1_TVC21
  buffer_load_dwordx2 v[150:151], v13, s[44:47], 0 offen sc1
  s_branch K1_TVD21
K1_TVC21:
  s_add_u32 m0, s15, 0
  s_add_u32 s8, s58, 0
  buffer_load_dwordx4 v3, s[44:47], s8 offen offset:2048 sc1 lds
  buffer_load_dwordx4 v3, s[44:47], s8 offen offset:3072 sc1 lds
  s_add_u32 m0, s15, 4096
  s_add_u32 s8, s58, 4096
  buffer_load_dwordx4 v3, s[44:47], s8 offen offset:2048 sc1 lds
  buffer_load_dwordx4 v3, s[44:47], s8 offen offset:3072 sc1 lds
  s_add_u32 m0, s15, 8192
  s_add_u32 s8, s58, 8192
  buffer_load_dwordx4 v3, s[44:47], s8 offen offset:2048 sc1 lds
  buffer_load_dwordx4 v3, s[44:47], s8 offen offset:3072 sc1 lds
  s_add_u32 m0, s15, 12288
  s_add_u32 s8, s58, 12288
  buffer_load_dwordx4 v3, s[44:47], s8 offen offset:2048 sc1 lds
  buffer_load_dwordx4 v3, s[44:47], s8 offen offset:3072 sc1 lds
  s_mov_b32 s12, 1
K1_TVD21:
  s_waitcnt lgkmcnt(1)
  v_mfma_f32_32x32x16_bf16 v[48:63], v[208:211], v[192:195], 0
  v_cvt_pk_bf16_f32 v16, v16, v17
  v_cvt_pk_bf16_f32 v17, v18, v19
  v_cvt_pk_bf16_f32 v18, v20, v21
  v_cvt_pk_bf16_f32 v19, v22, v23
  v_exp_f32 v24, v24
  s_waitcnt lgkmcnt(0)
  v_mfma_f32_32x32x16_bf16 v[48:63], v[212:215], v[196:199], v[48:63]
  v_exp_f32 v25, v25
  v_exp_f32 v26, v26
  v_exp_f32 v27, v27
  v_mfma_f32_32x32x16_bf16 v[64:79], v[208:211], v[200:203], v[240:255]
  v_exp_f32 v28, v28
  v_exp_f32 v29, v29
  v_exp_f32 v30, v30
  v_mfma_f32_32x32x16_bf16 v[96:111], v[128:131], v[16:19], v[96:111]
  s_nop 3
  v_exp_f32 v48, v48
  v_exp_f32 v49, v49
  v_exp_f32 v31, v31
  v_mfma_f32_32x32x16_bf16 v[64:79], v[212:215], v[204:207], v[64:79]
  v_cvt_pk_bf16_f32 v48, v48, v49
  s_cmp_eq_u32 s12, 1
  s_nop 8
  s_cbranch_scc1 K1_TVD22
K1_TVA22:
  s_waitcnt vmcnt(0)
  v_readfirstlane_b32 s8, v151
  s_nop 1
  s_cmp_eq_u32 s8, s35
  s_nop 0
  s_cbranch_scc1 K1_TVC22
  s_add_u32 s59, s59, 1
  s_cmp_ge_u32 s59, 131072
  s_cbranch_scc1 K1_TVC22
  s_sleep 2
  buffer_load_dwordx2 v[150:151], v13, s[44:47], 0 offen sc1
  s_branch K1_TVA22
K1_TVC22:
  s_add_u32 m0, s15, 0
  s_add_u32 s8, s58, 0
  buffer_load_dwordx4 v3, s[44:47], s8 offen offset:2048 sc1 lds
  buffer_load_dwordx4 v3, s[44:47], s8 offen offset:3072 sc1 lds
  s_add_u32 m0, s15, 4096
  s_add_u32 s8, s58, 4096
  buffer_load_dwordx4 v3, s[44:47], s8 offen offset:2048 sc1 lds
  buffer_load_dwordx4 v3, s[44:47], s8 offen offset:3072 sc1 lds
  s_add_u32 m0, s15, 8192
  s_add_u32 s8, s58, 8192
  buffer_load_dwordx4 v3, s[44:47], s8 offen offset:2048 sc1 lds
  buffer_load_dwordx4 v3, s[44:47], s8 offen offset:3072 sc1 lds
  s_add_u32 m0, s15, 12288
  s_add_u32 s8, s58, 12288
  buffer_load_dwordx4 v3, s[44:47], s8 offen offset:2048 sc1 lds
  buffer_load_dwordx4 v3, s[44:47], s8 offen offset:3072 sc1 lds
  s_mov_b32 s12, 1
K1_TVD22:
  s_waitcnt vmcnt(0)
  s_barrier
  ds_read_b128 v[224:227], v2 offset:26624
  ds_read_b128 v[228:231], v2 offset:27648
  ds_read_b128 v[232:235], v2 offset:30720
  ds_read_b128 v[236:239], v2 offset:31744
  ds_read_b128 v[216:219], v2 offset:12288
  ds_read_b128 v[220:223], v2 offset:13312
  v_cvt_pk_bf16_f32 v24, v24, v25
  v_cvt_pk_bf16_f32 v25, v26, v27
  v_cvt_pk_bf16_f32 v26, v28, v29
  v_cvt_pk_bf16_f32 v27, v30, v31
  v_exp_f32 v32, v32
  s_nop 0
  v_mfma_f32_32x32x16_bf16 v[96:111], v[128:131], v[24:27], v[96:111]
  v_exp_f32 v33, v33
  v_exp_f32 v34, v34
  v_exp_f32 v35, v35
  v_exp_f32 v36, v36
  v_exp_f32 v37, v37
  v_exp_f32 v38, v38
  v_exp_f32 v39, v39
  v_cvt_pk_bf16_f32 v32, v32, v33
  v_cvt_pk_bf16_f32 v33, v34, v35
  v_cvt_pk_bf16_f32 v34, v36, v37
  v_cvt_pk_bf16_f32 v35, v38, v39
  v_exp_f32 v40, v40
  s_nop 0
  v_mfma_f32_32x32x16_bf16 v[96:111], v[128:131], v[32:35], v[96:111]
  v_exp_f32 v41, v41
  v_exp_f32 v42, v42
  v_exp_f32 v43, v43
  s_waitcnt lgkmcnt(5)
  v_mfma_f32_32x32x16_bf16 v[160:175], v[224:227], v[16:19], v[160:175]
  ds_read_b128 v[224:227], v2 offset:22528
  v_exp_f32 v44, v44
  v_exp_f32 v45, v45
  v_exp_f32 v46, v46
  s_waitcnt lgkmcnt(5)
  v_mfma_f32_32x32x16_bf16 v[160:175], v[228:231], v[24:27], v[160:175]
  ds_read_b128 v[228:231], v2 offset:23552
  ds_read_b128 v[208:211], v2 offset:4096
  ds_read_b128 v[212:215], v2 offset:5120
  v_exp_f32 v47, v47
  v_cvt_pk_bf16_f32 v40, v40, v41
  s_waitcnt lgkmcnt(7)
  v_mfma_f32_32x32x16_bf16 v[160:175], v[232:235], v[32:35], v[160:175]
  ds_read_b128 v[232:235], v2 offset:14336
  v_cvt_pk_bf16_f32 v41, v42, v43
  v_cvt_pk_bf16_f32 v42, v44, v45
  v_cvt_pk_bf16_f32 v43, v46, v47
  v_exp_f32 v64, v64
  s_waitcnt lgkmcnt(7)
  v_mfma_f32_32x32x16_bf16 v[160:175], v[236:239], v[40:43], v[160:175]
  ds_read_b128 v[236:239], v2 offset:15360
  v_exp_f32 v65, v65
  v_exp_f32 v50, v50
  v_exp_f32 v51, v51
  s_waitcnt lgkmcnt(7)
  v_mfma_f32_32x32x16_bf16 v[80:95], v[216:219], v[192:195], 0
  v_exp_f32 v66, v66
  v_exp_f32 v67, v67
  v_exp_f32 v52, v52
  v_mfma_f32_32x32x16_bf16 v[16:31], v[216:219], v[200:203], 0
  ds_read_b128 v[216:219], v2 offset:16384
  v_exp_f32 v53, v53
  v_exp_f32 v54, v54
  v_exp_f32 v55, v55
  s_waitcnt lgkmcnt(7)
  v_mfma_f32_32x32x16_bf16 v[80:95], v[220:223], v[196:199], v[80:95]
  v_exp_f32 v68, v68
  v_exp_f32 v69, v69
  v_exp_f32 v70, v70
  v_mfma_f32_32x32x16_bf16 v[16:31], v[220:223], v[204:207], v[16:31]
  ds_read_b128 v[220:223], v2 offset:17408
  v_exp_f32 v71, v71
  v_cvt_pk_bf16_f32 v64, v64, v65
  v_cvt_pk_bf16_f32 v49, v50, v51
  v_cvt_pk_bf16_f32 v65, v66, v67
  v_mfma_f32_32x32x16_bf16 v[96:111], v[128:131], v[40:43], v[96:111]
  v_cvt_pk_bf16_f32 v50, v52, v53
  v_cvt_pk_bf16_f32 v51, v54, v55
  v_cvt_pk_bf16_f32 v66, v68, v69
  v_cvt_pk_bf16_f32 v67, v70, v71
  v_exp_f32 v56, v56
  s_waitcnt lgkmcnt(7)
  v_mfma_f32_32x32x16_bf16 v[160:175], v[224:227], v[48:51], v[160:175]
  v_exp_f32 v57, v57
  v_exp_f32 v72, v72
  v_exp_f32 v73, v73
  v_mfma_f32_32x32x16_bf16 v[176:191], v[224:227], v[64:67], v[176:191]
  ds_read_b128 v[224:227], v2 offset:6144
  v_exp_f32 v58, v58
  v_exp_f32 v59, v59
  v_exp_f32 v74, v74
  s_waitcnt lgkmcnt(6)
  v_mfma_f32_32x32x16_bf16 v[32:47], v[208:211], v[192:195], 0
  v_exp_f32 v75, v75
  v_exp_f32 v60, v60
  v_exp_f32 v61, v61
  v_mfma_f32_32x32x16_bf16 v[96:111], v[128:131], v[48:51], v[96:111]
  v_exp_f32 v62, v62
  v_exp_f32 v63, v63
  v_exp_f32 v76, v76
  v_mfma_f32_32x32x16_bf16 v[112:127], v[128:131], v[64:67], v[112:127]
  v_exp_f32 v77, v77
  v_exp_f32 v78, v78
  v_exp_f32 v79, v79
  s_waitcnt lgkmcnt(5)
  v_mfma_f32_32x32x16_bf16 v[32:47], v[212:215], v[196:199], v[32:47]
  v_cvt_pk_bf16_f32 v56, v56, v57
  v_cvt_pk_bf16_f32 v72, v72, v73
  v_cvt_pk_bf16_f32 v57, v58, v59
  v_cvt_pk_bf16_f32 v73, v74, v75
  v_cvt_pk_bf16_f32 v58, v60, v61
  v_cvt_pk_bf16_f32 v59, v62, v63
  v_cvt_pk_bf16_f32 v74, v76, v77
  v_cvt_pk_bf16_f32 v75, v78, v79
  v_mfma_f32_32x32x16_bf16 v[160:175], v[228:231], v[56:59], v[160:175]
  v_exp_f32 v80, v80
  v_exp_f32 v81, v81
  v_exp_f32 v16, v16
  v_mfma_f32_32x32x16_bf16 v[176:191], v[228:231], v[72:75], v[176:191]
  ds_read_b128 v[228:231], v2 offset:7168
  v_exp_f32 v17, v17
  v_exp_f32 v82, v82
  v_exp_f32 v83, v83
  v_mfma_f32_32x32x16_bf16 v[96:111], v[128:131], v[56:59], v[96:111]
  v_exp_f32 v18, v18
  v_exp_f32 v19, v19
  v_exp_f32 v84, v84
  v_mfma_f32_32x32x16_bf16 v[112:127], v[128:131], v[72:75], v[112:127]
  v_exp_f32 v85, v85
  v_exp_f32 v86, v86
  v_exp_f32 v87, v87
  v_mfma_f32_32x32x16_bf16 v[48:63], v[208:211], v[200:203], 0
  v_exp_f32 v20, v20
  v_exp_f32 v21, v21
  v_exp_f32 v22, v22
  s_waitcnt lgkmcnt(3)
  v_mfma_f32_32x32x16_bf16 v[64:79], v[216:219], v[192:195], v[240:255]
  v_exp_f32 v23, v23
  v_cvt_pk_bf16_f32 v80, v80, v81
  v_cvt_pk_bf16_f32 v16, v16, v17
  v_cvt_pk_bf16_f32 v81, v82, v83
  v_cvt_pk_bf16_f32 v17, v18, v19
  v_mfma_f32_32x32x16_bf16 v[48:63], v[212:215], v[204:207], v[48:63]
  v_cvt_pk_bf16_f32 v82, v84, v85
  v_cvt_pk_bf16_f32 v83, v86, v87
  v_cvt_pk_bf16_f32 v18, v20, v21
  v_cvt_pk_bf16_f32 v19, v22, v23
  v_exp_f32 v88, v88
  v_mfma_f32_32x32x16_bf16 v[160:175], v[232:235], v[80:83], v[160:175]
  v_exp_f32 v89, v89
  v_exp_f32 v24, v24
  v_exp_f32 v25, v25
  v_mfma_f32_32x32x16_bf16 v[176:191], v[232:235], v[16:19], v[176:191]
  ds_read_b128 v[232:235], v2 offset:18432
  v_exp_f32 v90, v90
  v_exp_f32 v91, v91
  v_exp_f32 v26, v26
  v_mfma_f32_32x32x16_bf16 v[96:111], v[128:131], v[80:83], v[96:111]
  v_exp_f32 v27, v27
  v_exp_f32 v92, v92
  v_exp_f32 v93, v93
  s_waitcnt lgkmcnt(3)
  v_mfma_f32_32x32x16_bf16 v[64:79], v[220:223], v[196:199], v[64:79]
  v_exp_f32 v94, v94
  v_exp_f32 v95, v95
  v_exp_f32 v28, v28
  v_mfma_f32_32x32x16_bf16 v[112:127], v[128:131], v[16:19], v[112:127]
  v_exp_f32 v29, v29
  v_exp_f32 v30, v30
  v_exp_f32 v31, v31
  v_cvt_pk_bf16_f32 v88, v88, v89
  v_cvt_pk_bf16_f32 v24, v24, v25
  v_cvt_pk_bf16_f32 v89, v90, v91
  v_cvt_pk_bf16_f32 v25, v26, v27
  v_cvt_pk_bf16_f32 v90, v92, v93
  v_cvt_pk_bf16_f32 v91, v94, v95
  v_cvt_pk_bf16_f32 v26, v28, v29
  v_cvt_pk_bf16_f32 v27, v30, v31
  v_mfma_f32_32x32x16_bf16 v[160:175], v[236:239], v[88:91], v[160:175]
  v_exp_f32 v32, v32
  v_exp_f32 v33, v33
  v_exp_f32 v34, v34
  v_mfma_f32_32x32x16_bf16 v[176:191], v[236:239], v[24:27], v[176:191]
  ds_read_b128 v[236:239], v2 offset:19456
  v_exp_f32 v35, v35
  v_exp_f32 v36, v36
  v_exp_f32 v37, v37
  v_mfma_f32_32x32x16_bf16 v[96:111], v[128:131], v[88:91], v[96:111]
  v_exp_f32 v38, v38
  v_exp_f32 v39, v39
  v_cvt_pk_bf16_f32 v32, v32, v33
  v_cvt_pk_bf16_f32 v33, v34, v35
  v_mfma_f32_32x32x16_bf16 v[112:127], v[128:131], v[24:27], v[112:127]
  v_cvt_pk_bf16_f32 v34, v36, v37
  v_cvt_pk_bf16_f32 v35, v38, v39
  v_exp_f32 v40, v40
  v_exp_f32 v41, v41
  s_waitcnt lgkmcnt(3)
  v_mfma_f32_32x32x16_bf16 v[160:175], v[224:227], v[32:35], v[160:175]
  v_exp_f32 v42, v42
  v_exp_f32 v43, v43
  v_exp_f32 v44, v44
  v_mfma_f32_32x32x16_bf16 v[96:111], v[128:131], v[32:35], v[96:111]
  v_exp_f32 v45, v45
  v_exp_f32 v46, v46
  v_exp_f32 v47, v47
  v_cvt_pk_bf16_f32 v40, v40, v41
  v_cvt_pk_bf16_f32 v41, v42, v43
  v_cvt_pk_bf16_f32 v42, v44, v45
  v_cvt_pk_bf16_f32 v43, v46, v47
  v_exp_f32 v48, v48
  s_waitcnt lgkmcnt(2)
  v_mfma_f32_32x32x16_bf16 v[160:175], v[228:231], v[40:43], v[160:175]
  v_exp_f32 v49, v49
  v_exp_f32 v64, v64
  v_exp_f32 v65, v65
  v_mfma_f32_32x32x16_bf16 v[96:111], v[128:131], v[40:43], v[96:111]
  v_exp_f32 v50, v50
  v_exp_f32 v51, v51
  v_exp_f32 v66, v66
  v_exp_f32 v67, v67
  v_exp_f32 v52, v52
  v_exp_f32 v53, v53
  v_exp_f32 v54, v54
  v_exp_f32 v55, v55
  v_exp_f32 v68, v68
  v_exp_f32 v69, v69
  v_exp_f32 v70, v70
  v_exp_f32 v71, v71
  v_cvt_pk_bf16_f32 v48, v48, v49
  v_cvt_pk_bf16_f32 v64, v64, v65
  v_cvt_pk_bf16_f32 v49, v50, v51
  v_cvt_pk_bf16_f32 v65, v66, v67
  v_cvt_pk_bf16_f32 v50, v52, v53
  v_cvt_pk_bf16_f32 v51, v54, v55
  v_cvt_pk_bf16_f32 v66, v68, v69
  v_cvt_pk_bf16_f32 v67, v70, v71
  v_mfma_f32_32x32x16_bf16 v[176:191], v[224:227], v[48:51], v[176:191]
  v_exp_f32 v56, v56
  v_exp_f32 v57, v57
  v_exp_f32 v72, v72
  v_mfma_f32_32x32x16_bf16 v[112:127], v[128:131], v[48:51], v[112:127]
  v_exp_f32 v73, v73
  v_exp_f32 v58, v58
  v_exp_f32 v59, v59
  s_waitcnt lgkmcnt(1)
  v_mfma_f32_32x32x16_bf16 v[160:175], v[232:235], v[64:67], v[160:175]
  v_exp_f32 v74, v74
  v_exp_f32 v75, v75
  v_exp_f32 v60, v60
  v_mfma_f32_32x32x16_bf16 v[96:111], v[128:131], v[64:67], v[96:111]
  v_exp_f32 v61, v61
  v_exp_f32 v62, v62
  v_exp_f32 v63, v63
  v_exp_f32 v76, v76
  v_exp_f32 v77, v77
  v_exp_f32 v78, v78
  v_exp_f32 v79, v79
  v_cvt_pk_bf16_f32 v56, v56, v57
  v_cvt_pk_bf16_f32 v72, v72, v73
  v_cvt_pk_bf16_f32 v57, v58, v59
  v_cvt_pk_bf16_f32 v73, v74, v75
  v_cvt_pk_bf16_f32 v58, v60, v61
  v_cvt_pk_bf16_f32 v59, v62, v63
  v_cvt_pk_bf16_f32 v74, v76, v77
  v_cvt_pk_bf16_f32 v75, v78, v79
  v_mfma_f32_32x32x16_bf16 v[176:191], v[228:231], v[56:59], v[176:191]
  v_mfma_f32_32x32x16_bf16 v[112:127], v[128:131], v[56:59], v[112:127]
  s_waitcnt lgkmcnt(0)
  v_mfma_f32_32x32x16_bf16 v[160:175], v[236:239], v[72:75], v[160:175]
  v_mfma_f32_32x32x16_bf16 v[96:111], v[128:131], v[72:75], v[96:111]
  s_nop 10
  s_branch K1_CHECK
K1_P2_3:
  ds_read_b128 v[208:211], v2 offset:28672
  ds_read_b128 v[212:215], v2 offset:29696
  ds_read_b128 v[216:219], v2 offset:20480
  ds_read_b128 v[220:223], v2 offset:21504
  s_waitcnt lgkmcnt(3)
  v_mfma_f32_32x32x16_bf16 v[16:31], v[208:211], v[192:195], 0
  s_waitcnt lgkmcnt(1)
  v_mfma_f32_32x32x16_bf16 v[48:63], v[216:219], v[192:195], 0
  s_waitcnt lgkmcnt(0)
  v_mfma_f32_32x32x16_bf16 v[48:63], v[220:223], v[196:199], v[48:63]
  v_mfma_f32_32x32x16_bf16 v[32:47], v[208:211], v[200:203], v[240:255]
  v_mfma_f32_32x32x16_bf16 v[16:31], v[212:215], v[196:199], v[16:31]
  s_nop 9
  v_exp_f32 v48, v48
  v_exp_f32 v49, v49
  v_exp_f32 v50, v50
  v_mfma_f32_32x32x16_bf16 v[32:47], v[212:215], v[204:207], v[32:47]
  v_cvt_pk_bf16_f32 v48, v48, v49
  s_cmp_eq_u32 s12, 1
  s_nop 8
  s_cbranch_scc1 K1_TVD23
K1_TVA23:
  s_waitcnt vmcnt(0)
  v_readfirstlane_b32 s8, v151
  s_nop 1
  s_cmp_eq_u32 s8, s35
  s_nop 0
  s_cbranch_scc1 K1_TVC23
  s_add_u32 s59, s59, 1
  s_cmp_ge_u32 s59, 131072
  s_cbranch_scc1 K1_TVC23
  s_sleep 2
  buffer_load_dwordx2 v[150:151], v13, s[44:47], 0 offen sc1
  s_branch K1_TVA23
K1_TVC23:
  s_add_u32 m0, s15, 0
  s_add_u32 s8, s58, 0
  buffer_load_dwordx4 v3, s[44:47], s8 offen offset:2048 sc1 lds
  buffer_load_dwordx4 v3, s[44:47], s8 offen offset:3072 sc1 lds
  s_add_u32 m0, s15, 4096
  s_add_u32 s8, s58, 4096
  buffer_load_dwordx4 v3, s[44:47], s8 offen offset:2048 sc1 lds
  buffer_load_dwordx4 v3, s[44:47], s8 offen offset:3072 sc1 lds
  s_add_u32 m0, s15, 8192
  s_add_u32 s8, s58, 8192
  buffer_load_dwordx4 v3, s[44:47], s8 offen offset:2048 sc1 lds
  buffer_load_dwordx4 v3, s[44:47], s8 offen offset:3072 sc1 lds
  s_add_u32 m0, s15, 12288
  s_add_u32 s8, s58, 12288
  buffer_load_dwordx4 v3, s[44:47], s8 offen offset:2048 sc1 lds
  buffer_load_dwordx4 v3, s[44:47], s8 offen offset:3072 sc1 lds
  s_mov_b32 s12, 1
K1_TVD23:
  s_waitcnt vmcnt(0)
  s_barrier
  ds_read_b128 v[224:227], v2 offset:30720
  ds_read_b128 v[228:231], v2 offset:31744
  ds_read_b128 v[208:211], v2 offset:12288
  s_cmp_eq_u32 s12, 1
  s_cbranch_scc1 K1_TVD24
K1_TVA24:
  s_waitcnt vmcnt(0)
  v_readfirstlane_b32 s8, v151
  s_nop 1
  s_cmp_eq_u32 s8, s35
  s_nop 0
  s_cbranch_scc1 K1_TVC24
  buffer_load_dwordx2 v[150:151], v13, s[44:47], 0 offen sc1
  s_branch K1_TVD24
K1_TVC24:
  s_add_u32 m0, s15, 0
  s_add_u32 s8, s58, 0
  buffer_load_dwordx4 v3, s[44:47], s8 offen offset:2048 sc1 lds
  buffer_load_dwordx4 v3, s[44:47], s8 offen offset:3072 sc1 lds
  s_add_u32 m0, s15, 4096
  s_add_u32 s8, s58, 4096
  buffer_load_dwordx4 v3, s[44:47], s8 offen offset:2048 sc1 lds
  buffer_load_dwordx4 v3, s[44:47], s8 offen offset:3072 sc1 lds
  s_add_u32 m0, s15, 8192
  s_add_u32 s8, s58, 8192
  buffer_load_dwordx4 v3, s[44:47], s8 offen offset:2048 sc1 lds
  buffer_load_dwordx4 v3, s[44:47], s8 offen offset:3072 sc1 lds
  s_add_u32 m0, s15, 12288
  s_add_u32 s8, s58, 12288
  buffer_load_dwordx4 v3, s[44:47], s8 offen offset:2048 sc1 lds
  buffer_load_dwordx4 v3, s[44:47], s8 offen offset:3072 sc1 lds
  s_mov_b32 s12, 1
K1_TVD24:
  ds_read_b128 v[212:215], v2 offset:13312
  ds_read_b128 v[232:235], v2 offset:22528
  ds_read_b128 v[236:239], v2 offset:23552
  v_mfma_f32_32x32x16_bf16 v[64:79], v[216:219], v[200:203], 0
  ds_read_b128 v[216:219], v2 offset:4096
  v_exp_f32 v16, v16
  v_exp_f32 v17, v17
  v_exp_f32 v18, v18
  v_mfma_f32_32x32x16_bf16 v[64:79], v[220:223], v[204:207], v[64:79]
  ds_read_b128 v[220:223], v2 offset:5120
  v_exp_f32 v32, v32
  v_exp_f32 v33, v33
  v_exp_f32 v19, v19
  v_exp_f32 v34, v34
  v_exp_f32 v35, v35
  v_exp_f32 v20, v20
  v_exp_f32 v21, v21
  v_exp_f32 v22, v22
  v_exp_f32 v23, v23
  v_cvt_pk_bf16_f32 v16, v16, v17
  v_exp_f32 v36, v36
  v_exp_f32 v37, v37
  v_exp_f32 v38, v38
  s_waitcnt lgkmcnt(5)
  v_mfma_f32_32x32x16_bf16 v[80:95], v[208:211], v[192:195], 0
  v_exp_f32 v39, v39
  v_cvt_pk_bf16_f32 v32, v32, v33
  v_cvt_pk_bf16_f32 v17, v18, v19
  v_cvt_pk_bf16_f32 v33, v34, v35
  v_cvt_pk_bf16_f32 v18, v20, v21
  s_waitcnt lgkmcnt(4)
  v_mfma_f32_32x32x16_bf16 v[80:95], v[212:215], v[196:199], v[80:95]
  v_cvt_pk_bf16_f32 v19, v22, v23
  v_cvt_pk_bf16_f32 v34, v36, v37
  v_cvt_pk_bf16_f32 v35, v38, v39
  v_exp_f32 v24, v24
  v_exp_f32 v25, v25
  v_mfma_f32_32x32x16_bf16 v[160:175], v[224:227], v[16:19], v[160:175]
  v_exp_f32 v40, v40
  v_exp_f32 v41, v41
  v_exp_f32 v26, v26
  v_mfma_f32_32x32x16_bf16 v[96:111], v[128:131], v[16:19], v[96:111]
  v_exp_f32 v27, v27
  v_exp_f32 v42, v42
  v_exp_f32 v43, v43
  v_mfma_f32_32x32x16_bf16 v[176:191], v[224:227], v[32:35], v[176:191]
  ds_read_b128 v[224:227], v2 offset:14336
  v_exp_f32 v28, v28
  v_exp_f32 v29, v29
  v_exp_f32 v30, v30
  v_mfma_f32_32x32x16_bf16 v[112:127], v[128:131], v[32:35], v[112:127]
  v_exp_f32 v31, v31
  v_cvt_pk_bf16_f32 v24, v24, v25
  v_exp_f32 v44, v44
  v_exp_f32 v45, v45
  v_exp_f32 v46, v46
  v_exp_f32 v47, v47
  v_cvt_pk_bf16_f32 v40, v40, v41
  v_cvt_pk_bf16_f32 v25, v26, v27
  v_cvt_pk_bf16_f32 v41, v42, v43
  v_cvt_pk_bf16_f32 v26, v28, v29
  v_cvt_pk_bf16_f32 v27, v30, v31
  v_cvt_pk_bf16_f32 v42, v44, v45
  v_cvt_pk_bf16_f32 v43, v46, v47
  v_mfma_f32_32x32x16_bf16 v[160:175], v[228:231], v[24:27], v[160:175]
  v_exp_f32 v64, v64
  v_exp_f32 v65, v65
  v_exp_f32 v51, v51
  v_mfma_f32_32x32x16_bf16 v[96:111], v[128:131], v[24:27], v[96:111]
  v_exp_f32 v66, v66
  v_exp_f32 v67, v67
  v_exp_f32 v52, v52
  v_mfma_f32_32x32x16_bf16 v[176:191], v[228:231], v[40:43], v[176:191]
  ds_read_b128 v[228:231], v2 offset:15360
  v_exp_f32 v53, v53
  v_exp_f32 v54, v54
  v_exp_f32 v55, v55
  v_mfma_f32_32x32x16_bf16 v[16:31], v[208:211], v[200:203], 0
  ds_read_b128 v[208:211], v2 offset:24576
  v_exp_f32 v68, v68
  v_exp_f32 v69, v69
  v_exp_f32 v70, v70
  v_mfma_f32_32x32x16_bf16 v[16:31], v[212:215], v[204:207], v[16:31]
  ds_read_b128 v[212:215], v2 offset:25600
  v_exp_f32 v71, v71
  v_cvt_pk_bf16_f32 v64, v64, v65
  v_cvt_pk_bf16_f32 v49, v50, v51
  v_cvt_pk_bf16_f32 v65, v66, v67
  v_mfma_f32_32x32x16_bf16 v[112:127], v[128:131], v[40:43], v[112:127]
  v_cvt_pk_bf16_f32 v50, v52, v53
  v_cvt_pk_bf16_f32 v51, v54, v55
  v_cvt_pk_bf16_f32 v66, v68, v69
  v_cvt_pk_bf16_f32 v67, v70, v71
  v_exp_f32 v56, v56
  s_waitcnt lgkmcnt(7)
  v_mfma_f32_32x32x16_bf16 v[160:175], v[232:235], v[48:51], v[160:175]
  v_exp_f32 v57, v57
  v_exp_f32 v72, v72
  v_exp_f32 v73, v73
  v_mfma_f32_32x32x16_bf16 v[176:191], v[232:235], v[64:67], v[176:191]
  ds_read_b128 v[232:235], v2 offset:6144
  v_exp_f32 v58, v58
  v_exp_f32 v59, v59
  v_exp_f32 v74, v74
  s_waitcnt lgkmcnt(6)
  v_mfma_f32_32x32x16_bf16 v[32:47], v[216:219], v[192:195], 0
  v_exp_f32 v75, v75
  v_exp_f32 v60, v60
  v_exp_f32 v61, v61
  v_mfma_f32_32x32x16_bf16 v[96:111], v[128:131], v[48:51], v[96:111]
  v_exp_f32 v62, v62
  v_exp_f32 v63, v63
  v_exp_f32 v76, v76
  v_mfma_f32_32x32x16_bf16 v[112:127], v[128:131], v[64:67], v[112:127]
  v_exp_f32 v77, v77
  v_exp_f32 v78, v78
  v_exp_f32 v79, v79
  s_waitcnt lgkmcnt(5)
  v_mfma_f32_32x32x16_bf16 v[32:47], v[220:223], v[196:199], v[32:47]
  v_cvt_pk_bf16_f32 v56, v56, v57
  v_cvt_pk_bf16_f32 v72, v72, v73
  v_cvt_pk_bf16_f32 v57, v58, v59
  v_cvt_pk_bf16_f32 v73, v74, v75
  v_cvt_pk_bf16_f32 v58, v60, v61
  v_cvt_pk_bf16_f32 v59, v62, v63
  v_cvt_pk_bf16_f32 v74, v76, v77
  v_cvt_pk_bf16_f32 v75, v78, v79
  v_mfma_f32_32x32x16_bf16 v[160:175], v[236:239], v[56:59], v[160:175]
  v_exp_f32 v80, v80
  v_exp_f32 v81, v81
  v_exp_f32 v16, v16
  v_mfma_f32_32x32x16_bf16 v[176:191], v[236:239], v[72:75], v[176:191]
  ds_read_b128 v[236:239], v2 offset:7168
  v_exp_f32 v17, v17
  v_exp_f32 v82, v82
  v_exp_f32 v83, v83
  v_mfma_f32_32x32x16_bf16 v[96:111], v[128:131], v[56:59], v[96:111]
  v_exp_f32 v18, v18
  v_exp_f32 v19, v19
  v_exp_f32 v84, v84
  v_mfma_f32_32x32x16_bf16 v[112:127], v[128:131], v[72:75], v[112:127]
  v_exp_f32 v85, v85
  v_exp_f32 v86, v86
  v_exp_f32 v87, v87
  v_mfma_f32_32x32x16_bf16 v[48:63], v[216:219], v[200:203], 0
  v_exp_f32 v20, v20
  v_exp_f32 v21, v21
  v_exp_f32 v22, v22
  s_waitcnt lgkmcnt(3)
  v_mfma_f32_32x32x16_bf16 v[64:79], v[208:211], v[192:195], v[240:255]
  v_exp_f32 v23, v23
  v_cvt_pk_bf16_f32 v80, v80, v81
  v_cvt_pk_bf16_f32 v16, v16, v17
  v_cvt_pk_bf16_f32 v81, v82, v83
  v_cvt_pk_bf16_f32 v17, v18, v19
  v_mfma_f32_32x32x16_bf16 v[48:63], v[220:223], v[204:207], v[48:63]
  v_cvt_pk_bf16_f32 v82, v84, v85
  v_cvt_pk_bf16_f32 v83, v86, v87
  v_cvt_pk_bf16_f32 v18, v20, v21
  v_cvt_pk_bf16_f32 v19, v22, v23
  v_exp_f32 v88, v88
  v_mfma_f32_32x32x16_bf16 v[160:175], v[224:227], v[80:83], v[160:175]
  v_exp_f32 v89, v89
  v_exp_f32 v24, v24
  v_exp_f32 v25, v25
  v_mfma_f32_32x32x16_bf16 v[176:191], v[224:227], v[16:19], v[176:191]
  ds_read_b128 v[224:227], v2 offset:26624
  v_exp_f32 v90, v90
  v_exp_f32 v91, v91
  v_exp_f32 v26, v26
  v_mfma_f32_32x32x16_bf16 v[96:111], v[128:131], v[80:83], v[96:111]
  v_exp_f32 v27, v27
  v_exp_f32 v92, v92
  v_exp_f32 v93, v93
  s_waitcnt lgkmcnt(3)
  v_mfma_f32_32x32x16_bf16 v[64:79], v[212:215], v[196:199], v[64:79]
  v_exp_f32 v94, v94
  v_exp_f32 v95, v95
  v_exp_f32 v28, v28
  v_mfma_f32_32x32x16_bf16 v[112:127], v[128:131], v[16:19], v[112:127]
  v_exp_f32 v29, v29
  v_exp_f32 v30, v30
  v_exp_f32 v31, v31
  v_cvt_pk_bf16_f32 v88, v88, v89
  v_cvt_pk_bf16_f32 v24, v24, v25
  v_cvt_pk_bf16_f32 v89, v90, v91
  v_cvt_pk_bf16_f32 v25, v26, v27
  v_cvt_pk_bf16_f32 v90, v92, v93
  v_cvt_pk_bf16_f32 v91, v94, v95
  v_cvt_pk_bf16_f32 v26, v28, v29
  v_cvt_pk_bf16_f32 v27, v30, v31
  v_mfma_f32_32x32x16_bf16 v[160:175], v[228:231], v[88:91], v[160:175]
  v_exp_f32 v32, v32
  v_exp_f32 v33, v33
  v_exp_f32 v34, v34
  v_mfma_f32_32x32x16_bf16 v[176:191], v[228:231], v[24:27], v[176:191]
  ds_read_b128 v[228:231], v2 offset:27648
  v_exp_f32 v35, v35
  v_exp_f32 v36, v36
  v_exp_f32 v37, v37
  v_mfma_f32_32x32x16_bf16 v[96:111], v[128:131], v[88:91], v[96:111]
  v_exp_f32 v38, v38
  v_exp_f32 v39, v39
  v_cvt_pk_bf16_f32 v32, v32, v33
  v_cvt_pk_bf16_f32 v33, v34, v35
  v_mfma_f32_32x32x16_bf16 v[112:127], v[128:131], v[24:27], v[112:127]
  v_cvt_pk_bf16_f32 v34, v36, v37
  v_cvt_pk_bf16_f32 v35, v38, v39
  v_exp_f32 v40, v40
  v_exp_f32 v41, v41
  s_waitcnt lgkmcnt(3)
  v_mfma_f32_32x32x16_bf16 v[160:175], v[232:235], v[32:35], v[160:175]
  v_exp_f32 v42, v42
  v_exp_f32 v43, v43
  v_exp_f32 v44, v44
  v_mfma_f32_32x32x16_bf16 v[96:111], v[128:131], v[32:35], v[96:111]
  v_exp_f32 v45, v45
  v_exp_f32 v46, v46
  v_exp_f32 v47, v47
  v_cvt_pk_bf16_f32 v40, v40, v41
  v_cvt_pk_bf16_f32 v41, v42, v43
  v_cvt_pk_bf16_f32 v42, v44, v45
  v_cvt_pk_bf16_f32 v43, v46, v47
  v_exp_f32 v48, v48
  s_waitcnt lgkmcnt(2)
  v_mfma_f32_32x32x16_bf16 v[160:175], v[236:239], v[40:43], v[160:175]
  v_exp_f32 v49, v49
  v_exp_f32 v64, v64
  v_exp_f32 v65, v65
  v_mfma_f32_32x32x16_bf16 v[96:111], v[128:131], v[40:43], v[96:111]
  v_exp_f32 v50, v50
  v_exp_f32 v51, v51
  v_exp_f32 v66, v66
  v_exp_f32 v67, v67
  v_exp_f32 v52, v52
  v_exp_f32 v53, v53
  v_exp_f32 v54, v54
  v_exp_f32 v55, v55
  v_exp_f32 v68, v68
  v_exp_f32 v69, v69
  v_exp_f32 v70, v70
  v_exp_f32 v71, v71
  v_cvt_pk_bf16_f32 v48, v48, v49
  v_cvt_pk_bf16_f32 v64, v64, v65
  v_cvt_pk_bf16_f32 v49, v50, v51
  v_cvt_pk_bf16_f32 v65, v66, v67
  v_cvt_pk_bf16_f32 v50, v52, v53
  v_cvt_pk_bf16_f32 v51, v54, v55
  v_cvt_pk_bf16_f32 v66, v68, v69
  v_cvt_pk_bf16_f32 v67, v70, v71
  v_mfma_f32_32x32x16_bf16 v[176:191], v[232:235], v[48:51], v[176:191]
  v_exp_f32 v56, v56
  v_exp_f32 v57, v57
  v_exp_f32 v72, v72
  v_mfma_f32_32x32x16_bf16 v[112:127], v[128:131], v[48:51], v[112:127]
  v_exp_f32 v73, v73
  v_exp_f32 v58, v58
  v_exp_f32 v59, v59
  s_waitcnt lgkmcnt(1)
  v_mfma_f32_32x32x16_bf16 v[160:175], v[224:227], v[64:67], v[160:175]
  v_exp_f32 v74, v74
  v_exp_f32 v75, v75
  v_exp_f32 v60, v60
  v_mfma_f32_32x32x16_bf16 v[96:111], v[128:131], v[64:67], v[96:111]
  v_exp_f32 v61, v61
  v_exp_f32 v62, v62
  v_exp_f32 v63, v63
  v_exp_f32 v76, v76
  v_exp_f32 v77, v77
  v_exp_f32 v78, v78
  v_exp_f32 v79, v79
  v_cvt_pk_bf16_f32 v56, v56, v57
  v_cvt_pk_bf16_f32 v72, v72, v73
  v_cvt_pk_bf16_f32 v57, v58, v59
  v_cvt_pk_bf16_f32 v73, v74, v75
  v_cvt_pk_bf16_f32 v58, v60, v61
  v_cvt_pk_bf16_f32 v59, v62, v63
  v_cvt_pk_bf16_f32 v74, v76, v77
  v_cvt_pk_bf16_f32 v75, v78, v79
  v_mfma_f32_32x32x16_bf16 v[176:191], v[236:239], v[56:59], v[176:191]
  v_mfma_f32_32x32x16_bf16 v[112:127], v[128:131], v[56:59], v[112:127]
  s_waitcnt lgkmcnt(0)
  v_mfma_f32_32x32x16_bf16 v[160:175], v[228:231], v[72:75], v[160:175]
  v_mfma_f32_32x32x16_bf16 v[96:111], v[128:131], v[72:75], v[96:111]
  s_nop 11
K1_CHECK:
  v_pk_mul_f32 v[148:149], v[160:161], 0
  v_pk_fma_f32 v[148:149], v[162:163], 0, v[148:149]
  v_pk_fma_f32 v[148:149], v[164:165], 0, v[148:149]
  v_pk_fma_f32 v[148:149], v[166:167], 0, v[148:149]
  v_pk_fma_f32 v[148:149], v[168:169], 0, v[148:149]
  v_pk_fma_f32 v[148:149], v[170:171], 0, v[148:149]
  v_pk_fma_f32 v[148:149], v[172:173], 0, v[148:149]
  v_pk_fma_f32 v[148:149], v[174:175], 0, v[148:149]
  v_pk_fma_f32 v[148:149], v[176:177], 0, v[148:149]
  v_pk_fma_f32 v[148:149], v[178:179], 0, v[148:149]
  v_pk_fma_f32 v[148:149], v[180:181], 0, v[148:149]
  v_pk_fma_f32 v[148:149], v[182:183], 0, v[148:149]
  v_pk_fma_f32 v[148:149], v[184:185], 0, v[148:149]
  v_pk_fma_f32 v[148:149], v[186:187], 0, v[148:149]
  v_pk_fma_f32 v[148:149], v[188:189], 0, v[148:149]
  v_pk_fma_f32 v[148:149], v[190:191], 0, v[148:149]
  v_mov_b32 v7, v96
  v_mov_b32 v8, v112
  v_add_f32 v148, v148, v149
  v_max_f32 v9, v7, v8
  v_min_f32 v10, v7, v8
  v_add_f32 v11, v7, v8
  v_add_f32 v148, v148, v11
  s_mov_b32 s8, 0x4e800000
  s_mov_b32 s9, 0x30800000
  v_cmp_ge_f32 s[80:81], s8, v9
  v_cmp_le_f32 s[82:83], s9, v10
  v_cmp_o_f32 s[84:85], v148, v148
  s_nop 0
  s_and_b64 s[80:81], s[80:81], s[82:83]
  s_and_b64 s[80:81], s[80:81], s[84:85]
  s_cmp_eq_u64 s[80:81], -1
  s_cbranch_scc0 K1_SLOW
K1_FIN:
  v_rcp_f32 v7, v7
  v_rcp_f32 v8, v8
  v_mul_f32 v160, v160, v7
  v_mul_f32 v161, v161, v7
  v_mul_f32 v162, v162, v7
  v_mul_f32 v163, v163, v7
  v_mul_f32 v164, v164, v7
  v_mul_f32 v165, v165, v7
  v_mul_f32 v166, v166, v7
  v_mul_f32 v167, v167, v7
  v_mul_f32 v168, v168, v7
  v_mul_f32 v169, v169, v7
  v_mul_f32 v170, v170, v7
  v_mul_f32 v171, v171, v7
  v_mul_f32 v172, v172, v7
  v_mul_f32 v173, v173, v7
  v_mul_f32 v174, v174, v7
  v_mul_f32 v175, v175, v7
  v_cvt_pk_bf16_f32 v160, v160, v161
  v_cvt_pk_bf16_f32 v161, v162, v163
  v_cvt_pk_bf16_f32 v162, v164, v165
  v_cvt_pk_bf16_f32 v163, v166, v167
  buffer_store_dwordx4 v[160:163], v4, s[44:47], s56 offen offset:0 sc1
  v_cvt_pk_bf16_f32 v168, v168, v169
  v_cvt_pk_bf16_f32 v169, v170, v171
  v_cvt_pk_bf16_f32 v170, v172, v173
  v_cvt_pk_bf16_f32 v171, v174, v175
  buffer_store_dwordx4 v[168:171], v4, s[44:47], s56 offen offset:1024 sc1
  v_mul_f32 v176, v176, v8
  v_mul_f32 v177, v177, v8
  v_mul_f32 v178, v178, v8
  v_mul_f32 v179, v179, v8
  v_mul_f32 v180, v180, v8
  v_mul_f32 v181, v181, v8
  v_mul_f32 v182, v182, v8
  v_mul_f32 v183, v183, v8
  v_mul_f32 v184, v184, v8
  v_mul_f32 v185, v185, v8
  v_mul_f32 v186, v186, v8
  v_mul_f32 v187, v187, v8
  v_mul_f32 v188, v188, v8
  v_mul_f32 v189, v189, v8
  v_mul_f32 v190, v190, v8
  v_mul_f32 v191, v191, v8
  v_cvt_pk_bf16_f32 v176, v176, v177
  v_cvt_pk_bf16_f32 v177, v178, v179
  v_cvt_pk_bf16_f32 v178, v180, v181
  v_cvt_pk_bf16_f32 v179, v182, v183
  buffer_store_dwordx4 v[176:179], v4, s[44:47], s57 offen offset:0 sc1
  v_cvt_pk_bf16_f32 v184, v184, v185
  v_cvt_pk_bf16_f32 v185, v186, v187
  v_cvt_pk_bf16_f32 v186, v188, v189
  v_cvt_pk_bf16_f32 v187, v190, v191
  buffer_store_dwordx4 v[184:187], v4, s[44:47], s57 offen offset:1024 sc1
  s_lshl_b32 s16, s5, 3
  s_bfe_u32 s8, s6, 0x10002
  s_lshl_b32 s8, s8, 2
  s_add_u32 s16, s16, s8
  s_lshr_b32 s17, s6, 3
  s_lshl_b32 s17, s17, 2
  s_and_b32 s8, s6, 3
  s_add_u32 s17, s17, s8
  s_and_b32 s12, s3, 3
  v_lshrrev_b32 v10, 4, v0
  v_and_b32 v11, 15, v0
  v_lshlrev_b32 v12, 1, v10
  v_xor_b32 v11, v11, v12
  s_lshl_b32 s8, s12, 4
  v_add_u32 v10, s8, v10
  v_lshlrev_b32 v10, 11, v10
  v_lshl_add_u32 v10, v11, 4, v10
  s_lshl_b32 s8, s17, 8
  v_add_u32 v16, s8, v10
  v_xor_b32 v12, 128, v16
  v_add_u32 v17, 7168, v12
  v_add_u32 v18, 14336, v16
  v_add_u32 v19, 21504, v12
  s_lshl_b32 s56, s12, 12
  s_lshl_b32 s8, s7, 5
  s_lshl_b32 s9, s3, 2
  s_add_u32 s8, s8, s9
  s_add_u32 s8, s8, 26214400
  v_mov_b32 v20, s35
  v_mov_b32 v21, s8
  v_mov_b32 v23, s32
  s_mov_b32 s22, 65536
  s_and_b32 s18, s6, 8
  s_xor_b32 s19, s18, 8
  s_cmp_ge_u32 s3, 4
  s_cbranch_scc1 PJ_LOADER
  s_waitcnt vmcnt(0)
  s_mov_b64 exec, 1
  buffer_store_dword v20, v21, s[44:47], 0 offen sc1
  s_mov_b64 exec, -1
  s_barrier
  s_and_b32 s13, s3, 1
  s_lshr_b32 s14, s3, 1
  v_and_b32 v10, 15, v0
  v_lshrrev_b32 v11, 4, v0
  v_lshlrev_b32 v12, 4, v10
  v_lshl_add_u32 v12, v11, 9, v12
  s_lshl_b32 s8, s13, 13
  s_add_u32 s8, s8, 98304
  v_add_u32 v1, s8, v12
  v_bfe_u32 v12, v0, 2, 2
  v_and_b32 v13, 1, v11
  v_lshl_add_u32 v12, v13, 2, v12
  v_lshrrev_b32 v13, 1, v11
  v_lshl_add_u32 v13, v13, 4, v12
  v_lshlrev_b32 v13, 8, v13
  v_and_b32 v14, 3, v0
  v_lshl_add_u32 v13, v14, 3, v13
  s_lshl_b32 s8, s14, 2
  v_xor_b32 v12, s8, v12
  v_xor_b32 v14, 0, v12
  v_lshl_add_u32 v2, v14, 5, v13
  v_add_u32 v6, 0x10000, v2
  v_xor_b32 v14, 1, v12
  v_lshl_add_u32 v3, v14, 5, v13
  v_add_u32 v7, 0x10000, v3
  v_xor_b32 v14, 2, v12
  v_lshl_add_u32 v4, v14, 5, v13
  v_add_u32 v8, 0x10000, v4
  v_xor_b32 v14, 3, v12
  v_lshl_add_u32 v5, v14, 5, v13
  v_add_u32 v9, 0x10000, v5
  s_barrier
  ds_read_b128 v[96:99], v1 offset:0
  ds_read_b64_tr_b16 v[128:129], v2 offset:0
  ds_read_b64_tr_b16 v[130:131], v2 offset:2048
  ds_read_b128 v[100:103], v1 offset:256
  ds_read_b64_tr_b16 v[132:133], v3 offset:0
  ds_read_b64_tr_b16 v[134:135], v3 offset:2048
  ds_read_b128 v[104:107], v1 offset:4096
  ds_read_b64_tr_b16 v[136:137], v4 offset:0
  ds_read_b64_tr_b16 v[138:139], v4 offset:2048
  ds_read_b128 v[108:111], v1 offset:4352
  ds_read_b64_tr_b16 v[140:141], v5 offset:0
  ds_read_b64_tr_b16 v[142:143], v5 offset:2048
  s_waitcnt lgkmcnt(9)
  v_mfma_f32_16x16x32_bf16 v[32:35], v[128:131], v[96:99], 0
  s_waitcnt lgkmcnt(8)
  v_mfma_f32_16x16x32_bf16 v[36:39], v[128:131], v[100:103], 0
  ds_read_b128 v[112:115], v1 offset:2048
  s_waitcnt lgkmcnt(7)
  v_mfma_f32_16x16x32_bf16 v[48:51], v[132:135], v[96:99], 0
  ds_read_b64_tr_b16 v[144:145], v2 offset:8192
  v_mfma_f32_16x16x32_bf16 v[52:55], v[132:135], v[100:103], 0
  ds_read_b64_tr_b16 v[146:147], v2 offset:10240
  s_waitcnt lgkmcnt(8)
  v_mfma_f32_16x16x32_bf16 v[40:43], v[128:131], v[104:107], 0
  ds_read_b128 v[116:119], v1 offset:2304
  v_mfma_f32_16x16x32_bf16 v[56:59], v[132:135], v[104:107], 0
  ds_read_b64_tr_b16 v[148:149], v3 offset:8192
  s_waitcnt lgkmcnt(8)
  v_mfma_f32_16x16x32_bf16 v[64:67], v[136:139], v[96:99], 0
  ds_read_b64_tr_b16 v[150:151], v3 offset:10240
  v_mfma_f32_16x16x32_bf16 v[68:71], v[136:139], v[100:103], 0
  ds_read_b128 v[120:123], v1 offset:6144
  v_mfma_f32_16x16x32_bf16 v[72:75], v[136:139], v[104:107], 0
  ds_read_b64_tr_b16 v[152:153], v4 offset:8192
  s_waitcnt lgkmcnt(10)
  v_mfma_f32_16x16x32_bf16 v[44:47], v[128:131], v[108:111], 0
  ds_read_b64_tr_b16 v[154:155], v4 offset:10240
  v_mfma_f32_16x16x32_bf16 v[60:63], v[132:135], v[108:111], 0
  ds_read_b128 v[124:127], v1 offset:6400
  v_mfma_f32_16x16x32_bf16 v[76:79], v[136:139], v[108:111], 0
  ds_read_b64_tr_b16 v[156:157], v5 offset:8192
  s_waitcnt lgkmcnt(11)
  v_mfma_f32_16x16x32_bf16 v[80:83], v[140:143], v[96:99], 0
  ds_read_b64_tr_b16 v[158:159], v5 offset:10240
  v_mfma_f32_16x16x32_bf16 v[84:87], v[140:143], v[100:103], 0
  v_mfma_f32_16x16x32_bf16 v[88:91], v[140:143], v[104:107], 0
  v_mfma_f32_16x16x32_bf16 v[92:95], v[140:143], v[108:111], 0
  s_waitcnt lgkmcnt(9)
  v_mfma_f32_16x16x32_bf16 v[32:35], v[144:147], v[112:115], v[32:35]
  s_barrier
  s_waitcnt lgkmcnt(8)
  v_mfma_f32_16x16x32_bf16 v[36:39], v[144:147], v[116:119], v[36:39]
  ds_read_b128 v[96:99], v1 offset:16384
  s_waitcnt lgkmcnt(7)
  v_mfma_f32_16x16x32_bf16 v[48:51], v[148:151], v[112:115], v[48:51]
  ds_read_b64_tr_b16 v[128:129], v2 offset:16384
  v_mfma_f32_16x16x32_bf16 v[52:55], v[148:151], v[116:119], v[52:55]
  ds_read_b64_tr_b16 v[130:131], v2 offset:18432
  s_waitcnt lgkmcnt(8)
  v_mfma_f32_16x16x32_bf16 v[40:43], v[144:147], v[120:123], v[40:43]
  ds_read_b128 v[100:103], v1 offset:16640
  v_mfma_f32_16x16x32_bf16 v[56:59], v[148:151], v[120:123], v[56:59]
  ds_read_b64_tr_b16 v[132:133], v3 offset:16384
  s_waitcnt lgkmcnt(8)
  v_mfma_f32_16x16x32_bf16 v[64:67], v[152:155], v[112:115], v[64:67]
  ds_read_b64_tr_b16 v[134:135], v3 offset:18432
  v_mfma_f32_16x16x32_bf16 v[68:71], v[152:155], v[116:119], v[68:71]
  ds_read_b128 v[104:107], v1 offset:20480
  v_mfma_f32_16x16x32_bf16 v[72:75], v[152:155], v[120:123], v[72:75]
  ds_read_b64_tr_b16 v[136:137], v4 offset:16384
  s_waitcnt lgkmcnt(10)
  v_mfma_f32_16x16x32_bf16 v[44:47], v[144:147], v[124:127], v[44:47]
  ds_read_b64_tr_b16 v[138:139], v4 offset:18432
  v_mfma_f32_16x16x32_bf16 v[60:63], v[148:151], v[124:127], v[60:63]
  ds_read_b128 v[108:111], v1 offset:20736
  v_mfma_f32_16x16x32_bf16 v[76:79], v[152:155], v[124:127], v[76:79]
  ds_read_b64_tr_b16 v[140:141], v5 offset:16384
  s_waitcnt lgkmcnt(11)
  v_mfma_f32_16x16x32_bf16 v[80:83], v[156:159], v[112:115], v[80:83]
  ds_read_b64_tr_b16 v[142:143], v5 offset:18432
  v_mfma_f32_16x16x32_bf16 v[84:87], v[156:159], v[116:119], v[84:87]
  v_mfma_f32_16x16x32_bf16 v[88:91], v[156:159], v[120:123], v[88:91]
  v_mfma_f32_16x16x32_bf16 v[92:95], v[156:159], v[124:127], v[92:95]
  s_waitcnt lgkmcnt(9)
  v_mfma_f32_16x16x32_bf16 v[32:35], v[128:131], v[96:99], v[32:35]
  s_waitcnt lgkmcnt(8)
  v_mfma_f32_16x16x32_bf16 v[36:39], v[128:131], v[100:103], v[36:39]
  ds_read_b128 v[112:115], v1 offset:18432
  s_waitcnt lgkmcnt(7)
  v_mfma_f32_16x16x32_bf16 v[48:51], v[132:135], v[96:99], v[48:51]
  ds_read_b64_tr_b16 v[144:145], v2 offset:24576
  v_mfma_f32_16x16x32_bf16 v[52:55], v[132:135], v[100:103], v[52:55]
  ds_read_b64_tr_b16 v[146:147], v2 offset:26624
  s_waitcnt lgkmcnt(8)
  v_mfma_f32_16x16x32_bf16 v[40:43], v[128:131], v[104:107], v[40:43]
  ds_read_b128 v[116:119], v1 offset:18688
  v_mfma_f32_16x16x32_bf16 v[56:59], v[132:135], v[104:107], v[56:59]
  ds_read_b64_tr_b16 v[148:149], v3 offset:24576
  s_waitcnt lgkmcnt(8)
  v_mfma_f32_16x16x32_bf16 v[64:67], v[136:139], v[96:99], v[64:67]
  ds_read_b64_tr_b16 v[150:151], v3 offset:26624
  v_mfma_f32_16x16x32_bf16 v[68:71], v[136:139], v[100:103], v[68:71]
  ds_read_b128 v[120:123], v1 offset:22528
  v_mfma_f32_16x16x32_bf16 v[72:75], v[136:139], v[104:107], v[72:75]
  ds_read_b64_tr_b16 v[152:153], v4 offset:24576
  s_waitcnt lgkmcnt(10)
  v_mfma_f32_16x16x32_bf16 v[44:47], v[128:131], v[108:111], v[44:47]
  ds_read_b64_tr_b16 v[154:155], v4 offset:26624
  v_mfma_f32_16x16x32_bf16 v[60:63], v[132:135], v[108:111], v[60:63]
  ds_read_b128 v[124:127], v1 offset:22784
  v_mfma_f32_16x16x32_bf16 v[76:79], v[136:139], v[108:111], v[76:79]
  ds_read_b64_tr_b16 v[156:157], v5 offset:24576
  s_waitcnt lgkmcnt(11)
  v_mfma_f32_16x16x32_bf16 v[80:83], v[140:143], v[96:99], v[80:83]
  ds_read_b64_tr_b16 v[158:159], v5 offset:26624
  v_mfma_f32_16x16x32_bf16 v[84:87], v[140:143], v[100:103], v[84:87]
  v_mfma_f32_16x16x32_bf16 v[88:91], v[140:143], v[104:107], v[88:91]
  v_mfma_f32_16x16x32_bf16 v[92:95], v[140:143], v[108:111], v[92:95]
  s_waitcnt lgkmcnt(9)
  v_mfma_f32_16x16x32_bf16 v[32:35], v[144:147], v[112:115], v[32:35]
  s_barrier
  s_waitcnt lgkmcnt(8)
  v_mfma_f32_16x16x32_bf16 v[36:39], v[144:147], v[116:119], v[36:39]
  ds_read_b128 v[96:99], v1 offset:32768
  s_waitcnt lgkmcnt(7)
  v_mfma_f32_16x16x32_bf16 v[48:51], v[148:151], v[112:115], v[48:51]
  ds_read_b64_tr_b16 v[128:129], v2 offset:32768
  v_mfma_f32_16x16x32_bf16 v[52:55], v[148:151], v[116:119], v[52:55]
  ds_read_b64_tr_b16 v[130:131], v2 offset:34816
  s_waitcnt lgkmcnt(8)
  v_mfma_f32_16x16x32_bf16 v[40:43], v[144:147], v[120:123], v[40:43]
  ds_read_b128 v[100:103], v1 offset:33024
  v_mfma_f32_16x16x32_bf16 v[56:59], v[148:151], v[120:123], v[56:59]
  ds_read_b64_tr_b16 v[132:133], v3 offset:32768
  s_waitcnt lgkmcnt(8)
  v_mfma_f32_16x16x32_bf16 v[64:67], v[152:155], v[112:115], v[64:67]
  ds_read_b64_tr_b16 v[134:135], v3 offset:34816
  v_mfma_f32_16x16x32_bf16 v[68:71], v[152:155], v[116:119], v[68:71]
  ds_read_b128 v[104:107], v1 offset:36864
  v_mfma_f32_16x16x32_bf16 v[72:75], v[152:155], v[120:123], v[72:75]
  ds_read_b64_tr_b16 v[136:137], v4 offset:32768
  s_waitcnt lgkmcnt(10)
  v_mfma_f32_16x16x32_bf16 v[44:47], v[144:147], v[124:127], v[44:47]
  ds_read_b64_tr_b16 v[138:139], v4 offset:34816
  v_mfma_f32_16x16x32_bf16 v[60:63], v[148:151], v[124:127], v[60:63]
  ds_read_b128 v[108:111], v1 offset:37120
  v_mfma_f32_16x16x32_bf16 v[76:79], v[152:155], v[124:127], v[76:79]
  ds_read_b64_tr_b16 v[140:141], v5 offset:32768
  s_waitcnt lgkmcnt(11)
  v_mfma_f32_16x16x32_bf16 v[80:83], v[156:159], v[112:115], v[80:83]
  ds_read_b64_tr_b16 v[142:143], v5 offset:34816
  v_mfma_f32_16x16x32_bf16 v[84:87], v[156:159], v[116:119], v[84:87]
  v_mfma_f32_16x16x32_bf16 v[88:91], v[156:159], v[120:123], v[88:91]
  v_mfma_f32_16x16x32_bf16 v[92:95], v[156:159], v[124:127], v[92:95]
  s_waitcnt lgkmcnt(9)
  v_mfma_f32_16x16x32_bf16 v[32:35], v[128:131], v[96:99], v[32:35]
  s_waitcnt lgkmcnt(8)
  v_mfma_f32_16x16x32_bf16 v[36:39], v[128:131], v[100:103], v[36:39]
  ds_read_b128 v[112:115], v1 offset:34816
  s_waitcnt lgkmcnt(7)
  v_mfma_f32_16x16x32_bf16 v[48:51], v[132:135], v[96:99], v[48:51]
  ds_read_b64_tr_b16 v[144:145], v2 offset:40960
  v_mfma_f32_16x16x32_bf16 v[52:55], v[132:135], v[100:103], v[52:55]
  ds_read_b64_tr_b16 v[146:147], v2 offset:43008
  s_waitcnt lgkmcnt(8)
  v_mfma_f32_16x16x32_bf16 v[40:43], v[128:131], v[104:107], v[40:43]
  ds_read_b128 v[116:119], v1 offset:35072
  v_mfma_f32_16x16x32_bf16 v[56:59], v[132:135], v[104:107], v[56:59]
  ds_read_b64_tr_b16 v[148:149], v3 offset:40960
  s_waitcnt lgkmcnt(8)
  v_mfma_f32_16x16x32_bf16 v[64:67], v[136:139], v[96:99], v[64:67]
  ds_read_b64_tr_b16 v[150:151], v3 offset:43008
  v_mfma_f32_16x16x32_bf16 v[68:71], v[136:139], v[100:103], v[68:71]
  ds_read_b128 v[120:123], v1 offset:38912
  v_mfma_f32_16x16x32_bf16 v[72:75], v[136:139], v[104:107], v[72:75]
  ds_read_b64_tr_b16 v[152:153], v4 offset:40960
  s_waitcnt lgkmcnt(10)
  v_mfma_f32_16x16x32_bf16 v[44:47], v[128:131], v[108:111], v[44:47]
  ds_read_b64_tr_b16 v[154:155], v4 offset:43008
  v_mfma_f32_16x16x32_bf16 v[60:63], v[132:135], v[108:111], v[60:63]
  ds_read_b128 v[124:127], v1 offset:39168
  v_mfma_f32_16x16x32_bf16 v[76:79], v[136:139], v[108:111], v[76:79]
  ds_read_b64_tr_b16 v[156:157], v5 offset:40960
  s_waitcnt lgkmcnt(11)
  v_mfma_f32_16x16x32_bf16 v[80:83], v[140:143], v[96:99], v[80:83]
  ds_read_b64_tr_b16 v[158:159], v5 offset:43008
  v_mfma_f32_16x16x32_bf16 v[84:87], v[140:143], v[100:103], v[84:87]
  v_mfma_f32_16x16x32_bf16 v[88:91], v[140:143], v[104:107], v[88:91]
  v_mfma_f32_16x16x32_bf16 v[92:95], v[140:143], v[108:111], v[92:95]
  s_waitcnt lgkmcnt(9)
  v_mfma_f32_16x16x32_bf16 v[32:35], v[144:147], v[112:115], v[32:35]
  s_barrier
  s_waitcnt lgkmcnt(8)
  v_mfma_f32_16x16x32_bf16 v[36:39], v[144:147], v[116:119], v[36:39]
  ds_read_b128 v[96:99], v1 offset:49152
  s_waitcnt lgkmcnt(7)
  v_mfma_f32_16x16x32_bf16 v[48:51], v[148:151], v[112:115], v[48:51]
  ds_read_b64_tr_b16 v[128:129], v2 offset:49152
  v_mfma_f32_16x16x32_bf16 v[52:55], v[148:151], v[116:119], v[52:55]
  ds_read_b64_tr_b16 v[130:131], v2 offset:51200
  s_waitcnt lgkmcnt(8)
  v_mfma_f32_16x16x32_bf16 v[40:43], v[144:147], v[120:123], v[40:43]
  ds_read_b128 v[100:103], v1 offset:49408
  v_mfma_f32_16x16x32_bf16 v[56:59], v[148:151], v[120:123], v[56:59]
  ds_read_b64_tr_b16 v[132:133], v3 offset:49152
  s_waitcnt lgkmcnt(8)
  v_mfma_f32_16x16x32_bf16 v[64:67], v[152:155], v[112:115], v[64:67]
  ds_read_b64_tr_b16 v[134:135], v3 offset:51200
  v_mfma_f32_16x16x32_bf16 v[68:71], v[152:155], v[116:119], v[68:71]
  ds_read_b128 v[104:107], v1 offset:53248
  v_mfma_f32_16x16x32_bf16 v[72:75], v[152:155], v[120:123], v[72:75]
  ds_read_b64_tr_b16 v[136:137], v4 offset:49152
  s_waitcnt lgkmcnt(10)
  v_mfma_f32_16x16x32_bf16 v[44:47], v[144:147], v[124:127], v[44:47]
  ds_read_b64_tr_b16 v[138:139], v4 offset:51200
  v_mfma_f32_16x16x32_bf16 v[60:63], v[148:151], v[124:127], v[60:63]
  ds_read_b128 v[108:111], v1 offset:53504
  v_mfma_f32_16x16x32_bf16 v[76:79], v[152:155], v[124:127], v[76:79]
  ds_read_b64_tr_b16 v[140:141], v5 offset:49152
  s_waitcnt lgkmcnt(11)
  v_mfma_f32_16x16x32_bf16 v[80:83], v[156:159], v[112:115], v[80:83]
  ds_read_b64_tr_b16 v[142:143], v5 offset:51200
  v_mfma_f32_16x16x32_bf16 v[84:87], v[156:159], v[116:119], v[84:87]
  v_mfma_f32_16x16x32_bf16 v[88:91], v[156:159], v[120:123], v[88:91]
  v_mfma_f32_16x16x32_bf16 v[92:95], v[156:159], v[124:127], v[92:95]
  s_waitcnt lgkmcnt(9)
  v_mfma_f32_16x16x32_bf16 v[32:35], v[128:131], v[96:99], v[32:35]
  s_waitcnt lgkmcnt(8)
  v_mfma_f32_16x16x32_bf16 v[36:39], v[128:131], v[100:103], v[36:39]
  ds_read_b128 v[112:115], v1 offset:51200
  s_waitcnt lgkmcnt(7)
  v_mfma_f32_16x16x32_bf16 v[48:51], v[132:135], v[96:99], v[48:51]
  ds_read_b64_tr_b16 v[144:145], v2 offset:57344
  v_mfma_f32_16x16x32_bf16 v[52:55], v[132:135], v[100:103], v[52:55]
  ds_read_b64_tr_b16 v[146:147], v2 offset:59392
  s_waitcnt lgkmcnt(8)
  v_mfma_f32_16x16x32_bf16 v[40:43], v[128:131], v[104:107], v[40:43]
  ds_read_b128 v[116:119], v1 offset:51456
  v_mfma_f32_16x16x32_bf16 v[56:59], v[132:135], v[104:107], v[56:59]
  ds_read_b64_tr_b16 v[148:149], v3 offset:57344
  s_waitcnt lgkmcnt(8)
  v_mfma_f32_16x16x32_bf16 v[64:67], v[136:139], v[96:99], v[64:67]
  ds_read_b64_tr_b16 v[150:151], v3 offset:59392
  v_mfma_f32_16x16x32_bf16 v[68:71], v[136:139], v[100:103], v[68:71]
  ds_read_b128 v[120:123], v1 offset:55296
  v_mfma_f32_16x16x32_bf16 v[72:75], v[136:139], v[104:107], v[72:75]
  ds_read_b64_tr_b16 v[152:153], v4 offset:57344
  s_waitcnt lgkmcnt(10)
  v_mfma_f32_16x16x32_bf16 v[44:47], v[128:131], v[108:111], v[44:47]
  ds_read_b64_tr_b16 v[154:155], v4 offset:59392
  v_mfma_f32_16x16x32_bf16 v[60:63], v[132:135], v[108:111], v[60:63]
  ds_read_b128 v[124:127], v1 offset:55552
  v_mfma_f32_16x16x32_bf16 v[76:79], v[136:139], v[108:111], v[76:79]
  ds_read_b64_tr_b16 v[156:157], v5 offset:57344
  s_waitcnt lgkmcnt(11)
  v_mfma_f32_16x16x32_bf16 v[80:83], v[140:143], v[96:99], v[80:83]
  ds_read_b64_tr_b16 v[158:159], v5 offset:59392
  v_mfma_f32_16x16x32_bf16 v[84:87], v[140:143], v[100:103], v[84:87]
  v_mfma_f32_16x16x32_bf16 v[88:91], v[140:143], v[104:107], v[88:91]
  v_mfma_f32_16x16x32_bf16 v[92:95], v[140:143], v[108:111], v[92:95]
  s_waitcnt lgkmcnt(9)
  v_mfma_f32_16x16x32_bf16 v[32:35], v[144:147], v[112:115], v[32:35]
  s_barrier
  s_waitcnt lgkmcnt(8)
  v_mfma_f32_16x16x32_bf16 v[36:39], v[144:147], v[116:119], v[36:39]
  ds_read_b128 v[96:99], v1 offset:0
  s_waitcnt lgkmcnt(7)
  v_mfma_f32_16x16x32_bf16 v[48:51], v[148:151], v[112:115], v[48:51]
  ds_read_b64_tr_b16 v[128:129], v6 offset:0
  v_mfma_f32_16x16x32_bf16 v[52:55], v[148:151], v[116:119], v[52:55]
  ds_read_b64_tr_b16 v[130:131], v6 offset:2048
  s_waitcnt lgkmcnt(8)
  v_mfma_f32_16x16x32_bf16 v[40:43], v[144:147], v[120:123], v[40:43]
  ds_read_b128 v[100:103], v1 offset:256
  v_mfma_f32_16x16x32_bf16 v[56:59], v[148:151], v[120:123], v[56:59]
  ds_read_b64_tr_b16 v[132:133], v7 offset:0
  s_waitcnt lgkmcnt(8)
  v_mfma_f32_16x16x32_bf16 v[64:67], v[152:155], v[112:115], v[64:67]
  ds_read_b64_tr_b16 v[134:135], v7 offset:2048
  v_mfma_f32_16x16x32_bf16 v[68:71], v[152:155], v[116:119], v[68:71]
  ds_read_b128 v[104:107], v1 offset:4096
  v_mfma_f32_16x16x32_bf16 v[72:75], v[152:155], v[120:123], v[72:75]
  ds_read_b64_tr_b16 v[136:137], v8 offset:0
  s_waitcnt lgkmcnt(10)
  v_mfma_f32_16x16x32_bf16 v[44:47], v[144:147], v[124:127], v[44:47]
  ds_read_b64_tr_b16 v[138:139], v8 offset:2048
  v_mfma_f32_16x16x32_bf16 v[60:63], v[148:151], v[124:127], v[60:63]
  ds_read_b128 v[108:111], v1 offset:4352
  v_mfma_f32_16x16x32_bf16 v[76:79], v[152:155], v[124:127], v[76:79]
  ds_read_b64_tr_b16 v[140:141], v9 offset:0
  s_waitcnt lgkmcnt(11)
  v_mfma_f32_16x16x32_bf16 v[80:83], v[156:159], v[112:115], v[80:83]
  ds_read_b64_tr_b16 v[142:143], v9 offset:2048
  v_mfma_f32_16x16x32_bf16 v[84:87], v[156:159], v[116:119], v[84:87]
  v_mfma_f32_16x16x32_bf16 v[88:91], v[156:159], v[120:123], v[88:91]
  v_mfma_f32_16x16x32_bf16 v[92:95], v[156:159], v[124:127], v[92:95]
  s_waitcnt lgkmcnt(9)
  v_mfma_f32_16x16x32_bf16 v[32:35], v[128:131], v[96:99], v[32:35]
  s_waitcnt lgkmcnt(8)
  v_mfma_f32_16x16x32_bf16 v[36:39], v[128:131], v[100:103], v[36:39]
  ds_read_b128 v[112:115], v1 offset:2048
  s_waitcnt lgkmcnt(7)
  v_mfma_f32_16x16x32_bf16 v[48:51], v[132:135], v[96:99], v[48:51]
  ds_read_b64_tr_b16 v[144:145], v6 offset:8192
  v_mfma_f32_16x16x32_bf16 v[52:55], v[132:135], v[100:103], v[52:55]
  ds_read_b64_tr_b16 v[146:147], v6 offset:10240
  s_waitcnt lgkmcnt(8)
  v_mfma_f32_16x16x32_bf16 v[40:43], v[128:131], v[104:107], v[40:43]
  ds_read_b128 v[116:119], v1 offset:2304
  v_mfma_f32_16x16x32_bf16 v[56:59], v[132:135], v[104:107], v[56:59]
  ds_read_b64_tr_b16 v[148:149], v7 offset:8192
  s_waitcnt lgkmcnt(8)
  v_mfma_f32_16x16x32_bf16 v[64:67], v[136:139], v[96:99], v[64:67]
  ds_read_b64_tr_b16 v[150:151], v7 offset:10240
  v_mfma_f32_16x16x32_bf16 v[68:71], v[136:139], v[100:103], v[68:71]
  ds_read_b128 v[120:123], v1 offset:6144
  v_mfma_f32_16x16x32_bf16 v[72:75], v[136:139], v[104:107], v[72:75]
  ds_read_b64_tr_b16 v[152:153], v8 offset:8192
  s_waitcnt lgkmcnt(10)
  v_mfma_f32_16x16x32_bf16 v[44:47], v[128:131], v[108:111], v[44:47]
  ds_read_b64_tr_b16 v[154:155], v8 offset:10240
  v_mfma_f32_16x16x32_bf16 v[60:63], v[132:135], v[108:111], v[60:63]
  ds_read_b128 v[124:127], v1 offset:6400
  v_mfma_f32_16x16x32_bf16 v[76:79], v[136:139], v[108:111], v[76:79]
  ds_read_b64_tr_b16 v[156:157], v9 offset:8192
  s_waitcnt lgkmcnt(11)
  v_mfma_f32_16x16x32_bf16 v[80:83], v[140:143], v[96:99], v[80:83]
  ds_read_b64_tr_b16 v[158:159], v9 offset:10240
  v_mfma_f32_16x16x32_bf16 v[84:87], v[140:143], v[100:103], v[84:87]
  v_mfma_f32_16x16x32_bf16 v[88:91], v[140:143], v[104:107], v[88:91]
  v_mfma_f32_16x16x32_bf16 v[92:95], v[140:143], v[108:111], v[92:95]
  s_waitcnt lgkmcnt(9)
  v_mfma_f32_16x16x32_bf16 v[32:35], v[144:147], v[112:115], v[32:35]
  s_barrier
  s_waitcnt lgkmcnt(8)
  v_mfma_f32_16x16x32_bf16 v[36:39], v[144:147], v[116:119], v[36:39]
  ds_read_b128 v[96:99], v1 offset:16384
  s_waitcnt lgkmcnt(7)
  v_mfma_f32_16x16x32_bf16 v[48:51], v[148:151], v[112:115], v[48:51]
  ds_read_b64_tr_b16 v[128:129], v6 offset:16384
  v_mfma_f32_16x16x32_bf16 v[52:55], v[148:151], v[116:119], v[52:55]
  ds_read_b64_tr_b16 v[130:131], v6 offset:18432
  s_waitcnt lgkmcnt(8)
  v_mfma_f32_16x16x32_bf16 v[40:43], v[144:147], v[120:123], v[40:43]
  ds_read_b128 v[100:103], v1 offset:16640
  v_mfma_f32_16x16x32_bf16 v[56:59], v[148:151], v[120:123], v[56:59]
  ds_read_b64_tr_b16 v[132:133], v7 offset:16384
  s_waitcnt lgkmcnt(8)
  v_mfma_f32_16x16x32_bf16 v[64:67], v[152:155], v[112:115], v[64:67]
  ds_read_b64_tr_b16 v[134:135], v7 offset:18432
  v_mfma_f32_16x16x32_bf16 v[68:71], v[152:155], v[116:119], v[68:71]
  ds_read_b128 v[104:107], v1 offset:20480
  v_mfma_f32_16x16x32_bf16 v[72:75], v[152:155], v[120:123], v[72:75]
  ds_read_b64_tr_b16 v[136:137], v8 offset:16384
  s_waitcnt lgkmcnt(10)
  v_mfma_f32_16x16x32_bf16 v[44:47], v[144:147], v[124:127], v[44:47]
  ds_read_b64_tr_b16 v[138:139], v8 offset:18432
  v_mfma_f32_16x16x32_bf16 v[60:63], v[148:151], v[124:127], v[60:63]
  ds_read_b128 v[108:111], v1 offset:20736
  v_mfma_f32_16x16x32_bf16 v[76:79], v[152:155], v[124:127], v[76:79]
  ds_read_b64_tr_b16 v[140:141], v9 offset:16384
  s_waitcnt lgkmcnt(11)
  v_mfma_f32_16x16x32_bf16 v[80:83], v[156:159], v[112:115], v[80:83]
  ds_read_b64_tr_b16 v[142:143], v9 offset:18432
  v_mfma_f32_16x16x32_bf16 v[84:87], v[156:159], v[116:119], v[84:87]
  v_mfma_f32_16x16x32_bf16 v[88:91], v[156:159], v[120:123], v[88:91]
  v_mfma_f32_16x16x32_bf16 v[92:95], v[156:159], v[124:127], v[92:95]
  s_waitcnt lgkmcnt(9)
  v_mfma_f32_16x16x32_bf16 v[32:35], v[128:131], v[96:99], v[32:35]
  s_waitcnt lgkmcnt(8)
  v_mfma_f32_16x16x32_bf16 v[36:39], v[128:131], v[100:103], v[36:39]
  ds_read_b128 v[112:115], v1 offset:18432
  s_waitcnt lgkmcnt(7)
  v_mfma_f32_16x16x32_bf16 v[48:51], v[132:135], v[96:99], v[48:51]
  ds_read_b64_tr_b16 v[144:145], v6 offset:24576
  v_mfma_f32_16x16x32_bf16 v[52:55], v[132:135], v[100:103], v[52:55]
  ds_read_b64_tr_b16 v[146:147], v6 offset:26624
  s_waitcnt lgkmcnt(8)
  v_mfma_f32_16x16x32_bf16 v[40:43], v[128:131], v[104:107], v[40:43]
  ds_read_b128 v[116:119], v1 offset:18688
  v_mfma_f32_16x16x32_bf16 v[56:59], v[132:135], v[104:107], v[56:59]
  ds_read_b64_tr_b16 v[148:149], v7 offset:24576
  s_waitcnt lgkmcnt(8)
  v_mfma_f32_16x16x32_bf16 v[64:67], v[136:139], v[96:99], v[64:67]
  ds_read_b64_tr_b16 v[150:151], v7 offset:26624
  v_mfma_f32_16x16x32_bf16 v[68:71], v[136:139], v[100:103], v[68:71]
  ds_read_b128 v[120:123], v1 offset:22528
  v_mfma_f32_16x16x32_bf16 v[72:75], v[136:139], v[104:107], v[72:75]
  ds_read_b64_tr_b16 v[152:153], v8 offset:24576
  s_waitcnt lgkmcnt(10)
  v_mfma_f32_16x16x32_bf16 v[44:47], v[128:131], v[108:111], v[44:47]
  ds_read_b64_tr_b16 v[154:155], v8 offset:26624
  v_mfma_f32_16x16x32_bf16 v[60:63], v[132:135], v[108:111], v[60:63]
  ds_read_b128 v[124:127], v1 offset:22784
  v_mfma_f32_16x16x32_bf16 v[76:79], v[136:139], v[108:111], v[76:79]
  ds_read_b64_tr_b16 v[156:157], v9 offset:24576
  s_waitcnt lgkmcnt(11)
  v_mfma_f32_16x16x32_bf16 v[80:83], v[140:143], v[96:99], v[80:83]
  ds_read_b64_tr_b16 v[158:159], v9 offset:26624
  v_mfma_f32_16x16x32_bf16 v[84:87], v[140:143], v[100:103], v[84:87]
  v_mfma_f32_16x16x32_bf16 v[88:91], v[140:143], v[104:107], v[88:91]
  v_mfma_f32_16x16x32_bf16 v[92:95], v[140:143], v[108:111], v[92:95]
  s_waitcnt lgkmcnt(9)
  v_mfma_f32_16x16x32_bf16 v[32:35], v[144:147], v[112:115], v[32:35]
  s_barrier
  s_waitcnt lgkmcnt(8)
  v_mfma_f32_16x16x32_bf16 v[36:39], v[144:147], v[116:119], v[36:39]
  ds_read_b128 v[96:99], v1 offset:32768
  s_waitcnt lgkmcnt(7)
  v_mfma_f32_16x16x32_bf16 v[48:51], v[148:151], v[112:115], v[48:51]
  ds_read_b64_tr_b16 v[128:129], v2 offset:0
  v_mfma_f32_16x16x32_bf16 v[52:55], v[148:151], v[116:119], v[52:55]
  ds_read_b64_tr_b16 v[130:131], v2 offset:2048
  s_waitcnt lgkmcnt(8)
  v_mfma_f32_16x16x32_bf16 v[40:43], v[144:147], v[120:123], v[40:43]
  ds_read_b128 v[100:103], v1 offset:33024
  v_mfma_f32_16x16x32_bf16 v[56:59], v[148:151], v[120:123], v[56:59]
  ds_read_b64_tr_b16 v[132:133], v3 offset:0
  s_waitcnt lgkmcnt(8)
  v_mfma_f32_16x16x32_bf16 v[64:67], v[152:155], v[112:115], v[64:67]
  ds_read_b64_tr_b16 v[134:135], v3 offset:2048
  v_mfma_f32_16x16x32_bf16 v[68:71], v[152:155], v[116:119], v[68:71]
  ds_read_b128 v[104:107], v1 offset:36864
  v_mfma_f32_16x16x32_bf16 v[72:75], v[152:155], v[120:123], v[72:75]
  ds_read_b64_tr_b16 v[136:137], v4 offset:0
  s_waitcnt lgkmcnt(10)
  v_mfma_f32_16x16x32_bf16 v[44:47], v[144:147], v[124:127], v[44:47]
  ds_read_b64_tr_b16 v[138:139], v4 offset:2048
  v_mfma_f32_16x16x32_bf16 v[60:63], v[148:151], v[124:127], v[60:63]
  ds_read_b128 v[108:111], v1 offset:37120
  v_mfma_f32_16x16x32_bf16 v[76:79], v[152:155], v[124:127], v[76:79]
  ds_read_b64_tr_b16 v[140:141], v5 offset:0
  s_waitcnt lgkmcnt(11)
  v_mfma_f32_16x16x32_bf16 v[80:83], v[156:159], v[112:115], v[80:83]
  ds_read_b64_tr_b16 v[142:143], v5 offset:2048
  v_mfma_f32_16x16x32_bf16 v[84:87], v[156:159], v[116:119], v[84:87]
  v_mfma_f32_16x16x32_bf16 v[88:91], v[156:159], v[120:123], v[88:91]
  v_mfma_f32_16x16x32_bf16 v[92:95], v[156:159], v[124:127], v[92:95]
  s_waitcnt lgkmcnt(9)
  v_mfma_f32_16x16x32_bf16 v[32:35], v[128:131], v[96:99], v[32:35]
  s_waitcnt lgkmcnt(8)
  v_mfma_f32_16x16x32_bf16 v[36:39], v[128:131], v[100:103], v[36:39]
  ds_read_b128 v[112:115], v1 offset:34816
  s_waitcnt lgkmcnt(7)
  v_mfma_f32_16x16x32_bf16 v[48:51], v[132:135], v[96:99], v[48:51]
  ds_read_b64_tr_b16 v[144:145], v2 offset:8192
  v_mfma_f32_16x16x32_bf16 v[52:55], v[132:135], v[100:103], v[52:55]
  ds_read_b64_tr_b16 v[146:147], v2 offset:10240
  s_waitcnt lgkmcnt(8)
  v_mfma_f32_16x16x32_bf16 v[40:43], v[128:131], v[104:107], v[40:43]
  ds_read_b128 v[116:119], v1 offset:35072
  v_mfma_f32_16x16x32_bf16 v[56:59], v[132:135], v[104:107], v[56:59]
  ds_read_b64_tr_b16 v[148:149], v3 offset:8192
  s_waitcnt lgkmcnt(8)
  v_mfma_f32_16x16x32_bf16 v[64:67], v[136:139], v[96:99], v[64:67]
  ds_read_b64_tr_b16 v[150:151], v3 offset:10240
  v_mfma_f32_16x16x32_bf16 v[68:71], v[136:139], v[100:103], v[68:71]
  ds_read_b128 v[120:123], v1 offset:38912
  v_mfma_f32_16x16x32_bf16 v[72:75], v[136:139], v[104:107], v[72:75]
  ds_read_b64_tr_b16 v[152:153], v4 offset:8192
  s_waitcnt lgkmcnt(10)
  v_mfma_f32_16x16x32_bf16 v[44:47], v[128:131], v[108:111], v[44:47]
  ds_read_b64_tr_b16 v[154:155], v4 offset:10240
  v_mfma_f32_16x16x32_bf16 v[60:63], v[132:135], v[108:111], v[60:63]
  ds_read_b128 v[124:127], v1 offset:39168
  v_mfma_f32_16x16x32_bf16 v[76:79], v[136:139], v[108:111], v[76:79]
  ds_read_b64_tr_b16 v[156:157], v5 offset:8192
  s_waitcnt lgkmcnt(11)
  v_mfma_f32_16x16x32_bf16 v[80:83], v[140:143], v[96:99], v[80:83]
  ds_read_b64_tr_b16 v[158:159], v5 offset:10240
  v_mfma_f32_16x16x32_bf16 v[84:87], v[140:143], v[100:103], v[84:87]
  v_mfma_f32_16x16x32_bf16 v[88:91], v[140:143], v[104:107], v[88:91]
  v_mfma_f32_16x16x32_bf16 v[92:95], v[140:143], v[108:111], v[92:95]
  s_waitcnt lgkmcnt(9)
  v_mfma_f32_16x16x32_bf16 v[32:35], v[144:147], v[112:115], v[32:35]
  s_barrier
  s_waitcnt lgkmcnt(8)
  v_mfma_f32_16x16x32_bf16 v[36:39], v[144:147], v[116:119], v[36:39]
  ds_read_b128 v[96:99], v1 offset:49152
  s_waitcnt lgkmcnt(7)
  v_mfma_f32_16x16x32_bf16 v[48:51], v[148:151], v[112:115], v[48:51]
  ds_read_b64_tr_b16 v[128:129], v2 offset:16384
  v_mfma_f32_16x16x32_bf16 v[52:55], v[148:151], v[116:119], v[52:55]
  ds_read_b64_tr_b16 v[130:131], v2 offset:18432
  s_waitcnt lgkmcnt(8)
  v_mfma_f32_16x16x32_bf16 v[40:43], v[144:147], v[120:123], v[40:43]
  ds_read_b128 v[100:103], v1 offset:49408
  v_mfma_f32_16x16x32_bf16 v[56:59], v[148:151], v[120:123], v[56:59]
  ds_read_b64_tr_b16 v[132:133], v3 offset:16384
  s_waitcnt lgkmcnt(8)
  v_mfma_f32_16x16x32_bf16 v[64:67], v[152:155], v[112:115], v[64:67]
  ds_read_b64_tr_b16 v[134:135], v3 offset:18432
  v_mfma_f32_16x16x32_bf16 v[68:71], v[152:155], v[116:119], v[68:71]
  ds_read_b128 v[104:107], v1 offset:53248
  v_mfma_f32_16x16x32_bf16 v[72:75], v[152:155], v[120:123], v[72:75]
  ds_read_b64_tr_b16 v[136:137], v4 offset:16384
  s_waitcnt lgkmcnt(10)
  v_mfma_f32_16x16x32_bf16 v[44:47], v[144:147], v[124:127], v[44:47]
  ds_read_b64_tr_b16 v[138:139], v4 offset:18432
  v_mfma_f32_16x16x32_bf16 v[60:63], v[148:151], v[124:127], v[60:63]
  ds_read_b128 v[108:111], v1 offset:53504
  v_mfma_f32_16x16x32_bf16 v[76:79], v[152:155], v[124:127], v[76:79]
  ds_read_b64_tr_b16 v[140:141], v5 offset:16384
  s_waitcnt lgkmcnt(11)
  v_mfma_f32_16x16x32_bf16 v[80:83], v[156:159], v[112:115], v[80:83]
  ds_read_b64_tr_b16 v[142:143], v5 offset:18432
  v_mfma_f32_16x16x32_bf16 v[84:87], v[156:159], v[116:119], v[84:87]
  v_mfma_f32_16x16x32_bf16 v[88:91], v[156:159], v[120:123], v[88:91]
  v_mfma_f32_16x16x32_bf16 v[92:95], v[156:159], v[124:127], v[92:95]
  s_waitcnt lgkmcnt(9)
  v_mfma_f32_16x16x32_bf16 v[32:35], v[128:131], v[96:99], v[32:35]
  s_waitcnt lgkmcnt(8)
  v_mfma_f32_16x16x32_bf16 v[36:39], v[128:131], v[100:103], v[36:39]
  ds_read_b128 v[112:115], v1 offset:51200
  s_waitcnt lgkmcnt(7)
  v_mfma_f32_16x16x32_bf16 v[48:51], v[132:135], v[96:99], v[48:51]
  ds_read_b64_tr_b16 v[144:145], v2 offset:24576
  v_mfma_f32_16x16x32_bf16 v[52:55], v[132:135], v[100:103], v[52:55]
  ds_read_b64_tr_b16 v[146:147], v2 offset:26624
  s_waitcnt lgkmcnt(8)
  v_mfma_f32_16x16x32_bf16 v[40:43], v[128:131], v[104:107], v[40:43]
  ds_read_b128 v[116:119], v1 offset:51456
  v_mfma_f32_16x16x32_bf16 v[56:59], v[132:135], v[104:107], v[56:59]
  ds_read_b64_tr_b16 v[148:149], v3 offset:24576
  s_waitcnt lgkmcnt(8)
  v_mfma_f32_16x16x32_bf16 v[64:67], v[136:139], v[96:99], v[64:67]
  ds_read_b64_tr_b16 v[150:151], v3 offset:26624
  v_mfma_f32_16x16x32_bf16 v[68:71], v[136:139], v[100:103], v[68:71]
  ds_read_b128 v[120:123], v1 offset:55296
  v_mfma_f32_16x16x32_bf16 v[72:75], v[136:139], v[104:107], v[72:75]
  ds_read_b64_tr_b16 v[152:153], v4 offset:24576
  s_waitcnt lgkmcnt(10)
  v_mfma_f32_16x16x32_bf16 v[44:47], v[128:131], v[108:111], v[44:47]
  ds_read_b64_tr_b16 v[154:155], v4 offset:26624
  v_mfma_f32_16x16x32_bf16 v[60:63], v[132:135], v[108:111], v[60:63]
  ds_read_b128 v[124:127], v1 offset:55552
  v_mfma_f32_16x16x32_bf16 v[76:79], v[136:139], v[108:111], v[76:79]
  ds_read_b64_tr_b16 v[156:157], v5 offset:24576
  s_waitcnt lgkmcnt(11)
  v_mfma_f32_16x16x32_bf16 v[80:83], v[140:143], v[96:99], v[80:83]
  ds_read_b64_tr_b16 v[158:159], v5 offset:26624
  v_mfma_f32_16x16x32_bf16 v[84:87], v[140:143], v[100:103], v[84:87]
  v_mfma_f32_16x16x32_bf16 v[88:91], v[140:143], v[104:107], v[88:91]
  v_mfma_f32_16x16x32_bf16 v[92:95], v[140:143], v[108:111], v[92:95]
  s_waitcnt lgkmcnt(9)
  v_mfma_f32_16x16x32_bf16 v[32:35], v[144:147], v[112:115], v[32:35]
  s_barrier
  s_waitcnt lgkmcnt(8)
  v_mfma_f32_16x16x32_bf16 v[36:39], v[144:147], v[116:119], v[36:39]
  ds_read_b128 v[96:99], v1 offset:0
  s_waitcnt lgkmcnt(7)
  v_mfma_f32_16x16x32_bf16 v[48:51], v[148:151], v[112:115], v[48:51]
  ds_read_b64_tr_b16 v[128:129], v2 offset:32768
  v_mfma_f32_16x16x32_bf16 v[52:55], v[148:151], v[116:119], v[52:55]
  ds_read_b64_tr_b16 v[130:131], v2 offset:34816
  s_waitcnt lgkmcnt(8)
  v_mfma_f32_16x16x32_bf16 v[40:43], v[144:147], v[120:123], v[40:43]
  ds_read_b128 v[100:103], v1 offset:256
  v_mfma_f32_16x16x32_bf16 v[56:59], v[148:151], v[120:123], v[56:59]
  ds_read_b64_tr_b16 v[132:133], v3 offset:32768
  s_waitcnt lgkmcnt(8)
  v_mfma_f32_16x16x32_bf16 v[64:67], v[152:155], v[112:115], v[64:67]
  ds_read_b64_tr_b16 v[134:135], v3 offset:34816
  v_mfma_f32_16x16x32_bf16 v[68:71], v[152:155], v[116:119], v[68:71]
  ds_read_b128 v[104:107], v1 offset:4096
  v_mfma_f32_16x16x32_bf16 v[72:75], v[152:155], v[120:123], v[72:75]
  ds_read_b64_tr_b16 v[136:137], v4 offset:32768
  s_waitcnt lgkmcnt(10)
  v_mfma_f32_16x16x32_bf16 v[44:47], v[144:147], v[124:127], v[44:47]
  ds_read_b64_tr_b16 v[138:139], v4 offset:34816
  v_mfma_f32_16x16x32_bf16 v[60:63], v[148:151], v[124:127], v[60:63]
  ds_read_b128 v[108:111], v1 offset:4352
  v_mfma_f32_16x16x32_bf16 v[76:79], v[152:155], v[124:127], v[76:79]
  ds_read_b64_tr_b16 v[140:141], v5 offset:32768
  s_waitcnt lgkmcnt(11)
  v_mfma_f32_16x16x32_bf16 v[80:83], v[156:159], v[112:115], v[80:83]
  ds_read_b64_tr_b16 v[142:143], v5 offset:34816
  v_mfma_f32_16x16x32_bf16 v[84:87], v[156:159], v[116:119], v[84:87]
  v_mfma_f32_16x16x32_bf16 v[88:91], v[156:159], v[120:123], v[88:91]
  v_mfma_f32_16x16x32_bf16 v[92:95], v[156:159], v[124:127], v[92:95]
  s_waitcnt lgkmcnt(9)
  v_mfma_f32_16x16x32_bf16 v[32:35], v[128:131], v[96:99], v[32:35]
  s_waitcnt lgkmcnt(8)
  v_mfma_f32_16x16x32_bf16 v[36:39], v[128:131], v[100:103], v[36:39]
  ds_read_b128 v[112:115], v1 offset:2048
  s_waitcnt lgkmcnt(7)
  v_mfma_f32_16x16x32_bf16 v[48:51], v[132:135], v[96:99], v[48:51]
  ds_read_b64_tr_b16 v[144:145], v2 offset:40960
  v_mfma_f32_16x16x32_bf16 v[52:55], v[132:135], v[100:103], v[52:55]
  ds_read_b64_tr_b16 v[146:147], v2 offset:43008
  s_waitcnt lgkmcnt(8)
  v_mfma_f32_16x16x32_bf16 v[40:43], v[128:131], v[104:107], v[40:43]
  ds_read_b128 v[116:119], v1 offset:2304
  v_mfma_f32_16x16x32_bf16 v[56:59], v[132:135], v[104:107], v[56:59]
  ds_read_b64_tr_b16 v[148:149], v3 offset:40960
  s_waitcnt lgkmcnt(8)
  v_mfma_f32_16x16x32_bf16 v[64:67], v[136:139], v[96:99], v[64:67]
  ds_read_b64_tr_b16 v[150:151], v3 offset:43008
  v_mfma_f32_16x16x32_bf16 v[68:71], v[136:139], v[100:103], v[68:71]
  ds_read_b128 v[120:123], v1 offset:6144
  v_mfma_f32_16x16x32_bf16 v[72:75], v[136:139], v[104:107], v[72:75]
  ds_read_b64_tr_b16 v[152:153], v4 offset:40960
  s_waitcnt lgkmcnt(10)
  v_mfma_f32_16x16x32_bf16 v[44:47], v[128:131], v[108:111], v[44:47]
  ds_read_b64_tr_b16 v[154:155], v4 offset:43008
  v_mfma_f32_16x16x32_bf16 v[60:63], v[132:135], v[108:111], v[60:63]
  ds_read_b128 v[124:127], v1 offset:6400
  v_mfma_f32_16x16x32_bf16 v[76:79], v[136:139], v[108:111], v[76:79]
  ds_read_b64_tr_b16 v[156:157], v5 offset:40960
  s_waitcnt lgkmcnt(11)
  v_mfma_f32_16x16x32_bf16 v[80:83], v[140:143], v[96:99], v[80:83]
  ds_read_b64_tr_b16 v[158:159], v5 offset:43008
  v_mfma_f32_16x16x32_bf16 v[84:87], v[140:143], v[100:103], v[84:87]
  v_mfma_f32_16x16x32_bf16 v[88:91], v[140:143], v[104:107], v[88:91]
  v_mfma_f32_16x16x32_bf16 v[92:95], v[140:143], v[108:111], v[92:95]
  s_waitcnt lgkmcnt(9)
  v_mfma_f32_16x16x32_bf16 v[32:35], v[144:147], v[112:115], v[32:35]
  s_barrier
  s_waitcnt lgkmcnt(8)
  v_mfma_f32_16x16x32_bf16 v[36:39], v[144:147], v[116:119], v[36:39]
  ds_read_b128 v[96:99], v1 offset:16384
  s_waitcnt lgkmcnt(7)
  v_mfma_f32_16x16x32_bf16 v[48:51], v[148:151], v[112:115], v[48:51]
  ds_read_b64_tr_b16 v[128:129], v2 offset:49152
  v_mfma_f32_16x16x32_bf16 v[52:55], v[148:151], v[116:119], v[52:55]
  ds_read_b64_tr_b16 v[130:131], v2 offset:51200
  s_waitcnt lgkmcnt(8)
  v_mfma_f32_16x16x32_bf16 v[40:43], v[144:147], v[120:123], v[40:43]
  ds_read_b128 v[100:103], v1 offset:16640
  v_mfma_f32_16x16x32_bf16 v[56:59], v[148:151], v[120:123], v[56:59]
  ds_read_b64_tr_b16 v[132:133], v3 offset:49152
  s_waitcnt lgkmcnt(8)
  v_mfma_f32_16x16x32_bf16 v[64:67], v[152:155], v[112:115], v[64:67]
  ds_read_b64_tr_b16 v[134:135], v3 offset:51200
  v_mfma_f32_16x16x32_bf16 v[68:71], v[152:155], v[116:119], v[68:71]
  ds_read_b128 v[104:107], v1 offset:20480
  v_mfma_f32_16x16x32_bf16 v[72:75], v[152:155], v[120:123], v[72:75]
  ds_read_b64_tr_b16 v[136:137], v4 offset:49152
  s_waitcnt lgkmcnt(10)
  v_mfma_f32_16x16x32_bf16 v[44:47], v[144:147], v[124:127], v[44:47]
  ds_read_b64_tr_b16 v[138:139], v4 offset:51200
  v_mfma_f32_16x16x32_bf16 v[60:63], v[148:151], v[124:127], v[60:63]
  ds_read_b128 v[108:111], v1 offset:20736
  v_mfma_f32_16x16x32_bf16 v[76:79], v[152:155], v[124:127], v[76:79]
  ds_read_b64_tr_b16 v[140:141], v5 offset:49152
  s_waitcnt lgkmcnt(11)
  v_mfma_f32_16x16x32_bf16 v[80:83], v[156:159], v[112:115], v[80:83]
  ds_read_b64_tr_b16 v[142:143], v5 offset:51200
  v_mfma_f32_16x16x32_bf16 v[84:87], v[156:159], v[116:119], v[84:87]
  v_mfma_f32_16x16x32_bf16 v[88:91], v[156:159], v[120:123], v[88:91]
  v_mfma_f32_16x16x32_bf16 v[92:95], v[156:159], v[124:127], v[92:95]
  s_waitcnt lgkmcnt(9)
  v_mfma_f32_16x16x32_bf16 v[32:35], v[128:131], v[96:99], v[32:35]
  s_waitcnt lgkmcnt(8)
  v_mfma_f32_16x16x32_bf16 v[36:39], v[128:131], v[100:103], v[36:39]
  ds_read_b128 v[112:115], v1 offset:18432
  s_waitcnt lgkmcnt(7)
  v_mfma_f32_16x16x32_bf16 v[48:51], v[132:135], v[96:99], v[48:51]
  ds_read_b64_tr_b16 v[144:145], v2 offset:57344
  v_mfma_f32_16x16x32_bf16 v[52:55], v[132:135], v[100:103], v[52:55]
  ds_read_b64_tr_b16 v[146:147], v2 offset:59392
  s_waitcnt lgkmcnt(8)
  v_mfma_f32_16x16x32_bf16 v[40:43], v[128:131], v[104:107], v[40:43]
  ds_read_b128 v[116:119], v1 offset:18688
  v_mfma_f32_16x16x32_bf16 v[56:59], v[132:135], v[104:107], v[56:59]
  ds_read_b64_tr_b16 v[148:149], v3 offset:57344
  s_waitcnt lgkmcnt(8)
  v_mfma_f32_16x16x32_bf16 v[64:67], v[136:139], v[96:99], v[64:67]
  ds_read_b64_tr_b16 v[150:151], v3 offset:59392
  v_mfma_f32_16x16x32_bf16 v[68:71], v[136:139], v[100:103], v[68:71]
  ds_read_b128 v[120:123], v1 offset:22528
  v_mfma_f32_16x16x32_bf16 v[72:75], v[136:139], v[104:107], v[72:75]
  ds_read_b64_tr_b16 v[152:153], v4 offset:57344
  s_waitcnt lgkmcnt(10)
  v_mfma_f32_16x16x32_bf16 v[44:47], v[128:131], v[108:111], v[44:47]
  ds_read_b64_tr_b16 v[154:155], v4 offset:59392
  v_mfma_f32_16x16x32_bf16 v[60:63], v[132:135], v[108:111], v[60:63]
  ds_read_b128 v[124:127], v1 offset:22784
  v_mfma_f32_16x16x32_bf16 v[76:79], v[136:139], v[108:111], v[76:79]
  ds_read_b64_tr_b16 v[156:157], v5 offset:57344
  s_waitcnt lgkmcnt(11)
  v_mfma_f32_16x16x32_bf16 v[80:83], v[140:143], v[96:99], v[80:83]
  ds_read_b64_tr_b16 v[158:159], v5 offset:59392
  v_mfma_f32_16x16x32_bf16 v[84:87], v[140:143], v[100:103], v[84:87]
  v_mfma_f32_16x16x32_bf16 v[88:91], v[140:143], v[104:107], v[88:91]
  v_mfma_f32_16x16x32_bf16 v[92:95], v[140:143], v[108:111], v[92:95]
  s_waitcnt lgkmcnt(9)
  v_mfma_f32_16x16x32_bf16 v[32:35], v[144:147], v[112:115], v[32:35]
  s_barrier
  s_waitcnt lgkmcnt(8)
  v_mfma_f32_16x16x32_bf16 v[36:39], v[144:147], v[116:119], v[36:39]
  ds_read_b128 v[96:99], v1 offset:32768
  s_waitcnt lgkmcnt(7)
  v_mfma_f32_16x16x32_bf16 v[48:51], v[148:151], v[112:115], v[48:51]
  ds_read_b64_tr_b16 v[128:129], v6 offset:0
  v_mfma_f32_16x16x32_bf16 v[52:55], v[148:151], v[116:119], v[52:55]
  ds_read_b64_tr_b16 v[130:131], v6 offset:2048
  s_waitcnt lgkmcnt(8)
  v_mfma_f32_16x16x32_bf16 v[40:43], v[144:147], v[120:123], v[40:43]
  ds_read_b128 v[100:103], v1 offset:33024
  v_mfma_f32_16x16x32_bf16 v[56:59], v[148:151], v[120:123], v[56:59]
  ds_read_b64_tr_b16 v[132:133], v7 offset:0
  s_waitcnt lgkmcnt(8)
  v_mfma_f32_16x16x32_bf16 v[64:67], v[152:155], v[112:115], v[64:67]
  ds_read_b64_tr_b16 v[134:135], v7 offset:2048
  v_mfma_f32_16x16x32_bf16 v[68:71], v[152:155], v[116:119], v[68:71]
  ds_read_b128 v[104:107], v1 offset:36864
  v_mfma_f32_16x16x32_bf16 v[72:75], v[152:155], v[120:123], v[72:75]
  ds_read_b64_tr_b16 v[136:137], v8 offset:0
  s_waitcnt lgkmcnt(10)
  v_mfma_f32_16x16x32_bf16 v[44:47], v[144:147], v[124:127], v[44:47]
  ds_read_b64_tr_b16 v[138:139], v8 offset:2048
  v_mfma_f32_16x16x32_bf16 v[60:63], v[148:151], v[124:127], v[60:63]
  ds_read_b128 v[108:111], v1 offset:37120
  v_mfma_f32_16x16x32_bf16 v[76:79], v[152:155], v[124:127], v[76:79]
  ds_read_b64_tr_b16 v[140:141], v9 offset:0
  s_waitcnt lgkmcnt(11)
  v_mfma_f32_16x16x32_bf16 v[80:83], v[156:159], v[112:115], v[80:83]
  ds_read_b64_tr_b16 v[142:143], v9 offset:2048
  v_mfma_f32_16x16x32_bf16 v[84:87], v[156:159], v[116:119], v[84:87]
  v_mfma_f32_16x16x32_bf16 v[88:91], v[156:159], v[120:123], v[88:91]
  v_mfma_f32_16x16x32_bf16 v[92:95], v[156:159], v[124:127], v[92:95]
  s_waitcnt lgkmcnt(9)
  v_mfma_f32_16x16x32_bf16 v[32:35], v[128:131], v[96:99], v[32:35]
  s_waitcnt lgkmcnt(8)
  v_mfma_f32_16x16x32_bf16 v[36:39], v[128:131], v[100:103], v[36:39]
  ds_read_b128 v[112:115], v1 offset:34816
  s_waitcnt lgkmcnt(7)
  v_mfma_f32_16x16x32_bf16 v[48:51], v[132:135], v[96:99], v[48:51]
  ds_read_b64_tr_b16 v[144:145], v6 offset:8192
  v_mfma_f32_16x16x32_bf16 v[52:55], v[132:135], v[100:103], v[52:55]
  ds_read_b64_tr_b16 v[146:147], v6 offset:10240
  s_waitcnt lgkmcnt(8)
  v_mfma_f32_16x16x32_bf16 v[40:43], v[128:131], v[104:107], v[40:43]
  ds_read_b128 v[116:119], v1 offset:35072
  v_mfma_f32_16x16x32_bf16 v[56:59], v[132:135], v[104:107], v[56:59]
  ds_read_b64_tr_b16 v[148:149], v7 offset:8192
  s_waitcnt lgkmcnt(8)
  v_mfma_f32_16x16x32_bf16 v[64:67], v[136:139], v[96:99], v[64:67]
  ds_read_b64_tr_b16 v[150:151], v7 offset:10240
  v_mfma_f32_16x16x32_bf16 v[68:71], v[136:139], v[100:103], v[68:71]
  ds_read_b128 v[120:123], v1 offset:38912
  v_mfma_f32_16x16x32_bf16 v[72:75], v[136:139], v[104:107], v[72:75]
  ds_read_b64_tr_b16 v[152:153], v8 offset:8192
  s_waitcnt lgkmcnt(10)
  v_mfma_f32_16x16x32_bf16 v[44:47], v[128:131], v[108:111], v[44:47]
  ds_read_b64_tr_b16 v[154:155], v8 offset:10240
  v_mfma_f32_16x16x32_bf16 v[60:63], v[132:135], v[108:111], v[60:63]
  ds_read_b128 v[124:127], v1 offset:39168
  v_mfma_f32_16x16x32_bf16 v[76:79], v[136:139], v[108:111], v[76:79]
  ds_read_b64_tr_b16 v[156:157], v9 offset:8192
  s_waitcnt lgkmcnt(11)
  v_mfma_f32_16x16x32_bf16 v[80:83], v[140:143], v[96:99], v[80:83]
  ds_read_b64_tr_b16 v[158:159], v9 offset:10240
  v_mfma_f32_16x16x32_bf16 v[84:87], v[140:143], v[100:103], v[84:87]
  v_mfma_f32_16x16x32_bf16 v[88:91], v[140:143], v[104:107], v[88:91]
  v_mfma_f32_16x16x32_bf16 v[92:95], v[140:143], v[108:111], v[92:95]
  s_waitcnt lgkmcnt(9)
  v_mfma_f32_16x16x32_bf16 v[32:35], v[144:147], v[112:115], v[32:35]
  s_barrier
  s_waitcnt lgkmcnt(8)
  v_mfma_f32_16x16x32_bf16 v[36:39], v[144:147], v[116:119], v[36:39]
  ds_read_b128 v[96:99], v1 offset:49152
  s_waitcnt lgkmcnt(7)
  v_mfma_f32_16x16x32_bf16 v[48:51], v[148:151], v[112:115], v[48:51]
  ds_read_b64_tr_b16 v[128:129], v6 offset:16384
  v_mfma_f32_16x16x32_bf16 v[52:55], v[148:151], v[116:119], v[52:55]
  ds_read_b64_tr_b16 v[130:131], v6 offset:18432
  s_waitcnt lgkmcnt(8)
  v_mfma_f32_16x16x32_bf16 v[40:43], v[144:147], v[120:123], v[40:43]
  ds_read_b128 v[100:103], v1 offset:49408
  v_mfma_f32_16x16x32_bf16 v[56:59], v[148:151], v[120:123], v[56:59]
  ds_read_b64_tr_b16 v[132:133], v7 offset:16384
  s_waitcnt lgkmcnt(8)
  v_mfma_f32_16x16x32_bf16 v[64:67], v[152:155], v[112:115], v[64:67]
  ds_read_b64_tr_b16 v[134:135], v7 offset:18432
  v_mfma_f32_16x16x32_bf16 v[68:71], v[152:155], v[116:119], v[68:71]
  ds_read_b128 v[104:107], v1 offset:53248
  v_mfma_f32_16x16x32_bf16 v[72:75], v[152:155], v[120:123], v[72:75]
  ds_read_b64_tr_b16 v[136:137], v8 offset:16384
  s_waitcnt lgkmcnt(10)
  v_mfma_f32_16x16x32_bf16 v[44:47], v[144:147], v[124:127], v[44:47]
  ds_read_b64_tr_b16 v[138:139], v8 offset:18432
  v_mfma_f32_16x16x32_bf16 v[60:63], v[148:151], v[124:127], v[60:63]
  ds_read_b128 v[108:111], v1 offset:53504
  v_mfma_f32_16x16x32_bf16 v[76:79], v[152:155], v[124:127], v[76:79]
  ds_read_b64_tr_b16 v[140:141], v9 offset:16384
  s_waitcnt lgkmcnt(11)
  v_mfma_f32_16x16x32_bf16 v[80:83], v[156:159], v[112:115], v[80:83]
  ds_read_b64_tr_b16 v[142:143], v9 offset:18432
  v_mfma_f32_16x16x32_bf16 v[84:87], v[156:159], v[116:119], v[84:87]
  v_mfma_f32_16x16x32_bf16 v[88:91], v[156:159], v[120:123], v[88:91]
  v_mfma_f32_16x16x32_bf16 v[92:95], v[156:159], v[124:127], v[92:95]
  s_waitcnt lgkmcnt(9)
  v_mfma_f32_16x16x32_bf16 v[32:35], v[128:131], v[96:99], v[32:35]
  s_waitcnt lgkmcnt(8)
  v_mfma_f32_16x16x32_bf16 v[36:39], v[128:131], v[100:103], v[36:39]
  ds_read_b128 v[112:115], v1 offset:51200
  s_waitcnt lgkmcnt(7)
  v_mfma_f32_16x16x32_bf16 v[48:51], v[132:135], v[96:99], v[48:51]
  ds_read_b64_tr_b16 v[144:145], v6 offset:24576
  v_mfma_f32_16x16x32_bf16 v[52:55], v[132:135], v[100:103], v[52:55]
  ds_read_b64_tr_b16 v[146:147], v6 offset:26624
  s_waitcnt lgkmcnt(8)
  v_mfma_f32_16x16x32_bf16 v[40:43], v[128:131], v[104:107], v[40:43]
  ds_read_b128 v[116:119], v1 offset:51456
  v_mfma_f32_16x16x32_bf16 v[56:59], v[132:135], v[104:107], v[56:59]
  ds_read_b64_tr_b16 v[148:149], v7 offset:24576
  s_waitcnt lgkmcnt(8)
  v_mfma_f32_16x16x32_bf16 v[64:67], v[136:139], v[96:99], v[64:67]
  ds_read_b64_tr_b16 v[150:151], v7 offset:26624
  v_mfma_f32_16x16x32_bf16 v[68:71], v[136:139], v[100:103], v[68:71]
  ds_read_b128 v[120:123], v1 offset:55296
  v_mfma_f32_16x16x32_bf16 v[72:75], v[136:139], v[104:107], v[72:75]
  ds_read_b64_tr_b16 v[152:153], v8 offset:24576
  s_waitcnt lgkmcnt(10)
  v_mfma_f32_16x16x32_bf16 v[44:47], v[128:131], v[108:111], v[44:47]
  ds_read_b64_tr_b16 v[154:155], v8 offset:26624
  v_mfma_f32_16x16x32_bf16 v[60:63], v[132:135], v[108:111], v[60:63]
  ds_read_b128 v[124:127], v1 offset:55552
  v_mfma_f32_16x16x32_bf16 v[76:79], v[136:139], v[108:111], v[76:79]
  ds_read_b64_tr_b16 v[156:157], v9 offset:24576
  s_waitcnt lgkmcnt(11)
  v_mfma_f32_16x16x32_bf16 v[80:83], v[140:143], v[96:99], v[80:83]
  ds_read_b64_tr_b16 v[158:159], v9 offset:26624
  v_mfma_f32_16x16x32_bf16 v[84:87], v[140:143], v[100:103], v[84:87]
  v_mfma_f32_16x16x32_bf16 v[88:91], v[140:143], v[104:107], v[88:91]
  v_mfma_f32_16x16x32_bf16 v[92:95], v[140:143], v[108:111], v[92:95]
  s_waitcnt lgkmcnt(9)
  v_mfma_f32_16x16x32_bf16 v[32:35], v[144:147], v[112:115], v[32:35]
  s_barrier
  s_waitcnt lgkmcnt(8)
  v_mfma_f32_16x16x32_bf16 v[36:39], v[144:147], v[116:119], v[36:39]
  ds_read_b128 v[96:99], v1 offset:0
  s_waitcnt lgkmcnt(7)
  v_mfma_f32_16x16x32_bf16 v[48:51], v[148:151], v[112:115], v[48:51]
  ds_read_b64_tr_b16 v[128:129], v2 offset:0
  v_mfma_f32_16x16x32_bf16 v[52:55], v[148:151], v[116:119], v[52:55]
  ds_read_b64_tr_b16 v[130:131], v2 offset:2048
  s_waitcnt lgkmcnt(8)
  v_mfma_f32_16x16x32_bf16 v[40:43], v[144:147], v[120:123], v[40:43]
  ds_read_b128 v[100:103], v1 offset:256
  v_mfma_f32_16x16x32_bf16 v[56:59], v[148:151], v[120:123], v[56:59]
  ds_read_b64_tr_b16 v[132:133], v3 offset:0
  s_waitcnt lgkmcnt(8)
  v_mfma_f32_16x16x32_bf16 v[64:67], v[152:155], v[112:115], v[64:67]
  ds_read_b64_tr_b16 v[134:135], v3 offset:2048
  v_mfma_f32_16x16x32_bf16 v[68:71], v[152:155], v[116:119], v[68:71]
  ds_read_b128 v[104:107], v1 offset:4096
  v_mfma_f32_16x16x32_bf16 v[72:75], v[152:155], v[120:123], v[72:75]
  ds_read_b64_tr_b16 v[136:137], v4 offset:0
  s_waitcnt lgkmcnt(10)
  v_mfma_f32_16x16x32_bf16 v[44:47], v[144:147], v[124:127], v[44:47]
  ds_read_b64_tr_b16 v[138:139], v4 offset:2048
  v_mfma_f32_16x16x32_bf16 v[60:63], v[148:151], v[124:127], v[60:63]
  ds_read_b128 v[108:111], v1 offset:4352
  v_mfma_f32_16x16x32_bf16 v[76:79], v[152:155], v[124:127], v[76:79]
  ds_read_b64_tr_b16 v[140:141], v5 offset:0
  s_waitcnt lgkmcnt(11)
  v_mfma_f32_16x16x32_bf16 v[80:83], v[156:159], v[112:115], v[80:83]
  ds_read_b64_tr_b16 v[142:143], v5 offset:2048
  v_mfma_f32_16x16x32_bf16 v[84:87], v[156:159], v[116:119], v[84:87]
  v_mfma_f32_16x16x32_bf16 v[88:91], v[156:159], v[120:123], v[88:91]
  v_mfma_f32_16x16x32_bf16 v[92:95], v[156:159], v[124:127], v[92:95]
  s_waitcnt lgkmcnt(9)
  v_mfma_f32_16x16x32_bf16 v[32:35], v[128:131], v[96:99], v[32:35]
  s_waitcnt lgkmcnt(8)
  v_mfma_f32_16x16x32_bf16 v[36:39], v[128:131], v[100:103], v[36:39]
  ds_read_b128 v[112:115], v1 offset:2048
  s_waitcnt lgkmcnt(7)
  v_mfma_f32_16x16x32_bf16 v[48:51], v[132:135], v[96:99], v[48:51]
  ds_read_b64_tr_b16 v[144:145], v2 offset:8192
  v_mfma_f32_16x16x32_bf16 v[52:55], v[132:135], v[100:103], v[52:55]
  ds_read_b64_tr_b16 v[146:147], v2 offset:10240
  s_waitcnt lgkmcnt(8)
  v_mfma_f32_16x16x32_bf16 v[40:43], v[128:131], v[104:107], v[40:43]
  ds_read_b128 v[116:119], v1 offset:2304
  v_mfma_f32_16x16x32_bf16 v[56:59], v[132:135], v[104:107], v[56:59]
  ds_read_b64_tr_b16 v[148:149], v3 offset:8192
  s_waitcnt lgkmcnt(8)
  v_mfma_f32_16x16x32_bf16 v[64:67], v[136:139], v[96:99], v[64:67]
  ds_read_b64_tr_b16 v[150:151], v3 offset:10240
  v_mfma_f32_16x16x32_bf16 v[68:71], v[136:139], v[100:103], v[68:71]
  ds_read_b128 v[120:123], v1 offset:6144
  v_mfma_f32_16x16x32_bf16 v[72:75], v[136:139], v[104:107], v[72:75]
  ds_read_b64_tr_b16 v[152:153], v4 offset:8192
  s_waitcnt lgkmcnt(10)
  v_mfma_f32_16x16x32_bf16 v[44:47], v[128:131], v[108:111], v[44:47]
  ds_read_b64_tr_b16 v[154:155], v4 offset:10240
  v_mfma_f32_16x16x32_bf16 v[60:63], v[132:135], v[108:111], v[60:63]
  ds_read_b128 v[124:127], v1 offset:6400
  v_mfma_f32_16x16x32_bf16 v[76:79], v[136:139], v[108:111], v[76:79]
  ds_read_b64_tr_b16 v[156:157], v5 offset:8192
  s_waitcnt lgkmcnt(11)
  v_mfma_f32_16x16x32_bf16 v[80:83], v[140:143], v[96:99], v[80:83]
  ds_read_b64_tr_b16 v[158:159], v5 offset:10240
  v_mfma_f32_16x16x32_bf16 v[84:87], v[140:143], v[100:103], v[84:87]
  v_mfma_f32_16x16x32_bf16 v[88:91], v[140:143], v[104:107], v[88:91]
  v_mfma_f32_16x16x32_bf16 v[92:95], v[140:143], v[108:111], v[92:95]
  s_waitcnt lgkmcnt(9)
  v_mfma_f32_16x16x32_bf16 v[32:35], v[144:147], v[112:115], v[32:35]
  s_barrier
  s_waitcnt lgkmcnt(8)
  v_mfma_f32_16x16x32_bf16 v[36:39], v[144:147], v[116:119], v[36:39]
  ds_read_b128 v[96:99], v1 offset:16384
  s_waitcnt lgkmcnt(7)
  v_mfma_f32_16x16x32_bf16 v[48:51], v[148:151], v[112:115], v[48:51]
  ds_read_b64_tr_b16 v[128:129], v2 offset:16384
  v_mfma_f32_16x16x32_bf16 v[52:55], v[148:151], v[116:119], v[52:55]
  ds_read_b64_tr_b16 v[130:131], v2 offset:18432
  s_waitcnt lgkmcnt(8)
  v_mfma_f32_16x16x32_bf16 v[40:43], v[144:147], v[120:123], v[40:43]
  ds_read_b128 v[100:103], v1 offset:16640
  v_mfma_f32_16x16x32_bf16 v[56:59], v[148:151], v[120:123], v[56:59]
  ds_read_b64_tr_b16 v[132:133], v3 offset:16384
  s_waitcnt lgkmcnt(8)
  v_mfma_f32_16x16x32_bf16 v[64:67], v[152:155], v[112:115], v[64:67]
  ds_read_b64_tr_b16 v[134:135], v3 offset:18432
  v_mfma_f32_16x16x32_bf16 v[68:71], v[152:155], v[116:119], v[68:71]
  ds_read_b128 v[104:107], v1 offset:20480
  v_mfma_f32_16x16x32_bf16 v[72:75], v[152:155], v[120:123], v[72:75]
  ds_read_b64_tr_b16 v[136:137], v4 offset:16384
  s_waitcnt lgkmcnt(10)
  v_mfma_f32_16x16x32_bf16 v[44:47], v[144:147], v[124:127], v[44:47]
  ds_read_b64_tr_b16 v[138:139], v4 offset:18432
  v_mfma_f32_16x16x32_bf16 v[60:63], v[148:151], v[124:127], v[60:63]
  ds_read_b128 v[108:111], v1 offset:20736
  v_mfma_f32_16x16x32_bf16 v[76:79], v[152:155], v[124:127], v[76:79]
  ds_read_b64_tr_b16 v[140:141], v5 offset:16384
  s_waitcnt lgkmcnt(11)
  v_mfma_f32_16x16x32_bf16 v[80:83], v[156:159], v[112:115], v[80:83]
  ds_read_b64_tr_b16 v[142:143], v5 offset:18432
  v_mfma_f32_16x16x32_bf16 v[84:87], v[156:159], v[116:119], v[84:87]
  v_mfma_f32_16x16x32_bf16 v[88:91], v[156:159], v[120:123], v[88:91]
  v_mfma_f32_16x16x32_bf16 v[92:95], v[156:159], v[124:127], v[92:95]
  s_waitcnt lgkmcnt(9)
  v_mfma_f32_16x16x32_bf16 v[32:35], v[128:131], v[96:99], v[32:35]
  s_waitcnt lgkmcnt(8)
  v_mfma_f32_16x16x32_bf16 v[36:39], v[128:131], v[100:103], v[36:39]
  ds_read_b128 v[112:115], v1 offset:18432
  s_waitcnt lgkmcnt(7)
  v_mfma_f32_16x16x32_bf16 v[48:51], v[132:135], v[96:99], v[48:51]
  ds_read_b64_tr_b16 v[144:145], v2 offset:24576
  v_mfma_f32_16x16x32_bf16 v[52:55], v[132:135], v[100:103], v[52:55]
  ds_read_b64_tr_b16 v[146:147], v2 offset:26624
  s_waitcnt lgkmcnt(8)
  v_mfma_f32_16x16x32_bf16 v[40:43], v[128:131], v[104:107], v[40:43]
  ds_read_b128 v[116:119], v1 offset:18688
  v_mfma_f32_16x16x32_bf16 v[56:59], v[132:135], v[104:107], v[56:59]
  ds_read_b64_tr_b16 v[148:149], v3 offset:24576
  s_waitcnt lgkmcnt(8)
  v_mfma_f32_16x16x32_bf16 v[64:67], v[136:139], v[96:99], v[64:67]
  ds_read_b64_tr_b16 v[150:151], v3 offset:26624
  v_mfma_f32_16x16x32_bf16 v[68:71], v[136:139], v[100:103], v[68:71]
  ds_read_b128 v[120:123], v1 offset:22528
  v_mfma_f32_16x16x32_bf16 v[72:75], v[136:139], v[104:107], v[72:75]
  ds_read_b64_tr_b16 v[152:153], v4 offset:24576
  s_waitcnt lgkmcnt(10)
  v_mfma_f32_16x16x32_bf16 v[44:47], v[128:131], v[108:111], v[44:47]
  ds_read_b64_tr_b16 v[154:155], v4 offset:26624
  v_mfma_f32_16x16x32_bf16 v[60:63], v[132:135], v[108:111], v[60:63]
  ds_read_b128 v[124:127], v1 offset:22784
  v_mfma_f32_16x16x32_bf16 v[76:79], v[136:139], v[108:111], v[76:79]
  ds_read_b64_tr_b16 v[156:157], v5 offset:24576
  s_waitcnt lgkmcnt(11)
  v_mfma_f32_16x16x32_bf16 v[80:83], v[140:143], v[96:99], v[80:83]
  ds_read_b64_tr_b16 v[158:159], v5 offset:26624
  v_mfma_f32_16x16x32_bf16 v[84:87], v[140:143], v[100:103], v[84:87]
  v_mfma_f32_16x16x32_bf16 v[88:91], v[140:143], v[104:107], v[88:91]
  v_mfma_f32_16x16x32_bf16 v[92:95], v[140:143], v[108:111], v[92:95]
  s_waitcnt lgkmcnt(9)
  v_mfma_f32_16x16x32_bf16 v[32:35], v[144:147], v[112:115], v[32:35]
  s_barrier
  s_waitcnt lgkmcnt(8)
  v_mfma_f32_16x16x32_bf16 v[36:39], v[144:147], v[116:119], v[36:39]
  ds_read_b128 v[96:99], v1 offset:32768
  s_waitcnt lgkmcnt(7)
  v_mfma_f32_16x16x32_bf16 v[48:51], v[148:151], v[112:115], v[48:51]
  ds_read_b64_tr_b16 v[128:129], v2 offset:32768
  v_mfma_f32_16x16x32_bf16 v[52:55], v[148:151], v[116:119], v[52:55]
  ds_read_b64_tr_b16 v[130:131], v2 offset:34816
  s_waitcnt lgkmcnt(8)
  v_mfma_f32_16x16x32_bf16 v[40:43], v[144:147], v[120:123], v[40:43]
  ds_read_b128 v[100:103], v1 offset:33024
  v_mfma_f32_16x16x32_bf16 v[56:59], v[148:151], v[120:123], v[56:59]
  ds_read_b64_tr_b16 v[132:133], v3 offset:32768
  s_waitcnt lgkmcnt(8)
  v_mfma_f32_16x16x32_bf16 v[64:67], v[152:155], v[112:115], v[64:67]
  ds_read_b64_tr_b16 v[134:135], v3 offset:34816
  v_mfma_f32_16x16x32_bf16 v[68:71], v[152:155], v[116:119], v[68:71]
  ds_read_b128 v[104:107], v1 offset:36864
  v_mfma_f32_16x16x32_bf16 v[72:75], v[152:155], v[120:123], v[72:75]
  ds_read_b64_tr_b16 v[136:137], v4 offset:32768
  s_waitcnt lgkmcnt(10)
  v_mfma_f32_16x16x32_bf16 v[44:47], v[144:147], v[124:127], v[44:47]
  ds_read_b64_tr_b16 v[138:139], v4 offset:34816
  v_mfma_f32_16x16x32_bf16 v[60:63], v[148:151], v[124:127], v[60:63]
  ds_read_b128 v[108:111], v1 offset:37120
  v_mfma_f32_16x16x32_bf16 v[76:79], v[152:155], v[124:127], v[76:79]
  ds_read_b64_tr_b16 v[140:141], v5 offset:32768
  s_waitcnt lgkmcnt(11)
  v_mfma_f32_16x16x32_bf16 v[80:83], v[156:159], v[112:115], v[80:83]
  ds_read_b64_tr_b16 v[142:143], v5 offset:34816
  v_mfma_f32_16x16x32_bf16 v[84:87], v[156:159], v[116:119], v[84:87]
  v_mfma_f32_16x16x32_bf16 v[88:91], v[156:159], v[120:123], v[88:91]
  v_mfma_f32_16x16x32_bf16 v[92:95], v[156:159], v[124:127], v[92:95]
  s_waitcnt lgkmcnt(9)
  v_mfma_f32_16x16x32_bf16 v[32:35], v[128:131], v[96:99], v[32:35]
  s_waitcnt lgkmcnt(8)
  v_mfma_f32_16x16x32_bf16 v[36:39], v[128:131], v[100:103], v[36:39]
  ds_read_b128 v[112:115], v1 offset:34816
  s_waitcnt lgkmcnt(7)
  v_mfma_f32_16x16x32_bf16 v[48:51], v[132:135], v[96:99], v[48:51]
  ds_read_b64_tr_b16 v[144:145], v2 offset:40960
  v_mfma_f32_16x16x32_bf16 v[52:55], v[132:135], v[100:103], v[52:55]
  ds_read_b64_tr_b16 v[146:147], v2 offset:43008
  s_waitcnt lgkmcnt(8)
  v_mfma_f32_16x16x32_bf16 v[40:43], v[128:131], v[104:107], v[40:43]
  ds_read_b128 v[116:119], v1 offset:35072
  v_mfma_f32_16x16x32_bf16 v[56:59], v[132:135], v[104:107], v[56:59]
  ds_read_b64_tr_b16 v[148:149], v3 offset:40960
  s_waitcnt lgkmcnt(8)
  v_mfma_f32_16x16x32_bf16 v[64:67], v[136:139], v[96:99], v[64:67]
  ds_read_b64_tr_b16 v[150:151], v3 offset:43008
  v_mfma_f32_16x16x32_bf16 v[68:71], v[136:139], v[100:103], v[68:71]
  ds_read_b128 v[120:123], v1 offset:38912
  v_mfma_f32_16x16x32_bf16 v[72:75], v[136:139], v[104:107], v[72:75]
  ds_read_b64_tr_b16 v[152:153], v4 offset:40960
  s_waitcnt lgkmcnt(10)
  v_mfma_f32_16x16x32_bf16 v[44:47], v[128:131], v[108:111], v[44:47]
  ds_read_b64_tr_b16 v[154:155], v4 offset:43008
  v_mfma_f32_16x16x32_bf16 v[60:63], v[132:135], v[108:111], v[60:63]
  ds_read_b128 v[124:127], v1 offset:39168
  v_mfma_f32_16x16x32_bf16 v[76:79], v[136:139], v[108:111], v[76:79]
  ds_read_b64_tr_b16 v[156:157], v5 offset:40960
  s_waitcnt lgkmcnt(11)
  v_mfma_f32_16x16x32_bf16 v[80:83], v[140:143], v[96:99], v[80:83]
  ds_read_b64_tr_b16 v[158:159], v5 offset:43008
  v_mfma_f32_16x16x32_bf16 v[84:87], v[140:143], v[100:103], v[84:87]
  v_mfma_f32_16x16x32_bf16 v[88:91], v[140:143], v[104:107], v[88:91]
  v_mfma_f32_16x16x32_bf16 v[92:95], v[140:143], v[108:111], v[92:95]
  s_waitcnt lgkmcnt(9)
  v_mfma_f32_16x16x32_bf16 v[32:35], v[144:147], v[112:115], v[32:35]
  s_barrier
  s_waitcnt lgkmcnt(8)
  v_mfma_f32_16x16x32_bf16 v[36:39], v[144:147], v[116:119], v[36:39]
  ds_read_b128 v[96:99], v1 offset:49152
  s_waitcnt lgkmcnt(7)
  v_mfma_f32_16x16x32_bf16 v[48:51], v[148:151], v[112:115], v[48:51]
  ds_read_b64_tr_b16 v[128:129], v2 offset:49152
  v_mfma_f32_16x16x32_bf16 v[52:55], v[148:151], v[116:119], v[52:55]
  ds_read_b64_tr_b16 v[130:131], v2 offset:51200
  s_waitcnt lgkmcnt(8)
  v_mfma_f32_16x16x32_bf16 v[40:43], v[144:147], v[120:123], v[40:43]
  ds_read_b128 v[100:103], v1 offset:49408
  v_mfma_f32_16x16x32_bf16 v[56:59], v[148:151], v[120:123], v[56:59]
  ds_read_b64_tr_b16 v[132:133], v3 offset:49152
  s_waitcnt lgkmcnt(8)
  v_mfma_f32_16x16x32_bf16 v[64:67], v[152:155], v[112:115], v[64:67]
  ds_read_b64_tr_b16 v[134:135], v3 offset:51200
  v_mfma_f32_16x16x32_bf16 v[68:71], v[152:155], v[116:119], v[68:71]
  ds_read_b128 v[104:107], v1 offset:53248
  v_mfma_f32_16x16x32_bf16 v[72:75], v[152:155], v[120:123], v[72:75]
  ds_read_b64_tr_b16 v[136:137], v4 offset:49152
  s_waitcnt lgkmcnt(10)
  v_mfma_f32_16x16x32_bf16 v[44:47], v[144:147], v[124:127], v[44:47]
  ds_read_b64_tr_b16 v[138:139], v4 offset:51200
  v_mfma_f32_16x16x32_bf16 v[60:63], v[148:151], v[124:127], v[60:63]
  ds_read_b128 v[108:111], v1 offset:53504
  v_mfma_f32_16x16x32_bf16 v[76:79], v[152:155], v[124:127], v[76:79]
  ds_read_b64_tr_b16 v[140:141], v5 offset:49152
  s_waitcnt lgkmcnt(11)
  v_mfma_f32_16x16x32_bf16 v[80:83], v[156:159], v[112:115], v[80:83]
  ds_read_b64_tr_b16 v[142:143], v5 offset:51200
  v_mfma_f32_16x16x32_bf16 v[84:87], v[156:159], v[116:119], v[84:87]
  v_mfma_f32_16x16x32_bf16 v[88:91], v[156:159], v[120:123], v[88:91]
  v_mfma_f32_16x16x32_bf16 v[92:95], v[156:159], v[124:127], v[92:95]
  s_waitcnt lgkmcnt(9)
  v_mfma_f32_16x16x32_bf16 v[32:35], v[128:131], v[96:99], v[32:35]
  s_waitcnt lgkmcnt(8)
  v_mfma_f32_16x16x32_bf16 v[36:39], v[128:131], v[100:103], v[36:39]
  ds_read_b128 v[112:115], v1 offset:51200
  s_waitcnt lgkmcnt(7)
  v_mfma_f32_16x16x32_bf16 v[48:51], v[132:135], v[96:99], v[48:51]
  ds_read_b64_tr_b16 v[144:145], v2 offset:57344
  v_mfma_f32_16x16x32_bf16 v[52:55], v[132:135], v[100:103], v[52:55]
  ds_read_b64_tr_b16 v[146:147], v2 offset:59392
  s_waitcnt lgkmcnt(8)
  v_mfma_f32_16x16x32_bf16 v[40:43], v[128:131], v[104:107], v[40:43]
  ds_read_b128 v[116:119], v1 offset:51456
  v_mfma_f32_16x16x32_bf16 v[56:59], v[132:135], v[104:107], v[56:59]
  ds_read_b64_tr_b16 v[148:149], v3 offset:57344
  s_waitcnt lgkmcnt(8)
  v_mfma_f32_16x16x32_bf16 v[64:67], v[136:139], v[96:99], v[64:67]
  ds_read_b64_tr_b16 v[150:151], v3 offset:59392
  v_mfma_f32_16x16x32_bf16 v[68:71], v[136:139], v[100:103], v[68:71]
  ds_read_b128 v[120:123], v1 offset:55296
  v_mfma_f32_16x16x32_bf16 v[72:75], v[136:139], v[104:107], v[72:75]
  ds_read_b64_tr_b16 v[152:153], v4 offset:57344
  s_waitcnt lgkmcnt(10)
  v_mfma_f32_16x16x32_bf16 v[44:47], v[128:131], v[108:111], v[44:47]
  ds_read_b64_tr_b16 v[154:155], v4 offset:59392
  v_mfma_f32_16x16x32_bf16 v[60:63], v[132:135], v[108:111], v[60:63]
  ds_read_b128 v[124:127], v1 offset:55552
  v_mfma_f32_16x16x32_bf16 v[76:79], v[136:139], v[108:111], v[76:79]
  ds_read_b64_tr_b16 v[156:157], v5 offset:57344
  s_waitcnt lgkmcnt(11)
  v_mfma_f32_16x16x32_bf16 v[80:83], v[140:143], v[96:99], v[80:83]
  ds_read_b64_tr_b16 v[158:159], v5 offset:59392
  v_mfma_f32_16x16x32_bf16 v[84:87], v[140:143], v[100:103], v[84:87]
  v_mfma_f32_16x16x32_bf16 v[88:91], v[140:143], v[104:107], v[88:91]
  v_mfma_f32_16x16x32_bf16 v[92:95], v[140:143], v[108:111], v[92:95]
  s_waitcnt lgkmcnt(9)
  v_mfma_f32_16x16x32_bf16 v[32:35], v[144:147], v[112:115], v[32:35]
  s_waitcnt lgkmcnt(8)
  v_mfma_f32_16x16x32_bf16 v[36:39], v[144:147], v[116:119], v[36:39]
  s_waitcnt lgkmcnt(6)
  v_mfma_f32_16x16x32_bf16 v[48:51], v[148:151], v[112:115], v[48:51]
  v_mfma_f32_16x16x32_bf16 v[52:55], v[148:151], v[116:119], v[52:55]
  s_waitcnt lgkmcnt(5)
  v_mfma_f32_16x16x32_bf16 v[40:43], v[144:147], v[120:123], v[40:43]
  v_mfma_f32_16x16x32_bf16 v[56:59], v[148:151], v[120:123], v[56:59]
  s_waitcnt lgkmcnt(3)
  v_mfma_f32_16x16x32_bf16 v[64:67], v[152:155], v[112:115], v[64:67]
  v_mfma_f32_16x16x32_bf16 v[68:71], v[152:155], v[116:119], v[68:71]
  v_mfma_f32_16x16x32_bf16 v[72:75], v[152:155], v[120:123], v[72:75]
  s_waitcnt lgkmcnt(2)
  v_mfma_f32_16x16x32_bf16 v[44:47], v[144:147], v[124:127], v[44:47]
  v_mfma_f32_16x16x32_bf16 v[60:63], v[148:151], v[124:127], v[60:63]
  v_mfma_f32_16x16x32_bf16 v[76:79], v[152:155], v[124:127], v[76:79]
  s_waitcnt lgkmcnt(0)
  v_mfma_f32_16x16x32_bf16 v[80:83], v[156:159], v[112:115], v[80:83]
  v_mfma_f32_16x16x32_bf16 v[84:87], v[156:159], v[116:119], v[84:87]
  v_mfma_f32_16x16x32_bf16 v[88:91], v[156:159], v[120:123], v[88:91]
  v_mfma_f32_16x16x32_bf16 v[92:95], v[156:159], v[124:127], v[92:95]
  v_and_b32 v10, 15, v0
  v_lshrrev_b32 v11, 4, v0
  v_lshlrev_b32 v13, 7, v10
  s_lshl_b32 s8, s3, 13
  v_add_u32 v13, s8, v13
  v_and_b32 v12, 1, v11
  v_lshl_add_u32 v13, v12, 3, v13
  v_lshrrev_b32 v12, 1, v11
  v_xor_b32 v12, v12, v10
  v_and_b32 v12, 7, v12
  v_lshlrev_b32 v14, 4, v0
  v_add_u32 v14, s8, v14
  v_lshrrev_b32 v15, 3, v0
  v_xor_b32 v16, v15, v0
  v_and_b32 v16, 7, v16
  v_and_b32 v14, 0xffffff8f, v14
  v_lshl_add_u32 v14, v16, 4, v14
  s_lshl_b32 s8, s16, 5
  s_lshl_b32 s9, s13, 6
  s_add_u32 s8, s8, s9
  v_add_u32 v15, s8, v15
  v_lshlrev_b32 v15, 12, v15
  v_and_b32 v16, 7, v0
  v_lshl_add_u32 v15, v16, 4, v15
  s_lshl_b32 s8, s4, 11
  s_lshl_b32 s9, s17, 8
  s_add_u32 s8, s8, s9
  s_lshl_b32 s9, s14, 7
  s_add_u32 s8, s8, s9
  v_add_u32 v15, s8, v15
  v_xor_b32 v16, 0, v12
  v_lshl_add_u32 v20, v16, 4, v13
  v_xor_b32 v16, 2, v12
  v_lshl_add_u32 v21, v16, 4, v13
  v_xor_b32 v16, 4, v12
  v_lshl_add_u32 v22, v16, 4, v13
  v_xor_b32 v16, 6, v12
  v_lshl_add_u32 v23, v16, 4, v13
  v_cvt_pk_bf16_f32 v32, v32, v33
  v_cvt_pk_bf16_f32 v33, v34, v35
  ds_write_b64 v20, v[32:33] offset:0
  v_cvt_pk_bf16_f32 v48, v48, v49
  v_cvt_pk_bf16_f32 v49, v50, v51
  ds_write_b64 v21, v[48:49] offset:0
  v_cvt_pk_bf16_f32 v64, v64, v65
  v_cvt_pk_bf16_f32 v65, v66, v67
  ds_write_b64 v22, v[64:65] offset:0
  v_cvt_pk_bf16_f32 v80, v80, v81
  v_cvt_pk_bf16_f32 v81, v82, v83
  ds_write_b64 v23, v[80:81] offset:0
  ds_read_b128 v[96:99], v14 offset:0
  ds_read_b128 v[100:103], v14 offset:1024
  v_cvt_pk_bf16_f32 v36, v36, v37
  v_cvt_pk_bf16_f32 v37, v38, v39
  ds_write_b64 v20, v[36:37] offset:2048
  v_cvt_pk_bf16_f32 v52, v52, v53
  v_cvt_pk_bf16_f32 v53, v54, v55
  ds_write_b64 v21, v[52:53] offset:2048
  v_cvt_pk_bf16_f32 v68, v68, v69
  v_cvt_pk_bf16_f32 v69, v70, v71
  ds_write_b64 v22, v[68:69] offset:2048
  v_cvt_pk_bf16_f32 v84, v84, v85
  v_cvt_pk_bf16_f32 v85, v86, v87
  ds_write_b64 v23, v[84:85] offset:2048
  ds_read_b128 v[104:107], v14 offset:2048
  ds_read_b128 v[108:111], v14 offset:3072
  s_mov_b32 s57, 0
  s_waitcnt lgkmcnt(7)
  buffer_store_dwordx4 v[96:99], v15, s[96:99], s57 offen sc0 sc1
  s_mov_b32 s57, 32768
  s_waitcnt lgkmcnt(6)
  buffer_store_dwordx4 v[100:103], v15, s[96:99], s57 offen sc0 sc1
  v_cvt_pk_bf16_f32 v40, v40, v41
  v_cvt_pk_bf16_f32 v41, v42, v43
  ds_write_b64 v20, v[40:41] offset:4096
  v_cvt_pk_bf16_f32 v56, v56, v57
  v_cvt_pk_bf16_f32 v57, v58, v59
  ds_write_b64 v21, v[56:57] offset:4096
  v_cvt_pk_bf16_f32 v72, v72, v73
  v_cvt_pk_bf16_f32 v73, v74, v75
  ds_write_b64 v22, v[72:73] offset:4096
  v_cvt_pk_bf16_f32 v88, v88, v89
  v_cvt_pk_bf16_f32 v89, v90, v91
  ds_write_b64 v23, v[88:89] offset:4096
  ds_read_b128 v[112:115], v14 offset:4096
  ds_read_b128 v[116:119], v14 offset:5120
  s_mov_b32 s57, 65536
  s_waitcnt lgkmcnt(7)
  buffer_store_dwordx4 v[104:107], v15, s[96:99], s57 offen sc0 sc1
  s_mov_b32 s57, 98304
  s_waitcnt lgkmcnt(6)
  buffer_store_dwordx4 v[108:111], v15, s[96:99], s57 offen sc0 sc1
  v_cvt_pk_bf16_f32 v44, v44, v45
  v_cvt_pk_bf16_f32 v45, v46, v47
  ds_write_b64 v20, v[44:45] offset:6144
  v_cvt_pk_bf16_f32 v60, v60, v61
  v_cvt_pk_bf16_f32 v61, v62, v63
  ds_write_b64 v21, v[60:61] offset:6144
  v_cvt_pk_bf16_f32 v76, v76, v77
  v_cvt_pk_bf16_f32 v77, v78, v79
  ds_write_b64 v22, v[76:77] offset:6144
  v_cvt_pk_bf16_f32 v92, v92, v93
  v_cvt_pk_bf16_f32 v93, v94, v95
  ds_write_b64 v23, v[92:93] offset:6144
  ds_read_b128 v[120:123], v14 offset:6144
  ds_read_b128 v[124:127], v14 offset:7168
  s_mov_b32 s57, 131072
  s_waitcnt lgkmcnt(7)
  buffer_store_dwordx4 v[112:115], v15, s[96:99], s57 offen sc0 sc1
  s_mov_b32 s57, 163840
  s_waitcnt lgkmcnt(6)
  buffer_store_dwordx4 v[116:119], v15, s[96:99], s57 offen sc0 sc1
  s_mov_b32 s57, 196608
  s_waitcnt lgkmcnt(1)
  buffer_store_dwordx4 v[120:123], v15, s[96:99], s57 offen sc0 sc1
  s_mov_b32 s57, 229376
  s_waitcnt lgkmcnt(0)
  buffer_store_dwordx4 v[124:127], v15, s[96:99], s57 offen sc0 sc1
  s_nop 0
  s_endpgm
PJ_LOADER:
  s_lshl_b32 s8, s4, 6
  s_add_u32 s8, s8, s16
  s_add_u32 s8, s8, s12
  s_lshl_b32 s8, s8, 16
  s_add_u32 s8, s8, 0
  v_lshlrev_b32 v1, 4, v0
  v_add_u32 v1, s8, v1
  s_add_u32 s57, s56, 98304
  s_waitcnt vmcnt(0)
  s_mov_b64 exec, 1
  buffer_store_dword v20, v21, s[44:47], 0 offen sc1
  s_mov_b64 exec, -1
  s_barrier
  s_lshr_b32 s8, s7, 4
  s_lshl_b32 s8, s8, 9
  s_add_u32 s8, s8, 26214400
  v_lshlrev_b32 v22, 3, v0
  v_add_u32 v22, s8, v22
  s_mov_b32 s51, 0
  s_mov_b32 s23, 0
  s_add_u32 s58, s6, 0
  s_and_b32 s58, s58, 7
  s_or_b32 s58, s58, s18
  s_lshl_b32 s58, s58, 12
  s_add_u32 s58, s58, s23
  s_add_u32 m0, s57, 0
  s_nop 0
  buffer_load_dwordx4 v1, s[44:47], s58 offen offset:0 sc1 lds
  buffer_load_dwordx4 v1, s[44:47], s58 offen offset:1024 sc1 lds
  buffer_load_dwordx4 v1, s[44:47], s58 offen offset:2048 sc1 lds
  buffer_load_dwordx4 v1, s[44:47], s58 offen offset:3072 sc1 lds
  s_add_u32 s59, s6, 0
  s_and_b32 s59, s59, 7
  s_or_b32 s59, s59, s18
  s_lshl_b32 s59, s59, 17
  s_add_u32 m0, s56, 0
  s_nop 0
  buffer_load_dwordx4 v16, s[52:55], s59 offen offset:0  lds
  buffer_load_dwordx4 v17, s[52:55], s59 offen offset:1024  lds
  buffer_load_dwordx4 v18, s[52:55], s59 offen offset:2048  lds
  buffer_load_dwordx4 v19, s[52:55], s59 offen offset:3072  lds
  s_add_u32 s59, s6, 1
  s_and_b32 s59, s59, 7
  s_or_b32 s59, s59, s18
  s_lshl_b32 s59, s59, 17
  s_add_u32 m0, s56, 16384
  s_nop 0
  buffer_load_dwordx4 v16, s[52:55], s59 offen offset:0  lds
  buffer_load_dwordx4 v17, s[52:55], s59 offen offset:1024  lds
  buffer_load_dwordx4 v18, s[52:55], s59 offen offset:2048  lds
  buffer_load_dwordx4 v19, s[52:55], s59 offen offset:3072  lds
  s_waitcnt vmcnt(4)
  s_barrier
PJ_WA:
  buffer_load_dwordx2 v[24:25], v22, s[44:47], 0 offen sc1
  s_waitcnt vmcnt(0)
PJ_WA_T:
  v_xor_b32 v24, s35, v24
  v_xor_b32 v25, s35, v25
  v_or_b32 v24, v24, v25
  v_cmp_eq_u32 s[20:21], 0, v24
  s_mov_b32 s23, 0
  s_cmp_eq_u32 s18, 0
  s_cselect_b32 s8, s20, s21
  s_cmp_eq_u32 s8, -1
  s_cbranch_scc1 PJ_WA_OK
  s_add_u32 s51, s51, 1
  s_cmp_ge_u32 s51, 131072
  s_cbranch_scc1 PJ_WA_OK
  s_sleep 3
  s_branch PJ_WA
PJ_WA_OK:
  s_add_u32 s58, s6, 1
  s_and_b32 s58, s58, 7
  s_or_b32 s58, s58, s18
  s_lshl_b32 s58, s58, 12
  s_add_u32 s58, s58, s23
  s_add_u32 m0, s57, 16384
  s_nop 0
  buffer_load_dwordx4 v1, s[44:47], s58 offen offset:0 sc1 lds
  buffer_load_dwordx4 v1, s[44:47], s58 offen offset:1024 sc1 lds
  buffer_load_dwordx4 v1, s[44:47], s58 offen offset:2048 sc1 lds
  buffer_load_dwordx4 v1, s[44:47], s58 offen offset:3072 sc1 lds
  s_add_u32 s58, s6, 2
  s_and_b32 s58, s58, 7
  s_or_b32 s58, s58, s18
  s_lshl_b32 s58, s58, 12
  s_add_u32 s58, s58, s23
  s_add_u32 m0, s57, 32768
  s_nop 0
  buffer_load_dwordx4 v1, s[44:47], s58 offen offset:0 sc1 lds
  buffer_load_dwordx4 v1, s[44:47], s58 offen offset:1024 sc1 lds
  buffer_load_dwordx4 v1, s[44:47], s58 offen offset:2048 sc1 lds
  buffer_load_dwordx4 v1, s[44:47], s58 offen offset:3072 sc1 lds
  s_add_u32 s59, s6, 2
  s_and_b32 s59, s59, 7
  s_or_b32 s59, s59, s18
  s_lshl_b32 s59, s59, 17
  s_add_u32 m0, s56, 32768
  s_nop 0
  buffer_load_dwordx4 v16, s[52:55], s59 offen offset:0  lds
  buffer_load_dwordx4 v17, s[52:55], s59 offen offset:1024  lds
  buffer_load_dwordx4 v18, s[52:55], s59 offen offset:2048  lds
  buffer_load_dwordx4 v19, s[52:55], s59 offen offset:3072  lds
  s_add_u32 s59, s6, 3
  s_and_b32 s59, s59, 7
  s_or_b32 s59, s59, s18
  s_lshl_b32 s59, s59, 17
  s_add_u32 m0, s56, 49152
  s_nop 0
  buffer_load_dwordx4 v16, s[52:55], s59 offen offset:0  lds
  buffer_load_dwordx4 v17, s[52:55], s59 offen offset:1024  lds
  buffer_load_dwordx4 v18, s[52:55], s59 offen offset:2048  lds
  buffer_load_dwordx4 v19, s[52:55], s59 offen offset:3072  lds
  s_add_u32 s59, s6, 4
  s_and_b32 s59, s59, 7
  s_or_b32 s59, s59, s18
  s_lshl_b32 s59, s59, 17
  s_add_u32 m0, s56, 65536
  s_nop 0
  buffer_load_dwordx4 v16, s[52:55], s59 offen offset:0  lds
  buffer_load_dwordx4 v17, s[52:55], s59 offen offset:1024  lds
  buffer_load_dwordx4 v18, s[52:55], s59 offen offset:2048  lds
  buffer_load_dwordx4 v19, s[52:55], s59 offen offset:3072  lds
  s_add_u32 s59, s6, 5
  s_and_b32 s59, s59, 7
  s_or_b32 s59, s59, s18
  s_lshl_b32 s59, s59, 17
  s_add_u32 m0, s56, 81920
  s_nop 0
  buffer_load_dwordx4 v16, s[52:55], s59 offen offset:0  lds
  buffer_load_dwordx4 v17, s[52:55], s59 offen offset:1024  lds
  buffer_load_dwordx4 v18, s[52:55], s59 offen offset:2048  lds
  buffer_load_dwordx4 v19, s[52:55], s59 offen offset:3072  lds
  s_waitcnt vmcnt(20)
  s_barrier
  s_add_u32 s58, s6, 3
  s_and_b32 s58, s58, 7
  s_or_b32 s58, s58, s18
  s_lshl_b32 s58, s58, 12
  s_add_u32 s58, s58, s23
  s_add_u32 m0, s57, 49152
  s_nop 0
  buffer_load_dwordx4 v1, s[44:47], s58 offen offset:0 sc1 lds
  buffer_load_dwordx4 v1, s[44:47], s58 offen offset:1024 sc1 lds
  buffer_load_dwordx4 v1, s[44:47], s58 offen offset:2048 sc1 lds
  buffer_load_dwordx4 v1, s[44:47], s58 offen offset:3072 sc1 lds
  s_waitcnt vmcnt(16)
  s_barrier
  s_add_u32 s58, s6, 4
  s_and_b32 s58, s58, 7
  s_or_b32 s58, s58, s18
  s_lshl_b32 s58, s58, 12
  s_add_u32 s58, s58, s23
  s_add_u32 m0, s57, 0
  s_nop 0
  buffer_load_dwordx4 v1, s[44:47], s58 offen offset:0 sc1 lds
  buffer_load_dwordx4 v1, s[44:47], s58 offen offset:1024 sc1 lds
  buffer_load_dwordx4 v1, s[44:47], s58 offen offset:2048 sc1 lds
  buffer_load_dwordx4 v1, s[44:47], s58 offen offset:3072 sc1 lds
  s_add_u32 s59, s6, 6
  s_and_b32 s59, s59, 7
  s_or_b32 s59, s59, s18
  s_lshl_b32 s59, s59, 17
  s_add_u32 m0, s56, 0
  s_nop 0
  buffer_load_dwordx4 v16, s[52:55], s59 offen offset:0  lds
  buffer_load_dwordx4 v17, s[52:55], s59 offen offset:1024  lds
  buffer_load_dwordx4 v18, s[52:55], s59 offen offset:2048  lds
  buffer_load_dwordx4 v19, s[52:55], s59 offen offset:3072  lds
  s_waitcnt vmcnt(8)
  s_barrier
  s_add_u32 s58, s6, 5
  s_and_b32 s58, s58, 7
  s_or_b32 s58, s58, s18
  s_lshl_b32 s58, s58, 12
  s_add_u32 s58, s58, s23
  s_add_u32 m0, s57, 16384
  s_nop 0
  buffer_load_dwordx4 v1, s[44:47], s58 offen offset:0 sc1 lds
  buffer_load_dwordx4 v1, s[44:47], s58 offen offset:1024 sc1 lds
  buffer_load_dwordx4 v1, s[44:47], s58 offen offset:2048 sc1 lds
  buffer_load_dwordx4 v1, s[44:47], s58 offen offset:3072 sc1 lds
  s_add_u32 s59, s6, 7
  s_and_b32 s59, s59, 7
  s_or_b32 s59, s59, s18
  s_lshl_b32 s59, s59, 17
  s_add_u32 m0, s56, 16384
  s_nop 0
  buffer_load_dwordx4 v16, s[52:55], s59 offen offset:0  lds
  buffer_load_dwordx4 v17, s[52:55], s59 offen offset:1024  lds
  buffer_load_dwordx4 v18, s[52:55], s59 offen offset:2048  lds
  buffer_load_dwordx4 v19, s[52:55], s59 offen offset:3072  lds
  s_waitcnt vmcnt(12)
  s_barrier
  s_add_u32 s58, s6, 6
  s_and_b32 s58, s58, 7
  s_or_b32 s58, s58, s18
  s_lshl_b32 s58, s58, 12
  s_add_u32 s58, s58, s23
  s_add_u32 m0, s57, 32768
  s_nop 0
  buffer_load_dwordx4 v1, s[44:47], s58 offen offset:0 sc1 lds
  buffer_load_dwordx4 v1, s[44:47], s58 offen offset:1024 sc1 lds
  buffer_load_dwordx4 v1, s[44:47], s58 offen offset:2048 sc1 lds
  buffer_load_dwordx4 v1, s[44:47], s58 offen offset:3072 sc1 lds
  s_add_u32 s59, s6, 8
  s_and_b32 s59, s59, 7
  s_or_b32 s59, s59, s19
  s_lshl_b32 s59, s59, 17
  s_add_u32 m0, s56, 32768
  s_nop 0
  buffer_load_dwordx4 v16, s[52:55], s59 offen offset:0  lds
  buffer_load_dwordx4 v17, s[52:55], s59 offen offset:1024  lds
  buffer_load_dwordx4 v18, s[52:55], s59 offen offset:2048  lds
  buffer_load_dwordx4 v19, s[52:55], s59 offen offset:3072  lds
  s_waitcnt vmcnt(12)
  s_barrier
  s_add_u32 s58, s6, 7
  s_and_b32 s58, s58, 7
  s_or_b32 s58, s58, s18
  s_lshl_b32 s58, s58, 12
  s_add_u32 s58, s58, s23
  s_add_u32 m0, s57, 49152
  s_nop 0
  buffer_load_dwordx4 v1, s[44:47], s58 offen offset:0 sc1 lds
  buffer_load_dwordx4 v1, s[44:47], s58 offen offset:1024 sc1 lds
  buffer_load_dwordx4 v1, s[44:47], s58 offen offset:2048 sc1 lds
  buffer_load_dwordx4 v1, s[44:47], s58 offen offset:3072 sc1 lds
  s_add_u32 s59, s6, 9
  s_and_b32 s59, s59, 7
  s_or_b32 s59, s59, s19
  s_lshl_b32 s59, s59, 17
  s_add_u32 m0, s56, 49152
  s_nop 0
  buffer_load_dwordx4 v16, s[52:55], s59 offen offset:0  lds
  buffer_load_dwordx4 v17, s[52:55], s59 offen offset:1024  lds
  buffer_load_dwordx4 v18, s[52:55], s59 offen offset:2048  lds
  buffer_load_dwordx4 v19, s[52:55], s59 offen offset:3072  lds
  s_waitcnt vmcnt(12)
  s_barrier
  s_mov_b32 s23, 0
  s_cmp_eq_u32 s19, 0
  s_cselect_b32 s8, s20, s21
  s_cmp_eq_u32 s8, -1
  s_cbranch_scc1 PJ_WB_OK
PJ_WB:
  buffer_load_dwordx2 v[24:25], v22, s[44:47], 0 offen sc1
  s_waitcnt vmcnt(0)
PJ_WB_T:
  v_xor_b32 v24, s35, v24
  v_xor_b32 v25, s35, v25
  v_or_b32 v24, v24, v25
  v_cmp_eq_u32 s[20:21], 0, v24
  s_mov_b32 s23, 0
  s_cmp_eq_u32 s19, 0
  s_cselect_b32 s8, s20, s21
  s_cmp_eq_u32 s8, -1
  s_cbranch_scc1 PJ_WB_OK
  s_add_u32 s51, s51, 1
  s_cmp_ge_u32 s51, 131072
  s_cbranch_scc1 PJ_WB_OK
  s_sleep 3
  s_branch PJ_WB
PJ_WB_OK:
  s_add_u32 s58, s6, 8
  s_and_b32 s58, s58, 7
  s_or_b32 s58, s58, s19
  s_lshl_b32 s58, s58, 12
  s_add_u32 s58, s58, s23
  s_add_u32 m0, s57, 0
  s_nop 0
  buffer_load_dwordx4 v1, s[44:47], s58 offen offset:0 sc1 lds
  buffer_load_dwordx4 v1, s[44:47], s58 offen offset:1024 sc1 lds
  buffer_load_dwordx4 v1, s[44:47], s58 offen offset:2048 sc1 lds
  buffer_load_dwordx4 v1, s[44:47], s58 offen offset:3072 sc1 lds
  s_add_u32 s59, s6, 10
  s_and_b32 s59, s59, 7
  s_or_b32 s59, s59, s19
  s_lshl_b32 s59, s59, 17
  s_add_u32 m0, s56, 65536
  s_nop 0
  buffer_load_dwordx4 v16, s[52:55], s59 offen offset:0  lds
  buffer_load_dwordx4 v17, s[52:55], s59 offen offset:1024  lds
  buffer_load_dwordx4 v18, s[52:55], s59 offen offset:2048  lds
  buffer_load_dwordx4 v19, s[52:55], s59 offen offset:3072  lds
  s_waitcnt vmcnt(12)
  s_barrier
  s_add_u32 s58, s6, 9
  s_and_b32 s58, s58, 7
  s_or_b32 s58, s58, s19
  s_lshl_b32 s58, s58, 12
  s_add_u32 s58, s58, s23
  s_add_u32 m0, s57, 16384
  s_nop 0
  buffer_load_dwordx4 v1, s[44:47], s58 offen offset:0 sc1 lds
  buffer_load_dwordx4 v1, s[44:47], s58 offen offset:1024 sc1 lds
  buffer_load_dwordx4 v1, s[44:47], s58 offen offset:2048 sc1 lds
  buffer_load_dwordx4 v1, s[44:47], s58 offen offset:3072 sc1 lds
  s_add_u32 s59, s6, 11
  s_and_b32 s59, s59, 7
  s_or_b32 s59, s59, s19
  s_lshl_b32 s59, s59, 17
  s_add_u32 m0, s56, 81920
  s_nop 0
  buffer_load_dwordx4 v16, s[52:55], s59 offen offset:0  lds
  buffer_load_dwordx4 v17, s[52:55], s59 offen offset:1024  lds
  buffer_load_dwordx4 v18, s[52:55], s59 offen offset:2048  lds
  buffer_load_dwordx4 v19, s[52:55], s59 offen offset:3072  lds
  s_waitcnt vmcnt(12)
  s_barrier
  s_add_u32 s58, s6, 10
  s_and_b32 s58, s58, 7
  s_or_b32 s58, s58, s19
  s_lshl_b32 s58, s58, 12
  s_add_u32 s58, s58, s23
  s_add_u32 m0, s57, 32768
  s_nop 0
  buffer_load_dwordx4 v1, s[44:47], s58 offen offset:0 sc1 lds
  buffer_load_dwordx4 v1, s[44:47], s58 offen offset:1024 sc1 lds
  buffer_load_dwordx4 v1, s[44:47], s58 offen offset:2048 sc1 lds
  buffer_load_dwordx4 v1, s[44:47], s58 offen offset:3072 sc1 lds
  s_add_u32 s59, s6, 12
  s_and_b32 s59, s59, 7
  s_or_b32 s59, s59, s19
  s_lshl_b32 s59, s59, 17
  s_add_u32 m0, s56, 0
  s_nop 0
  buffer_load_dwordx4 v16, s[52:55], s59 offen offset:0  lds
  buffer_load_dwordx4 v17, s[52:55], s59 offen offset:1024  lds
  buffer_load_dwordx4 v18, s[52:55], s59 offen offset:2048  lds
  buffer_load_dwordx4 v19, s[52:55], s59 offen offset:3072  lds
  s_waitcnt vmcnt(12)
  s_barrier
  s_add_u32 s58, s6, 11
  s_and_b32 s58, s58, 7
  s_or_b32 s58, s58, s19
  s_lshl_b32 s58, s58, 12
  s_add_u32 s58, s58, s23
  s_add_u32 m0, s57, 49152
  s_nop 0
  buffer_load_dwordx4 v1, s[44:47], s58 offen offset:0 sc1 lds
  buffer_load_dwordx4 v1, s[44:47], s58 offen offset:1024 sc1 lds
  buffer_load_dwordx4 v1, s[44:47], s58 offen offset:2048 sc1 lds
  buffer_load_dwordx4 v1, s[44:47], s58 offen offset:3072 sc1 lds
  s_add_u32 s59, s6, 13
  s_and_b32 s59, s59, 7
  s_or_b32 s59, s59, s19
  s_lshl_b32 s59, s59, 17
  s_add_u32 m0, s56, 16384
  s_nop 0
  buffer_load_dwordx4 v16, s[52:55], s59 offen offset:0  lds
  buffer_load_dwordx4 v17, s[52:55], s59 offen offset:1024  lds
  buffer_load_dwordx4 v18, s[52:55], s59 offen offset:2048  lds
  buffer_load_dwordx4 v19, s[52:55], s59 offen offset:3072  lds
  s_waitcnt vmcnt(12)
  s_barrier
  s_add_u32 s58, s6, 12
  s_and_b32 s58, s58, 7
  s_or_b32 s58, s58, s19
  s_lshl_b32 s58, s58, 12
  s_add_u32 s58, s58, s23
  s_add_u32 m0, s57, 0
  s_nop 0
  buffer_load_dwordx4 v1, s[44:47], s58 offen offset:0 sc1 lds
  buffer_load_dwordx4 v1, s[44:47], s58 offen offset:1024 sc1 lds
  buffer_load_dwordx4 v1, s[44:47], s58 offen offset:2048 sc1 lds
  buffer_load_dwordx4 v1, s[44:47], s58 offen offset:3072 sc1 lds
  s_add_u32 s59, s6, 14
  s_and_b32 s59, s59, 7
  s_or_b32 s59, s59, s19
  s_lshl_b32 s59, s59, 17
  s_add_u32 m0, s56, 32768
  s_nop 0
  buffer_load_dwordx4 v16, s[52:55], s59 offen offset:0  lds
  buffer_load_dwordx4 v17, s[52:55], s59 offen offset:1024  lds
  buffer_load_dwordx4 v18, s[52:55], s59 offen offset:2048  lds
  buffer_load_dwordx4 v19, s[52:55], s59 offen offset:3072  lds
  s_waitcnt vmcnt(12)
  s_barrier
  s_add_u32 s58, s6, 13
  s_and_b32 s58, s58, 7
  s_or_b32 s58, s58, s19
  s_lshl_b32 s58, s58, 12
  s_add_u32 s58, s58, s23
  s_add_u32 m0, s57, 16384
  s_nop 0
  buffer_load_dwordx4 v1, s[44:47], s58 offen offset:0 sc1 lds
  buffer_load_dwordx4 v1, s[44:47], s58 offen offset:1024 sc1 lds
  buffer_load_dwordx4 v1, s[44:47], s58 offen offset:2048 sc1 lds
  buffer_load_dwordx4 v1, s[44:47], s58 offen offset:3072 sc1 lds
  s_add_u32 s59, s6, 15
  s_and_b32 s59, s59, 7
  s_or_b32 s59, s59, s19
  s_lshl_b32 s59, s59, 17
  s_add_u32 m0, s56, 49152
  s_nop 0
  buffer_load_dwordx4 v16, s[52:55], s59 offen offset:0  lds
  buffer_load_dwordx4 v17, s[52:55], s59 offen offset:1024  lds
  buffer_load_dwordx4 v18, s[52:55], s59 offen offset:2048  lds
  buffer_load_dwordx4 v19, s[52:55], s59 offen offset:3072  lds
  s_waitcnt vmcnt(12)
  s_barrier
  s_add_u32 s58, s6, 14
  s_and_b32 s58, s58, 7
  s_or_b32 s58, s58, s19
  s_lshl_b32 s58, s58, 12
  s_add_u32 s58, s58, s23
  s_add_u32 m0, s57, 32768
  s_nop 0
  buffer_load_dwordx4 v1, s[44:47], s58 offen offset:0 sc1 lds
  buffer_load_dwordx4 v1, s[44:47], s58 offen offset:1024 sc1 lds
  buffer_load_dwordx4 v1, s[44:47], s58 offen offset:2048 sc1 lds
  buffer_load_dwordx4 v1, s[44:47], s58 offen offset:3072 sc1 lds
  s_waitcnt vmcnt(8)
  s_barrier
  s_add_u32 s58, s6, 15
  s_and_b32 s58, s58, 7
  s_or_b32 s58, s58, s19
  s_lshl_b32 s58, s58, 12
  s_add_u32 s58, s58, s23
  s_add_u32 m0, s57, 49152
  s_nop 0
  buffer_load_dwordx4 v1, s[44:47], s58 offen offset:0 sc1 lds
  buffer_load_dwordx4 v1, s[44:47], s58 offen offset:1024 sc1 lds
  buffer_load_dwordx4 v1, s[44:47], s58 offen offset:2048 sc1 lds
  buffer_load_dwordx4 v1, s[44:47], s58 offen offset:3072 sc1 lds
  s_waitcnt vmcnt(4)
  s_barrier
  s_waitcnt vmcnt(0)
  s_barrier
K1_END:
  s_endpgm
K1_SLOW:
  s_cmp_eq_u32 s14, 1
  s_cbranch_scc1 K1_S1_1
  s_cmp_eq_u32 s14, 2
  s_cbranch_scc1 K1_S1_2
  s_cmp_eq_u32 s14, 3
  s_cbranch_scc1 K1_S1_3
K1_S1_0:
  ds_read_b128 v[208:211], v1 offset:0
  ds_read_b128 v[212:215], v1 offset:1024
  ds_read_b128 v[216:219], v1 offset:8192
  ds_read_b128 v[220:223], v1 offset:9216
  ds_read_b128 v[224:227], v1 offset:16384
  ds_read_b128 v[228:231], v1 offset:17408
  ds_read_b128 v[232:235], v1 offset:24576
  ds_read_b128 v[236:239], v1 offset:25600
  v_lshrrev_b32 v155, 5, v0
  v_and_b32 v154, 31, v0
  v_lshlrev_b32 v155, 2, v155
  v_sub_u32 v154, v154, v155
  v_mov_b32 v155, 0
  v_mov_b32 v156, 0xf149f2ca
  v_cmp_le_i32 s[80:81], 0, v154
  v_cmp_le_i32 s[82:83], 1, v154
  v_cmp_le_i32 s[84:85], 2, v154
  v_cmp_le_i32 s[86:87], 3, v154
  v_cndmask_b32 v240, v156, v155, s[80:81]
  v_cndmask_b32 v241, v156, v155, s[82:83]
  v_cndmask_b32 v242, v156, v155, s[84:85]
  v_cndmask_b32 v243, v156, v155, s[86:87]
  v_cmp_le_i32 s[80:81], 8, v154
  v_cmp_le_i32 s[82:83], 9, v154
  v_cmp_le_i32 s[84:85], 10, v154
  v_cmp_le_i32 s[86:87], 11, v154
  v_cndmask_b32 v244, v156, v155, s[80:81]
  v_cndmask_b32 v245, v156, v155, s[82:83]
  v_cndmask_b32 v246, v156, v155, s[84:85]
  v_cndmask_b32 v247, v156, v155, s[86:87]
  v_cmp_le_i32 s[80:81], 16, v154
  v_cmp_le_i32 s[82:83], 17, v154
  v_cmp_le_i32 s[84:85], 18, v154
  v_cmp_le_i32 s[86:87], 19, v154
  v_cndmask_b32 v248, v156, v155, s[80:81]
  v_cndmask_b32 v249, v156, v155, s[82:83]
  v_cndmask_b32 v250, v156, v155, s[84:85]
  v_cndmask_b32 v251, v156, v155, s[86:87]
  v_cmp_le_i32 s[80:81], 24, v154
  v_cmp_le_i32 s[82:83], 25, v154
  s_waitcnt lgkmcnt(7)
  v_mfma_f32_32x32x16_bf16 v[16:31], v[208:211], v[200:203], 0
  v_cmp_le_i32 s[84:85], 26, v154
  v_cmp_le_i32 s[86:87], 27, v154
  v_cndmask_b32 v252, v156, v155, s[80:81]
  v_cndmask_b32 v253, v156, v155, s[82:83]
  v_cndmask_b32 v254, v156, v155, s[84:85]
  v_cndmask_b32 v255, v156, v155, s[86:87]
  s_waitcnt lgkmcnt(6)
  v_mfma_f32_32x32x16_bf16 v[16:31], v[212:215], v[204:207], v[16:31]
  v_mfma_f32_32x32x16_bf16 v[144:159], v[208:211], v[192:195], v[240:255]
  ds_read_b128 v[208:211], v1 offset:28672
  v_mfma_f32_32x32x16_bf16 v[144:159], v[212:215], v[196:199], v[144:159]
  ds_read_b128 v[212:215], v1 offset:29696
  s_nop 7
  v_max_f32 v11, v16, v17
  v_max3_f32 v11, v18, v19, v11
  v_max3_f32 v11, v20, v21, v11
  v_max3_f32 v11, v22, v23, v11
  v_max3_f32 v11, v24, v25, v11
  s_waitcnt lgkmcnt(7)
  v_mfma_f32_32x32x16_bf16 v[32:47], v[216:219], v[200:203], 0
  ds_read_b128 v[216:219], v1 offset:20480
  v_max3_f32 v11, v26, v27, v11
  v_max3_f32 v11, v28, v29, v11
  v_max3_f32 v11, v30, v31, v11
  s_waitcnt lgkmcnt(7)
  v_mfma_f32_32x32x16_bf16 v[32:47], v[220:223], v[204:207], v[32:47]
  ds_read_b128 v[220:223], v1 offset:21504
  v_max_f32 v9, v144, v145
  v_max3_f32 v9, v146, v147, v9
  v_max3_f32 v9, v148, v149, v9
  v_max3_f32 v9, v150, v151, v9
  v_max3_f32 v9, v152, v153, v9
  s_waitcnt lgkmcnt(7)
  v_mfma_f32_32x32x16_bf16 v[48:63], v[224:227], v[200:203], 0
  ds_read_b128 v[224:227], v1 offset:12288
  v_max3_f32 v9, v154, v155, v9
  v_max3_f32 v9, v156, v157, v9
  v_max3_f32 v9, v158, v159, v9
  v_mov_b32 v10, v9
  s_waitcnt lgkmcnt(7)
  v_mfma_f32_32x32x16_bf16 v[48:63], v[228:231], v[204:207], v[48:63]
  ds_read_b128 v[228:231], v1 offset:13312
  v_max3_f32 v11, v32, v33, v11
  v_max3_f32 v11, v34, v35, v11
  v_max3_f32 v11, v36, v37, v11
  v_max3_f32 v11, v38, v39, v11
  s_waitcnt lgkmcnt(7)
  v_mfma_f32_32x32x16_bf16 v[64:79], v[232:235], v[200:203], 0
  ds_read_b128 v[232:235], v1 offset:4096
  v_max3_f32 v11, v40, v41, v11
  v_max3_f32 v11, v42, v43, v11
  v_max3_f32 v11, v44, v45, v11
  v_max3_f32 v11, v46, v47, v11
  s_waitcnt lgkmcnt(7)
  v_mfma_f32_32x32x16_bf16 v[64:79], v[236:239], v[204:207], v[64:79]
  ds_read_b128 v[236:239], v1 offset:5120
  v_max3_f32 v11, v48, v49, v11
  v_max3_f32 v11, v50, v51, v11
  v_max3_f32 v11, v52, v53, v11
  v_max3_f32 v11, v54, v55, v11
  s_waitcnt lgkmcnt(7)
  v_mfma_f32_32x32x16_bf16 v[80:95], v[208:211], v[200:203], 0
  ds_read_b128 v[208:211], v1 offset:2048
  v_max3_f32 v11, v56, v57, v11
  v_max3_f32 v11, v58, v59, v11
  v_max3_f32 v11, v60, v61, v11
  v_max3_f32 v11, v62, v63, v11
  s_waitcnt lgkmcnt(7)
  v_mfma_f32_32x32x16_bf16 v[80:95], v[212:215], v[204:207], v[80:95]
  ds_read_b128 v[212:215], v1 offset:3072
  v_max3_f32 v11, v64, v65, v11
  v_max3_f32 v11, v66, v67, v11
  v_max3_f32 v11, v68, v69, v11
  v_max3_f32 v11, v70, v71, v11
  s_waitcnt lgkmcnt(7)
  v_mfma_f32_32x32x16_bf16 v[96:111], v[216:219], v[200:203], 0
  ds_read_b128 v[216:219], v1 offset:10240
  v_max3_f32 v11, v72, v73, v11
  v_max3_f32 v11, v74, v75, v11
  v_max3_f32 v11, v76, v77, v11
  v_max3_f32 v11, v78, v79, v11
  s_waitcnt lgkmcnt(7)
  v_mfma_f32_32x32x16_bf16 v[96:111], v[220:223], v[204:207], v[96:111]
  ds_read_b128 v[220:223], v1 offset:11264
  v_max3_f32 v11, v80, v81, v11
  v_max3_f32 v11, v82, v83, v11
  v_max3_f32 v11, v84, v85, v11
  v_max3_f32 v11, v86, v87, v11
  s_waitcnt lgkmcnt(7)
  v_mfma_f32_32x32x16_bf16 v[112:127], v[224:227], v[200:203], 0
  ds_read_b128 v[224:227], v1 offset:18432
  v_max3_f32 v11, v88, v89, v11
  v_max3_f32 v11, v90, v91, v11
  v_max3_f32 v11, v92, v93, v11
  v_max3_f32 v11, v94, v95, v11
  s_waitcnt lgkmcnt(7)
  v_mfma_f32_32x32x16_bf16 v[112:127], v[228:231], v[204:207], v[112:127]
  ds_read_b128 v[228:231], v1 offset:19456
  v_max3_f32 v11, v96, v97, v11
  v_max3_f32 v11, v98, v99, v11
  v_max3_f32 v11, v100, v101, v11
  v_max3_f32 v11, v102, v103, v11
  s_waitcnt lgkmcnt(7)
  v_mfma_f32_32x32x16_bf16 v[128:143], v[232:235], v[200:203], v[240:255]
  ds_read_b128 v[232:235], v1 offset:26624
  v_max3_f32 v11, v104, v105, v11
  v_max3_f32 v11, v106, v107, v11
  v_max3_f32 v11, v108, v109, v11
  v_max3_f32 v11, v110, v111, v11
  s_waitcnt lgkmcnt(7)
  v_mfma_f32_32x32x16_bf16 v[128:143], v[236:239], v[204:207], v[128:143]
  ds_read_b128 v[236:239], v1 offset:27648
  v_max3_f32 v11, v112, v113, v11
  v_max3_f32 v11, v114, v115, v11
  v_max3_f32 v11, v116, v117, v11
  v_max3_f32 v11, v118, v119, v11
  v_max3_f32 v11, v120, v121, v11
  v_max3_f32 v11, v122, v123, v11
  v_max3_f32 v11, v124, v125, v11
  v_max3_f32 v11, v126, v127, v11
  v_permlane32_swap_b32 v9, v10
  v_max_f32 v5, v9, v10
  v_sub_f32 v144, v144, v5
  v_sub_f32 v145, v145, v5
  v_exp_f32 v144, v144
  v_max3_f32 v11, v128, v129, v11
  v_max3_f32 v11, v130, v131, v11
  v_max3_f32 v11, v132, v133, v11
  v_max3_f32 v11, v134, v135, v11
  v_max3_f32 v11, v136, v137, v11
  v_max3_f32 v11, v138, v139, v11
  v_max3_f32 v11, v140, v141, v11
  v_max3_f32 v11, v142, v143, v11
  v_mov_b32 v12, v11
  v_exp_f32 v145, v145
  s_nop 0
  v_permlane32_swap_b32 v11, v12
  v_max_f32 v6, v11, v12
  v_sub_f32 v16, v16, v6
  v_sub_f32 v17, v17, v6
  v_exp_f32 v16, v16
  v_exp_f32 v17, v17
  v_sub_f32 v18, v18, v6
  v_sub_f32 v19, v19, v6
  v_exp_f32 v18, v18
  v_exp_f32 v19, v19
  v_sub_f32 v20, v20, v6
  v_sub_f32 v21, v21, v6
  v_sub_f32 v22, v22, v6
  v_sub_f32 v23, v23, v6
  v_add_f32 v8, v16, v17
  v_exp_f32 v20, v20
  v_exp_f32 v21, v21
  v_exp_f32 v22, v22
  v_exp_f32 v23, v23
  v_cvt_pk_bf16_f32 v16, v16, v17
  v_add_f32 v8, v8, v18
  v_cvt_pk_bf16_f32 v17, v18, v19
  v_add_f32 v8, v8, v19
  v_sub_f32 v24, v24, v6
  v_add_f32 v8, v8, v20
  v_cvt_pk_bf16_f32 v18, v20, v21
  v_cvt_pk_bf16_f32 v19, v22, v23
  v_exp_f32 v24, v24
  s_waitcnt lgkmcnt(7)
  v_mfma_f32_32x32x16_bf16 v[176:191], v[208:211], v[16:19], 0
  v_sub_f32 v25, v25, v6
  v_add_f32 v8, v8, v21
  v_exp_f32 v25, v25
  v_sub_f32 v26, v26, v6
  v_add_f32 v8, v8, v22
  v_sub_f32 v27, v27, v6
  v_exp_f32 v26, v26
  v_add_f32 v8, v8, v23
  v_exp_f32 v27, v27
  v_sub_f32 v28, v28, v6
  v_sub_f32 v29, v29, v6
  v_sub_f32 v30, v30, v6
  v_sub_f32 v31, v31, v6
  v_add_f32 v8, v8, v24
  v_exp_f32 v28, v28
  v_exp_f32 v29, v29
  v_exp_f32 v30, v30
  v_exp_f32 v31, v31
  v_add_f32 v8, v8, v25
  v_cvt_pk_bf16_f32 v24, v24, v25
  v_add_f32 v8, v8, v26
  v_cvt_pk_bf16_f32 v25, v26, v27
  v_add_f32 v8, v8, v27
  v_add_f32 v8, v8, v28
  v_cvt_pk_bf16_f32 v26, v28, v29
  v_cvt_pk_bf16_f32 v27, v30, v31
  v_sub_f32 v32, v32, v6
  v_add_f32 v8, v8, v29
  s_waitcnt lgkmcnt(6)
  v_mfma_f32_32x32x16_bf16 v[176:191], v[212:215], v[24:27], v[176:191]
  v_exp_f32 v32, v32
  v_sub_f32 v33, v33, v6
  v_add_f32 v8, v8, v30
  v_exp_f32 v33, v33
  v_sub_f32 v34, v34, v6
  v_sub_f32 v35, v35, v6
  v_add_f32 v8, v8, v31
  v_exp_f32 v34, v34
  v_exp_f32 v35, v35
  v_sub_f32 v36, v36, v6
  v_sub_f32 v37, v37, v6
  v_sub_f32 v38, v38, v6
  v_sub_f32 v39, v39, v6
  v_add_f32 v8, v8, v32
  v_exp_f32 v36, v36
  v_exp_f32 v37, v37
  v_exp_f32 v38, v38
  v_exp_f32 v39, v39
  v_add_f32 v8, v8, v33
  v_cvt_pk_bf16_f32 v32, v32, v33
  v_add_f32 v8, v8, v34
  v_cvt_pk_bf16_f32 v33, v34, v35
  v_add_f32 v8, v8, v35
  v_sub_f32 v40, v40, v6
  v_add_f32 v8, v8, v36
  v_cvt_pk_bf16_f32 v34, v36, v37
  v_cvt_pk_bf16_f32 v35, v38, v39
  v_sub_f32 v146, v146, v5
  v_sub_f32 v147, v147, v5
  s_waitcnt lgkmcnt(5)
  v_mfma_f32_32x32x16_bf16 v[176:191], v[216:219], v[32:35], v[176:191]
  v_exp_f32 v40, v40
  v_sub_f32 v41, v41, v6
  v_add_f32 v8, v8, v37
  v_exp_f32 v146, v146
  v_exp_f32 v147, v147
  v_exp_f32 v41, v41
  v_sub_f32 v42, v42, v6
  v_add_f32 v8, v8, v38
  v_sub_f32 v148, v148, v5
  v_sub_f32 v149, v149, v5
  v_sub_f32 v150, v150, v5
  v_sub_f32 v151, v151, v5
  v_add_f32 v7, v144, v145
  v_sub_f32 v43, v43, v6
  v_exp_f32 v42, v42
  v_add_f32 v8, v8, v39
  v_exp_f32 v148, v148
  v_exp_f32 v149, v149
  v_exp_f32 v150, v150
  v_exp_f32 v151, v151
  v_cvt_pk_bf16_f32 v144, v144, v145
  v_exp_f32 v43, v43
  v_sub_f32 v44, v44, v6
  v_sub_f32 v45, v45, v6
  v_sub_f32 v46, v46, v6
  v_sub_f32 v47, v47, v6
  v_add_f32 v8, v8, v40
  v_add_f32 v7, v7, v146
  v_cvt_pk_bf16_f32 v145, v146, v147
  v_exp_f32 v44, v44
  v_exp_f32 v45, v45
  v_exp_f32 v46, v46
  v_exp_f32 v47, v47
  v_add_f32 v8, v8, v41
  v_add_f32 v7, v7, v147
  v_cvt_pk_bf16_f32 v40, v40, v41
  v_add_f32 v8, v8, v42
  v_sub_f32 v152, v152, v5
  v_add_f32 v7, v7, v148
  v_cvt_pk_bf16_f32 v146, v148, v149
  v_cvt_pk_bf16_f32 v147, v150, v151
  v_cvt_pk_bf16_f32 v41, v42, v43
  v_add_f32 v8, v8, v43
  v_mfma_f32_32x32x16_bf16 v[160:175], v[208:211], v[144:147], 0
  ds_read_b128 v[208:211], v1 offset:30720
  v_exp_f32 v152, v152
  v_sub_f32 v153, v153, v5
  v_add_f32 v7, v7, v149
  v_add_f32 v8, v8, v44
  v_cvt_pk_bf16_f32 v42, v44, v45
  v_cvt_pk_bf16_f32 v43, v46, v47
  v_sub_f32 v48, v48, v6
  v_exp_f32 v153, v153
  s_waitcnt lgkmcnt(5)
  v_mfma_f32_32x32x16_bf16 v[176:191], v[220:223], v[40:43], v[176:191]
  v_sub_f32 v154, v154, v5
  v_add_f32 v7, v7, v150
  v_sub_f32 v155, v155, v5
  v_add_f32 v8, v8, v45
  v_exp_f32 v48, v48
  v_sub_f32 v49, v49, v6
  v_exp_f32 v154, v154
  v_add_f32 v7, v7, v151
  v_exp_f32 v155, v155
  v_add_f32 v8, v8, v46
  v_exp_f32 v49, v49
  v_sub_f32 v50, v50, v6
  v_sub_f32 v156, v156, v5
  v_sub_f32 v157, v157, v5
  v_sub_f32 v158, v158, v5
  v_sub_f32 v159, v159, v5
  v_add_f32 v7, v7, v152
  v_sub_f32 v51, v51, v6
  v_add_f32 v8, v8, v47
  v_exp_f32 v50, v50
  v_exp_f32 v156, v156
  v_exp_f32 v157, v157
  v_exp_f32 v158, v158
  v_exp_f32 v159, v159
  v_add_f32 v7, v7, v153
  v_cvt_pk_bf16_f32 v152, v152, v153
  v_exp_f32 v51, v51
  v_sub_f32 v52, v52, v6
  v_sub_f32 v53, v53, v6
  v_sub_f32 v54, v54, v6
  v_sub_f32 v55, v55, v6
  v_add_f32 v8, v8, v48
  v_add_f32 v7, v7, v154
  v_cvt_pk_bf16_f32 v153, v154, v155
  v_exp_f32 v52, v52
  v_exp_f32 v53, v53
  v_exp_f32 v54, v54
  v_exp_f32 v55, v55
  v_add_f32 v8, v8, v49
  v_add_f32 v7, v7, v155
  v_cvt_pk_bf16_f32 v48, v48, v49
  v_add_f32 v8, v8, v50
  v_cvt_pk_bf16_f32 v154, v156, v157
  v_cvt_pk_bf16_f32 v155, v158, v159
  v_cvt_pk_bf16_f32 v49, v50, v51
  v_add_f32 v8, v8, v51
  v_mfma_f32_32x32x16_bf16 v[160:175], v[212:215], v[152:155], v[160:175]
  ds_read_b128 v[212:215], v1 offset:31744
  ds_read_b128 v[216:219], v1 offset:22528
  ds_read_b128 v[220:223], v1 offset:23552
  v_sub_f32 v56, v56, v6
  v_add_f32 v8, v8, v52
  v_cvt_pk_bf16_f32 v50, v52, v53
  v_cvt_pk_bf16_f32 v51, v54, v55
  v_exp_f32 v56, v56
  s_waitcnt lgkmcnt(7)
  v_mfma_f32_32x32x16_bf16 v[176:191], v[224:227], v[48:51], v[176:191]
  ds_read_b128 v[224:227], v1 offset:14336
  v_sub_f32 v57, v57, v6
  v_add_f32 v8, v8, v53
  v_exp_f32 v57, v57
  v_sub_f32 v58, v58, v6
  v_add_f32 v8, v8, v54
  v_sub_f32 v59, v59, v6
  v_exp_f32 v58, v58
  v_add_f32 v8, v8, v55
  v_exp_f32 v59, v59
  v_sub_f32 v60, v60, v6
  v_sub_f32 v61, v61, v6
  v_sub_f32 v62, v62, v6
  v_sub_f32 v63, v63, v6
  v_add_f32 v8, v8, v56
  v_exp_f32 v60, v60
  v_exp_f32 v61, v61
  v_exp_f32 v62, v62
  v_exp_f32 v63, v63
  v_add_f32 v8, v8, v57
  v_cvt_pk_bf16_f32 v56, v56, v57
  v_add_f32 v8, v8, v58
  v_cvt_pk_bf16_f32 v57, v58, v59
  v_add_f32 v8, v8, v59
  v_add_f32 v8, v8, v60
  v_cvt_pk_bf16_f32 v58, v60, v61
  v_cvt_pk_bf16_f32 v59, v62, v63
  v_sub_f32 v64, v64, v6
  v_add_f32 v8, v8, v61
  s_waitcnt lgkmcnt(7)
  v_mfma_f32_32x32x16_bf16 v[176:191], v[228:231], v[56:59], v[176:191]
  ds_read_b128 v[228:231], v1 offset:15360
  v_exp_f32 v64, v64
  v_sub_f32 v65, v65, v6
  v_add_f32 v8, v8, v62
  v_exp_f32 v65, v65
  v_sub_f32 v66, v66, v6
  v_sub_f32 v67, v67, v6
  v_add_f32 v8, v8, v63
  v_exp_f32 v66, v66
  v_exp_f32 v67, v67
  v_sub_f32 v68, v68, v6
  v_sub_f32 v69, v69, v6
  v_sub_f32 v70, v70, v6
  v_sub_f32 v71, v71, v6
  v_add_f32 v8, v8, v64
  v_exp_f32 v68, v68
  v_exp_f32 v69, v69
  v_exp_f32 v70, v70
  v_exp_f32 v71, v71
  v_add_f32 v8, v8, v65
  v_cvt_pk_bf16_f32 v64, v64, v65
  v_add_f32 v8, v8, v66
  v_cvt_pk_bf16_f32 v65, v66, v67
  v_add_f32 v8, v8, v67
  v_sub_f32 v72, v72, v6
  v_add_f32 v8, v8, v68
  v_cvt_pk_bf16_f32 v66, v68, v69
  v_cvt_pk_bf16_f32 v67, v70, v71
  v_exp_f32 v72, v72
  s_waitcnt lgkmcnt(7)
  v_mfma_f32_32x32x16_bf16 v[176:191], v[232:235], v[64:67], v[176:191]
  ds_read_b128 v[232:235], v1 offset:6144
  v_sub_f32 v73, v73, v6
  v_add_f32 v8, v8, v69
  v_exp_f32 v73, v73
  v_sub_f32 v74, v74, v6
  v_add_f32 v8, v8, v70
  v_sub_f32 v75, v75, v6
  v_exp_f32 v74, v74
  v_add_f32 v8, v8, v71
  v_exp_f32 v75, v75
  v_sub_f32 v76, v76, v6
  v_sub_f32 v77, v77, v6
  v_sub_f32 v78, v78, v6
  v_sub_f32 v79, v79, v6
  v_add_f32 v8, v8, v72
  v_exp_f32 v76, v76
  v_exp_f32 v77, v77
  v_exp_f32 v78, v78
  v_exp_f32 v79, v79
  v_add_f32 v8, v8, v73
  v_cvt_pk_bf16_f32 v72, v72, v73
  v_add_f32 v8, v8, v74
  v_cvt_pk_bf16_f32 v73, v74, v75
  v_add_f32 v8, v8, v75
  v_add_f32 v8, v8, v76
  v_cvt_pk_bf16_f32 v74, v76, v77
  v_cvt_pk_bf16_f32 v75, v78, v79
  v_sub_f32 v80, v80, v6
  v_add_f32 v8, v8, v77
  s_waitcnt lgkmcnt(7)
  v_mfma_f32_32x32x16_bf16 v[176:191], v[236:239], v[72:75], v[176:191]
  ds_read_b128 v[236:239], v1 offset:7168
  v_exp_f32 v80, v80
  v_sub_f32 v81, v81, v6
  v_add_f32 v8, v8, v78
  v_exp_f32 v81, v81
  v_sub_f32 v82, v82, v6
  v_sub_f32 v83, v83, v6
  v_add_f32 v8, v8, v79
  v_exp_f32 v82, v82
  v_exp_f32 v83, v83
  v_sub_f32 v84, v84, v6
  v_sub_f32 v85, v85, v6
  v_sub_f32 v86, v86, v6
  v_sub_f32 v87, v87, v6
  v_add_f32 v8, v8, v80
  v_exp_f32 v84, v84
  v_exp_f32 v85, v85
  v_exp_f32 v86, v86
  v_exp_f32 v87, v87
  v_add_f32 v8, v8, v81
  v_cvt_pk_bf16_f32 v80, v80, v81
  v_add_f32 v8, v8, v82
  v_cvt_pk_bf16_f32 v81, v82, v83
  v_add_f32 v8, v8, v83
  v_sub_f32 v88, v88, v6
  v_add_f32 v8, v8, v84
  v_cvt_pk_bf16_f32 v82, v84, v85
  v_cvt_pk_bf16_f32 v83, v86, v87
  v_exp_f32 v88, v88
  s_waitcnt lgkmcnt(7)
  v_mfma_f32_32x32x16_bf16 v[176:191], v[208:211], v[80:83], v[176:191]
  v_sub_f32 v89, v89, v6
  v_add_f32 v8, v8, v85
  v_exp_f32 v89, v89
  v_sub_f32 v90, v90, v6
  v_add_f32 v8, v8, v86
  v_sub_f32 v91, v91, v6
  v_exp_f32 v90, v90
  v_add_f32 v8, v8, v87
  v_exp_f32 v91, v91
  v_sub_f32 v92, v92, v6
  v_sub_f32 v93, v93, v6
  v_sub_f32 v94, v94, v6
  v_sub_f32 v95, v95, v6
  v_add_f32 v8, v8, v88
  v_exp_f32 v92, v92
  v_exp_f32 v93, v93
  v_exp_f32 v94, v94
  v_exp_f32 v95, v95
  v_add_f32 v8, v8, v89
  v_cvt_pk_bf16_f32 v88, v88, v89
  v_add_f32 v8, v8, v90
  v_cvt_pk_bf16_f32 v89, v90, v91
  v_add_f32 v8, v8, v91
  v_add_f32 v8, v8, v92
  v_cvt_pk_bf16_f32 v90, v92, v93
  v_cvt_pk_bf16_f32 v91, v94, v95
  v_sub_f32 v96, v96, v6
  v_add_f32 v8, v8, v93
  s_waitcnt lgkmcnt(6)
  v_mfma_f32_32x32x16_bf16 v[176:191], v[212:215], v[88:91], v[176:191]
  v_exp_f32 v96, v96
  v_sub_f32 v97, v97, v6
  v_add_f32 v8, v8, v94
  v_exp_f32 v97, v97
  v_sub_f32 v98, v98, v6
  v_sub_f32 v99, v99, v6
  v_add_f32 v8, v8, v95
  v_exp_f32 v98, v98
  v_exp_f32 v99, v99
  v_sub_f32 v100, v100, v6
  v_sub_f32 v101, v101, v6
  v_sub_f32 v102, v102, v6
  v_sub_f32 v103, v103, v6
  v_add_f32 v8, v8, v96
  v_exp_f32 v100, v100
  v_exp_f32 v101, v101
  v_exp_f32 v102, v102
  v_exp_f32 v103, v103
  v_add_f32 v8, v8, v97
  v_cvt_pk_bf16_f32 v96, v96, v97
  v_add_f32 v8, v8, v98
  v_cvt_pk_bf16_f32 v97, v98, v99
  v_add_f32 v8, v8, v99
  v_sub_f32 v104, v104, v6
  v_add_f32 v8, v8, v100
  v_cvt_pk_bf16_f32 v98, v100, v101
  v_cvt_pk_bf16_f32 v99, v102, v103
  v_exp_f32 v104, v104
  s_waitcnt lgkmcnt(5)
  v_mfma_f32_32x32x16_bf16 v[176:191], v[216:219], v[96:99], v[176:191]
  v_sub_f32 v105, v105, v6
  v_add_f32 v8, v8, v101
  v_exp_f32 v105, v105
  v_sub_f32 v106, v106, v6
  v_add_f32 v8, v8, v102
  v_sub_f32 v107, v107, v6
  v_exp_f32 v106, v106
  v_add_f32 v8, v8, v103
  v_exp_f32 v107, v107
  v_sub_f32 v108, v108, v6
  v_sub_f32 v109, v109, v6
  v_sub_f32 v110, v110, v6
  v_sub_f32 v111, v111, v6
  v_add_f32 v8, v8, v104
  v_exp_f32 v108, v108
  v_exp_f32 v109, v109
  v_exp_f32 v110, v110
  v_exp_f32 v111, v111
  v_add_f32 v8, v8, v105
  v_cvt_pk_bf16_f32 v104, v104, v105
  v_add_f32 v8, v8, v106
  v_cvt_pk_bf16_f32 v105, v106, v107
  v_add_f32 v8, v8, v107
  v_add_f32 v8, v8, v108
  v_cvt_pk_bf16_f32 v106, v108, v109
  v_cvt_pk_bf16_f32 v107, v110, v111
  v_sub_f32 v112, v112, v6
  v_add_f32 v8, v8, v109
  s_waitcnt lgkmcnt(4)
  v_mfma_f32_32x32x16_bf16 v[176:191], v[220:223], v[104:107], v[176:191]
  v_exp_f32 v112, v112
  v_sub_f32 v113, v113, v6
  v_add_f32 v8, v8, v110
  v_exp_f32 v113, v113
  v_sub_f32 v114, v114, v6
  v_sub_f32 v115, v115, v6
  v_add_f32 v8, v8, v111
  v_exp_f32 v114, v114
  v_exp_f32 v115, v115
  v_sub_f32 v116, v116, v6
  v_sub_f32 v117, v117, v6
  v_sub_f32 v118, v118, v6
  v_sub_f32 v119, v119, v6
  v_add_f32 v8, v8, v112
  v_exp_f32 v116, v116
  v_exp_f32 v117, v117
  v_exp_f32 v118, v118
  v_exp_f32 v119, v119
  v_add_f32 v8, v8, v113
  v_cvt_pk_bf16_f32 v112, v112, v113
  v_add_f32 v8, v8, v114
  v_cvt_pk_bf16_f32 v113, v114, v115
  v_add_f32 v8, v8, v115
  v_sub_f32 v120, v120, v6
  v_add_f32 v8, v8, v116
  v_cvt_pk_bf16_f32 v114, v116, v117
  v_cvt_pk_bf16_f32 v115, v118, v119
  v_exp_f32 v120, v120
  s_waitcnt lgkmcnt(3)
  v_mfma_f32_32x32x16_bf16 v[176:191], v[224:227], v[112:115], v[176:191]
  v_sub_f32 v121, v121, v6
  v_add_f32 v8, v8, v117
  v_exp_f32 v121, v121
  v_sub_f32 v122, v122, v6
  v_add_f32 v8, v8, v118
  v_sub_f32 v123, v123, v6
  v_exp_f32 v122, v122
  v_add_f32 v8, v8, v119
  v_exp_f32 v123, v123
  v_sub_f32 v124, v124, v6
  v_sub_f32 v125, v125, v6
  v_sub_f32 v126, v126, v6
  v_sub_f32 v127, v127, v6
  v_add_f32 v8, v8, v120
  v_exp_f32 v124, v124
  v_exp_f32 v125, v125
  v_exp_f32 v126, v126
  v_exp_f32 v127, v127
  v_add_f32 v8, v8, v121
  v_cvt_pk_bf16_f32 v120, v120, v121
  v_add_f32 v8, v8, v122
  v_cvt_pk_bf16_f32 v121, v122, v123
  v_add_f32 v8, v8, v123
  v_add_f32 v8, v8, v124
  v_cvt_pk_bf16_f32 v122, v124, v125
  v_cvt_pk_bf16_f32 v123, v126, v127
  v_sub_f32 v128, v128, v6
  v_add_f32 v8, v8, v125
  s_waitcnt lgkmcnt(2)
  v_mfma_f32_32x32x16_bf16 v[176:191], v[228:231], v[120:123], v[176:191]
  v_exp_f32 v128, v128
  v_sub_f32 v129, v129, v6
  v_add_f32 v8, v8, v126
  v_exp_f32 v129, v129
  v_sub_f32 v130, v130, v6
  v_sub_f32 v131, v131, v6
  v_add_f32 v8, v8, v127
  v_exp_f32 v130, v130
  v_exp_f32 v131, v131
  v_sub_f32 v132, v132, v6
  v_sub_f32 v133, v133, v6
  v_sub_f32 v134, v134, v6
  v_sub_f32 v135, v135, v6
  v_add_f32 v8, v8, v128
  v_exp_f32 v132, v132
  v_exp_f32 v133, v133
  v_exp_f32 v134, v134
  v_exp_f32 v135, v135
  v_add_f32 v8, v8, v129
  v_cvt_pk_bf16_f32 v128, v128, v129
  v_add_f32 v8, v8, v130
  v_cvt_pk_bf16_f32 v129, v130, v131
  v_add_f32 v8, v8, v131
  v_sub_f32 v136, v136, v6
  v_add_f32 v8, v8, v132
  v_cvt_pk_bf16_f32 v130, v132, v133
  v_cvt_pk_bf16_f32 v131, v134, v135
  v_exp_f32 v136, v136
  s_waitcnt lgkmcnt(1)
  v_mfma_f32_32x32x16_bf16 v[176:191], v[232:235], v[128:131], v[176:191]
  v_sub_f32 v137, v137, v6
  v_add_f32 v8, v8, v133
  v_exp_f32 v137, v137
  v_sub_f32 v138, v138, v6
  v_add_f32 v8, v8, v134
  v_sub_f32 v139, v139, v6
  v_exp_f32 v138, v138
  v_add_f32 v8, v8, v135
  v_exp_f32 v139, v139
  v_sub_f32 v140, v140, v6
  v_sub_f32 v141, v141, v6
  v_sub_f32 v142, v142, v6
  v_sub_f32 v143, v143, v6
  v_add_f32 v8, v8, v136
  v_exp_f32 v140, v140
  v_exp_f32 v141, v141
  v_exp_f32 v142, v142
  v_exp_f32 v143, v143
  v_add_f32 v8, v8, v137
  v_cvt_pk_bf16_f32 v136, v136, v137
  v_add_f32 v8, v8, v138
  v_cvt_pk_bf16_f32 v137, v138, v139
  v_add_f32 v8, v8, v139
  v_cvt_pk_bf16_f32 v138, v140, v141
  v_cvt_pk_bf16_f32 v139, v142, v143
  v_add_f32 v8, v8, v140
  v_add_f32 v7, v7, v156
  s_waitcnt lgkmcnt(0)
  v_mfma_f32_32x32x16_bf16 v[176:191], v[236:239], v[136:139], v[176:191]
  v_add_f32 v8, v8, v141
  v_add_f32 v7, v7, v157
  v_add_f32 v8, v8, v142
  v_add_f32 v7, v7, v158
  v_add_f32 v8, v8, v143
  v_add_f32 v7, v7, v159
  s_cmp_eq_u32 s5, 0
  s_nop 3
  s_cbranch_scc1 K1_SFIN
  ds_read_b128 v[208:211], v2 offset:0
  ds_read_b128 v[212:215], v2 offset:1024
  ds_read_b128 v[216:219], v2 offset:8192
  ds_read_b128 v[220:223], v2 offset:9216
  ds_read_b128 v[224:227], v2 offset:16384
  ds_read_b128 v[228:231], v2 offset:17408
  ds_read_b128 v[232:235], v2 offset:24576
  ds_read_b128 v[236:239], v2 offset:25600
  v_mov_b32 v156, 0xf149f2ca
  v_sub_f32 v240, v156, v240
  v_sub_f32 v241, v156, v241
  v_sub_f32 v242, v156, v242
  v_sub_f32 v243, v156, v243
  v_sub_f32 v244, v156, v244
  v_sub_f32 v245, v156, v245
  v_sub_f32 v246, v156, v246
  v_sub_f32 v247, v156, v247
  v_sub_f32 v248, v156, v248
  v_sub_f32 v249, v156, v249
  v_sub_f32 v250, v156, v250
  v_sub_f32 v251, v156, v251
  v_sub_f32 v252, v156, v252
  v_sub_f32 v253, v156, v253
  v_sub_f32 v254, v156, v254
  v_sub_f32 v255, v156, v255
  s_waitcnt lgkmcnt(7)
  s_nop 0
  v_mfma_f32_32x32x16_bf16 v[16:31], v[208:211], v[192:195], v[240:255]
  ds_read_b128 v[208:211], v2 offset:28672
  s_waitcnt lgkmcnt(7)
  v_mfma_f32_32x32x16_bf16 v[16:31], v[212:215], v[196:199], v[16:31]
  ds_read_b128 v[212:215], v2 offset:29696
  s_waitcnt lgkmcnt(7)
  v_mfma_f32_32x32x16_bf16 v[32:47], v[216:219], v[192:195], 0
  ds_read_b128 v[216:219], v2 offset:20480
  s_waitcnt lgkmcnt(7)
  v_mfma_f32_32x32x16_bf16 v[32:47], v[220:223], v[196:199], v[32:47]
  ds_read_b128 v[220:223], v2 offset:21504
  s_nop 4
  v_max3_f32 v9, v16, v17, v5
  v_max3_f32 v9, v18, v19, v9
  v_max3_f32 v9, v20, v21, v9
  v_max3_f32 v9, v22, v23, v9
  s_waitcnt lgkmcnt(7)
  v_mfma_f32_32x32x16_bf16 v[48:63], v[224:227], v[192:195], 0
  ds_read_b128 v[224:227], v2 offset:12288
  v_max3_f32 v9, v24, v25, v9
  v_max3_f32 v9, v26, v27, v9
  v_max3_f32 v9, v28, v29, v9
  v_max3_f32 v9, v30, v31, v9
  s_waitcnt lgkmcnt(7)
  v_mfma_f32_32x32x16_bf16 v[48:63], v[228:231], v[196:199], v[48:63]
  ds_read_b128 v[228:231], v2 offset:13312
  v_max3_f32 v9, v32, v33, v9
  v_max3_f32 v9, v34, v35, v9
  v_max3_f32 v9, v36, v37, v9
  v_max3_f32 v9, v38, v39, v9
  s_waitcnt lgkmcnt(7)
  v_mfma_f32_32x32x16_bf16 v[64:79], v[232:235], v[192:195], 0
  ds_read_b128 v[232:235], v2 offset:4096
  v_max3_f32 v9, v40, v41, v9
  v_max3_f32 v9, v42, v43, v9
  v_max3_f32 v9, v44, v45, v9
  v_max3_f32 v9, v46, v47, v9
  s_waitcnt lgkmcnt(7)
  v_mfma_f32_32x32x16_bf16 v[64:79], v[236:239], v[196:199], v[64:79]
  ds_read_b128 v[236:239], v2 offset:5120
  v_max3_f32 v9, v48, v49, v9
  v_max3_f32 v9, v50, v51, v9
  v_max3_f32 v9, v52, v53, v9
  v_max3_f32 v9, v54, v55, v9
  s_waitcnt lgkmcnt(7)
  v_mfma_f32_32x32x16_bf16 v[80:95], v[208:211], v[192:195], 0
  ds_read_b128 v[208:211], v2 offset:2048
  v_max3_f32 v9, v56, v57, v9
  v_max3_f32 v9, v58, v59, v9
  v_max3_f32 v9, v60, v61, v9
  v_max3_f32 v9, v62, v63, v9
  s_waitcnt lgkmcnt(7)
  v_mfma_f32_32x32x16_bf16 v[80:95], v[212:215], v[196:199], v[80:95]
  ds_read_b128 v[212:215], v2 offset:3072
  v_max3_f32 v9, v64, v65, v9
  v_max3_f32 v9, v66, v67, v9
  v_max3_f32 v9, v68, v69, v9
  v_max3_f32 v9, v70, v71, v9
  s_waitcnt lgkmcnt(7)
  v_mfma_f32_32x32x16_bf16 v[96:111], v[216:219], v[192:195], 0
  ds_read_b128 v[216:219], v2 offset:10240
  v_max3_f32 v9, v72, v73, v9
  v_max3_f32 v9, v74, v75, v9
  v_max3_f32 v9, v76, v77, v9
  v_max3_f32 v9, v78, v79, v9
  s_waitcnt lgkmcnt(7)
  v_mfma_f32_32x32x16_bf16 v[96:111], v[220:223], v[196:199], v[96:111]
  ds_read_b128 v[220:223], v2 offset:11264
  v_max3_f32 v9, v80, v81, v9
  v_max3_f32 v9, v82, v83, v9
  v_max3_f32 v9, v84, v85, v9
  v_max3_f32 v9, v86, v87, v9
  s_waitcnt lgkmcnt(7)
  v_mfma_f32_32x32x16_bf16 v[112:127], v[224:227], v[192:195], 0
  ds_read_b128 v[224:227], v2 offset:18432
  v_max3_f32 v9, v88, v89, v9
  v_max3_f32 v9, v90, v91, v9
  v_max3_f32 v9, v92, v93, v9
  v_max3_f32 v9, v94, v95, v9
  s_waitcnt lgkmcnt(7)
  v_mfma_f32_32x32x16_bf16 v[112:127], v[228:231], v[196:199], v[112:127]
  ds_read_b128 v[228:231], v2 offset:19456
  v_max3_f32 v9, v96, v97, v9
  v_max3_f32 v9, v98, v99, v9
  v_max3_f32 v9, v100, v101, v9
  v_max3_f32 v9, v102, v103, v9
  s_waitcnt lgkmcnt(7)
  v_mfma_f32_32x32x16_bf16 v[128:143], v[232:235], v[192:195], 0
  v_max3_f32 v9, v104, v105, v9
  v_max3_f32 v9, v106, v107, v9
  v_max3_f32 v9, v108, v109, v9
  v_max3_f32 v9, v110, v111, v9
  s_waitcnt lgkmcnt(6)
  v_mfma_f32_32x32x16_bf16 v[128:143], v[236:239], v[196:199], v[128:143]
  v_max3_f32 v9, v112, v113, v9
  v_max3_f32 v9, v114, v115, v9
  v_max3_f32 v9, v116, v117, v9
  v_max3_f32 v9, v118, v119, v9
  v_max3_f32 v9, v120, v121, v9
  v_mfma_f32_32x32x16_bf16 v[144:159], v[232:235], v[200:203], v[240:255]
  ds_read_b128 v[232:235], v2 offset:26624
  v_max3_f32 v9, v122, v123, v9
  v_max3_f32 v9, v124, v125, v9
  v_max3_f32 v9, v126, v127, v9
  v_mfma_f32_32x32x16_bf16 v[144:159], v[236:239], v[204:207], v[144:159]
  ds_read_b128 v[236:239], v2 offset:27648
  v_max3_f32 v9, v128, v129, v9
  v_max3_f32 v9, v130, v131, v9
  v_max3_f32 v9, v132, v133, v9
  v_max3_f32 v9, v134, v135, v9
  v_max3_f32 v9, v136, v137, v9
  v_max3_f32 v9, v138, v139, v9
  v_max3_f32 v9, v140, v141, v9
  v_max3_f32 v9, v142, v143, v9
  v_mov_b32 v10, v9
  s_nop 1
  v_permlane32_swap_b32 v9, v10
  v_max_f32 v9, v9, v10
  v_sub_f32 v10, v5, v9
  v_mov_b32 v5, v9
  v_exp_f32 v10, v10
  v_sub_f32 v16, v16, v5
  v_exp_f32 v16, v16
  v_sub_f32 v17, v17, v5
  v_exp_f32 v17, v17
  v_sub_f32 v18, v18, v5
  v_sub_f32 v19, v19, v5
  v_mul_f32 v7, v7, v10
  v_exp_f32 v18, v18
  v_exp_f32 v19, v19
  v_sub_f32 v20, v20, v5
  v_sub_f32 v21, v21, v5
  v_sub_f32 v22, v22, v5
  v_sub_f32 v23, v23, v5
  v_add_f32 v7, v7, v16
  v_exp_f32 v20, v20
  v_exp_f32 v21, v21
  v_exp_f32 v22, v22
  v_exp_f32 v23, v23
  v_add_f32 v7, v7, v17
  v_cvt_pk_bf16_f32 v16, v16, v17
  v_add_f32 v7, v7, v18
  v_cvt_pk_bf16_f32 v17, v18, v19
  v_add_f32 v7, v7, v19
  v_mul_f32 v160, v160, v10
  v_mul_f32 v161, v161, v10
  v_mul_f32 v162, v162, v10
  v_mul_f32 v163, v163, v10
  v_mul_f32 v164, v164, v10
  v_mul_f32 v165, v165, v10
  v_mul_f32 v166, v166, v10
  v_mul_f32 v167, v167, v10
  v_mul_f32 v168, v168, v10
  v_mul_f32 v169, v169, v10
  v_mul_f32 v170, v170, v10
  v_mul_f32 v171, v171, v10
  v_mul_f32 v172, v172, v10
  v_mul_f32 v173, v173, v10
  v_mul_f32 v174, v174, v10
  v_mul_f32 v175, v175, v10
  v_sub_f32 v24, v24, v5
  v_add_f32 v7, v7, v20
  v_cvt_pk_bf16_f32 v18, v20, v21
  v_cvt_pk_bf16_f32 v19, v22, v23
  v_exp_f32 v24, v24
  s_waitcnt lgkmcnt(7)
  v_mfma_f32_32x32x16_bf16 v[160:175], v[208:211], v[16:19], v[160:175]
  ds_read_b128 v[208:211], v2 offset:30720
  v_sub_f32 v25, v25, v5
  v_add_f32 v7, v7, v21
  v_exp_f32 v25, v25
  v_sub_f32 v26, v26, v5
  v_add_f32 v7, v7, v22
  v_sub_f32 v27, v27, v5
  v_exp_f32 v26, v26
  v_add_f32 v7, v7, v23
  v_exp_f32 v27, v27
  v_sub_f32 v28, v28, v5
  v_sub_f32 v29, v29, v5
  v_sub_f32 v30, v30, v5
  v_sub_f32 v31, v31, v5
  v_add_f32 v7, v7, v24
  v_exp_f32 v28, v28
  v_exp_f32 v29, v29
  v_exp_f32 v30, v30
  v_exp_f32 v31, v31
  v_add_f32 v7, v7, v25
  v_cvt_pk_bf16_f32 v24, v24, v25
  v_add_f32 v7, v7, v26
  v_cvt_pk_bf16_f32 v25, v26, v27
  v_add_f32 v7, v7, v27
  v_add_f32 v7, v7, v28
  v_cvt_pk_bf16_f32 v26, v28, v29
  v_cvt_pk_bf16_f32 v27, v30, v31
  v_sub_f32 v32, v32, v5
  v_add_f32 v7, v7, v29
  s_waitcnt lgkmcnt(7)
  v_mfma_f32_32x32x16_bf16 v[160:175], v[212:215], v[24:27], v[160:175]
  ds_read_b128 v[212:215], v2 offset:31744
  v_exp_f32 v32, v32
  v_sub_f32 v33, v33, v5
  v_add_f32 v7, v7, v30
  v_exp_f32 v33, v33
  v_sub_f32 v34, v34, v5
  v_sub_f32 v35, v35, v5
  v_add_f32 v7, v7, v31
  v_exp_f32 v34, v34
  v_exp_f32 v35, v35
  v_sub_f32 v36, v36, v5
  v_sub_f32 v37, v37, v5
  v_sub_f32 v38, v38, v5
  v_sub_f32 v39, v39, v5
  v_add_f32 v7, v7, v32
  v_exp_f32 v36, v36
  v_exp_f32 v37, v37
  v_exp_f32 v38, v38
  v_exp_f32 v39, v39
  v_add_f32 v7, v7, v33
  v_cvt_pk_bf16_f32 v32, v32, v33
  v_add_f32 v7, v7, v34
  v_cvt_pk_bf16_f32 v33, v34, v35
  v_add_f32 v7, v7, v35
  v_sub_f32 v40, v40, v5
  v_add_f32 v7, v7, v36
  v_cvt_pk_bf16_f32 v34, v36, v37
  v_cvt_pk_bf16_f32 v35, v38, v39
  v_exp_f32 v40, v40
  s_waitcnt lgkmcnt(7)
  v_mfma_f32_32x32x16_bf16 v[160:175], v[216:219], v[32:35], v[160:175]
  ds_read_b128 v[216:219], v2 offset:22528
  v_sub_f32 v41, v41, v5
  v_add_f32 v7, v7, v37
  v_exp_f32 v41, v41
  v_sub_f32 v42, v42, v5
  v_add_f32 v7, v7, v38
  v_sub_f32 v43, v43, v5
  v_exp_f32 v42, v42
  v_add_f32 v7, v7, v39
  v_exp_f32 v43, v43
  v_sub_f32 v44, v44, v5
  v_sub_f32 v45, v45, v5
  v_sub_f32 v46, v46, v5
  v_sub_f32 v47, v47, v5
  v_add_f32 v7, v7, v40
  v_exp_f32 v44, v44
  v_exp_f32 v45, v45
  v_exp_f32 v46, v46
  v_exp_f32 v47, v47
  v_add_f32 v7, v7, v41
  v_cvt_pk_bf16_f32 v40, v40, v41
  v_add_f32 v7, v7, v42
  v_cvt_pk_bf16_f32 v41, v42, v43
  v_add_f32 v7, v7, v43
  v_add_f32 v7, v7, v44
  v_cvt_pk_bf16_f32 v42, v44, v45
  v_cvt_pk_bf16_f32 v43, v46, v47
  v_sub_f32 v48, v48, v5
  v_add_f32 v7, v7, v45
  s_waitcnt lgkmcnt(7)
  v_mfma_f32_32x32x16_bf16 v[160:175], v[220:223], v[40:43], v[160:175]
  ds_read_b128 v[220:223], v2 offset:23552
  v_exp_f32 v48, v48
  v_sub_f32 v49, v49, v5
  v_add_f32 v7, v7, v46
  v_exp_f32 v49, v49
  v_sub_f32 v50, v50, v5
  v_sub_f32 v51, v51, v5
  v_add_f32 v7, v7, v47
  v_exp_f32 v50, v50
  v_exp_f32 v51, v51
  v_sub_f32 v52, v52, v5
  v_sub_f32 v53, v53, v5
  v_sub_f32 v54, v54, v5
  v_sub_f32 v55, v55, v5
  v_add_f32 v7, v7, v48
  v_exp_f32 v52, v52
  v_exp_f32 v53, v53
  v_exp_f32 v54, v54
  v_exp_f32 v55, v55
  v_add_f32 v7, v7, v49
  v_cvt_pk_bf16_f32 v48, v48, v49
  v_add_f32 v7, v7, v50
  v_cvt_pk_bf16_f32 v49, v50, v51
  v_add_f32 v7, v7, v51
  v_sub_f32 v56, v56, v5
  v_add_f32 v7, v7, v52
  v_cvt_pk_bf16_f32 v50, v52, v53
  v_cvt_pk_bf16_f32 v51, v54, v55
  v_exp_f32 v56, v56
  s_waitcnt lgkmcnt(7)
  v_mfma_f32_32x32x16_bf16 v[160:175], v[224:227], v[48:51], v[160:175]
  ds_read_b128 v[224:227], v2 offset:14336
  v_sub_f32 v57, v57, v5
  v_add_f32 v7, v7, v53
  v_exp_f32 v57, v57
  v_sub_f32 v58, v58, v5
  v_add_f32 v7, v7, v54
  v_sub_f32 v59, v59, v5
  v_exp_f32 v58, v58
  v_add_f32 v7, v7, v55
  v_exp_f32 v59, v59
  v_sub_f32 v60, v60, v5
  v_sub_f32 v61, v61, v5
  v_sub_f32 v62, v62, v5
  v_sub_f32 v63, v63, v5
  v_add_f32 v7, v7, v56
  v_exp_f32 v60, v60
  v_exp_f32 v61, v61
  v_exp_f32 v62, v62
  v_exp_f32 v63, v63
  v_add_f32 v7, v7, v57
  v_cvt_pk_bf16_f32 v56, v56, v57
  v_add_f32 v7, v7, v58
  v_cvt_pk_bf16_f32 v57, v58, v59
  v_add_f32 v7, v7, v59
  v_add_f32 v7, v7, v60
  v_cvt_pk_bf16_f32 v58, v60, v61
  v_cvt_pk_bf16_f32 v59, v62, v63
  v_sub_f32 v64, v64, v5
  v_add_f32 v7, v7, v61
  s_waitcnt lgkmcnt(7)
  v_mfma_f32_32x32x16_bf16 v[160:175], v[228:231], v[56:59], v[160:175]
  ds_read_b128 v[228:231], v2 offset:15360
  v_exp_f32 v64, v64
  v_sub_f32 v65, v65, v5
  v_add_f32 v7, v7, v62
  v_exp_f32 v65, v65
  v_sub_f32 v66, v66, v5
  v_sub_f32 v67, v67, v5
  v_add_f32 v7, v7, v63
  v_exp_f32 v66, v66
  v_exp_f32 v67, v67
  v_sub_f32 v68, v68, v5
  v_sub_f32 v69, v69, v5
  v_sub_f32 v70, v70, v5
  v_sub_f32 v71, v71, v5
  v_add_f32 v7, v7, v64
  v_exp_f32 v68, v68
  v_exp_f32 v69, v69
  v_exp_f32 v70, v70
  v_exp_f32 v71, v71
  v_add_f32 v7, v7, v65
  v_cvt_pk_bf16_f32 v64, v64, v65
  v_add_f32 v7, v7, v66
  v_cvt_pk_bf16_f32 v65, v66, v67
  v_add_f32 v7, v7, v67
  v_sub_f32 v72, v72, v5
  v_add_f32 v7, v7, v68
  v_cvt_pk_bf16_f32 v66, v68, v69
  v_cvt_pk_bf16_f32 v67, v70, v71
  v_exp_f32 v72, v72
  s_waitcnt lgkmcnt(7)
  v_mfma_f32_32x32x16_bf16 v[160:175], v[232:235], v[64:67], v[160:175]
  ds_read_b128 v[232:235], v2 offset:6144
  v_sub_f32 v73, v73, v5
  v_add_f32 v7, v7, v69
  v_exp_f32 v73, v73
  v_sub_f32 v74, v74, v5
  v_add_f32 v7, v7, v70
  v_sub_f32 v75, v75, v5
  v_exp_f32 v74, v74
  v_add_f32 v7, v7, v71
  v_exp_f32 v75, v75
  v_sub_f32 v76, v76, v5
  v_sub_f32 v77, v77, v5
  v_sub_f32 v78, v78, v5
  v_sub_f32 v79, v79, v5
  v_add_f32 v7, v7, v72
  v_exp_f32 v76, v76
  v_exp_f32 v77, v77
  v_exp_f32 v78, v78
  v_exp_f32 v79, v79
  v_add_f32 v7, v7, v73
  v_cvt_pk_bf16_f32 v72, v72, v73
  v_add_f32 v7, v7, v74
  v_cvt_pk_bf16_f32 v73, v74, v75
  v_add_f32 v7, v7, v75
  v_add_f32 v7, v7, v76
  v_cvt_pk_bf16_f32 v74, v76, v77
  v_cvt_pk_bf16_f32 v75, v78, v79
  v_sub_f32 v80, v80, v5
  v_add_f32 v7, v7, v77
  s_waitcnt lgkmcnt(7)
  v_mfma_f32_32x32x16_bf16 v[160:175], v[236:239], v[72:75], v[160:175]
  ds_read_b128 v[236:239], v2 offset:7168
  v_exp_f32 v80, v80
  v_sub_f32 v81, v81, v5
  v_add_f32 v7, v7, v78
  v_exp_f32 v81, v81
  v_sub_f32 v82, v82, v5
  v_sub_f32 v83, v83, v5
  v_add_f32 v7, v7, v79
  v_exp_f32 v82, v82
  v_exp_f32 v83, v83
  v_sub_f32 v84, v84, v5
  v_sub_f32 v85, v85, v5
  v_sub_f32 v86, v86, v5
  v_sub_f32 v87, v87, v5
  v_add_f32 v7, v7, v80
  v_exp_f32 v84, v84
  v_exp_f32 v85, v85
  v_exp_f32 v86, v86
  v_exp_f32 v87, v87
  v_add_f32 v7, v7, v81
  v_cvt_pk_bf16_f32 v80, v80, v81
  v_add_f32 v7, v7, v82
  v_cvt_pk_bf16_f32 v81, v82, v83
  v_add_f32 v7, v7, v83
  v_sub_f32 v88, v88, v5
  v_add_f32 v7, v7, v84
  v_cvt_pk_bf16_f32 v82, v84, v85
  v_cvt_pk_bf16_f32 v83, v86, v87
  v_exp_f32 v88, v88
  s_waitcnt lgkmcnt(7)
  v_mfma_f32_32x32x16_bf16 v[160:175], v[208:211], v[80:83], v[160:175]
  v_sub_f32 v89, v89, v5
  v_add_f32 v7, v7, v85
  v_exp_f32 v89, v89
  v_sub_f32 v90, v90, v5
  v_add_f32 v7, v7, v86
  v_sub_f32 v91, v91, v5
  v_exp_f32 v90, v90
  v_add_f32 v7, v7, v87
  v_exp_f32 v91, v91
  v_sub_f32 v92, v92, v5
  v_sub_f32 v93, v93, v5
  v_sub_f32 v94, v94, v5
  v_sub_f32 v95, v95, v5
  v_add_f32 v7, v7, v88
  v_exp_f32 v92, v92
  v_exp_f32 v93, v93
  v_exp_f32 v94, v94
  v_exp_f32 v95, v95
  v_add_f32 v7, v7, v89
  v_cvt_pk_bf16_f32 v88, v88, v89
  v_add_f32 v7, v7, v90
  v_cvt_pk_bf16_f32 v89, v90, v91
  v_add_f32 v7, v7, v91
  v_add_f32 v7, v7, v92
  v_cvt_pk_bf16_f32 v90, v92, v93
  v_cvt_pk_bf16_f32 v91, v94, v95
  v_sub_f32 v96, v96, v5
  v_add_f32 v7, v7, v93
  s_waitcnt lgkmcnt(6)
  v_mfma_f32_32x32x16_bf16 v[160:175], v[212:215], v[88:91], v[160:175]
  v_exp_f32 v96, v96
  v_sub_f32 v97, v97, v5
  v_add_f32 v7, v7, v94
  v_exp_f32 v97, v97
  v_sub_f32 v98, v98, v5
  v_sub_f32 v99, v99, v5
  v_add_f32 v7, v7, v95
  v_exp_f32 v98, v98
  v_exp_f32 v99, v99
  v_sub_f32 v100, v100, v5
  v_sub_f32 v101, v101, v5
  v_sub_f32 v102, v102, v5
  v_sub_f32 v103, v103, v5
  v_add_f32 v7, v7, v96
  v_exp_f32 v100, v100
  v_exp_f32 v101, v101
  v_exp_f32 v102, v102
  v_exp_f32 v103, v103
  v_add_f32 v7, v7, v97
  v_cvt_pk_bf16_f32 v96, v96, v97
  v_add_f32 v7, v7, v98
  v_cvt_pk_bf16_f32 v97, v98, v99
  v_add_f32 v7, v7, v99
  v_sub_f32 v104, v104, v5
  v_add_f32 v7, v7, v100
  v_cvt_pk_bf16_f32 v98, v100, v101
  v_cvt_pk_bf16_f32 v99, v102, v103
  v_exp_f32 v104, v104
  s_waitcnt lgkmcnt(5)
  v_mfma_f32_32x32x16_bf16 v[160:175], v[216:219], v[96:99], v[160:175]
  v_sub_f32 v105, v105, v5
  v_add_f32 v7, v7, v101
  v_exp_f32 v105, v105
  v_sub_f32 v106, v106, v5
  v_add_f32 v7, v7, v102
  v_sub_f32 v107, v107, v5
  v_exp_f32 v106, v106
  v_add_f32 v7, v7, v103
  v_exp_f32 v107, v107
  v_sub_f32 v108, v108, v5
  v_sub_f32 v109, v109, v5
  v_sub_f32 v110, v110, v5
  v_sub_f32 v111, v111, v5
  v_add_f32 v7, v7, v104
  v_exp_f32 v108, v108
  v_exp_f32 v109, v109
  v_exp_f32 v110, v110
  v_exp_f32 v111, v111
  v_add_f32 v7, v7, v105
  v_cvt_pk_bf16_f32 v104, v104, v105
  v_add_f32 v7, v7, v106
  v_cvt_pk_bf16_f32 v105, v106, v107
  v_add_f32 v7, v7, v107
  v_max3_f32 v11, v144, v145, v6
  v_add_f32 v7, v7, v108
  v_cvt_pk_bf16_f32 v106, v108, v109
  v_cvt_pk_bf16_f32 v107, v110, v111
  v_sub_f32 v112, v112, v5
  v_max3_f32 v11, v146, v147, v11
  s_waitcnt lgkmcnt(4)
  v_mfma_f32_32x32x16_bf16 v[160:175], v[220:223], v[104:107], v[160:175]
  v_add_f32 v7, v7, v109
  v_exp_f32 v112, v112
  v_sub_f32 v113, v113, v5
  v_max3_f32 v11, v148, v149, v11
  v_add_f32 v7, v7, v110
  v_exp_f32 v113, v113
  v_sub_f32 v114, v114, v5
  v_sub_f32 v115, v115, v5
  v_max3_f32 v11, v150, v151, v11
  v_add_f32 v7, v7, v111
  v_exp_f32 v114, v114
  v_exp_f32 v115, v115
  v_sub_f32 v116, v116, v5
  v_sub_f32 v117, v117, v5
  v_sub_f32 v118, v118, v5
  v_sub_f32 v119, v119, v5
  v_add_f32 v7, v7, v112
  v_max3_f32 v11, v152, v153, v11
  v_exp_f32 v116, v116
  v_exp_f32 v117, v117
  v_exp_f32 v118, v118
  v_exp_f32 v119, v119
  v_add_f32 v7, v7, v113
  v_max3_f32 v11, v154, v155, v11
  v_cvt_pk_bf16_f32 v112, v112, v113
  v_add_f32 v7, v7, v114
  v_max3_f32 v11, v156, v157, v11
  v_cvt_pk_bf16_f32 v113, v114, v115
  v_add_f32 v7, v7, v115
  v_max3_f32 v11, v158, v159, v11
  v_sub_f32 v120, v120, v5
  v_add_f32 v7, v7, v116
  v_cvt_pk_bf16_f32 v114, v116, v117
  v_cvt_pk_bf16_f32 v115, v118, v119
  v_exp_f32 v120, v120
  s_waitcnt lgkmcnt(3)
  v_mfma_f32_32x32x16_bf16 v[160:175], v[224:227], v[112:115], v[160:175]
  v_sub_f32 v121, v121, v5
  v_add_f32 v7, v7, v117
  v_mov_b32 v12, v11
  v_exp_f32 v121, v121
  v_sub_f32 v122, v122, v5
  v_add_f32 v7, v7, v118
  v_sub_f32 v123, v123, v5
  v_exp_f32 v122, v122
  v_add_f32 v7, v7, v119
  v_exp_f32 v123, v123
  v_sub_f32 v124, v124, v5
  v_sub_f32 v125, v125, v5
  v_sub_f32 v126, v126, v5
  v_sub_f32 v127, v127, v5
  v_add_f32 v7, v7, v120
  v_permlane32_swap_b32 v11, v12
  v_exp_f32 v124, v124
  v_exp_f32 v125, v125
  v_exp_f32 v126, v126
  v_exp_f32 v127, v127
  v_add_f32 v7, v7, v121
  v_max_f32 v11, v11, v12
  v_cvt_pk_bf16_f32 v120, v120, v121
  v_add_f32 v7, v7, v122
  v_sub_f32 v12, v6, v11
  v_cvt_pk_bf16_f32 v121, v122, v123
  v_add_f32 v7, v7, v123
  v_mov_b32 v6, v11
  v_add_f32 v7, v7, v124
  v_cvt_pk_bf16_f32 v122, v124, v125
  v_cvt_pk_bf16_f32 v123, v126, v127
  v_sub_f32 v128, v128, v5
  v_exp_f32 v12, v12
  s_waitcnt lgkmcnt(2)
  v_mfma_f32_32x32x16_bf16 v[160:175], v[228:231], v[120:123], v[160:175]
  v_sub_f32 v144, v144, v6
  v_add_f32 v7, v7, v125
  v_exp_f32 v128, v128
  v_sub_f32 v129, v129, v5
  v_exp_f32 v144, v144
  v_sub_f32 v145, v145, v6
  v_add_f32 v7, v7, v126
  v_exp_f32 v129, v129
  v_sub_f32 v130, v130, v5
  v_exp_f32 v145, v145
  v_sub_f32 v146, v146, v6
  v_sub_f32 v131, v131, v5
  v_sub_f32 v147, v147, v6
  v_add_f32 v7, v7, v127
  v_exp_f32 v130, v130
  v_mul_f32 v8, v8, v12
  v_exp_f32 v146, v146
  v_exp_f32 v131, v131
  v_exp_f32 v147, v147
  v_sub_f32 v132, v132, v5
  v_sub_f32 v133, v133, v5
  v_sub_f32 v134, v134, v5
  v_sub_f32 v135, v135, v5
  v_add_f32 v7, v7, v128
  v_sub_f32 v148, v148, v6
  v_sub_f32 v149, v149, v6
  v_sub_f32 v150, v150, v6
  v_sub_f32 v151, v151, v6
  v_add_f32 v8, v8, v144
  v_exp_f32 v132, v132
  v_exp_f32 v133, v133
  v_exp_f32 v134, v134
  v_exp_f32 v135, v135
  v_add_f32 v7, v7, v129
  v_exp_f32 v148, v148
  v_exp_f32 v149, v149
  v_exp_f32 v150, v150
  v_exp_f32 v151, v151
  v_add_f32 v8, v8, v145
  v_cvt_pk_bf16_f32 v128, v128, v129
  v_cvt_pk_bf16_f32 v144, v144, v145
  v_add_f32 v7, v7, v130
  v_add_f32 v8, v8, v146
  v_cvt_pk_bf16_f32 v129, v130, v131
  v_cvt_pk_bf16_f32 v145, v146, v147
  v_add_f32 v7, v7, v131
  v_add_f32 v8, v8, v147
  v_sub_f32 v136, v136, v5
  v_add_f32 v7, v7, v132
  v_cvt_pk_bf16_f32 v130, v132, v133
  v_cvt_pk_bf16_f32 v131, v134, v135
  v_mul_f32 v176, v176, v12
  v_mul_f32 v177, v177, v12
  s_waitcnt lgkmcnt(1)
  v_mfma_f32_32x32x16_bf16 v[160:175], v[232:235], v[128:131], v[160:175]
  v_mul_f32 v178, v178, v12
  v_mul_f32 v179, v179, v12
  v_mul_f32 v180, v180, v12
  v_mul_f32 v181, v181, v12
  v_mul_f32 v182, v182, v12
  v_mul_f32 v183, v183, v12
  v_mul_f32 v184, v184, v12
  v_mul_f32 v185, v185, v12
  v_mul_f32 v186, v186, v12
  v_mul_f32 v187, v187, v12
  v_mul_f32 v188, v188, v12
  v_mul_f32 v189, v189, v12
  v_mul_f32 v190, v190, v12
  v_mul_f32 v191, v191, v12
  v_sub_f32 v152, v152, v6
  v_add_f32 v8, v8, v148
  v_cvt_pk_bf16_f32 v146, v148, v149
  v_cvt_pk_bf16_f32 v147, v150, v151
  v_exp_f32 v136, v136
  s_nop 0
  v_mfma_f32_32x32x16_bf16 v[176:191], v[232:235], v[144:147], v[176:191]
  v_sub_f32 v137, v137, v5
  v_add_f32 v7, v7, v133
  v_exp_f32 v152, v152
  v_sub_f32 v153, v153, v6
  v_add_f32 v8, v8, v149
  v_exp_f32 v137, v137
  v_sub_f32 v138, v138, v5
  v_add_f32 v7, v7, v134
  v_exp_f32 v153, v153
  v_sub_f32 v154, v154, v6
  v_add_f32 v8, v8, v150
  v_sub_f32 v139, v139, v5
  v_sub_f32 v155, v155, v6
  v_exp_f32 v138, v138
  v_add_f32 v7, v7, v135
  v_exp_f32 v154, v154
  v_add_f32 v8, v8, v151
  v_exp_f32 v139, v139
  v_exp_f32 v155, v155
  v_sub_f32 v140, v140, v5
  v_sub_f32 v141, v141, v5
  v_sub_f32 v142, v142, v5
  v_sub_f32 v143, v143, v5
  v_add_f32 v7, v7, v136
  v_sub_f32 v156, v156, v6
  v_sub_f32 v157, v157, v6
  v_sub_f32 v158, v158, v6
  v_sub_f32 v159, v159, v6
  v_add_f32 v8, v8, v152
  v_exp_f32 v140, v140
  v_exp_f32 v141, v141
  v_exp_f32 v142, v142
  v_exp_f32 v143, v143
  v_add_f32 v7, v7, v137
  v_exp_f32 v156, v156
  v_exp_f32 v157, v157
  v_exp_f32 v158, v158
  v_exp_f32 v159, v159
  v_add_f32 v8, v8, v153
  v_cvt_pk_bf16_f32 v136, v136, v137
  v_cvt_pk_bf16_f32 v152, v152, v153
  v_add_f32 v7, v7, v138
  v_add_f32 v8, v8, v154
  v_cvt_pk_bf16_f32 v137, v138, v139
  v_cvt_pk_bf16_f32 v153, v154, v155
  v_add_f32 v7, v7, v139
  v_add_f32 v8, v8, v155
  v_cvt_pk_bf16_f32 v138, v140, v141
  v_cvt_pk_bf16_f32 v139, v142, v143
  v_cvt_pk_bf16_f32 v154, v156, v157
  v_cvt_pk_bf16_f32 v155, v158, v159
  s_waitcnt lgkmcnt(0)
  v_mfma_f32_32x32x16_bf16 v[160:175], v[236:239], v[136:139], v[160:175]
  v_add_f32 v7, v7, v140
  v_add_f32 v8, v8, v156
  v_add_f32 v7, v7, v141
  v_add_f32 v8, v8, v157
  v_add_f32 v7, v7, v142
  v_add_f32 v8, v8, v158
  v_mfma_f32_32x32x16_bf16 v[176:191], v[236:239], v[152:155], v[176:191]
  v_add_f32 v7, v7, v143
  v_add_f32 v8, v8, v159
  s_nop 8
  s_branch K1_SFIN
K1_S1_1:
  ds_read_b128 v[208:211], v1 offset:0
  ds_read_b128 v[212:215], v1 offset:1024
  ds_read_b128 v[216:219], v1 offset:8192
  ds_read_b128 v[220:223], v1 offset:9216
  ds_read_b128 v[224:227], v1 offset:16384
  ds_read_b128 v[228:231], v1 offset:17408
  ds_read_b128 v[232:235], v1 offset:24576
  ds_read_b128 v[236:239], v1 offset:25600
  v_lshrrev_b32 v155, 5, v0
  v_and_b32 v154, 31, v0
  v_lshlrev_b32 v155, 2, v155
  v_sub_u32 v154, v154, v155
  v_mov_b32 v155, 0
  v_mov_b32 v156, 0xf149f2ca
  v_cmp_le_i32 s[80:81], 0, v154
  v_cmp_le_i32 s[82:83], 1, v154
  v_cmp_le_i32 s[84:85], 2, v154
  v_cmp_le_i32 s[86:87], 3, v154
  v_cndmask_b32 v240, v156, v155, s[80:81]
  v_cndmask_b32 v241, v156, v155, s[82:83]
  v_cndmask_b32 v242, v156, v155, s[84:85]
  v_cndmask_b32 v243, v156, v155, s[86:87]
  v_cmp_le_i32 s[80:81], 8, v154
  v_cmp_le_i32 s[82:83], 9, v154
  v_cmp_le_i32 s[84:85], 10, v154
  v_cmp_le_i32 s[86:87], 11, v154
  v_cndmask_b32 v244, v156, v155, s[80:81]
  v_cndmask_b32 v245, v156, v155, s[82:83]
  v_cndmask_b32 v246, v156, v155, s[84:85]
  v_cndmask_b32 v247, v156, v155, s[86:87]
  v_cmp_le_i32 s[80:81], 16, v154
  v_cmp_le_i32 s[82:83], 17, v154
  v_cmp_le_i32 s[84:85], 18, v154
  v_cmp_le_i32 s[86:87], 19, v154
  v_cndmask_b32 v248, v156, v155, s[80:81]
  v_cndmask_b32 v249, v156, v155, s[82:83]
  v_cndmask_b32 v250, v156, v155, s[84:85]
  v_cndmask_b32 v251, v156, v155, s[86:87]
  v_cmp_le_i32 s[80:81], 24, v154
  v_cmp_le_i32 s[82:83], 25, v154
  s_waitcnt lgkmcnt(7)
  v_mfma_f32_32x32x16_bf16 v[16:31], v[208:211], v[200:203], 0
  v_cmp_le_i32 s[84:85], 26, v154
  v_cmp_le_i32 s[86:87], 27, v154
  v_cndmask_b32 v252, v156, v155, s[80:81]
  v_cndmask_b32 v253, v156, v155, s[82:83]
  v_cndmask_b32 v254, v156, v155, s[84:85]
  v_cndmask_b32 v255, v156, v155, s[86:87]
  v_mfma_f32_32x32x16_bf16 v[128:143], v[208:211], v[192:195], 0
  ds_read_b128 v[208:211], v1 offset:28672
  s_waitcnt lgkmcnt(7)
  v_mfma_f32_32x32x16_bf16 v[16:31], v[212:215], v[204:207], v[16:31]
  v_mfma_f32_32x32x16_bf16 v[128:143], v[212:215], v[196:199], v[128:143]
  ds_read_b128 v[212:215], v1 offset:29696
  s_waitcnt lgkmcnt(7)
  v_mfma_f32_32x32x16_bf16 v[32:47], v[216:219], v[200:203], 0
  s_nop 7
  v_max_f32 v11, v16, v17
  v_max3_f32 v11, v18, v19, v11
  v_max3_f32 v11, v20, v21, v11
  v_max3_f32 v11, v22, v23, v11
  v_max3_f32 v11, v24, v25, v11
  v_mfma_f32_32x32x16_bf16 v[144:159], v[216:219], v[192:195], v[240:255]
  ds_read_b128 v[216:219], v1 offset:20480
  v_max3_f32 v11, v26, v27, v11
  v_max3_f32 v11, v28, v29, v11
  v_max3_f32 v11, v30, v31, v11
  v_max_f32 v9, v128, v129
  v_max3_f32 v9, v130, v131, v9
  s_waitcnt lgkmcnt(7)
  v_mfma_f32_32x32x16_bf16 v[32:47], v[220:223], v[204:207], v[32:47]
  v_max3_f32 v9, v132, v133, v9
  v_max3_f32 v9, v134, v135, v9
  v_max3_f32 v9, v136, v137, v9
  v_max3_f32 v9, v138, v139, v9
  v_max3_f32 v9, v140, v141, v9
  v_mfma_f32_32x32x16_bf16 v[144:159], v[220:223], v[196:199], v[144:159]
  ds_read_b128 v[220:223], v1 offset:21504
  v_max3_f32 v9, v142, v143, v9
  s_waitcnt lgkmcnt(7)
  v_mfma_f32_32x32x16_bf16 v[48:63], v[224:227], v[200:203], 0
  ds_read_b128 v[224:227], v1 offset:12288
  s_nop 0
  v_max3_f32 v11, v32, v33, v11
  v_max3_f32 v11, v34, v35, v11
  v_max3_f32 v11, v36, v37, v11
  v_max3_f32 v11, v38, v39, v11
  s_waitcnt lgkmcnt(7)
  v_mfma_f32_32x32x16_bf16 v[48:63], v[228:231], v[204:207], v[48:63]
  ds_read_b128 v[228:231], v1 offset:13312
  v_max3_f32 v11, v40, v41, v11
  v_max3_f32 v11, v42, v43, v11
  v_max3_f32 v11, v44, v45, v11
  v_max3_f32 v11, v46, v47, v11
  s_waitcnt lgkmcnt(7)
  v_mfma_f32_32x32x16_bf16 v[64:79], v[232:235], v[200:203], 0
  ds_read_b128 v[232:235], v1 offset:2048
  v_max3_f32 v9, v144, v145, v9
  v_max3_f32 v9, v146, v147, v9
  v_max3_f32 v9, v148, v149, v9
  v_max3_f32 v9, v150, v151, v9
  s_waitcnt lgkmcnt(7)
  v_mfma_f32_32x32x16_bf16 v[64:79], v[236:239], v[204:207], v[64:79]
  ds_read_b128 v[236:239], v1 offset:3072
  v_max3_f32 v11, v48, v49, v11
  v_max3_f32 v11, v50, v51, v11
  v_max3_f32 v11, v52, v53, v11
  v_max3_f32 v11, v54, v55, v11
  s_waitcnt lgkmcnt(7)
  v_mfma_f32_32x32x16_bf16 v[80:95], v[208:211], v[200:203], 0
  ds_read_b128 v[208:211], v1 offset:10240
  v_max3_f32 v11, v56, v57, v11
  v_max3_f32 v11, v58, v59, v11
  v_max3_f32 v11, v60, v61, v11
  v_max3_f32 v11, v62, v63, v11
  s_waitcnt lgkmcnt(7)
  v_mfma_f32_32x32x16_bf16 v[80:95], v[212:215], v[204:207], v[80:95]
  ds_read_b128 v[212:215], v1 offset:11264
  v_max3_f32 v11, v64, v65, v11
  v_max3_f32 v11, v66, v67, v11
  v_max3_f32 v11, v68, v69, v11
  v_max3_f32 v11, v70, v71, v11
  s_waitcnt lgkmcnt(7)
  v_mfma_f32_32x32x16_bf16 v[96:111], v[216:219], v[200:203], 0
  ds_read_b128 v[216:219], v1 offset:18432
  v_max3_f32 v11, v72, v73, v11
  v_max3_f32 v11, v74, v75, v11
  v_max3_f32 v11, v76, v77, v11
  v_max3_f32 v11, v78, v79, v11
  s_waitcnt lgkmcnt(7)
  v_mfma_f32_32x32x16_bf16 v[96:111], v[220:223], v[204:207], v[96:111]
  ds_read_b128 v[220:223], v1 offset:19456
  v_max3_f32 v11, v80, v81, v11
  v_max3_f32 v11, v82, v83, v11
  v_max3_f32 v11, v84, v85, v11
  v_max3_f32 v11, v86, v87, v11
  s_waitcnt lgkmcnt(7)
  v_mfma_f32_32x32x16_bf16 v[112:127], v[224:227], v[200:203], v[240:255]
  ds_read_b128 v[224:227], v1 offset:26624
  v_max3_f32 v11, v88, v89, v11
  v_max3_f32 v11, v90, v91, v11
  v_max3_f32 v11, v92, v93, v11
  v_max3_f32 v11, v94, v95, v11
  s_waitcnt lgkmcnt(7)
  v_mfma_f32_32x32x16_bf16 v[112:127], v[228:231], v[204:207], v[112:127]
  ds_read_b128 v[228:231], v1 offset:27648
  v_max3_f32 v11, v96, v97, v11
  v_max3_f32 v11, v98, v99, v11
  v_max3_f32 v11, v100, v101, v11
  v_max3_f32 v11, v102, v103, v11
  v_max3_f32 v11, v104, v105, v11
  v_max3_f32 v11, v106, v107, v11
  v_max3_f32 v11, v108, v109, v11
  v_max3_f32 v11, v110, v111, v11
  v_max3_f32 v9, v152, v153, v9
  v_max3_f32 v9, v154, v155, v9
  v_max3_f32 v9, v156, v157, v9
  v_max3_f32 v9, v158, v159, v9
  v_max3_f32 v11, v112, v113, v11
  v_max3_f32 v11, v114, v115, v11
  v_max3_f32 v11, v116, v117, v11
  v_max3_f32 v11, v118, v119, v11
  v_max3_f32 v11, v120, v121, v11
  v_max3_f32 v11, v122, v123, v11
  v_max3_f32 v11, v124, v125, v11
  v_max3_f32 v11, v126, v127, v11
  v_mov_b32 v12, v11
  v_mov_b32 v10, v9
  s_nop 0
  v_permlane32_swap_b32 v11, v12
  v_max_f32 v6, v11, v12
  v_sub_f32 v16, v16, v6
  v_sub_f32 v17, v17, v6
  v_exp_f32 v16, v16
  v_exp_f32 v17, v17
  v_sub_f32 v18, v18, v6
  v_sub_f32 v19, v19, v6
  v_exp_f32 v18, v18
  v_exp_f32 v19, v19
  v_sub_f32 v20, v20, v6
  v_sub_f32 v21, v21, v6
  v_sub_f32 v22, v22, v6
  v_sub_f32 v23, v23, v6
  v_add_f32 v8, v16, v17
  v_exp_f32 v20, v20
  v_exp_f32 v21, v21
  v_exp_f32 v22, v22
  v_exp_f32 v23, v23
  v_cvt_pk_bf16_f32 v16, v16, v17
  v_add_f32 v8, v8, v18
  v_cvt_pk_bf16_f32 v17, v18, v19
  v_add_f32 v8, v8, v19
  v_sub_f32 v24, v24, v6
  v_add_f32 v8, v8, v20
  v_cvt_pk_bf16_f32 v18, v20, v21
  v_cvt_pk_bf16_f32 v19, v22, v23
  v_exp_f32 v24, v24
  s_waitcnt lgkmcnt(7)
  v_mfma_f32_32x32x16_bf16 v[176:191], v[232:235], v[16:19], 0
  v_sub_f32 v25, v25, v6
  v_add_f32 v8, v8, v21
  v_exp_f32 v25, v25
  v_sub_f32 v26, v26, v6
  v_add_f32 v8, v8, v22
  v_sub_f32 v27, v27, v6
  v_exp_f32 v26, v26
  v_add_f32 v8, v8, v23
  v_exp_f32 v27, v27
  v_sub_f32 v28, v28, v6
  v_sub_f32 v29, v29, v6
  v_sub_f32 v30, v30, v6
  v_sub_f32 v31, v31, v6
  v_add_f32 v8, v8, v24
  v_exp_f32 v28, v28
  v_exp_f32 v29, v29
  v_exp_f32 v30, v30
  v_exp_f32 v31, v31
  v_add_f32 v8, v8, v25
  v_cvt_pk_bf16_f32 v24, v24, v25
  v_add_f32 v8, v8, v26
  v_cvt_pk_bf16_f32 v25, v26, v27
  v_add_f32 v8, v8, v27
  v_add_f32 v8, v8, v28
  v_cvt_pk_bf16_f32 v26, v28, v29
  v_cvt_pk_bf16_f32 v27, v30, v31
  v_sub_f32 v32, v32, v6
  v_add_f32 v8, v8, v29
  s_waitcnt lgkmcnt(6)
  v_mfma_f32_32x32x16_bf16 v[176:191], v[236:239], v[24:27], v[176:191]
  v_exp_f32 v32, v32
  v_sub_f32 v33, v33, v6
  v_add_f32 v8, v8, v30
  v_exp_f32 v33, v33
  v_sub_f32 v34, v34, v6
  v_sub_f32 v35, v35, v6
  v_add_f32 v8, v8, v31
  v_exp_f32 v34, v34
  v_exp_f32 v35, v35
  v_sub_f32 v36, v36, v6
  v_sub_f32 v37, v37, v6
  v_sub_f32 v38, v38, v6
  v_sub_f32 v39, v39, v6
  v_add_f32 v8, v8, v32
  v_permlane32_swap_b32 v9, v10
  v_exp_f32 v36, v36
  v_exp_f32 v37, v37
  v_exp_f32 v38, v38
  v_exp_f32 v39, v39
  v_add_f32 v8, v8, v33
  v_cvt_pk_bf16_f32 v32, v32, v33
  v_max_f32 v5, v9, v10
  v_add_f32 v8, v8, v34
  v_sub_f32 v128, v128, v5
  v_sub_f32 v129, v129, v5
  v_cvt_pk_bf16_f32 v33, v34, v35
  v_add_f32 v8, v8, v35
  v_exp_f32 v128, v128
  v_exp_f32 v129, v129
  v_sub_f32 v40, v40, v6
  v_add_f32 v8, v8, v36
  v_cvt_pk_bf16_f32 v34, v36, v37
  v_cvt_pk_bf16_f32 v35, v38, v39
  v_sub_f32 v130, v130, v5
  v_sub_f32 v131, v131, v5
  s_waitcnt lgkmcnt(5)
  v_mfma_f32_32x32x16_bf16 v[176:191], v[208:211], v[32:35], v[176:191]
  v_exp_f32 v40, v40
  v_sub_f32 v41, v41, v6
  v_add_f32 v8, v8, v37
  v_exp_f32 v130, v130
  v_exp_f32 v131, v131
  v_exp_f32 v41, v41
  v_sub_f32 v42, v42, v6
  v_add_f32 v8, v8, v38
  v_sub_f32 v132, v132, v5
  v_sub_f32 v133, v133, v5
  v_sub_f32 v134, v134, v5
  v_sub_f32 v135, v135, v5
  v_add_f32 v7, v128, v129
  v_sub_f32 v43, v43, v6
  v_exp_f32 v42, v42
  v_add_f32 v8, v8, v39
  v_exp_f32 v132, v132
  v_exp_f32 v133, v133
  v_exp_f32 v134, v134
  v_exp_f32 v135, v135
  v_cvt_pk_bf16_f32 v128, v128, v129
  v_exp_f32 v43, v43
  v_sub_f32 v44, v44, v6
  v_sub_f32 v45, v45, v6
  v_sub_f32 v46, v46, v6
  v_sub_f32 v47, v47, v6
  v_add_f32 v8, v8, v40
  v_add_f32 v7, v7, v130
  v_cvt_pk_bf16_f32 v129, v130, v131
  v_exp_f32 v44, v44
  v_exp_f32 v45, v45
  v_exp_f32 v46, v46
  v_exp_f32 v47, v47
  v_add_f32 v8, v8, v41
  v_add_f32 v7, v7, v131
  v_cvt_pk_bf16_f32 v40, v40, v41
  v_add_f32 v8, v8, v42
  v_sub_f32 v136, v136, v5
  v_add_f32 v7, v7, v132
  v_cvt_pk_bf16_f32 v130, v132, v133
  v_cvt_pk_bf16_f32 v131, v134, v135
  v_cvt_pk_bf16_f32 v41, v42, v43
  v_add_f32 v8, v8, v43
  v_mfma_f32_32x32x16_bf16 v[160:175], v[232:235], v[128:131], 0
  ds_read_b128 v[232:235], v1 offset:30720
  v_exp_f32 v136, v136
  v_sub_f32 v137, v137, v5
  v_add_f32 v7, v7, v133
  v_add_f32 v8, v8, v44
  v_cvt_pk_bf16_f32 v42, v44, v45
  v_cvt_pk_bf16_f32 v43, v46, v47
  v_sub_f32 v48, v48, v6
  v_exp_f32 v137, v137
  s_waitcnt lgkmcnt(5)
  v_mfma_f32_32x32x16_bf16 v[176:191], v[212:215], v[40:43], v[176:191]
  v_sub_f32 v138, v138, v5
  v_add_f32 v7, v7, v134
  v_sub_f32 v139, v139, v5
  v_add_f32 v8, v8, v45
  v_exp_f32 v48, v48
  v_sub_f32 v49, v49, v6
  v_exp_f32 v138, v138
  v_add_f32 v7, v7, v135
  v_exp_f32 v139, v139
  v_add_f32 v8, v8, v46
  v_exp_f32 v49, v49
  v_sub_f32 v50, v50, v6
  v_sub_f32 v140, v140, v5
  v_sub_f32 v141, v141, v5
  v_sub_f32 v142, v142, v5
  v_sub_f32 v143, v143, v5
  v_add_f32 v7, v7, v136
  v_sub_f32 v51, v51, v6
  v_add_f32 v8, v8, v47
  v_exp_f32 v50, v50
  v_exp_f32 v140, v140
  v_exp_f32 v141, v141
  v_exp_f32 v142, v142
  v_exp_f32 v143, v143
  v_add_f32 v7, v7, v137
  v_cvt_pk_bf16_f32 v136, v136, v137
  v_exp_f32 v51, v51
  v_sub_f32 v52, v52, v6
  v_sub_f32 v53, v53, v6
  v_sub_f32 v54, v54, v6
  v_sub_f32 v55, v55, v6
  v_add_f32 v8, v8, v48
  v_add_f32 v7, v7, v138
  v_cvt_pk_bf16_f32 v137, v138, v139
  v_exp_f32 v52, v52
  v_exp_f32 v53, v53
  v_exp_f32 v54, v54
  v_exp_f32 v55, v55
  v_add_f32 v8, v8, v49
  v_add_f32 v7, v7, v139
  v_cvt_pk_bf16_f32 v48, v48, v49
  v_add_f32 v8, v8, v50
  v_add_f32 v7, v7, v140
  v_cvt_pk_bf16_f32 v138, v140, v141
  v_cvt_pk_bf16_f32 v139, v142, v143
  v_sub_f32 v144, v144, v5
  v_cvt_pk_bf16_f32 v49, v50, v51
  v_mfma_f32_32x32x16_bf16 v[160:175], v[236:239], v[136:139], v[160:175]
  ds_read_b128 v[236:239], v1 offset:31744
  v_add_f32 v8, v8, v51
  v_add_f32 v7, v7, v141
  v_exp_f32 v144, v144
  v_sub_f32 v145, v145, v5
  v_sub_f32 v56, v56, v6
  v_add_f32 v8, v8, v52
  v_cvt_pk_bf16_f32 v50, v52, v53
  v_cvt_pk_bf16_f32 v51, v54, v55
  v_add_f32 v7, v7, v142
  v_exp_f32 v145, v145
  s_waitcnt lgkmcnt(5)
  v_mfma_f32_32x32x16_bf16 v[176:191], v[216:219], v[48:51], v[176:191]
  v_sub_f32 v146, v146, v5
  v_sub_f32 v147, v147, v5
  v_exp_f32 v56, v56
  v_sub_f32 v57, v57, v6
  v_add_f32 v8, v8, v53
  v_add_f32 v7, v7, v143
  v_exp_f32 v146, v146
  v_exp_f32 v147, v147
  v_exp_f32 v57, v57
  v_sub_f32 v58, v58, v6
  v_add_f32 v8, v8, v54
  v_sub_f32 v148, v148, v5
  v_sub_f32 v149, v149, v5
  v_sub_f32 v150, v150, v5
  v_sub_f32 v151, v151, v5
  v_add_f32 v7, v7, v144
  v_sub_f32 v59, v59, v6
  v_exp_f32 v58, v58
  v_add_f32 v8, v8, v55
  v_exp_f32 v148, v148
  v_exp_f32 v149, v149
  v_exp_f32 v150, v150
  v_exp_f32 v151, v151
  v_add_f32 v7, v7, v145
  v_cvt_pk_bf16_f32 v144, v144, v145
  v_exp_f32 v59, v59
  v_sub_f32 v60, v60, v6
  v_sub_f32 v61, v61, v6
  v_sub_f32 v62, v62, v6
  v_sub_f32 v63, v63, v6
  v_add_f32 v8, v8, v56
  v_add_f32 v7, v7, v146
  v_cvt_pk_bf16_f32 v145, v146, v147
  v_exp_f32 v60, v60
  v_exp_f32 v61, v61
  v_exp_f32 v62, v62
  v_exp_f32 v63, v63
  v_add_f32 v8, v8, v57
  v_add_f32 v7, v7, v147
  v_cvt_pk_bf16_f32 v56, v56, v57
  v_add_f32 v8, v8, v58
  v_sub_f32 v152, v152, v5
  v_add_f32 v7, v7, v148
  v_cvt_pk_bf16_f32 v146, v148, v149
  v_cvt_pk_bf16_f32 v147, v150, v151
  v_cvt_pk_bf16_f32 v57, v58, v59
  v_add_f32 v8, v8, v59
  v_mfma_f32_32x32x16_bf16 v[160:175], v[208:211], v[144:147], v[160:175]
  ds_read_b128 v[208:211], v1 offset:22528
  v_exp_f32 v152, v152
  v_sub_f32 v153, v153, v5
  v_add_f32 v7, v7, v149
  v_add_f32 v8, v8, v60
  v_cvt_pk_bf16_f32 v58, v60, v61
  v_cvt_pk_bf16_f32 v59, v62, v63
  v_sub_f32 v64, v64, v6
  v_exp_f32 v153, v153
  s_waitcnt lgkmcnt(5)
  v_mfma_f32_32x32x16_bf16 v[176:191], v[220:223], v[56:59], v[176:191]
  v_sub_f32 v154, v154, v5
  v_add_f32 v7, v7, v150
  v_sub_f32 v155, v155, v5
  v_add_f32 v8, v8, v61
  v_exp_f32 v64, v64
  v_sub_f32 v65, v65, v6
  v_exp_f32 v154, v154
  v_add_f32 v7, v7, v151
  v_exp_f32 v155, v155
  v_add_f32 v8, v8, v62
  v_exp_f32 v65, v65
  v_sub_f32 v66, v66, v6
  v_sub_f32 v156, v156, v5
  v_sub_f32 v157, v157, v5
  v_sub_f32 v158, v158, v5
  v_sub_f32 v159, v159, v5
  v_add_f32 v7, v7, v152
  v_sub_f32 v67, v67, v6
  v_add_f32 v8, v8, v63
  v_exp_f32 v66, v66
  v_exp_f32 v156, v156
  v_exp_f32 v157, v157
  v_exp_f32 v158, v158
  v_exp_f32 v159, v159
  v_add_f32 v7, v7, v153
  v_cvt_pk_bf16_f32 v152, v152, v153
  v_exp_f32 v67, v67
  v_sub_f32 v68, v68, v6
  v_sub_f32 v69, v69, v6
  v_sub_f32 v70, v70, v6
  v_sub_f32 v71, v71, v6
  v_add_f32 v8, v8, v64
  v_add_f32 v7, v7, v154
  v_cvt_pk_bf16_f32 v153, v154, v155
  v_exp_f32 v68, v68
  v_exp_f32 v69, v69
  v_exp_f32 v70, v70
  v_exp_f32 v71, v71
  v_add_f32 v8, v8, v65
  v_add_f32 v7, v7, v155
  v_cvt_pk_bf16_f32 v64, v64, v65
  v_add_f32 v8, v8, v66
  v_cvt_pk_bf16_f32 v154, v156, v157
  v_cvt_pk_bf16_f32 v155, v158, v159
  v_cvt_pk_bf16_f32 v65, v66, v67
  v_add_f32 v8, v8, v67
  v_mfma_f32_32x32x16_bf16 v[160:175], v[212:215], v[152:155], v[160:175]
  ds_read_b128 v[212:215], v1 offset:23552
  ds_read_b128 v[216:219], v1 offset:14336
  ds_read_b128 v[220:223], v1 offset:15360
  v_sub_f32 v72, v72, v6
  v_add_f32 v8, v8, v68
  v_cvt_pk_bf16_f32 v66, v68, v69
  v_cvt_pk_bf16_f32 v67, v70, v71
  v_exp_f32 v72, v72
  s_waitcnt lgkmcnt(7)
  v_mfma_f32_32x32x16_bf16 v[176:191], v[224:227], v[64:67], v[176:191]
  v_sub_f32 v73, v73, v6
  v_add_f32 v8, v8, v69
  v_exp_f32 v73, v73
  v_sub_f32 v74, v74, v6
  v_add_f32 v8, v8, v70
  v_sub_f32 v75, v75, v6
  v_exp_f32 v74, v74
  v_add_f32 v8, v8, v71
  v_exp_f32 v75, v75
  v_sub_f32 v76, v76, v6
  v_sub_f32 v77, v77, v6
  v_sub_f32 v78, v78, v6
  v_sub_f32 v79, v79, v6
  v_add_f32 v8, v8, v72
  v_exp_f32 v76, v76
  v_exp_f32 v77, v77
  v_exp_f32 v78, v78
  v_exp_f32 v79, v79
  v_add_f32 v8, v8, v73
  v_cvt_pk_bf16_f32 v72, v72, v73
  v_add_f32 v8, v8, v74
  v_cvt_pk_bf16_f32 v73, v74, v75
  v_add_f32 v8, v8, v75
  v_add_f32 v8, v8, v76
  v_cvt_pk_bf16_f32 v74, v76, v77
  v_cvt_pk_bf16_f32 v75, v78, v79
  v_sub_f32 v80, v80, v6
  v_add_f32 v8, v8, v77
  s_waitcnt lgkmcnt(6)
  v_mfma_f32_32x32x16_bf16 v[176:191], v[228:231], v[72:75], v[176:191]
  v_exp_f32 v80, v80
  v_sub_f32 v81, v81, v6
  v_add_f32 v8, v8, v78
  v_exp_f32 v81, v81
  v_sub_f32 v82, v82, v6
  v_sub_f32 v83, v83, v6
  v_add_f32 v8, v8, v79
  v_exp_f32 v82, v82
  v_exp_f32 v83, v83
  v_sub_f32 v84, v84, v6
  v_sub_f32 v85, v85, v6
  v_sub_f32 v86, v86, v6
  v_sub_f32 v87, v87, v6
  v_add_f32 v8, v8, v80
  v_exp_f32 v84, v84
  v_exp_f32 v85, v85
  v_exp_f32 v86, v86
  v_exp_f32 v87, v87
  v_add_f32 v8, v8, v81
  v_cvt_pk_bf16_f32 v80, v80, v81
  v_add_f32 v8, v8, v82
  v_cvt_pk_bf16_f32 v81, v82, v83
  v_add_f32 v8, v8, v83
  v_sub_f32 v88, v88, v6
  v_add_f32 v8, v8, v84
  v_cvt_pk_bf16_f32 v82, v84, v85
  v_cvt_pk_bf16_f32 v83, v86, v87
  v_exp_f32 v88, v88
  s_waitcnt lgkmcnt(5)
  v_mfma_f32_32x32x16_bf16 v[176:191], v[232:235], v[80:83], v[176:191]
  v_sub_f32 v89, v89, v6
  v_add_f32 v8, v8, v85
  v_exp_f32 v89, v89
  v_sub_f32 v90, v90, v6
  v_add_f32 v8, v8, v86
  v_sub_f32 v91, v91, v6
  v_exp_f32 v90, v90
  v_add_f32 v8, v8, v87
  v_exp_f32 v91, v91
  v_sub_f32 v92, v92, v6
  v_sub_f32 v93, v93, v6
  v_sub_f32 v94, v94, v6
  v_sub_f32 v95, v95, v6
  v_add_f32 v8, v8, v88
  v_exp_f32 v92, v92
  v_exp_f32 v93, v93
  v_exp_f32 v94, v94
  v_exp_f32 v95, v95
  v_add_f32 v8, v8, v89
  v_cvt_pk_bf16_f32 v88, v88, v89
  v_add_f32 v8, v8, v90
  v_cvt_pk_bf16_f32 v89, v90, v91
  v_add_f32 v8, v8, v91
  v_add_f32 v8, v8, v92
  v_cvt_pk_bf16_f32 v90, v92, v93
  v_cvt_pk_bf16_f32 v91, v94, v95
  v_sub_f32 v96, v96, v6
  v_add_f32 v8, v8, v93
  s_waitcnt lgkmcnt(4)
  v_mfma_f32_32x32x16_bf16 v[176:191], v[236:239], v[88:91], v[176:191]
  v_exp_f32 v96, v96
  v_sub_f32 v97, v97, v6
  v_add_f32 v8, v8, v94
  v_exp_f32 v97, v97
  v_sub_f32 v98, v98, v6
  v_sub_f32 v99, v99, v6
  v_add_f32 v8, v8, v95
  v_exp_f32 v98, v98
  v_exp_f32 v99, v99
  v_sub_f32 v100, v100, v6
  v_sub_f32 v101, v101, v6
  v_sub_f32 v102, v102, v6
  v_sub_f32 v103, v103, v6
  v_add_f32 v8, v8, v96
  v_exp_f32 v100, v100
  v_exp_f32 v101, v101
  v_exp_f32 v102, v102
  v_exp_f32 v103, v103
  v_add_f32 v8, v8, v97
  v_cvt_pk_bf16_f32 v96, v96, v97
  v_add_f32 v8, v8, v98
  v_cvt_pk_bf16_f32 v97, v98, v99
  v_add_f32 v8, v8, v99
  v_sub_f32 v104, v104, v6
  v_add_f32 v8, v8, v100
  v_cvt_pk_bf16_f32 v98, v100, v101
  v_cvt_pk_bf16_f32 v99, v102, v103
  v_exp_f32 v104, v104
  s_waitcnt lgkmcnt(3)
  v_mfma_f32_32x32x16_bf16 v[176:191], v[208:211], v[96:99], v[176:191]
  v_sub_f32 v105, v105, v6
  v_add_f32 v8, v8, v101
  v_exp_f32 v105, v105
  v_sub_f32 v106, v106, v6
  v_add_f32 v8, v8, v102
  v_sub_f32 v107, v107, v6
  v_exp_f32 v106, v106
  v_add_f32 v8, v8, v103
  v_exp_f32 v107, v107
  v_sub_f32 v108, v108, v6
  v_sub_f32 v109, v109, v6
  v_sub_f32 v110, v110, v6
  v_sub_f32 v111, v111, v6
  v_add_f32 v8, v8, v104
  v_exp_f32 v108, v108
  v_exp_f32 v109, v109
  v_exp_f32 v110, v110
  v_exp_f32 v111, v111
  v_add_f32 v8, v8, v105
  v_cvt_pk_bf16_f32 v104, v104, v105
  v_add_f32 v8, v8, v106
  v_cvt_pk_bf16_f32 v105, v106, v107
  v_add_f32 v8, v8, v107
  v_add_f32 v8, v8, v108
  v_cvt_pk_bf16_f32 v106, v108, v109
  v_cvt_pk_bf16_f32 v107, v110, v111
  v_sub_f32 v112, v112, v6
  v_add_f32 v8, v8, v109
  s_waitcnt lgkmcnt(2)
  v_mfma_f32_32x32x16_bf16 v[176:191], v[212:215], v[104:107], v[176:191]
  v_exp_f32 v112, v112
  v_sub_f32 v113, v113, v6
  v_add_f32 v8, v8, v110
  v_exp_f32 v113, v113
  v_sub_f32 v114, v114, v6
  v_sub_f32 v115, v115, v6
  v_add_f32 v8, v8, v111
  v_exp_f32 v114, v114
  v_exp_f32 v115, v115
  v_sub_f32 v116, v116, v6
  v_sub_f32 v117, v117, v6
  v_sub_f32 v118, v118, v6
  v_sub_f32 v119, v119, v6
  v_add_f32 v8, v8, v112
  v_exp_f32 v116, v116
  v_exp_f32 v117, v117
  v_exp_f32 v118, v118
  v_exp_f32 v119, v119
  v_add_f32 v8, v8, v113
  v_cvt_pk_bf16_f32 v112, v112, v113
  v_add_f32 v8, v8, v114
  v_cvt_pk_bf16_f32 v113, v114, v115
  v_add_f32 v8, v8, v115
  v_sub_f32 v120, v120, v6
  v_add_f32 v8, v8, v116
  v_cvt_pk_bf16_f32 v114, v116, v117
  v_cvt_pk_bf16_f32 v115, v118, v119
  v_exp_f32 v120, v120
  s_waitcnt lgkmcnt(1)
  v_mfma_f32_32x32x16_bf16 v[176:191], v[216:219], v[112:115], v[176:191]
  v_sub_f32 v121, v121, v6
  v_add_f32 v8, v8, v117
  v_exp_f32 v121, v121
  v_sub_f32 v122, v122, v6
  v_add_f32 v8, v8, v118
  v_sub_f32 v123, v123, v6
  v_exp_f32 v122, v122
  v_add_f32 v8, v8, v119
  v_exp_f32 v123, v123
  v_sub_f32 v124, v124, v6
  v_sub_f32 v125, v125, v6
  v_sub_f32 v126, v126, v6
  v_sub_f32 v127, v127, v6
  v_add_f32 v8, v8, v120
  v_exp_f32 v124, v124
  v_exp_f32 v125, v125
  v_exp_f32 v126, v126
  v_exp_f32 v127, v127
  v_add_f32 v8, v8, v121
  v_cvt_pk_bf16_f32 v120, v120, v121
  v_add_f32 v8, v8, v122
  v_cvt_pk_bf16_f32 v121, v122, v123
  v_add_f32 v8, v8, v123
  v_cvt_pk_bf16_f32 v122, v124, v125
  v_cvt_pk_bf16_f32 v123, v126, v127
  v_add_f32 v8, v8, v124
  v_add_f32 v7, v7, v156
  s_waitcnt lgkmcnt(0)
  v_mfma_f32_32x32x16_bf16 v[176:191], v[220:223], v[120:123], v[176:191]
  v_add_f32 v8, v8, v125
  v_add_f32 v7, v7, v157
  v_add_f32 v8, v8, v126
  v_add_f32 v7, v7, v158
  v_add_f32 v8, v8, v127
  v_add_f32 v7, v7, v159
  s_cmp_eq_u32 s5, 0
  s_nop 3
  s_cbranch_scc1 K1_SFIN
  ds_read_b128 v[208:211], v2 offset:8192
  ds_read_b128 v[212:215], v2 offset:9216
  ds_read_b128 v[216:219], v2 offset:16384
  ds_read_b128 v[220:223], v2 offset:17408
  ds_read_b128 v[224:227], v2 offset:24576
  ds_read_b128 v[228:231], v2 offset:25600
  ds_read_b128 v[232:235], v2 offset:28672
  ds_read_b128 v[236:239], v2 offset:29696
  v_mov_b32 v156, 0xf149f2ca
  v_sub_f32 v240, v156, v240
  v_sub_f32 v241, v156, v241
  v_sub_f32 v242, v156, v242
  v_sub_f32 v243, v156, v243
  v_sub_f32 v244, v156, v244
  v_sub_f32 v245, v156, v245
  v_sub_f32 v246, v156, v246
  v_sub_f32 v247, v156, v247
  v_sub_f32 v248, v156, v248
  v_sub_f32 v249, v156, v249
  v_sub_f32 v250, v156, v250
  v_sub_f32 v251, v156, v251
  v_sub_f32 v252, v156, v252
  v_sub_f32 v253, v156, v253
  v_sub_f32 v254, v156, v254
  v_sub_f32 v255, v156, v255
  s_waitcnt lgkmcnt(7)
  s_nop 0
  v_mfma_f32_32x32x16_bf16 v[16:31], v[208:211], v[192:195], v[240:255]
  ds_read_b128 v[208:211], v2 offset:20480
  s_waitcnt lgkmcnt(7)
  v_mfma_f32_32x32x16_bf16 v[16:31], v[212:215], v[196:199], v[16:31]
  ds_read_b128 v[212:215], v2 offset:21504
  s_waitcnt lgkmcnt(7)
  v_mfma_f32_32x32x16_bf16 v[32:47], v[216:219], v[192:195], 0
  ds_read_b128 v[216:219], v2 offset:12288
  s_waitcnt lgkmcnt(7)
  v_mfma_f32_32x32x16_bf16 v[32:47], v[220:223], v[196:199], v[32:47]
  ds_read_b128 v[220:223], v2 offset:13312
  s_nop 4
  v_max3_f32 v9, v16, v17, v5
  v_max3_f32 v9, v18, v19, v9
  v_max3_f32 v9, v20, v21, v9
  v_max3_f32 v9, v22, v23, v9
  s_waitcnt lgkmcnt(7)
  v_mfma_f32_32x32x16_bf16 v[48:63], v[224:227], v[192:195], 0
  ds_read_b128 v[224:227], v2 offset:4096
  v_max3_f32 v9, v24, v25, v9
  v_max3_f32 v9, v26, v27, v9
  v_max3_f32 v9, v28, v29, v9
  v_max3_f32 v9, v30, v31, v9
  s_waitcnt lgkmcnt(7)
  v_mfma_f32_32x32x16_bf16 v[48:63], v[228:231], v[196:199], v[48:63]
  ds_read_b128 v[228:231], v2 offset:5120
  v_max3_f32 v9, v32, v33, v9
  v_max3_f32 v9, v34, v35, v9
  v_max3_f32 v9, v36, v37, v9
  v_max3_f32 v9, v38, v39, v9
  s_waitcnt lgkmcnt(7)
  v_mfma_f32_32x32x16_bf16 v[64:79], v[232:235], v[192:195], 0
  ds_read_b128 v[232:235], v2 offset:10240
  v_max3_f32 v9, v40, v41, v9
  v_max3_f32 v9, v42, v43, v9
  v_max3_f32 v9, v44, v45, v9
  v_max3_f32 v9, v46, v47, v9
  s_waitcnt lgkmcnt(7)
  v_mfma_f32_32x32x16_bf16 v[64:79], v[236:239], v[196:199], v[64:79]
  ds_read_b128 v[236:239], v2 offset:11264
  v_max3_f32 v9, v48, v49, v9
  v_max3_f32 v9, v50, v51, v9
  v_max3_f32 v9, v52, v53, v9
  v_max3_f32 v9, v54, v55, v9
  s_waitcnt lgkmcnt(7)
  v_mfma_f32_32x32x16_bf16 v[80:95], v[208:211], v[192:195], 0
  ds_read_b128 v[208:211], v2 offset:18432
  v_max3_f32 v9, v56, v57, v9
  v_max3_f32 v9, v58, v59, v9
  v_max3_f32 v9, v60, v61, v9
  v_max3_f32 v9, v62, v63, v9
  s_waitcnt lgkmcnt(7)
  v_mfma_f32_32x32x16_bf16 v[80:95], v[212:215], v[196:199], v[80:95]
  ds_read_b128 v[212:215], v2 offset:19456
  v_max3_f32 v9, v64, v65, v9
  v_max3_f32 v9, v66, v67, v9
  v_max3_f32 v9, v68, v69, v9
  v_max3_f32 v9, v70, v71, v9
  s_waitcnt lgkmcnt(7)
  v_mfma_f32_32x32x16_bf16 v[96:111], v[216:219], v[192:195], 0
  v_max3_f32 v9, v72, v73, v9
  v_max3_f32 v9, v74, v75, v9
  v_max3_f32 v9, v76, v77, v9
  v_max3_f32 v9, v78, v79, v9
  s_waitcnt lgkmcnt(6)
  v_mfma_f32_32x32x16_bf16 v[96:111], v[220:223], v[196:199], v[96:111]
  v_max3_f32 v9, v80, v81, v9
  v_max3_f32 v9, v82, v83, v9
  v_max3_f32 v9, v84, v85, v9
  v_max3_f32 v9, v86, v87, v9
  v_max3_f32 v9, v88, v89, v9
  s_waitcnt lgkmcnt(5)
  v_mfma_f32_32x32x16_bf16 v[112:127], v[224:227], v[192:195], 0
  v_max3_f32 v9, v90, v91, v9
  v_max3_f32 v9, v92, v93, v9
  v_max3_f32 v9, v94, v95, v9
  s_waitcnt lgkmcnt(4)
  v_mfma_f32_32x32x16_bf16 v[112:127], v[228:231], v[196:199], v[112:127]
  v_max3_f32 v9, v96, v97, v9
  v_max3_f32 v9, v98, v99, v9
  v_max3_f32 v9, v100, v101, v9
  v_max3_f32 v9, v102, v103, v9
  v_max3_f32 v9, v104, v105, v9
  v_mfma_f32_32x32x16_bf16 v[128:143], v[216:219], v[200:203], v[240:255]
  ds_read_b128 v[216:219], v2 offset:26624
  v_max3_f32 v9, v106, v107, v9
  v_max3_f32 v9, v108, v109, v9
  v_max3_f32 v9, v110, v111, v9
  v_mfma_f32_32x32x16_bf16 v[128:143], v[220:223], v[204:207], v[128:143]
  ds_read_b128 v[220:223], v2 offset:27648
  v_max3_f32 v9, v112, v113, v9
  v_max3_f32 v9, v114, v115, v9
  v_max3_f32 v9, v116, v117, v9
  v_max3_f32 v9, v118, v119, v9
  v_mfma_f32_32x32x16_bf16 v[144:159], v[224:227], v[200:203], 0
  ds_read_b128 v[224:227], v2 offset:30720
  v_max3_f32 v9, v120, v121, v9
  v_max3_f32 v9, v122, v123, v9
  v_max3_f32 v9, v124, v125, v9
  v_max3_f32 v9, v126, v127, v9
  v_mfma_f32_32x32x16_bf16 v[144:159], v[228:231], v[204:207], v[144:159]
  ds_read_b128 v[228:231], v2 offset:31744
  v_mov_b32 v10, v9
  v_max3_f32 v11, v128, v129, v6
  v_max3_f32 v11, v130, v131, v11
  v_permlane32_swap_b32 v9, v10
  v_max_f32 v9, v9, v10
  v_sub_f32 v10, v5, v9
  v_mov_b32 v5, v9
  v_exp_f32 v10, v10
  v_sub_f32 v16, v16, v5
  v_exp_f32 v16, v16
  v_sub_f32 v17, v17, v5
  v_exp_f32 v17, v17
  v_sub_f32 v18, v18, v5
  v_sub_f32 v19, v19, v5
  v_mul_f32 v7, v7, v10
  v_exp_f32 v18, v18
  v_exp_f32 v19, v19
  v_sub_f32 v20, v20, v5
  v_sub_f32 v21, v21, v5
  v_sub_f32 v22, v22, v5
  v_sub_f32 v23, v23, v5
  v_add_f32 v7, v7, v16
  v_exp_f32 v20, v20
  v_exp_f32 v21, v21
  v_exp_f32 v22, v22
  v_exp_f32 v23, v23
  v_add_f32 v7, v7, v17
  v_cvt_pk_bf16_f32 v16, v16, v17
  v_add_f32 v7, v7, v18
  v_cvt_pk_bf16_f32 v17, v18, v19
  v_add_f32 v7, v7, v19
  v_mul_f32 v160, v160, v10
  v_mul_f32 v161, v161, v10
  v_mul_f32 v162, v162, v10
  v_mul_f32 v163, v163, v10
  v_mul_f32 v164, v164, v10
  v_mul_f32 v165, v165, v10
  v_mul_f32 v166, v166, v10
  v_mul_f32 v167, v167, v10
  v_mul_f32 v168, v168, v10
  v_mul_f32 v169, v169, v10
  v_mul_f32 v170, v170, v10
  v_mul_f32 v171, v171, v10
  v_mul_f32 v172, v172, v10
  v_mul_f32 v173, v173, v10
  v_mul_f32 v174, v174, v10
  v_mul_f32 v175, v175, v10
  v_sub_f32 v24, v24, v5
  v_add_f32 v7, v7, v20
  v_cvt_pk_bf16_f32 v18, v20, v21
  v_cvt_pk_bf16_f32 v19, v22, v23
  v_exp_f32 v24, v24
  s_waitcnt lgkmcnt(7)
  v_mfma_f32_32x32x16_bf16 v[160:175], v[232:235], v[16:19], v[160:175]
  ds_read_b128 v[232:235], v2 offset:22528
  v_sub_f32 v25, v25, v5
  v_add_f32 v7, v7, v21
  v_exp_f32 v25, v25
  v_sub_f32 v26, v26, v5
  v_add_f32 v7, v7, v22
  v_sub_f32 v27, v27, v5
  v_exp_f32 v26, v26
  v_add_f32 v7, v7, v23
  v_exp_f32 v27, v27
  v_sub_f32 v28, v28, v5
  v_sub_f32 v29, v29, v5
  v_sub_f32 v30, v30, v5
  v_sub_f32 v31, v31, v5
  v_add_f32 v7, v7, v24
  v_exp_f32 v28, v28
  v_exp_f32 v29, v29
  v_exp_f32 v30, v30
  v_exp_f32 v31, v31
  v_add_f32 v7, v7, v25
  v_cvt_pk_bf16_f32 v24, v24, v25
  v_add_f32 v7, v7, v26
  v_cvt_pk_bf16_f32 v25, v26, v27
  v_add_f32 v7, v7, v27
  v_add_f32 v7, v7, v28
  v_cvt_pk_bf16_f32 v26, v28, v29
  v_cvt_pk_bf16_f32 v27, v30, v31
  v_sub_f32 v32, v32, v5
  v_add_f32 v7, v7, v29
  s_waitcnt lgkmcnt(7)
  v_mfma_f32_32x32x16_bf16 v[160:175], v[236:239], v[24:27], v[160:175]
  ds_read_b128 v[236:239], v2 offset:23552
  v_exp_f32 v32, v32
  v_sub_f32 v33, v33, v5
  v_add_f32 v7, v7, v30
  v_exp_f32 v33, v33
  v_sub_f32 v34, v34, v5
  v_sub_f32 v35, v35, v5
  v_add_f32 v7, v7, v31
  v_exp_f32 v34, v34
  v_exp_f32 v35, v35
  v_sub_f32 v36, v36, v5
  v_sub_f32 v37, v37, v5
  v_sub_f32 v38, v38, v5
  v_sub_f32 v39, v39, v5
  v_add_f32 v7, v7, v32
  v_exp_f32 v36, v36
  v_exp_f32 v37, v37
  v_exp_f32 v38, v38
  v_exp_f32 v39, v39
  v_add_f32 v7, v7, v33
  v_cvt_pk_bf16_f32 v32, v32, v33
  v_add_f32 v7, v7, v34
  v_cvt_pk_bf16_f32 v33, v34, v35
  v_add_f32 v7, v7, v35
  v_sub_f32 v40, v40, v5
  v_add_f32 v7, v7, v36
  v_cvt_pk_bf16_f32 v34, v36, v37
  v_cvt_pk_bf16_f32 v35, v38, v39
  v_exp_f32 v40, v40
  s_waitcnt lgkmcnt(7)
  v_mfma_f32_32x32x16_bf16 v[160:175], v[208:211], v[32:35], v[160:175]
  ds_read_b128 v[208:211], v2 offset:14336
  v_sub_f32 v41, v41, v5
  v_add_f32 v7, v7, v37
  v_exp_f32 v41, v41
  v_sub_f32 v42, v42, v5
  v_add_f32 v7, v7, v38
  v_sub_f32 v43, v43, v5
  v_exp_f32 v42, v42
  v_add_f32 v7, v7, v39
  v_exp_f32 v43, v43
  v_sub_f32 v44, v44, v5
  v_sub_f32 v45, v45, v5
  v_sub_f32 v46, v46, v5
  v_sub_f32 v47, v47, v5
  v_add_f32 v7, v7, v40
  v_exp_f32 v44, v44
  v_exp_f32 v45, v45
  v_exp_f32 v46, v46
  v_exp_f32 v47, v47
  v_add_f32 v7, v7, v41
  v_cvt_pk_bf16_f32 v40, v40, v41
  v_add_f32 v7, v7, v42
  v_cvt_pk_bf16_f32 v41, v42, v43
  v_add_f32 v7, v7, v43
  v_add_f32 v7, v7, v44
  v_cvt_pk_bf16_f32 v42, v44, v45
  v_cvt_pk_bf16_f32 v43, v46, v47
  v_sub_f32 v48, v48, v5
  v_add_f32 v7, v7, v45
  s_waitcnt lgkmcnt(7)
  v_mfma_f32_32x32x16_bf16 v[160:175], v[212:215], v[40:43], v[160:175]
  ds_read_b128 v[212:215], v2 offset:15360
  v_exp_f32 v48, v48
  v_sub_f32 v49, v49, v5
  v_add_f32 v7, v7, v46
  v_exp_f32 v49, v49
  v_sub_f32 v50, v50, v5
  v_sub_f32 v51, v51, v5
  v_add_f32 v7, v7, v47
  v_exp_f32 v50, v50
  v_exp_f32 v51, v51
  v_sub_f32 v52, v52, v5
  v_sub_f32 v53, v53, v5
  v_sub_f32 v54, v54, v5
  v_sub_f32 v55, v55, v5
  v_add_f32 v7, v7, v48
  v_exp_f32 v52, v52
  v_exp_f32 v53, v53
  v_exp_f32 v54, v54
  v_exp_f32 v55, v55
  v_add_f32 v7, v7, v49
  v_cvt_pk_bf16_f32 v48, v48, v49
  v_add_f32 v7, v7, v50
  v_cvt_pk_bf16_f32 v49, v50, v51
  v_add_f32 v7, v7, v51
  v_sub_f32 v56, v56, v5
  v_add_f32 v7, v7, v52
  v_cvt_pk_bf16_f32 v50, v52, v53
  v_cvt_pk_bf16_f32 v51, v54, v55
  v_exp_f32 v56, v56
  s_waitcnt lgkmcnt(7)
  v_mfma_f32_32x32x16_bf16 v[160:175], v[216:219], v[48:51], v[160:175]
  ds_read_b128 v[216:219], v2 offset:6144
  v_sub_f32 v57, v57, v5
  v_add_f32 v7, v7, v53
  v_exp_f32 v57, v57
  v_sub_f32 v58, v58, v5
  v_add_f32 v7, v7, v54
  v_sub_f32 v59, v59, v5
  v_exp_f32 v58, v58
  v_add_f32 v7, v7, v55
  v_exp_f32 v59, v59
  v_sub_f32 v60, v60, v5
  v_sub_f32 v61, v61, v5
  v_sub_f32 v62, v62, v5
  v_sub_f32 v63, v63, v5
  v_add_f32 v7, v7, v56
  v_exp_f32 v60, v60
  v_exp_f32 v61, v61
  v_exp_f32 v62, v62
  v_exp_f32 v63, v63
  v_add_f32 v7, v7, v57
  v_cvt_pk_bf16_f32 v56, v56, v57
  v_add_f32 v7, v7, v58
  v_cvt_pk_bf16_f32 v57, v58, v59
  v_add_f32 v7, v7, v59
  v_add_f32 v7, v7, v60
  v_cvt_pk_bf16_f32 v58, v60, v61
  v_cvt_pk_bf16_f32 v59, v62, v63
  v_sub_f32 v64, v64, v5
  v_add_f32 v7, v7, v61
  s_waitcnt lgkmcnt(7)
  v_mfma_f32_32x32x16_bf16 v[160:175], v[220:223], v[56:59], v[160:175]
  ds_read_b128 v[220:223], v2 offset:7168
  v_exp_f32 v64, v64
  v_sub_f32 v65, v65, v5
  v_add_f32 v7, v7, v62
  v_exp_f32 v65, v65
  v_sub_f32 v66, v66, v5
  v_sub_f32 v67, v67, v5
  v_add_f32 v7, v7, v63
  v_exp_f32 v66, v66
  v_exp_f32 v67, v67
  v_sub_f32 v68, v68, v5
  v_sub_f32 v69, v69, v5
  v_sub_f32 v70, v70, v5
  v_sub_f32 v71, v71, v5
  v_add_f32 v7, v7, v64
  v_exp_f32 v68, v68
  v_exp_f32 v69, v69
  v_exp_f32 v70, v70
  v_exp_f32 v71, v71
  v_add_f32 v7, v7, v65
  v_cvt_pk_bf16_f32 v64, v64, v65
  v_add_f32 v7, v7, v66
  v_cvt_pk_bf16_f32 v65, v66, v67
  v_add_f32 v7, v7, v67
  v_max3_f32 v11, v132, v133, v11
  v_sub_f32 v72, v72, v5
  v_add_f32 v7, v7, v68
  v_cvt_pk_bf16_f32 v66, v68, v69
  v_cvt_pk_bf16_f32 v67, v70, v71
  v_max3_f32 v11, v134, v135, v11
  v_exp_f32 v72, v72
  s_waitcnt lgkmcnt(7)
  v_mfma_f32_32x32x16_bf16 v[160:175], v[224:227], v[64:67], v[160:175]
  v_sub_f32 v73, v73, v5
  v_add_f32 v7, v7, v69
  v_exp_f32 v73, v73
  v_sub_f32 v74, v74, v5
  v_add_f32 v7, v7, v70
  v_max3_f32 v11, v136, v137, v11
  v_sub_f32 v75, v75, v5
  v_exp_f32 v74, v74
  v_add_f32 v7, v7, v71
  v_max3_f32 v11, v138, v139, v11
  v_exp_f32 v75, v75
  v_sub_f32 v76, v76, v5
  v_sub_f32 v77, v77, v5
  v_sub_f32 v78, v78, v5
  v_sub_f32 v79, v79, v5
  v_add_f32 v7, v7, v72
  v_max3_f32 v11, v140, v141, v11
  v_exp_f32 v76, v76
  v_exp_f32 v77, v77
  v_exp_f32 v78, v78
  v_exp_f32 v79, v79
  v_add_f32 v7, v7, v73
  v_cvt_pk_bf16_f32 v72, v72, v73
  v_max3_f32 v11, v142, v143, v11
  v_add_f32 v7, v7, v74
  v_cvt_pk_bf16_f32 v73, v74, v75
  v_add_f32 v7, v7, v75
  v_max3_f32 v11, v144, v145, v11
  v_add_f32 v7, v7, v76
  v_cvt_pk_bf16_f32 v74, v76, v77
  v_cvt_pk_bf16_f32 v75, v78, v79
  v_sub_f32 v80, v80, v5
  v_max3_f32 v11, v146, v147, v11
  s_waitcnt lgkmcnt(6)
  v_mfma_f32_32x32x16_bf16 v[160:175], v[228:231], v[72:75], v[160:175]
  v_add_f32 v7, v7, v77
  v_exp_f32 v80, v80
  v_sub_f32 v81, v81, v5
  v_max3_f32 v11, v148, v149, v11
  v_add_f32 v7, v7, v78
  v_exp_f32 v81, v81
  v_sub_f32 v82, v82, v5
  v_sub_f32 v83, v83, v5
  v_max3_f32 v11, v150, v151, v11
  v_add_f32 v7, v7, v79
  v_exp_f32 v82, v82
  v_exp_f32 v83, v83
  v_sub_f32 v84, v84, v5
  v_sub_f32 v85, v85, v5
  v_sub_f32 v86, v86, v5
  v_sub_f32 v87, v87, v5
  v_add_f32 v7, v7, v80
  v_max3_f32 v11, v152, v153, v11
  v_exp_f32 v84, v84
  v_exp_f32 v85, v85
  v_exp_f32 v86, v86
  v_exp_f32 v87, v87
  v_add_f32 v7, v7, v81
  v_max3_f32 v11, v154, v155, v11
  v_cvt_pk_bf16_f32 v80, v80, v81
  v_add_f32 v7, v7, v82
  v_max3_f32 v11, v156, v157, v11
  v_cvt_pk_bf16_f32 v81, v82, v83
  v_add_f32 v7, v7, v83
  v_max3_f32 v11, v158, v159, v11
  v_sub_f32 v88, v88, v5
  v_add_f32 v7, v7, v84
  v_cvt_pk_bf16_f32 v82, v84, v85
  v_cvt_pk_bf16_f32 v83, v86, v87
  v_exp_f32 v88, v88
  s_waitcnt lgkmcnt(5)
  v_mfma_f32_32x32x16_bf16 v[160:175], v[232:235], v[80:83], v[160:175]
  v_sub_f32 v89, v89, v5
  v_add_f32 v7, v7, v85
  v_mov_b32 v12, v11
  v_exp_f32 v89, v89
  v_sub_f32 v90, v90, v5
  v_add_f32 v7, v7, v86
  v_sub_f32 v91, v91, v5
  v_exp_f32 v90, v90
  v_add_f32 v7, v7, v87
  v_exp_f32 v91, v91
  v_sub_f32 v92, v92, v5
  v_sub_f32 v93, v93, v5
  v_sub_f32 v94, v94, v5
  v_sub_f32 v95, v95, v5
  v_add_f32 v7, v7, v88
  v_permlane32_swap_b32 v11, v12
  v_exp_f32 v92, v92
  v_exp_f32 v93, v93
  v_exp_f32 v94, v94
  v_exp_f32 v95, v95
  v_add_f32 v7, v7, v89
  v_max_f32 v11, v11, v12
  v_cvt_pk_bf16_f32 v88, v88, v89
  v_add_f32 v7, v7, v90
  v_sub_f32 v12, v6, v11
  v_cvt_pk_bf16_f32 v89, v90, v91
  v_add_f32 v7, v7, v91
  v_mov_b32 v6, v11
  v_add_f32 v7, v7, v92
  v_cvt_pk_bf16_f32 v90, v92, v93
  v_cvt_pk_bf16_f32 v91, v94, v95
  v_sub_f32 v96, v96, v5
  v_exp_f32 v12, v12
  s_waitcnt lgkmcnt(4)
  v_mfma_f32_32x32x16_bf16 v[160:175], v[236:239], v[88:91], v[160:175]
  v_sub_f32 v128, v128, v6
  v_add_f32 v7, v7, v93
  v_exp_f32 v96, v96
  v_sub_f32 v97, v97, v5
  v_exp_f32 v128, v128
  v_sub_f32 v129, v129, v6
  v_add_f32 v7, v7, v94
  v_exp_f32 v97, v97
  v_sub_f32 v98, v98, v5
  v_exp_f32 v129, v129
  v_sub_f32 v130, v130, v6
  v_sub_f32 v99, v99, v5
  v_sub_f32 v131, v131, v6
  v_add_f32 v7, v7, v95
  v_exp_f32 v98, v98
  v_mul_f32 v8, v8, v12
  v_exp_f32 v130, v130
  v_exp_f32 v99, v99
  v_exp_f32 v131, v131
  v_sub_f32 v100, v100, v5
  v_sub_f32 v101, v101, v5
  v_sub_f32 v102, v102, v5
  v_sub_f32 v103, v103, v5
  v_add_f32 v7, v7, v96
  v_sub_f32 v132, v132, v6
  v_sub_f32 v133, v133, v6
  v_sub_f32 v134, v134, v6
  v_sub_f32 v135, v135, v6
  v_add_f32 v8, v8, v128
  v_exp_f32 v100, v100
  v_exp_f32 v101, v101
  v_exp_f32 v102, v102
  v_exp_f32 v103, v103
  v_add_f32 v7, v7, v97
  v_exp_f32 v132, v132
  v_exp_f32 v133, v133
  v_exp_f32 v134, v134
  v_exp_f32 v135, v135
  v_add_f32 v8, v8, v129
  v_cvt_pk_bf16_f32 v96, v96, v97
  v_cvt_pk_bf16_f32 v128, v128, v129
  v_add_f32 v7, v7, v98
  v_add_f32 v8, v8, v130
  v_cvt_pk_bf16_f32 v97, v98, v99
  v_cvt_pk_bf16_f32 v129, v130, v131
  v_add_f32 v7, v7, v99
  v_add_f32 v8, v8, v131
  v_sub_f32 v104, v104, v5
  v_add_f32 v7, v7, v100
  v_cvt_pk_bf16_f32 v98, v100, v101
  v_cvt_pk_bf16_f32 v99, v102, v103
  v_mul_f32 v176, v176, v12
  v_mul_f32 v177, v177, v12
  s_waitcnt lgkmcnt(3)
  v_mfma_f32_32x32x16_bf16 v[160:175], v[208:211], v[96:99], v[160:175]
  v_mul_f32 v178, v178, v12
  v_mul_f32 v179, v179, v12
  v_mul_f32 v180, v180, v12
  v_mul_f32 v181, v181, v12
  v_mul_f32 v182, v182, v12
  v_mul_f32 v183, v183, v12
  v_mul_f32 v184, v184, v12
  v_mul_f32 v185, v185, v12
  v_mul_f32 v186, v186, v12
  v_mul_f32 v187, v187, v12
  v_mul_f32 v188, v188, v12
  v_mul_f32 v189, v189, v12
  v_mul_f32 v190, v190, v12
  v_mul_f32 v191, v191, v12
  v_sub_f32 v136, v136, v6
  v_add_f32 v8, v8, v132
  v_cvt_pk_bf16_f32 v130, v132, v133
  v_cvt_pk_bf16_f32 v131, v134, v135
  v_exp_f32 v104, v104
  s_nop 0
  v_mfma_f32_32x32x16_bf16 v[176:191], v[208:211], v[128:131], v[176:191]
  v_sub_f32 v105, v105, v5
  v_add_f32 v7, v7, v101
  v_exp_f32 v136, v136
  v_sub_f32 v137, v137, v6
  v_add_f32 v8, v8, v133
  v_exp_f32 v105, v105
  v_sub_f32 v106, v106, v5
  v_add_f32 v7, v7, v102
  v_exp_f32 v137, v137
  v_sub_f32 v138, v138, v6
  v_add_f32 v8, v8, v134
  v_sub_f32 v107, v107, v5
  v_sub_f32 v139, v139, v6
  v_exp_f32 v106, v106
  v_add_f32 v7, v7, v103
  v_exp_f32 v138, v138
  v_add_f32 v8, v8, v135
  v_exp_f32 v107, v107
  v_exp_f32 v139, v139
  v_sub_f32 v108, v108, v5
  v_sub_f32 v109, v109, v5
  v_sub_f32 v110, v110, v5
  v_sub_f32 v111, v111, v5
  v_add_f32 v7, v7, v104
  v_sub_f32 v140, v140, v6
  v_sub_f32 v141, v141, v6
  v_sub_f32 v142, v142, v6
  v_sub_f32 v143, v143, v6
  v_add_f32 v8, v8, v136
  v_exp_f32 v108, v108
  v_exp_f32 v109, v109
  v_exp_f32 v110, v110
  v_exp_f32 v111, v111
  v_add_f32 v7, v7, v105
  v_exp_f32 v140, v140
  v_exp_f32 v141, v141
  v_exp_f32 v142, v142
  v_exp_f32 v143, v143
  v_add_f32 v8, v8, v137
  v_cvt_pk_bf16_f32 v104, v104, v105
  v_cvt_pk_bf16_f32 v136, v136, v137
  v_add_f32 v7, v7, v106
  v_add_f32 v8, v8, v138
  v_cvt_pk_bf16_f32 v105, v106, v107
  v_cvt_pk_bf16_f32 v137, v138, v139
  v_add_f32 v7, v7, v107
  v_add_f32 v8, v8, v139
  v_add_f32 v7, v7, v108
  v_cvt_pk_bf16_f32 v106, v108, v109
  v_cvt_pk_bf16_f32 v107, v110, v111
  v_sub_f32 v112, v112, v5
  v_add_f32 v8, v8, v140
  s_waitcnt lgkmcnt(2)
  v_mfma_f32_32x32x16_bf16 v[160:175], v[212:215], v[104:107], v[160:175]
  v_cvt_pk_bf16_f32 v138, v140, v141
  v_cvt_pk_bf16_f32 v139, v142, v143
  v_sub_f32 v144, v144, v6
  v_add_f32 v7, v7, v109
  v_exp_f32 v112, v112
  v_mfma_f32_32x32x16_bf16 v[176:191], v[212:215], v[136:139], v[176:191]
  v_sub_f32 v113, v113, v5
  v_add_f32 v8, v8, v141
  v_exp_f32 v144, v144
  v_sub_f32 v145, v145, v6
  v_add_f32 v7, v7, v110
  v_exp_f32 v113, v113
  v_sub_f32 v114, v114, v5
  v_add_f32 v8, v8, v142
  v_exp_f32 v145, v145
  v_sub_f32 v146, v146, v6
  v_sub_f32 v115, v115, v5
  v_sub_f32 v147, v147, v6
  v_add_f32 v7, v7, v111
  v_exp_f32 v114, v114
  v_add_f32 v8, v8, v143
  v_exp_f32 v146, v146
  v_exp_f32 v115, v115
  v_exp_f32 v147, v147
  v_sub_f32 v116, v116, v5
  v_sub_f32 v117, v117, v5
  v_sub_f32 v118, v118, v5
  v_sub_f32 v119, v119, v5
  v_add_f32 v7, v7, v112
  v_sub_f32 v148, v148, v6
  v_sub_f32 v149, v149, v6
  v_sub_f32 v150, v150, v6
  v_sub_f32 v151, v151, v6
  v_add_f32 v8, v8, v144
  v_exp_f32 v116, v116
  v_exp_f32 v117, v117
  v_exp_f32 v118, v118
  v_exp_f32 v119, v119
  v_add_f32 v7, v7, v113
  v_exp_f32 v148, v148
  v_exp_f32 v149, v149
  v_exp_f32 v150, v150
  v_exp_f32 v151, v151
  v_add_f32 v8, v8, v145
  v_cvt_pk_bf16_f32 v112, v112, v113
  v_cvt_pk_bf16_f32 v144, v144, v145
  v_add_f32 v7, v7, v114
  v_add_f32 v8, v8, v146
  v_cvt_pk_bf16_f32 v113, v114, v115
  v_cvt_pk_bf16_f32 v145, v146, v147
  v_add_f32 v7, v7, v115
  v_add_f32 v8, v8, v147
  v_sub_f32 v120, v120, v5
  v_add_f32 v7, v7, v116
  v_cvt_pk_bf16_f32 v114, v116, v117
  v_cvt_pk_bf16_f32 v115, v118, v119
  v_sub_f32 v152, v152, v6
  v_add_f32 v8, v8, v148
  s_waitcnt lgkmcnt(1)
  v_mfma_f32_32x32x16_bf16 v[160:175], v[216:219], v[112:115], v[160:175]
  v_cvt_pk_bf16_f32 v146, v148, v149
  v_cvt_pk_bf16_f32 v147, v150, v151
  v_exp_f32 v120, v120
  v_sub_f32 v121, v121, v5
  v_add_f32 v7, v7, v117
  v_mfma_f32_32x32x16_bf16 v[176:191], v[216:219], v[144:147], v[176:191]
  v_exp_f32 v152, v152
  v_sub_f32 v153, v153, v6
  v_add_f32 v8, v8, v149
  v_exp_f32 v121, v121
  v_sub_f32 v122, v122, v5
  v_add_f32 v7, v7, v118
  v_exp_f32 v153, v153
  v_sub_f32 v154, v154, v6
  v_add_f32 v8, v8, v150
  v_sub_f32 v123, v123, v5
  v_sub_f32 v155, v155, v6
  v_exp_f32 v122, v122
  v_add_f32 v7, v7, v119
  v_exp_f32 v154, v154
  v_add_f32 v8, v8, v151
  v_exp_f32 v123, v123
  v_exp_f32 v155, v155
  v_sub_f32 v124, v124, v5
  v_sub_f32 v125, v125, v5
  v_sub_f32 v126, v126, v5
  v_sub_f32 v127, v127, v5
  v_add_f32 v7, v7, v120
  v_sub_f32 v156, v156, v6
  v_sub_f32 v157, v157, v6
  v_sub_f32 v158, v158, v6
  v_sub_f32 v159, v159, v6
  v_add_f32 v8, v8, v152
  v_exp_f32 v124, v124
  v_exp_f32 v125, v125
  v_exp_f32 v126, v126
  v_exp_f32 v127, v127
  v_add_f32 v7, v7, v121
  v_exp_f32 v156, v156
  v_exp_f32 v157, v157
  v_exp_f32 v158, v158
  v_exp_f32 v159, v159
  v_add_f32 v8, v8, v153
  v_cvt_pk_bf16_f32 v120, v120, v121
  v_cvt_pk_bf16_f32 v152, v152, v153
  v_add_f32 v7, v7, v122
  v_add_f32 v8, v8, v154
  v_cvt_pk_bf16_f32 v121, v122, v123
  v_cvt_pk_bf16_f32 v153, v154, v155
  v_add_f32 v7, v7, v123
  v_add_f32 v8, v8, v155
  v_cvt_pk_bf16_f32 v122, v124, v125
  v_cvt_pk_bf16_f32 v123, v126, v127
  v_cvt_pk_bf16_f32 v154, v156, v157
  v_cvt_pk_bf16_f32 v155, v158, v159
  s_waitcnt lgkmcnt(0)
  v_mfma_f32_32x32x16_bf16 v[160:175], v[220:223], v[120:123], v[160:175]
  v_add_f32 v7, v7, v124
  v_add_f32 v8, v8, v156
  v_add_f32 v7, v7, v125
  v_add_f32 v8, v8, v157
  v_add_f32 v7, v7, v126
  v_add_f32 v8, v8, v158
  v_mfma_f32_32x32x16_bf16 v[176:191], v[220:223], v[152:155], v[176:191]
  v_add_f32 v7, v7, v127
  v_add_f32 v8, v8, v159
  s_nop 8
  s_branch K1_SFIN
K1_S1_2:
  ds_read_b128 v[208:211], v1 offset:0
  ds_read_b128 v[212:215], v1 offset:1024
  ds_read_b128 v[216:219], v1 offset:8192
  ds_read_b128 v[220:223], v1 offset:9216
  ds_read_b128 v[224:227], v1 offset:16384
  ds_read_b128 v[228:231], v1 offset:17408
  ds_read_b128 v[232:235], v1 offset:24576
  ds_read_b128 v[236:239], v1 offset:25600
  v_lshrrev_b32 v155, 5, v0
  v_and_b32 v154, 31, v0
  v_lshlrev_b32 v155, 2, v155
  v_sub_u32 v154, v154, v155
  v_mov_b32 v155, 0
  v_mov_b32 v156, 0xf149f2ca
  v_cmp_le_i32 s[80:81], 0, v154
  v_cmp_le_i32 s[82:83], 1, v154
  v_cmp_le_i32 s[84:85], 2, v154
  v_cmp_le_i32 s[86:87], 3, v154
  v_cndmask_b32 v240, v156, v155, s[80:81]
  v_cndmask_b32 v241, v156, v155, s[82:83]
  v_cndmask_b32 v242, v156, v155, s[84:85]
  v_cndmask_b32 v243, v156, v155, s[86:87]
  v_cmp_le_i32 s[80:81], 8, v154
  v_cmp_le_i32 s[82:83], 9, v154
  v_cmp_le_i32 s[84:85], 10, v154
  v_cmp_le_i32 s[86:87], 11, v154
  v_cndmask_b32 v244, v156, v155, s[80:81]
  v_cndmask_b32 v245, v156, v155, s[82:83]
  v_cndmask_b32 v246, v156, v155, s[84:85]
  v_cndmask_b32 v247, v156, v155, s[86:87]
  v_cmp_le_i32 s[80:81], 16, v154
  v_cmp_le_i32 s[82:83], 17, v154
  v_cmp_le_i32 s[84:85], 18, v154
  v_cmp_le_i32 s[86:87], 19, v154
  v_cndmask_b32 v248, v156, v155, s[80:81]
  v_cndmask_b32 v249, v156, v155, s[82:83]
  v_cndmask_b32 v250, v156, v155, s[84:85]
  v_cndmask_b32 v251, v156, v155, s[86:87]
  v_cmp_le_i32 s[80:81], 24, v154
  v_cmp_le_i32 s[82:83], 25, v154
  s_waitcnt lgkmcnt(7)
  v_mfma_f32_32x32x16_bf16 v[16:31], v[208:211], v[200:203], 0
  v_cmp_le_i32 s[84:85], 26, v154
  v_cmp_le_i32 s[86:87], 27, v154
  v_cndmask_b32 v252, v156, v155, s[80:81]
  v_cndmask_b32 v253, v156, v155, s[82:83]
  v_cndmask_b32 v254, v156, v155, s[84:85]
  v_cndmask_b32 v255, v156, v155, s[86:87]
  v_mfma_f32_32x32x16_bf16 v[112:127], v[208:211], v[192:195], 0
  ds_read_b128 v[208:211], v1 offset:28672
  s_waitcnt lgkmcnt(7)
  v_mfma_f32_32x32x16_bf16 v[16:31], v[212:215], v[204:207], v[16:31]
  v_mfma_f32_32x32x16_bf16 v[112:127], v[212:215], v[196:199], v[112:127]
  ds_read_b128 v[212:215], v1 offset:29696
  s_waitcnt lgkmcnt(7)
  v_mfma_f32_32x32x16_bf16 v[32:47], v[216:219], v[200:203], 0
  s_nop 7
  v_max_f32 v11, v16, v17
  v_max3_f32 v11, v18, v19, v11
  v_max3_f32 v11, v20, v21, v11
  v_max3_f32 v11, v22, v23, v11
  v_max3_f32 v11, v24, v25, v11
  v_mfma_f32_32x32x16_bf16 v[128:143], v[216:219], v[192:195], 0
  ds_read_b128 v[216:219], v1 offset:20480
  v_max3_f32 v11, v26, v27, v11
  v_max3_f32 v11, v28, v29, v11
  v_max3_f32 v11, v30, v31, v11
  v_max_f32 v9, v112, v113
  v_max3_f32 v9, v114, v115, v9
  s_waitcnt lgkmcnt(7)
  v_mfma_f32_32x32x16_bf16 v[32:47], v[220:223], v[204:207], v[32:47]
  v_max3_f32 v9, v116, v117, v9
  v_max3_f32 v9, v118, v119, v9
  v_max3_f32 v9, v120, v121, v9
  v_max3_f32 v9, v122, v123, v9
  v_max3_f32 v9, v124, v125, v9
  v_mfma_f32_32x32x16_bf16 v[128:143], v[220:223], v[196:199], v[128:143]
  ds_read_b128 v[220:223], v1 offset:21504
  v_max3_f32 v9, v126, v127, v9
  s_waitcnt lgkmcnt(7)
  v_mfma_f32_32x32x16_bf16 v[48:63], v[224:227], v[200:203], 0
  s_nop 1
  v_max3_f32 v11, v32, v33, v11
  v_max3_f32 v11, v34, v35, v11
  v_max3_f32 v11, v36, v37, v11
  v_max3_f32 v11, v38, v39, v11
  v_max3_f32 v11, v40, v41, v11
  s_waitcnt lgkmcnt(6)
  v_mfma_f32_32x32x16_bf16 v[48:63], v[228:231], v[204:207], v[48:63]
  v_max3_f32 v11, v42, v43, v11
  v_max3_f32 v11, v44, v45, v11
  v_max3_f32 v11, v46, v47, v11
  v_max3_f32 v9, v128, v129, v9
  v_max3_f32 v9, v130, v131, v9
  s_waitcnt lgkmcnt(5)
  v_mfma_f32_32x32x16_bf16 v[64:79], v[232:235], v[200:203], 0
  v_max3_f32 v9, v132, v133, v9
  v_max3_f32 v9, v134, v135, v9
  v_max3_f32 v9, v136, v137, v9
  v_max3_f32 v9, v138, v139, v9
  v_max3_f32 v9, v140, v141, v9
  s_waitcnt lgkmcnt(4)
  v_mfma_f32_32x32x16_bf16 v[64:79], v[236:239], v[204:207], v[64:79]
  v_max3_f32 v11, v48, v49, v11
  v_max3_f32 v11, v50, v51, v11
  v_max3_f32 v11, v52, v53, v11
  v_max3_f32 v11, v54, v55, v11
  v_max3_f32 v11, v56, v57, v11
  s_waitcnt lgkmcnt(3)
  v_mfma_f32_32x32x16_bf16 v[80:95], v[208:211], v[200:203], 0
  v_max3_f32 v11, v58, v59, v11
  v_max3_f32 v11, v60, v61, v11
  v_max3_f32 v11, v62, v63, v11
  v_max3_f32 v9, v142, v143, v9
  s_waitcnt lgkmcnt(2)
  v_mfma_f32_32x32x16_bf16 v[80:95], v[212:215], v[204:207], v[80:95]
  v_max3_f32 v11, v64, v65, v11
  v_max3_f32 v11, v66, v67, v11
  v_max3_f32 v11, v68, v69, v11
  v_max3_f32 v11, v70, v71, v11
  v_max3_f32 v11, v72, v73, v11
  s_waitcnt lgkmcnt(1)
  v_mfma_f32_32x32x16_bf16 v[96:111], v[216:219], v[200:203], v[240:255]
  v_max3_f32 v11, v74, v75, v11
  v_max3_f32 v11, v76, v77, v11
  v_max3_f32 v11, v78, v79, v11
  s_waitcnt lgkmcnt(0)
  v_mfma_f32_32x32x16_bf16 v[96:111], v[220:223], v[204:207], v[96:111]
  v_max3_f32 v11, v80, v81, v11
  v_max3_f32 v11, v82, v83, v11
  v_max3_f32 v11, v84, v85, v11
  v_max3_f32 v11, v86, v87, v11
  v_max3_f32 v11, v88, v89, v11
  v_mfma_f32_32x32x16_bf16 v[144:159], v[224:227], v[192:195], v[240:255]
  ds_read_b128 v[224:227], v1 offset:2048
  v_max3_f32 v11, v90, v91, v11
  v_max3_f32 v11, v92, v93, v11
  v_max3_f32 v11, v94, v95, v11
  v_mfma_f32_32x32x16_bf16 v[144:159], v[228:231], v[196:199], v[144:159]
  ds_read_b128 v[228:231], v1 offset:3072
  ds_read_b128 v[232:235], v1 offset:10240
  ds_read_b128 v[236:239], v1 offset:11264
  ds_read_b128 v[208:211], v1 offset:18432
  ds_read_b128 v[212:215], v1 offset:19456
  ds_read_b128 v[216:219], v1 offset:26624
  ds_read_b128 v[220:223], v1 offset:27648
  v_max3_f32 v11, v96, v97, v11
  v_max3_f32 v11, v98, v99, v11
  v_max3_f32 v11, v100, v101, v11
  v_max3_f32 v11, v102, v103, v11
  v_max3_f32 v11, v104, v105, v11
  v_max3_f32 v11, v106, v107, v11
  v_max3_f32 v11, v108, v109, v11
  v_max3_f32 v11, v110, v111, v11
  v_mov_b32 v12, v11
  v_max3_f32 v9, v144, v145, v9
  v_max3_f32 v9, v146, v147, v9
  v_permlane32_swap_b32 v11, v12
  v_max_f32 v6, v11, v12
  v_sub_f32 v16, v16, v6
  v_sub_f32 v17, v17, v6
  v_exp_f32 v16, v16
  v_exp_f32 v17, v17
  v_sub_f32 v18, v18, v6
  v_sub_f32 v19, v19, v6
  v_exp_f32 v18, v18
  v_exp_f32 v19, v19
  v_sub_f32 v20, v20, v6
  v_sub_f32 v21, v21, v6
  v_sub_f32 v22, v22, v6
  v_sub_f32 v23, v23, v6
  v_add_f32 v8, v16, v17
  v_exp_f32 v20, v20
  v_exp_f32 v21, v21
  v_exp_f32 v22, v22
  v_exp_f32 v23, v23
  v_cvt_pk_bf16_f32 v16, v16, v17
  v_add_f32 v8, v8, v18
  v_cvt_pk_bf16_f32 v17, v18, v19
  v_add_f32 v8, v8, v19
  v_sub_f32 v24, v24, v6
  v_add_f32 v8, v8, v20
  v_cvt_pk_bf16_f32 v18, v20, v21
  v_cvt_pk_bf16_f32 v19, v22, v23
  v_exp_f32 v24, v24
  s_waitcnt lgkmcnt(7)
  v_mfma_f32_32x32x16_bf16 v[176:191], v[224:227], v[16:19], 0
  v_sub_f32 v25, v25, v6
  v_add_f32 v8, v8, v21
  v_exp_f32 v25, v25
  v_sub_f32 v26, v26, v6
  v_add_f32 v8, v8, v22
  v_max3_f32 v9, v148, v149, v9
  v_sub_f32 v27, v27, v6
  v_exp_f32 v26, v26
  v_add_f32 v8, v8, v23
  v_max3_f32 v9, v150, v151, v9
  v_exp_f32 v27, v27
  v_sub_f32 v28, v28, v6
  v_sub_f32 v29, v29, v6
  v_sub_f32 v30, v30, v6
  v_sub_f32 v31, v31, v6
  v_add_f32 v8, v8, v24
  v_max3_f32 v9, v152, v153, v9
  v_exp_f32 v28, v28
  v_exp_f32 v29, v29
  v_exp_f32 v30, v30
  v_exp_f32 v31, v31
  v_add_f32 v8, v8, v25
  v_cvt_pk_bf16_f32 v24, v24, v25
  v_max3_f32 v9, v154, v155, v9
  v_add_f32 v8, v8, v26
  v_cvt_pk_bf16_f32 v25, v26, v27
  v_add_f32 v8, v8, v27
  v_max3_f32 v9, v156, v157, v9
  v_add_f32 v8, v8, v28
  v_cvt_pk_bf16_f32 v26, v28, v29
  v_cvt_pk_bf16_f32 v27, v30, v31
  v_sub_f32 v32, v32, v6
  v_max3_f32 v9, v158, v159, v9
  s_waitcnt lgkmcnt(6)
  v_mfma_f32_32x32x16_bf16 v[176:191], v[228:231], v[24:27], v[176:191]
  v_add_f32 v8, v8, v29
  v_exp_f32 v32, v32
  v_sub_f32 v33, v33, v6
  v_mov_b32 v10, v9
  v_add_f32 v8, v8, v30
  v_exp_f32 v33, v33
  v_sub_f32 v34, v34, v6
  v_sub_f32 v35, v35, v6
  v_add_f32 v8, v8, v31
  v_exp_f32 v34, v34
  v_exp_f32 v35, v35
  v_sub_f32 v36, v36, v6
  v_sub_f32 v37, v37, v6
  v_sub_f32 v38, v38, v6
  v_sub_f32 v39, v39, v6
  v_add_f32 v8, v8, v32
  v_permlane32_swap_b32 v9, v10
  v_exp_f32 v36, v36
  v_exp_f32 v37, v37
  v_exp_f32 v38, v38
  v_exp_f32 v39, v39
  v_add_f32 v8, v8, v33
  v_cvt_pk_bf16_f32 v32, v32, v33
  v_max_f32 v5, v9, v10
  v_add_f32 v8, v8, v34
  v_sub_f32 v112, v112, v5
  v_sub_f32 v113, v113, v5
  v_cvt_pk_bf16_f32 v33, v34, v35
  v_add_f32 v8, v8, v35
  v_exp_f32 v112, v112
  v_exp_f32 v113, v113
  v_sub_f32 v40, v40, v6
  v_add_f32 v8, v8, v36
  v_cvt_pk_bf16_f32 v34, v36, v37
  v_cvt_pk_bf16_f32 v35, v38, v39
  v_sub_f32 v114, v114, v5
  v_sub_f32 v115, v115, v5
  s_waitcnt lgkmcnt(5)
  v_mfma_f32_32x32x16_bf16 v[176:191], v[232:235], v[32:35], v[176:191]
  v_exp_f32 v40, v40
  v_sub_f32 v41, v41, v6
  v_add_f32 v8, v8, v37
  v_exp_f32 v114, v114
  v_exp_f32 v115, v115
  v_exp_f32 v41, v41
  v_sub_f32 v42, v42, v6
  v_add_f32 v8, v8, v38
  v_sub_f32 v116, v116, v5
  v_sub_f32 v117, v117, v5
  v_sub_f32 v118, v118, v5
  v_sub_f32 v119, v119, v5
  v_add_f32 v7, v112, v113
  v_sub_f32 v43, v43, v6
  v_exp_f32 v42, v42
  v_add_f32 v8, v8, v39
  v_exp_f32 v116, v116
  v_exp_f32 v117, v117
  v_exp_f32 v118, v118
  v_exp_f32 v119, v119
  v_cvt_pk_bf16_f32 v112, v112, v113
  v_exp_f32 v43, v43
  v_sub_f32 v44, v44, v6
  v_sub_f32 v45, v45, v6
  v_sub_f32 v46, v46, v6
  v_sub_f32 v47, v47, v6
  v_add_f32 v8, v8, v40
  v_add_f32 v7, v7, v114
  v_cvt_pk_bf16_f32 v113, v114, v115
  v_exp_f32 v44, v44
  v_exp_f32 v45, v45
  v_exp_f32 v46, v46
  v_exp_f32 v47, v47
  v_add_f32 v8, v8, v41
  v_add_f32 v7, v7, v115
  v_cvt_pk_bf16_f32 v40, v40, v41
  v_add_f32 v8, v8, v42
  v_sub_f32 v120, v120, v5
  v_add_f32 v7, v7, v116
  v_cvt_pk_bf16_f32 v114, v116, v117
  v_cvt_pk_bf16_f32 v115, v118, v119
  v_cvt_pk_bf16_f32 v41, v42, v43
  v_add_f32 v8, v8, v43
  v_mfma_f32_32x32x16_bf16 v[160:175], v[224:227], v[112:115], 0
  ds_read_b128 v[224:227], v1 offset:30720
  v_exp_f32 v120, v120
  v_sub_f32 v121, v121, v5
  v_add_f32 v7, v7, v117
  v_add_f32 v8, v8, v44
  v_cvt_pk_bf16_f32 v42, v44, v45
  v_cvt_pk_bf16_f32 v43, v46, v47
  v_sub_f32 v48, v48, v6
  v_exp_f32 v121, v121
  s_waitcnt lgkmcnt(5)
  v_mfma_f32_32x32x16_bf16 v[176:191], v[236:239], v[40:43], v[176:191]
  v_sub_f32 v122, v122, v5
  v_add_f32 v7, v7, v118
  v_sub_f32 v123, v123, v5
  v_add_f32 v8, v8, v45
  v_exp_f32 v48, v48
  v_sub_f32 v49, v49, v6
  v_exp_f32 v122, v122
  v_add_f32 v7, v7, v119
  v_exp_f32 v123, v123
  v_add_f32 v8, v8, v46
  v_exp_f32 v49, v49
  v_sub_f32 v50, v50, v6
  v_sub_f32 v124, v124, v5
  v_sub_f32 v125, v125, v5
  v_sub_f32 v126, v126, v5
  v_sub_f32 v127, v127, v5
  v_add_f32 v7, v7, v120
  v_sub_f32 v51, v51, v6
  v_add_f32 v8, v8, v47
  v_exp_f32 v50, v50
  v_exp_f32 v124, v124
  v_exp_f32 v125, v125
  v_exp_f32 v126, v126
  v_exp_f32 v127, v127
  v_add_f32 v7, v7, v121
  v_cvt_pk_bf16_f32 v120, v120, v121
  v_exp_f32 v51, v51
  v_sub_f32 v52, v52, v6
  v_sub_f32 v53, v53, v6
  v_sub_f32 v54, v54, v6
  v_sub_f32 v55, v55, v6
  v_add_f32 v8, v8, v48
  v_add_f32 v7, v7, v122
  v_cvt_pk_bf16_f32 v121, v122, v123
  v_exp_f32 v52, v52
  v_exp_f32 v53, v53
  v_exp_f32 v54, v54
  v_exp_f32 v55, v55
  v_add_f32 v8, v8, v49
  v_add_f32 v7, v7, v123
  v_cvt_pk_bf16_f32 v48, v48, v49
  v_add_f32 v8, v8, v50
  v_add_f32 v7, v7, v124
  v_cvt_pk_bf16_f32 v122, v124, v125
  v_cvt_pk_bf16_f32 v123, v126, v127
  v_sub_f32 v128, v128, v5
  v_cvt_pk_bf16_f32 v49, v50, v51
  v_mfma_f32_32x32x16_bf16 v[160:175], v[228:231], v[120:123], v[160:175]
  ds_read_b128 v[228:231], v1 offset:31744
  v_add_f32 v8, v8, v51
  v_add_f32 v7, v7, v125
  v_exp_f32 v128, v128
  v_sub_f32 v129, v129, v5
  v_sub_f32 v56, v56, v6
  v_add_f32 v8, v8, v52
  v_cvt_pk_bf16_f32 v50, v52, v53
  v_cvt_pk_bf16_f32 v51, v54, v55
  v_add_f32 v7, v7, v126
  v_exp_f32 v129, v129
  s_waitcnt lgkmcnt(5)
  v_mfma_f32_32x32x16_bf16 v[176:191], v[208:211], v[48:51], v[176:191]
  v_sub_f32 v130, v130, v5
  v_sub_f32 v131, v131, v5
  v_exp_f32 v56, v56
  v_sub_f32 v57, v57, v6
  v_add_f32 v8, v8, v53
  v_add_f32 v7, v7, v127
  v_exp_f32 v130, v130
  v_exp_f32 v131, v131
  v_exp_f32 v57, v57
  v_sub_f32 v58, v58, v6
  v_add_f32 v8, v8, v54
  v_sub_f32 v132, v132, v5
  v_sub_f32 v133, v133, v5
  v_sub_f32 v134, v134, v5
  v_sub_f32 v135, v135, v5
  v_add_f32 v7, v7, v128
  v_sub_f32 v59, v59, v6
  v_exp_f32 v58, v58
  v_add_f32 v8, v8, v55
  v_exp_f32 v132, v132
  v_exp_f32 v133, v133
  v_exp_f32 v134, v134
  v_exp_f32 v135, v135
  v_add_f32 v7, v7, v129
  v_cvt_pk_bf16_f32 v128, v128, v129
  v_exp_f32 v59, v59
  v_sub_f32 v60, v60, v6
  v_sub_f32 v61, v61, v6
  v_sub_f32 v62, v62, v6
  v_sub_f32 v63, v63, v6
  v_add_f32 v8, v8, v56
  v_add_f32 v7, v7, v130
  v_cvt_pk_bf16_f32 v129, v130, v131
  v_exp_f32 v60, v60
  v_exp_f32 v61, v61
  v_exp_f32 v62, v62
  v_exp_f32 v63, v63
  v_add_f32 v8, v8, v57
  v_add_f32 v7, v7, v131
  v_cvt_pk_bf16_f32 v56, v56, v57
  v_add_f32 v8, v8, v58
  v_sub_f32 v136, v136, v5
  v_add_f32 v7, v7, v132
  v_cvt_pk_bf16_f32 v130, v132, v133
  v_cvt_pk_bf16_f32 v131, v134, v135
  v_cvt_pk_bf16_f32 v57, v58, v59
  v_add_f32 v8, v8, v59
  v_mfma_f32_32x32x16_bf16 v[160:175], v[232:235], v[128:131], v[160:175]
  ds_read_b128 v[232:235], v1 offset:22528
  v_exp_f32 v136, v136
  v_sub_f32 v137, v137, v5
  v_add_f32 v7, v7, v133
  v_add_f32 v8, v8, v60
  v_cvt_pk_bf16_f32 v58, v60, v61
  v_cvt_pk_bf16_f32 v59, v62, v63
  v_sub_f32 v64, v64, v6
  v_exp_f32 v137, v137
  s_waitcnt lgkmcnt(5)
  v_mfma_f32_32x32x16_bf16 v[176:191], v[212:215], v[56:59], v[176:191]
  v_sub_f32 v138, v138, v5
  v_add_f32 v7, v7, v134
  v_sub_f32 v139, v139, v5
  v_add_f32 v8, v8, v61
  v_exp_f32 v64, v64
  v_sub_f32 v65, v65, v6
  v_exp_f32 v138, v138
  v_add_f32 v7, v7, v135
  v_exp_f32 v139, v139
  v_add_f32 v8, v8, v62
  v_exp_f32 v65, v65
  v_sub_f32 v66, v66, v6
  v_sub_f32 v140, v140, v5
  v_sub_f32 v141, v141, v5
  v_sub_f32 v142, v142, v5
  v_sub_f32 v143, v143, v5
  v_add_f32 v7, v7, v136
  v_sub_f32 v67, v67, v6
  v_add_f32 v8, v8, v63
  v_exp_f32 v66, v66
  v_exp_f32 v140, v140
  v_exp_f32 v141, v141
  v_exp_f32 v142, v142
  v_exp_f32 v143, v143
  v_add_f32 v7, v7, v137
  v_cvt_pk_bf16_f32 v136, v136, v137
  v_exp_f32 v67, v67
  v_sub_f32 v68, v68, v6
  v_sub_f32 v69, v69, v6
  v_sub_f32 v70, v70, v6
  v_sub_f32 v71, v71, v6
  v_add_f32 v8, v8, v64
  v_add_f32 v7, v7, v138
  v_cvt_pk_bf16_f32 v137, v138, v139
  v_exp_f32 v68, v68
  v_exp_f32 v69, v69
  v_exp_f32 v70, v70
  v_exp_f32 v71, v71
  v_add_f32 v8, v8, v65
  v_add_f32 v7, v7, v139
  v_cvt_pk_bf16_f32 v64, v64, v65
  v_add_f32 v8, v8, v66
  v_cvt_pk_bf16_f32 v138, v140, v141
  v_cvt_pk_bf16_f32 v139, v142, v143
  v_cvt_pk_bf16_f32 v65, v66, v67
  v_add_f32 v8, v8, v67
  v_mfma_f32_32x32x16_bf16 v[160:175], v[236:239], v[136:139], v[160:175]
  ds_read_b128 v[236:239], v1 offset:23552
  v_sub_f32 v72, v72, v6
  v_add_f32 v8, v8, v68
  v_cvt_pk_bf16_f32 v66, v68, v69
  v_cvt_pk_bf16_f32 v67, v70, v71
  v_exp_f32 v72, v72
  s_waitcnt lgkmcnt(5)
  v_mfma_f32_32x32x16_bf16 v[176:191], v[216:219], v[64:67], v[176:191]
  v_sub_f32 v73, v73, v6
  v_add_f32 v8, v8, v69
  v_exp_f32 v73, v73
  v_sub_f32 v74, v74, v6
  v_add_f32 v8, v8, v70
  v_sub_f32 v75, v75, v6
  v_exp_f32 v74, v74
  v_add_f32 v8, v8, v71
  v_exp_f32 v75, v75
  v_sub_f32 v76, v76, v6
  v_sub_f32 v77, v77, v6
  v_sub_f32 v78, v78, v6
  v_sub_f32 v79, v79, v6
  v_add_f32 v8, v8, v72
  v_exp_f32 v76, v76
  v_exp_f32 v77, v77
  v_exp_f32 v78, v78
  v_exp_f32 v79, v79
  v_add_f32 v8, v8, v73
  v_cvt_pk_bf16_f32 v72, v72, v73
  v_add_f32 v8, v8, v74
  v_cvt_pk_bf16_f32 v73, v74, v75
  v_add_f32 v8, v8, v75
  v_add_f32 v8, v8, v76
  v_cvt_pk_bf16_f32 v74, v76, v77
  v_cvt_pk_bf16_f32 v75, v78, v79
  v_sub_f32 v80, v80, v6
  v_add_f32 v8, v8, v77
  s_waitcnt lgkmcnt(4)
  v_mfma_f32_32x32x16_bf16 v[176:191], v[220:223], v[72:75], v[176:191]
  v_exp_f32 v80, v80
  v_sub_f32 v81, v81, v6
  v_add_f32 v8, v8, v78
  v_exp_f32 v81, v81
  v_sub_f32 v82, v82, v6
  v_sub_f32 v83, v83, v6
  v_add_f32 v8, v8, v79
  v_exp_f32 v82, v82
  v_exp_f32 v83, v83
  v_sub_f32 v84, v84, v6
  v_sub_f32 v85, v85, v6
  v_sub_f32 v86, v86, v6
  v_sub_f32 v87, v87, v6
  v_add_f32 v8, v8, v80
  v_exp_f32 v84, v84
  v_exp_f32 v85, v85
  v_exp_f32 v86, v86
  v_exp_f32 v87, v87
  v_add_f32 v8, v8, v81
  v_cvt_pk_bf16_f32 v80, v80, v81
  v_add_f32 v8, v8, v82
  v_cvt_pk_bf16_f32 v81, v82, v83
  v_add_f32 v8, v8, v83
  v_sub_f32 v88, v88, v6
  v_add_f32 v8, v8, v84
  v_cvt_pk_bf16_f32 v82, v84, v85
  v_cvt_pk_bf16_f32 v83, v86, v87
  v_exp_f32 v88, v88
  s_waitcnt lgkmcnt(3)
  v_mfma_f32_32x32x16_bf16 v[176:191], v[224:227], v[80:83], v[176:191]
  v_sub_f32 v89, v89, v6
  v_add_f32 v8, v8, v85
  v_exp_f32 v89, v89
  v_sub_f32 v90, v90, v6
  v_add_f32 v8, v8, v86
  v_sub_f32 v91, v91, v6
  v_exp_f32 v90, v90
  v_add_f32 v8, v8, v87
  v_exp_f32 v91, v91
  v_sub_f32 v92, v92, v6
  v_sub_f32 v93, v93, v6
  v_sub_f32 v94, v94, v6
  v_sub_f32 v95, v95, v6
  v_add_f32 v8, v8, v88
  v_exp_f32 v92, v92
  v_exp_f32 v93, v93
  v_exp_f32 v94, v94
  v_exp_f32 v95, v95
  v_add_f32 v8, v8, v89
  v_cvt_pk_bf16_f32 v88, v88, v89
  v_add_f32 v8, v8, v90
  v_cvt_pk_bf16_f32 v89, v90, v91
  v_add_f32 v8, v8, v91
  v_add_f32 v8, v8, v92
  v_cvt_pk_bf16_f32 v90, v92, v93
  v_cvt_pk_bf16_f32 v91, v94, v95
  v_sub_f32 v96, v96, v6
  v_add_f32 v7, v7, v140
  s_waitcnt lgkmcnt(2)
  v_mfma_f32_32x32x16_bf16 v[176:191], v[228:231], v[88:91], v[176:191]
  v_sub_f32 v144, v144, v5
  v_add_f32 v8, v8, v93
  v_exp_f32 v96, v96
  v_sub_f32 v97, v97, v6
  v_add_f32 v7, v7, v141
  v_exp_f32 v144, v144
  v_sub_f32 v145, v145, v5
  v_add_f32 v8, v8, v94
  v_exp_f32 v97, v97
  v_sub_f32 v98, v98, v6
  v_add_f32 v7, v7, v142
  v_exp_f32 v145, v145
  v_sub_f32 v146, v146, v5
  v_sub_f32 v99, v99, v6
  v_sub_f32 v147, v147, v5
  v_add_f32 v8, v8, v95
  v_exp_f32 v98, v98
  v_add_f32 v7, v7, v143
  v_exp_f32 v146, v146
  v_exp_f32 v99, v99
  v_exp_f32 v147, v147
  v_sub_f32 v100, v100, v6
  v_sub_f32 v101, v101, v6
  v_sub_f32 v102, v102, v6
  v_sub_f32 v103, v103, v6
  v_add_f32 v8, v8, v96
  v_sub_f32 v148, v148, v5
  v_sub_f32 v149, v149, v5
  v_sub_f32 v150, v150, v5
  v_sub_f32 v151, v151, v5
  v_add_f32 v7, v7, v144
  v_exp_f32 v100, v100
  v_exp_f32 v101, v101
  v_exp_f32 v102, v102
  v_exp_f32 v103, v103
  v_add_f32 v8, v8, v97
  v_exp_f32 v148, v148
  v_exp_f32 v149, v149
  v_exp_f32 v150, v150
  v_exp_f32 v151, v151
  v_add_f32 v7, v7, v145
  v_cvt_pk_bf16_f32 v96, v96, v97
  v_cvt_pk_bf16_f32 v144, v144, v145
  v_add_f32 v8, v8, v98
  v_add_f32 v7, v7, v146
  v_cvt_pk_bf16_f32 v97, v98, v99
  v_cvt_pk_bf16_f32 v145, v146, v147
  v_add_f32 v8, v8, v99
  v_add_f32 v7, v7, v147
  v_sub_f32 v104, v104, v6
  v_add_f32 v8, v8, v100
  v_cvt_pk_bf16_f32 v98, v100, v101
  v_cvt_pk_bf16_f32 v99, v102, v103
  v_sub_f32 v152, v152, v5
  v_add_f32 v7, v7, v148
  s_waitcnt lgkmcnt(1)
  v_mfma_f32_32x32x16_bf16 v[176:191], v[232:235], v[96:99], v[176:191]
  v_cvt_pk_bf16_f32 v146, v148, v149
  v_cvt_pk_bf16_f32 v147, v150, v151
  v_exp_f32 v104, v104
  v_sub_f32 v105, v105, v6
  v_add_f32 v8, v8, v101
  v_mfma_f32_32x32x16_bf16 v[160:175], v[208:211], v[144:147], v[160:175]
  v_exp_f32 v152, v152
  v_sub_f32 v153, v153, v5
  v_add_f32 v7, v7, v149
  v_exp_f32 v105, v105
  v_sub_f32 v106, v106, v6
  v_add_f32 v8, v8, v102
  v_exp_f32 v153, v153
  v_sub_f32 v154, v154, v5
  v_add_f32 v7, v7, v150
  v_sub_f32 v107, v107, v6
  v_sub_f32 v155, v155, v5
  v_exp_f32 v106, v106
  v_add_f32 v8, v8, v103
  v_exp_f32 v154, v154
  v_add_f32 v7, v7, v151
  v_exp_f32 v107, v107
  v_exp_f32 v155, v155
  v_sub_f32 v108, v108, v6
  v_sub_f32 v109, v109, v6
  v_sub_f32 v110, v110, v6
  v_sub_f32 v111, v111, v6
  v_add_f32 v8, v8, v104
  v_sub_f32 v156, v156, v5
  v_sub_f32 v157, v157, v5
  v_sub_f32 v158, v158, v5
  v_sub_f32 v159, v159, v5
  v_add_f32 v7, v7, v152
  v_exp_f32 v108, v108
  v_exp_f32 v109, v109
  v_exp_f32 v110, v110
  v_exp_f32 v111, v111
  v_add_f32 v8, v8, v105
  v_exp_f32 v156, v156
  v_exp_f32 v157, v157
  v_exp_f32 v158, v158
  v_exp_f32 v159, v159
  v_add_f32 v7, v7, v153
  v_cvt_pk_bf16_f32 v104, v104, v105
  v_cvt_pk_bf16_f32 v152, v152, v153
  v_add_f32 v8, v8, v106
  v_add_f32 v7, v7, v154
  v_cvt_pk_bf16_f32 v105, v106, v107
  v_cvt_pk_bf16_f32 v153, v154, v155
  v_add_f32 v8, v8, v107
  v_add_f32 v7, v7, v155
  v_cvt_pk_bf16_f32 v106, v108, v109
  v_cvt_pk_bf16_f32 v107, v110, v111
  v_cvt_pk_bf16_f32 v154, v156, v157
  v_cvt_pk_bf16_f32 v155, v158, v159
  s_waitcnt lgkmcnt(0)
  v_mfma_f32_32x32x16_bf16 v[176:191], v[236:239], v[104:107], v[176:191]
  v_add_f32 v8, v8, v108
  v_add_f32 v7, v7, v156
  v_add_f32 v8, v8, v109
  v_add_f32 v7, v7, v157
  v_add_f32 v8, v8, v110
  v_add_f32 v7, v7, v158
  v_mfma_f32_32x32x16_bf16 v[160:175], v[212:215], v[152:155], v[160:175]
  v_add_f32 v8, v8, v111
  v_add_f32 v7, v7, v159
  s_cmp_eq_u32 s5, 0
  s_nop 7
  s_cbranch_scc1 K1_SFIN
  ds_read_b128 v[208:211], v2 offset:16384
  ds_read_b128 v[212:215], v2 offset:17408
  ds_read_b128 v[216:219], v2 offset:24576
  ds_read_b128 v[220:223], v2 offset:25600
  ds_read_b128 v[224:227], v2 offset:28672
  ds_read_b128 v[228:231], v2 offset:29696
  ds_read_b128 v[232:235], v2 offset:20480
  ds_read_b128 v[236:239], v2 offset:21504
  v_mov_b32 v156, 0xf149f2ca
  v_sub_f32 v240, v156, v240
  v_sub_f32 v241, v156, v241
  v_sub_f32 v242, v156, v242
  v_sub_f32 v243, v156, v243
  v_sub_f32 v244, v156, v244
  v_sub_f32 v245, v156, v245
  v_sub_f32 v246, v156, v246
  v_sub_f32 v247, v156, v247
  v_sub_f32 v248, v156, v248
  v_sub_f32 v249, v156, v249
  v_sub_f32 v250, v156, v250
  v_sub_f32 v251, v156, v251
  v_sub_f32 v252, v156, v252
  v_sub_f32 v253, v156, v253
  v_sub_f32 v254, v156, v254
  v_sub_f32 v255, v156, v255
  s_waitcnt lgkmcnt(7)
  s_nop 0
  v_mfma_f32_32x32x16_bf16 v[16:31], v[208:211], v[192:195], v[240:255]
  ds_read_b128 v[208:211], v2 offset:12288
  s_waitcnt lgkmcnt(7)
  v_mfma_f32_32x32x16_bf16 v[16:31], v[212:215], v[196:199], v[16:31]
  ds_read_b128 v[212:215], v2 offset:13312
  s_waitcnt lgkmcnt(7)
  v_mfma_f32_32x32x16_bf16 v[32:47], v[216:219], v[192:195], 0
  ds_read_b128 v[216:219], v2 offset:4096
  s_waitcnt lgkmcnt(7)
  v_mfma_f32_32x32x16_bf16 v[32:47], v[220:223], v[196:199], v[32:47]
  ds_read_b128 v[220:223], v2 offset:5120
  s_nop 4
  v_max3_f32 v9, v16, v17, v5
  v_max3_f32 v9, v18, v19, v9
  v_max3_f32 v9, v20, v21, v9
  v_max3_f32 v9, v22, v23, v9
  s_waitcnt lgkmcnt(7)
  v_mfma_f32_32x32x16_bf16 v[48:63], v[224:227], v[192:195], 0
  ds_read_b128 v[224:227], v2 offset:18432
  v_max3_f32 v9, v24, v25, v9
  v_max3_f32 v9, v26, v27, v9
  v_max3_f32 v9, v28, v29, v9
  v_max3_f32 v9, v30, v31, v9
  s_waitcnt lgkmcnt(7)
  v_mfma_f32_32x32x16_bf16 v[48:63], v[228:231], v[196:199], v[48:63]
  ds_read_b128 v[228:231], v2 offset:19456
  v_max3_f32 v9, v32, v33, v9
  v_max3_f32 v9, v34, v35, v9
  v_max3_f32 v9, v36, v37, v9
  v_max3_f32 v9, v38, v39, v9
  s_waitcnt lgkmcnt(7)
  v_mfma_f32_32x32x16_bf16 v[64:79], v[232:235], v[192:195], 0
  v_max3_f32 v9, v40, v41, v9
  v_max3_f32 v9, v42, v43, v9
  v_max3_f32 v9, v44, v45, v9
  v_max3_f32 v9, v46, v47, v9
  s_waitcnt lgkmcnt(6)
  v_mfma_f32_32x32x16_bf16 v[64:79], v[236:239], v[196:199], v[64:79]
  v_max3_f32 v9, v48, v49, v9
  v_max3_f32 v9, v50, v51, v9
  v_max3_f32 v9, v52, v53, v9
  v_max3_f32 v9, v54, v55, v9
  v_max3_f32 v9, v56, v57, v9
  s_waitcnt lgkmcnt(5)
  v_mfma_f32_32x32x16_bf16 v[80:95], v[208:211], v[192:195], 0
  v_max3_f32 v9, v58, v59, v9
  v_max3_f32 v9, v60, v61, v9
  v_max3_f32 v9, v62, v63, v9
  s_waitcnt lgkmcnt(4)
  v_mfma_f32_32x32x16_bf16 v[80:95], v[212:215], v[196:199], v[80:95]
  v_max3_f32 v9, v64, v65, v9
  v_max3_f32 v9, v66, v67, v9
  v_max3_f32 v9, v68, v69, v9
  v_max3_f32 v9, v70, v71, v9
  v_max3_f32 v9, v72, v73, v9
  s_waitcnt lgkmcnt(3)
  v_mfma_f32_32x32x16_bf16 v[96:111], v[216:219], v[192:195], 0
  v_max3_f32 v9, v74, v75, v9
  v_max3_f32 v9, v76, v77, v9
  v_max3_f32 v9, v78, v79, v9
  s_waitcnt lgkmcnt(2)
  v_mfma_f32_32x32x16_bf16 v[96:111], v[220:223], v[196:199], v[96:111]
  v_max3_f32 v9, v80, v81, v9
  v_max3_f32 v9, v82, v83, v9
  v_max3_f32 v9, v84, v85, v9
  v_max3_f32 v9, v86, v87, v9
  v_max3_f32 v9, v88, v89, v9
  v_mfma_f32_32x32x16_bf16 v[112:127], v[232:235], v[200:203], v[240:255]
  ds_read_b128 v[232:235], v2 offset:26624
  v_max3_f32 v9, v90, v91, v9
  v_max3_f32 v9, v92, v93, v9
  v_max3_f32 v9, v94, v95, v9
  v_mfma_f32_32x32x16_bf16 v[112:127], v[236:239], v[204:207], v[112:127]
  ds_read_b128 v[236:239], v2 offset:27648
  v_max3_f32 v9, v96, v97, v9
  v_max3_f32 v9, v98, v99, v9
  v_max3_f32 v9, v100, v101, v9
  v_max3_f32 v9, v102, v103, v9
  v_mfma_f32_32x32x16_bf16 v[128:143], v[208:211], v[200:203], 0
  ds_read_b128 v[208:211], v2 offset:30720
  v_max3_f32 v9, v104, v105, v9
  v_max3_f32 v9, v106, v107, v9
  v_max3_f32 v9, v108, v109, v9
  v_max3_f32 v9, v110, v111, v9
  v_mfma_f32_32x32x16_bf16 v[128:143], v[212:215], v[204:207], v[128:143]
  ds_read_b128 v[212:215], v2 offset:31744
  v_mov_b32 v10, v9
  v_max3_f32 v11, v112, v113, v6
  v_max3_f32 v11, v114, v115, v11
  v_permlane32_swap_b32 v9, v10
  v_max_f32 v9, v9, v10
  v_mfma_f32_32x32x16_bf16 v[144:159], v[216:219], v[200:203], 0
  ds_read_b128 v[216:219], v2 offset:22528
  v_sub_f32 v10, v5, v9
  v_mov_b32 v5, v9
  v_exp_f32 v10, v10
  v_sub_f32 v16, v16, v5
  v_mfma_f32_32x32x16_bf16 v[144:159], v[220:223], v[204:207], v[144:159]
  ds_read_b128 v[220:223], v2 offset:23552
  v_exp_f32 v16, v16
  v_sub_f32 v17, v17, v5
  v_exp_f32 v17, v17
  v_sub_f32 v18, v18, v5
  v_sub_f32 v19, v19, v5
  v_mul_f32 v7, v7, v10
  v_exp_f32 v18, v18
  v_exp_f32 v19, v19
  v_sub_f32 v20, v20, v5
  v_sub_f32 v21, v21, v5
  v_sub_f32 v22, v22, v5
  v_sub_f32 v23, v23, v5
  v_add_f32 v7, v7, v16
  v_exp_f32 v20, v20
  v_exp_f32 v21, v21
  v_exp_f32 v22, v22
  v_exp_f32 v23, v23
  v_add_f32 v7, v7, v17
  v_cvt_pk_bf16_f32 v16, v16, v17
  v_add_f32 v7, v7, v18
  v_cvt_pk_bf16_f32 v17, v18, v19
  v_add_f32 v7, v7, v19
  v_mul_f32 v160, v160, v10
  v_mul_f32 v161, v161, v10
  v_mul_f32 v162, v162, v10
  v_mul_f32 v163, v163, v10
  v_mul_f32 v164, v164, v10
  v_mul_f32 v165, v165, v10
  v_mul_f32 v166, v166, v10
  v_mul_f32 v167, v167, v10
  v_mul_f32 v168, v168, v10
  v_mul_f32 v169, v169, v10
  v_mul_f32 v170, v170, v10
  v_mul_f32 v171, v171, v10
  v_mul_f32 v172, v172, v10
  v_mul_f32 v173, v173, v10
  v_mul_f32 v174, v174, v10
  v_mul_f32 v175, v175, v10
  v_sub_f32 v24, v24, v5
  v_add_f32 v7, v7, v20
  v_cvt_pk_bf16_f32 v18, v20, v21
  v_cvt_pk_bf16_f32 v19, v22, v23
  v_exp_f32 v24, v24
  s_waitcnt lgkmcnt(7)
  v_mfma_f32_32x32x16_bf16 v[160:175], v[224:227], v[16:19], v[160:175]
  ds_read_b128 v[224:227], v2 offset:14336
  v_sub_f32 v25, v25, v5
  v_add_f32 v7, v7, v21
  v_exp_f32 v25, v25
  v_sub_f32 v26, v26, v5
  v_add_f32 v7, v7, v22
  v_sub_f32 v27, v27, v5
  v_exp_f32 v26, v26
  v_add_f32 v7, v7, v23
  v_exp_f32 v27, v27
  v_sub_f32 v28, v28, v5
  v_sub_f32 v29, v29, v5
  v_sub_f32 v30, v30, v5
  v_sub_f32 v31, v31, v5
  v_add_f32 v7, v7, v24
  v_exp_f32 v28, v28
  v_exp_f32 v29, v29
  v_exp_f32 v30, v30
  v_exp_f32 v31, v31
  v_add_f32 v7, v7, v25
  v_cvt_pk_bf16_f32 v24, v24, v25
  v_max3_f32 v11, v116, v117, v11
  v_add_f32 v7, v7, v26
  v_cvt_pk_bf16_f32 v25, v26, v27
  v_max3_f32 v11, v118, v119, v11
  v_add_f32 v7, v7, v27
  v_add_f32 v7, v7, v28
  v_cvt_pk_bf16_f32 v26, v28, v29
  v_cvt_pk_bf16_f32 v27, v30, v31
  v_sub_f32 v32, v32, v5
  v_max3_f32 v11, v120, v121, v11
  s_waitcnt lgkmcnt(7)
  v_mfma_f32_32x32x16_bf16 v[160:175], v[228:231], v[24:27], v[160:175]
  ds_read_b128 v[228:231], v2 offset:15360
  v_add_f32 v7, v7, v29
  v_exp_f32 v32, v32
  v_sub_f32 v33, v33, v5
  v_max3_f32 v11, v122, v123, v11
  v_add_f32 v7, v7, v30
  v_exp_f32 v33, v33
  v_sub_f32 v34, v34, v5
  v_max3_f32 v11, v124, v125, v11
  v_sub_f32 v35, v35, v5
  v_add_f32 v7, v7, v31
  v_exp_f32 v34, v34
  v_exp_f32 v35, v35
  v_max3_f32 v11, v126, v127, v11
  v_sub_f32 v36, v36, v5
  v_sub_f32 v37, v37, v5
  v_sub_f32 v38, v38, v5
  v_sub_f32 v39, v39, v5
  v_add_f32 v7, v7, v32
  v_exp_f32 v36, v36
  v_exp_f32 v37, v37
  v_exp_f32 v38, v38
  v_exp_f32 v39, v39
  v_add_f32 v7, v7, v33
  v_max3_f32 v11, v128, v129, v11
  v_cvt_pk_bf16_f32 v32, v32, v33
  v_add_f32 v7, v7, v34
  v_max3_f32 v11, v130, v131, v11
  v_cvt_pk_bf16_f32 v33, v34, v35
  v_add_f32 v7, v7, v35
  v_max3_f32 v11, v132, v133, v11
  v_sub_f32 v40, v40, v5
  v_add_f32 v7, v7, v36
  v_cvt_pk_bf16_f32 v34, v36, v37
  v_cvt_pk_bf16_f32 v35, v38, v39
  v_max3_f32 v11, v134, v135, v11
  v_exp_f32 v40, v40
  s_waitcnt lgkmcnt(7)
  v_mfma_f32_32x32x16_bf16 v[160:175], v[232:235], v[32:35], v[160:175]
  ds_read_b128 v[232:235], v2 offset:6144
  v_sub_f32 v41, v41, v5
  v_add_f32 v7, v7, v37
  v_exp_f32 v41, v41
  v_sub_f32 v42, v42, v5
  v_add_f32 v7, v7, v38
  v_max3_f32 v11, v136, v137, v11
  v_sub_f32 v43, v43, v5
  v_exp_f32 v42, v42
  v_add_f32 v7, v7, v39
  v_max3_f32 v11, v138, v139, v11
  v_exp_f32 v43, v43
  v_sub_f32 v44, v44, v5
  v_sub_f32 v45, v45, v5
  v_sub_f32 v46, v46, v5
  v_sub_f32 v47, v47, v5
  v_add_f32 v7, v7, v40
  v_max3_f32 v11, v140, v141, v11
  v_exp_f32 v44, v44
  v_exp_f32 v45, v45
  v_exp_f32 v46, v46
  v_exp_f32 v47, v47
  v_add_f32 v7, v7, v41
  v_cvt_pk_bf16_f32 v40, v40, v41
  v_max3_f32 v11, v142, v143, v11
  v_add_f32 v7, v7, v42
  v_cvt_pk_bf16_f32 v41, v42, v43
  v_add_f32 v7, v7, v43
  v_max3_f32 v11, v144, v145, v11
  v_add_f32 v7, v7, v44
  v_cvt_pk_bf16_f32 v42, v44, v45
  v_cvt_pk_bf16_f32 v43, v46, v47
  v_sub_f32 v48, v48, v5
  v_max3_f32 v11, v146, v147, v11
  s_waitcnt lgkmcnt(7)
  v_mfma_f32_32x32x16_bf16 v[160:175], v[236:239], v[40:43], v[160:175]
  ds_read_b128 v[236:239], v2 offset:7168
  v_add_f32 v7, v7, v45
  v_exp_f32 v48, v48
  v_sub_f32 v49, v49, v5
  v_max3_f32 v11, v148, v149, v11
  v_add_f32 v7, v7, v46
  v_exp_f32 v49, v49
  v_sub_f32 v50, v50, v5
  v_sub_f32 v51, v51, v5
  v_max3_f32 v11, v150, v151, v11
  v_add_f32 v7, v7, v47
  v_exp_f32 v50, v50
  v_exp_f32 v51, v51
  v_sub_f32 v52, v52, v5
  v_sub_f32 v53, v53, v5
  v_sub_f32 v54, v54, v5
  v_sub_f32 v55, v55, v5
  v_add_f32 v7, v7, v48
  v_max3_f32 v11, v152, v153, v11
  v_exp_f32 v52, v52
  v_exp_f32 v53, v53
  v_exp_f32 v54, v54
  v_exp_f32 v55, v55
  v_add_f32 v7, v7, v49
  v_max3_f32 v11, v154, v155, v11
  v_cvt_pk_bf16_f32 v48, v48, v49
  v_add_f32 v7, v7, v50
  v_max3_f32 v11, v156, v157, v11
  v_cvt_pk_bf16_f32 v49, v50, v51
  v_add_f32 v7, v7, v51
  v_max3_f32 v11, v158, v159, v11
  v_sub_f32 v56, v56, v5
  v_add_f32 v7, v7, v52
  v_cvt_pk_bf16_f32 v50, v52, v53
  v_cvt_pk_bf16_f32 v51, v54, v55
  v_exp_f32 v56, v56
  s_waitcnt lgkmcnt(7)
  v_mfma_f32_32x32x16_bf16 v[160:175], v[208:211], v[48:51], v[160:175]
  v_sub_f32 v57, v57, v5
  v_add_f32 v7, v7, v53
  v_mov_b32 v12, v11
  v_exp_f32 v57, v57
  v_sub_f32 v58, v58, v5
  v_add_f32 v7, v7, v54
  v_sub_f32 v59, v59, v5
  v_exp_f32 v58, v58
  v_add_f32 v7, v7, v55
  v_exp_f32 v59, v59
  v_sub_f32 v60, v60, v5
  v_sub_f32 v61, v61, v5
  v_sub_f32 v62, v62, v5
  v_sub_f32 v63, v63, v5
  v_add_f32 v7, v7, v56
  v_permlane32_swap_b32 v11, v12
  v_exp_f32 v60, v60
  v_exp_f32 v61, v61
  v_exp_f32 v62, v62
  v_exp_f32 v63, v63
  v_add_f32 v7, v7, v57
  v_max_f32 v11, v11, v12
  v_cvt_pk_bf16_f32 v56, v56, v57
  v_add_f32 v7, v7, v58
  v_sub_f32 v12, v6, v11
  v_cvt_pk_bf16_f32 v57, v58, v59
  v_add_f32 v7, v7, v59
  v_mov_b32 v6, v11
  v_add_f32 v7, v7, v60
  v_cvt_pk_bf16_f32 v58, v60, v61
  v_cvt_pk_bf16_f32 v59, v62, v63
  v_sub_f32 v64, v64, v5
  v_exp_f32 v12, v12
  s_waitcnt lgkmcnt(6)
  v_mfma_f32_32x32x16_bf16 v[160:175], v[212:215], v[56:59], v[160:175]
  v_sub_f32 v112, v112, v6
  v_add_f32 v7, v7, v61
  v_exp_f32 v64, v64
  v_sub_f32 v65, v65, v5
  v_exp_f32 v112, v112
  v_sub_f32 v113, v113, v6
  v_add_f32 v7, v7, v62
  v_exp_f32 v65, v65
  v_sub_f32 v66, v66, v5
  v_exp_f32 v113, v113
  v_sub_f32 v114, v114, v6
  v_sub_f32 v67, v67, v5
  v_sub_f32 v115, v115, v6
  v_add_f32 v7, v7, v63
  v_exp_f32 v66, v66
  v_mul_f32 v8, v8, v12
  v_exp_f32 v114, v114
  v_exp_f32 v67, v67
  v_exp_f32 v115, v115
  v_sub_f32 v68, v68, v5
  v_sub_f32 v69, v69, v5
  v_sub_f32 v70, v70, v5
  v_sub_f32 v71, v71, v5
  v_add_f32 v7, v7, v64
  v_sub_f32 v116, v116, v6
  v_sub_f32 v117, v117, v6
  v_sub_f32 v118, v118, v6
  v_sub_f32 v119, v119, v6
  v_add_f32 v8, v8, v112
  v_exp_f32 v68, v68
  v_exp_f32 v69, v69
  v_exp_f32 v70, v70
  v_exp_f32 v71, v71
  v_add_f32 v7, v7, v65
  v_exp_f32 v116, v116
  v_exp_f32 v117, v117
  v_exp_f32 v118, v118
  v_exp_f32 v119, v119
  v_add_f32 v8, v8, v113
  v_cvt_pk_bf16_f32 v64, v64, v65
  v_cvt_pk_bf16_f32 v112, v112, v113
  v_add_f32 v7, v7, v66
  v_add_f32 v8, v8, v114
  v_cvt_pk_bf16_f32 v65, v66, v67
  v_cvt_pk_bf16_f32 v113, v114, v115
  v_add_f32 v7, v7, v67
  v_add_f32 v8, v8, v115
  v_sub_f32 v72, v72, v5
  v_add_f32 v7, v7, v68
  v_cvt_pk_bf16_f32 v66, v68, v69
  v_cvt_pk_bf16_f32 v67, v70, v71
  v_mul_f32 v176, v176, v12
  v_mul_f32 v177, v177, v12
  s_waitcnt lgkmcnt(5)
  v_mfma_f32_32x32x16_bf16 v[160:175], v[216:219], v[64:67], v[160:175]
  v_mul_f32 v178, v178, v12
  v_mul_f32 v179, v179, v12
  v_mul_f32 v180, v180, v12
  v_mul_f32 v181, v181, v12
  v_mul_f32 v182, v182, v12
  v_mul_f32 v183, v183, v12
  v_mul_f32 v184, v184, v12
  v_mul_f32 v185, v185, v12
  v_mul_f32 v186, v186, v12
  v_mul_f32 v187, v187, v12
  v_mul_f32 v188, v188, v12
  v_mul_f32 v189, v189, v12
  v_mul_f32 v190, v190, v12
  v_mul_f32 v191, v191, v12
  v_sub_f32 v120, v120, v6
  v_add_f32 v8, v8, v116
  v_cvt_pk_bf16_f32 v114, v116, v117
  v_cvt_pk_bf16_f32 v115, v118, v119
  v_exp_f32 v72, v72
  s_nop 0
  v_mfma_f32_32x32x16_bf16 v[176:191], v[216:219], v[112:115], v[176:191]
  v_sub_f32 v73, v73, v5
  v_add_f32 v7, v7, v69
  v_exp_f32 v120, v120
  v_sub_f32 v121, v121, v6
  v_add_f32 v8, v8, v117
  v_exp_f32 v73, v73
  v_sub_f32 v74, v74, v5
  v_add_f32 v7, v7, v70
  v_exp_f32 v121, v121
  v_sub_f32 v122, v122, v6
  v_add_f32 v8, v8, v118
  v_sub_f32 v75, v75, v5
  v_sub_f32 v123, v123, v6
  v_exp_f32 v74, v74
  v_add_f32 v7, v7, v71
  v_exp_f32 v122, v122
  v_add_f32 v8, v8, v119
  v_exp_f32 v75, v75
  v_exp_f32 v123, v123
  v_sub_f32 v76, v76, v5
  v_sub_f32 v77, v77, v5
  v_sub_f32 v78, v78, v5
  v_sub_f32 v79, v79, v5
  v_add_f32 v7, v7, v72
  v_sub_f32 v124, v124, v6
  v_sub_f32 v125, v125, v6
  v_sub_f32 v126, v126, v6
  v_sub_f32 v127, v127, v6
  v_add_f32 v8, v8, v120
  v_exp_f32 v76, v76
  v_exp_f32 v77, v77
  v_exp_f32 v78, v78
  v_exp_f32 v79, v79
  v_add_f32 v7, v7, v73
  v_exp_f32 v124, v124
  v_exp_f32 v125, v125
  v_exp_f32 v126, v126
  v_exp_f32 v127, v127
  v_add_f32 v8, v8, v121
  v_cvt_pk_bf16_f32 v72, v72, v73
  v_cvt_pk_bf16_f32 v120, v120, v121
  v_add_f32 v7, v7, v74
  v_add_f32 v8, v8, v122
  v_cvt_pk_bf16_f32 v73, v74, v75
  v_cvt_pk_bf16_f32 v121, v122, v123
  v_add_f32 v7, v7, v75
  v_add_f32 v8, v8, v123
  v_add_f32 v7, v7, v76
  v_cvt_pk_bf16_f32 v74, v76, v77
  v_cvt_pk_bf16_f32 v75, v78, v79
  v_sub_f32 v80, v80, v5
  v_add_f32 v8, v8, v124
  s_waitcnt lgkmcnt(4)
  v_mfma_f32_32x32x16_bf16 v[160:175], v[220:223], v[72:75], v[160:175]
  v_cvt_pk_bf16_f32 v122, v124, v125
  v_cvt_pk_bf16_f32 v123, v126, v127
  v_sub_f32 v128, v128, v6
  v_add_f32 v7, v7, v77
  v_exp_f32 v80, v80
  v_mfma_f32_32x32x16_bf16 v[176:191], v[220:223], v[120:123], v[176:191]
  v_sub_f32 v81, v81, v5
  v_add_f32 v8, v8, v125
  v_exp_f32 v128, v128
  v_sub_f32 v129, v129, v6
  v_add_f32 v7, v7, v78
  v_exp_f32 v81, v81
  v_sub_f32 v82, v82, v5
  v_add_f32 v8, v8, v126
  v_exp_f32 v129, v129
  v_sub_f32 v130, v130, v6
  v_sub_f32 v83, v83, v5
  v_sub_f32 v131, v131, v6
  v_add_f32 v7, v7, v79
  v_exp_f32 v82, v82
  v_add_f32 v8, v8, v127
  v_exp_f32 v130, v130
  v_exp_f32 v83, v83
  v_exp_f32 v131, v131
  v_sub_f32 v84, v84, v5
  v_sub_f32 v85, v85, v5
  v_sub_f32 v86, v86, v5
  v_sub_f32 v87, v87, v5
  v_add_f32 v7, v7, v80
  v_sub_f32 v132, v132, v6
  v_sub_f32 v133, v133, v6
  v_sub_f32 v134, v134, v6
  v_sub_f32 v135, v135, v6
  v_add_f32 v8, v8, v128
  v_exp_f32 v84, v84
  v_exp_f32 v85, v85
  v_exp_f32 v86, v86
  v_exp_f32 v87, v87
  v_add_f32 v7, v7, v81
  v_exp_f32 v132, v132
  v_exp_f32 v133, v133
  v_exp_f32 v134, v134
  v_exp_f32 v135, v135
  v_add_f32 v8, v8, v129
  v_cvt_pk_bf16_f32 v80, v80, v81
  v_cvt_pk_bf16_f32 v128, v128, v129
  v_add_f32 v7, v7, v82
  v_add_f32 v8, v8, v130
  v_cvt_pk_bf16_f32 v81, v82, v83
  v_cvt_pk_bf16_f32 v129, v130, v131
  v_add_f32 v7, v7, v83
  v_add_f32 v8, v8, v131
  v_sub_f32 v88, v88, v5
  v_add_f32 v7, v7, v84
  v_cvt_pk_bf16_f32 v82, v84, v85
  v_cvt_pk_bf16_f32 v83, v86, v87
  v_sub_f32 v136, v136, v6
  v_add_f32 v8, v8, v132
  s_waitcnt lgkmcnt(3)
  v_mfma_f32_32x32x16_bf16 v[160:175], v[224:227], v[80:83], v[160:175]
  v_cvt_pk_bf16_f32 v130, v132, v133
  v_cvt_pk_bf16_f32 v131, v134, v135
  v_exp_f32 v88, v88
  v_sub_f32 v89, v89, v5
  v_add_f32 v7, v7, v85
  v_mfma_f32_32x32x16_bf16 v[176:191], v[224:227], v[128:131], v[176:191]
  v_exp_f32 v136, v136
  v_sub_f32 v137, v137, v6
  v_add_f32 v8, v8, v133
  v_exp_f32 v89, v89
  v_sub_f32 v90, v90, v5
  v_add_f32 v7, v7, v86
  v_exp_f32 v137, v137
  v_sub_f32 v138, v138, v6
  v_add_f32 v8, v8, v134
  v_sub_f32 v91, v91, v5
  v_sub_f32 v139, v139, v6
  v_exp_f32 v90, v90
  v_add_f32 v7, v7, v87
  v_exp_f32 v138, v138
  v_add_f32 v8, v8, v135
  v_exp_f32 v91, v91
  v_exp_f32 v139, v139
  v_sub_f32 v92, v92, v5
  v_sub_f32 v93, v93, v5
  v_sub_f32 v94, v94, v5
  v_sub_f32 v95, v95, v5
  v_add_f32 v7, v7, v88
  v_sub_f32 v140, v140, v6
  v_sub_f32 v141, v141, v6
  v_sub_f32 v142, v142, v6
  v_sub_f32 v143, v143, v6
  v_add_f32 v8, v8, v136
  v_exp_f32 v92, v92
  v_exp_f32 v93, v93
  v_exp_f32 v94, v94
  v_exp_f32 v95, v95
  v_add_f32 v7, v7, v89
  v_exp_f32 v140, v140
  v_exp_f32 v141, v141
  v_exp_f32 v142, v142
  v_exp_f32 v143, v143
  v_add_f32 v8, v8, v137
  v_cvt_pk_bf16_f32 v88, v88, v89
  v_cvt_pk_bf16_f32 v136, v136, v137
  v_add_f32 v7, v7, v90
  v_add_f32 v8, v8, v138
  v_cvt_pk_bf16_f32 v89, v90, v91
  v_cvt_pk_bf16_f32 v137, v138, v139
  v_add_f32 v7, v7, v91
  v_add_f32 v8, v8, v139
  v_add_f32 v7, v7, v92
  v_cvt_pk_bf16_f32 v90, v92, v93
  v_cvt_pk_bf16_f32 v91, v94, v95
  v_sub_f32 v96, v96, v5
  v_add_f32 v8, v8, v140
  s_waitcnt lgkmcnt(2)
  v_mfma_f32_32x32x16_bf16 v[160:175], v[228:231], v[88:91], v[160:175]
  v_cvt_pk_bf16_f32 v138, v140, v141
  v_cvt_pk_bf16_f32 v139, v142, v143
  v_sub_f32 v144, v144, v6
  v_add_f32 v7, v7, v93
  v_exp_f32 v96, v96
  v_mfma_f32_32x32x16_bf16 v[176:191], v[228:231], v[136:139], v[176:191]
  v_sub_f32 v97, v97, v5
  v_add_f32 v8, v8, v141
  v_exp_f32 v144, v144
  v_sub_f32 v145, v145, v6
  v_add_f32 v7, v7, v94
  v_exp_f32 v97, v97
  v_sub_f32 v98, v98, v5
  v_add_f32 v8, v8, v142
  v_exp_f32 v145, v145
  v_sub_f32 v146, v146, v6
  v_sub_f32 v99, v99, v5
  v_sub_f32 v147, v147, v6
  v_add_f32 v7, v7, v95
  v_exp_f32 v98, v98
  v_add_f32 v8, v8, v143
  v_exp_f32 v146, v146
  v_exp_f32 v99, v99
  v_exp_f32 v147, v147
  v_sub_f32 v100, v100, v5
  v_sub_f32 v101, v101, v5
  v_sub_f32 v102, v102, v5
  v_sub_f32 v103, v103, v5
  v_add_f32 v7, v7, v96
  v_sub_f32 v148, v148, v6
  v_sub_f32 v149, v149, v6
  v_sub_f32 v150, v150, v6
  v_sub_f32 v151, v151, v6
  v_add_f32 v8, v8, v144
  v_exp_f32 v100, v100
  v_exp_f32 v101, v101
  v_exp_f32 v102, v102
  v_exp_f32 v103, v103
  v_add_f32 v7, v7, v97
  v_exp_f32 v148, v148
  v_exp_f32 v149, v149
  v_exp_f32 v150, v150
  v_exp_f32 v151, v151
  v_add_f32 v8, v8, v145
  v_cvt_pk_bf16_f32 v96, v96, v97
  v_cvt_pk_bf16_f32 v144, v144, v145
  v_add_f32 v7, v7, v98
  v_add_f32 v8, v8, v146
  v_cvt_pk_bf16_f32 v97, v98, v99
  v_cvt_pk_bf16_f32 v145, v146, v147
  v_add_f32 v7, v7, v99
  v_add_f32 v8, v8, v147
  v_sub_f32 v104, v104, v5
  v_add_f32 v7, v7, v100
  v_cvt_pk_bf16_f32 v98, v100, v101
  v_cvt_pk_bf16_f32 v99, v102, v103
  v_sub_f32 v152, v152, v6
  v_add_f32 v8, v8, v148
  s_waitcnt lgkmcnt(1)
  v_mfma_f32_32x32x16_bf16 v[160:175], v[232:235], v[96:99], v[160:175]
  v_cvt_pk_bf16_f32 v146, v148, v149
  v_cvt_pk_bf16_f32 v147, v150, v151
  v_exp_f32 v104, v104
  v_sub_f32 v105, v105, v5
  v_add_f32 v7, v7, v101
  v_mfma_f32_32x32x16_bf16 v[176:191], v[232:235], v[144:147], v[176:191]
  v_exp_f32 v152, v152
  v_sub_f32 v153, v153, v6
  v_add_f32 v8, v8, v149
  v_exp_f32 v105, v105
  v_sub_f32 v106, v106, v5
  v_add_f32 v7, v7, v102
  v_exp_f32 v153, v153
  v_sub_f32 v154, v154, v6
  v_add_f32 v8, v8, v150
  v_sub_f32 v107, v107, v5
  v_sub_f32 v155, v155, v6
  v_exp_f32 v106, v106
  v_add_f32 v7, v7, v103
  v_exp_f32 v154, v154
  v_add_f32 v8, v8, v151
  v_exp_f32 v107, v107
  v_exp_f32 v155, v155
  v_sub_f32 v108, v108, v5
  v_sub_f32 v109, v109, v5
  v_sub_f32 v110, v110, v5
  v_sub_f32 v111, v111, v5
  v_add_f32 v7, v7, v104
  v_sub_f32 v156, v156, v6
  v_sub_f32 v157, v157, v6
  v_sub_f32 v158, v158, v6
  v_sub_f32 v159, v159, v6
  v_add_f32 v8, v8, v152
  v_exp_f32 v108, v108
  v_exp_f32 v109, v109
  v_exp_f32 v110, v110
  v_exp_f32 v111, v111
  v_add_f32 v7, v7, v105
  v_exp_f32 v156, v156
  v_exp_f32 v157, v157
  v_exp_f32 v158, v158
  v_exp_f32 v159, v159
  v_add_f32 v8, v8, v153
  v_cvt_pk_bf16_f32 v104, v104, v105
  v_cvt_pk_bf16_f32 v152, v152, v153
  v_add_f32 v7, v7, v106
  v_add_f32 v8, v8, v154
  v_cvt_pk_bf16_f32 v105, v106, v107
  v_cvt_pk_bf16_f32 v153, v154, v155
  v_add_f32 v7, v7, v107
  v_add_f32 v8, v8, v155
  v_cvt_pk_bf16_f32 v106, v108, v109
  v_cvt_pk_bf16_f32 v107, v110, v111
  v_cvt_pk_bf16_f32 v154, v156, v157
  v_cvt_pk_bf16_f32 v155, v158, v159
  s_waitcnt lgkmcnt(0)
  v_mfma_f32_32x32x16_bf16 v[160:175], v[236:239], v[104:107], v[160:175]
  v_add_f32 v7, v7, v108
  v_add_f32 v8, v8, v156
  v_add_f32 v7, v7, v109
  v_add_f32 v8, v8, v157
  v_add_f32 v7, v7, v110
  v_add_f32 v8, v8, v158
  v_mfma_f32_32x32x16_bf16 v[176:191], v[236:239], v[152:155], v[176:191]
  v_add_f32 v7, v7, v111
  v_add_f32 v8, v8, v159
  s_nop 8
  s_branch K1_SFIN
K1_S1_3:
  ds_read_b128 v[208:211], v1 offset:0
  ds_read_b128 v[212:215], v1 offset:1024
  ds_read_b128 v[216:219], v1 offset:8192
  ds_read_b128 v[220:223], v1 offset:9216
  ds_read_b128 v[224:227], v1 offset:16384
  ds_read_b128 v[228:231], v1 offset:17408
  ds_read_b128 v[232:235], v1 offset:24576
  ds_read_b128 v[236:239], v1 offset:25600
  v_lshrrev_b32 v155, 5, v0
  v_and_b32 v154, 31, v0
  v_lshlrev_b32 v155, 2, v155
  v_sub_u32 v154, v154, v155
  v_mov_b32 v155, 0
  v_mov_b32 v156, 0xf149f2ca
  v_cmp_le_i32 s[80:81], 0, v154
  v_cmp_le_i32 s[82:83], 1, v154
  v_cmp_le_i32 s[84:85], 2, v154
  v_cmp_le_i32 s[86:87], 3, v154
  v_cndmask_b32 v240, v156, v155, s[80:81]
  v_cndmask_b32 v241, v156, v155, s[82:83]
  v_cndmask_b32 v242, v156, v155, s[84:85]
  v_cndmask_b32 v243, v156, v155, s[86:87]
  v_cmp_le_i32 s[80:81], 8, v154
  v_cmp_le_i32 s[82:83], 9, v154
  v_cmp_le_i32 s[84:85], 10, v154
  v_cmp_le_i32 s[86:87], 11, v154
  v_cndmask_b32 v244, v156, v155, s[80:81]
  v_cndmask_b32 v245, v156, v155, s[82:83]
  v_cndmask_b32 v246, v156, v155, s[84:85]
  v_cndmask_b32 v247, v156, v155, s[86:87]
  v_cmp_le_i32 s[80:81], 16, v154
  v_cmp_le_i32 s[82:83], 17, v154
  v_cmp_le_i32 s[84:85], 18, v154
  v_cmp_le_i32 s[86:87], 19, v154
  v_cndmask_b32 v248, v156, v155, s[80:81]
  v_cndmask_b32 v249, v156, v155, s[82:83]
  v_cndmask_b32 v250, v156, v155, s[84:85]
  v_cndmask_b32 v251, v156, v155, s[86:87]
  v_cmp_le_i32 s[80:81], 24, v154
  v_cmp_le_i32 s[82:83], 25, v154
  s_waitcnt lgkmcnt(7)
  v_mfma_f32_32x32x16_bf16 v[16:31], v[208:211], v[200:203], 0
  v_cmp_le_i32 s[84:85], 26, v154
  v_cmp_le_i32 s[86:87], 27, v154
  v_cndmask_b32 v252, v156, v155, s[80:81]
  v_cndmask_b32 v253, v156, v155, s[82:83]
  v_cndmask_b32 v254, v156, v155, s[84:85]
  v_cndmask_b32 v255, v156, v155, s[86:87]
  v_mfma_f32_32x32x16_bf16 v[96:111], v[208:211], v[192:195], 0
  ds_read_b128 v[208:211], v1 offset:28672
  s_waitcnt lgkmcnt(7)
  v_mfma_f32_32x32x16_bf16 v[16:31], v[212:215], v[204:207], v[16:31]
  v_mfma_f32_32x32x16_bf16 v[96:111], v[212:215], v[196:199], v[96:111]
  ds_read_b128 v[212:215], v1 offset:29696
  s_waitcnt lgkmcnt(7)
  v_mfma_f32_32x32x16_bf16 v[32:47], v[216:219], v[200:203], 0
  s_nop 7
  v_max_f32 v11, v16, v17
  v_max3_f32 v11, v18, v19, v11
  v_max3_f32 v11, v20, v21, v11
  v_max3_f32 v11, v22, v23, v11
  v_max3_f32 v11, v24, v25, v11
  s_waitcnt lgkmcnt(6)
  v_mfma_f32_32x32x16_bf16 v[32:47], v[220:223], v[204:207], v[32:47]
  v_max3_f32 v11, v26, v27, v11
  v_max3_f32 v11, v28, v29, v11
  v_max3_f32 v11, v30, v31, v11
  v_max_f32 v9, v96, v97
  v_max3_f32 v9, v98, v99, v9
  s_waitcnt lgkmcnt(5)
  v_mfma_f32_32x32x16_bf16 v[48:63], v[224:227], v[200:203], 0
  v_max3_f32 v9, v100, v101, v9
  v_max3_f32 v9, v102, v103, v9
  v_max3_f32 v9, v104, v105, v9
  v_max3_f32 v9, v106, v107, v9
  v_max3_f32 v9, v108, v109, v9
  s_waitcnt lgkmcnt(4)
  v_mfma_f32_32x32x16_bf16 v[48:63], v[228:231], v[204:207], v[48:63]
  v_max3_f32 v11, v32, v33, v11
  v_max3_f32 v11, v34, v35, v11
  v_max3_f32 v11, v36, v37, v11
  v_max3_f32 v11, v38, v39, v11
  v_max3_f32 v11, v40, v41, v11
  s_waitcnt lgkmcnt(3)
  v_mfma_f32_32x32x16_bf16 v[64:79], v[232:235], v[200:203], 0
  v_max3_f32 v11, v42, v43, v11
  v_max3_f32 v11, v44, v45, v11
  v_max3_f32 v11, v46, v47, v11
  v_max3_f32 v9, v110, v111, v9
  v_mfma_f32_32x32x16_bf16 v[112:127], v[216:219], v[192:195], 0
  ds_read_b128 v[216:219], v1 offset:2048
  v_max3_f32 v11, v48, v49, v11
  v_max3_f32 v11, v50, v51, v11
  v_max3_f32 v11, v52, v53, v11
  v_max3_f32 v11, v54, v55, v11
  s_waitcnt lgkmcnt(3)
  v_mfma_f32_32x32x16_bf16 v[64:79], v[236:239], v[204:207], v[64:79]
  v_max3_f32 v11, v56, v57, v11
  v_max3_f32 v11, v58, v59, v11
  v_max3_f32 v11, v60, v61, v11
  v_max3_f32 v11, v62, v63, v11
  s_waitcnt lgkmcnt(2)
  v_mfma_f32_32x32x16_bf16 v[80:95], v[208:211], v[200:203], v[240:255]
  v_mfma_f32_32x32x16_bf16 v[112:127], v[220:223], v[196:199], v[112:127]
  ds_read_b128 v[220:223], v1 offset:3072
  s_nop 3
  v_max3_f32 v11, v64, v65, v11
  v_max3_f32 v11, v66, v67, v11
  v_max3_f32 v11, v68, v69, v11
  v_max3_f32 v11, v70, v71, v11
  v_mfma_f32_32x32x16_bf16 v[128:143], v[224:227], v[192:195], 0
  ds_read_b128 v[224:227], v1 offset:10240
  v_max3_f32 v11, v72, v73, v11
  v_max3_f32 v11, v74, v75, v11
  v_max3_f32 v11, v76, v77, v11
  v_max3_f32 v11, v78, v79, v11
  s_waitcnt lgkmcnt(3)
  v_mfma_f32_32x32x16_bf16 v[80:95], v[212:215], v[204:207], v[80:95]
  v_max3_f32 v9, v112, v113, v9
  v_max3_f32 v9, v114, v115, v9
  v_max3_f32 v9, v116, v117, v9
  v_max3_f32 v9, v118, v119, v9
  v_max3_f32 v9, v120, v121, v9
  v_mfma_f32_32x32x16_bf16 v[128:143], v[228:231], v[196:199], v[128:143]
  ds_read_b128 v[228:231], v1 offset:11264
  v_max3_f32 v9, v122, v123, v9
  v_max3_f32 v9, v124, v125, v9
  v_max3_f32 v9, v126, v127, v9
  v_mfma_f32_32x32x16_bf16 v[144:159], v[232:235], v[192:195], v[240:255]
  ds_read_b128 v[232:235], v1 offset:18432
  v_max3_f32 v11, v80, v81, v11
  v_max3_f32 v11, v82, v83, v11
  v_max3_f32 v11, v84, v85, v11
  v_max3_f32 v11, v86, v87, v11
  v_mfma_f32_32x32x16_bf16 v[144:159], v[236:239], v[196:199], v[144:159]
  ds_read_b128 v[236:239], v1 offset:19456
  ds_read_b128 v[208:211], v1 offset:26624
  ds_read_b128 v[212:215], v1 offset:27648
  v_max3_f32 v11, v88, v89, v11
  v_max3_f32 v9, v128, v129, v9
  v_max3_f32 v11, v90, v91, v11
  v_max3_f32 v9, v130, v131, v9
  v_max3_f32 v11, v92, v93, v11
  v_max3_f32 v9, v132, v133, v9
  v_max3_f32 v11, v94, v95, v11
  v_max3_f32 v9, v134, v135, v9
  v_mov_b32 v12, v11
  v_max3_f32 v9, v136, v137, v9
  v_max3_f32 v9, v138, v139, v9
  v_permlane32_swap_b32 v11, v12
  v_max3_f32 v9, v140, v141, v9
  v_max_f32 v6, v11, v12
  v_max3_f32 v9, v142, v143, v9
  v_sub_f32 v16, v16, v6
  v_sub_f32 v17, v17, v6
  v_exp_f32 v16, v16
  v_exp_f32 v17, v17
  v_max3_f32 v9, v144, v145, v9
  v_sub_f32 v18, v18, v6
  v_sub_f32 v19, v19, v6
  v_max3_f32 v9, v146, v147, v9
  v_exp_f32 v18, v18
  v_exp_f32 v19, v19
  v_sub_f32 v20, v20, v6
  v_sub_f32 v21, v21, v6
  v_sub_f32 v22, v22, v6
  v_sub_f32 v23, v23, v6
  v_max3_f32 v9, v148, v149, v9
  v_add_f32 v8, v16, v17
  v_exp_f32 v20, v20
  v_exp_f32 v21, v21
  v_exp_f32 v22, v22
  v_exp_f32 v23, v23
  v_max3_f32 v9, v150, v151, v9
  v_cvt_pk_bf16_f32 v16, v16, v17
  v_add_f32 v8, v8, v18
  v_max3_f32 v9, v152, v153, v9
  v_cvt_pk_bf16_f32 v17, v18, v19
  v_add_f32 v8, v8, v19
  v_max3_f32 v9, v154, v155, v9
  v_sub_f32 v24, v24, v6
  v_add_f32 v8, v8, v20
  v_cvt_pk_bf16_f32 v18, v20, v21
  v_cvt_pk_bf16_f32 v19, v22, v23
  v_exp_f32 v24, v24
  s_waitcnt lgkmcnt(7)
  v_mfma_f32_32x32x16_bf16 v[176:191], v[216:219], v[16:19], 0
  v_sub_f32 v25, v25, v6
  v_add_f32 v8, v8, v21
  v_max3_f32 v9, v156, v157, v9
  v_exp_f32 v25, v25
  v_sub_f32 v26, v26, v6
  v_add_f32 v8, v8, v22
  v_max3_f32 v9, v158, v159, v9
  v_sub_f32 v27, v27, v6
  v_exp_f32 v26, v26
  v_add_f32 v8, v8, v23
  v_mov_b32 v10, v9
  v_exp_f32 v27, v27
  v_sub_f32 v28, v28, v6
  v_sub_f32 v29, v29, v6
  v_sub_f32 v30, v30, v6
  v_sub_f32 v31, v31, v6
  v_add_f32 v8, v8, v24
  v_exp_f32 v28, v28
  v_exp_f32 v29, v29
  v_exp_f32 v30, v30
  v_exp_f32 v31, v31
  v_add_f32 v8, v8, v25
  v_cvt_pk_bf16_f32 v24, v24, v25
  v_add_f32 v8, v8, v26
  v_permlane32_swap_b32 v9, v10
  v_cvt_pk_bf16_f32 v25, v26, v27
  v_add_f32 v8, v8, v27
  v_max_f32 v5, v9, v10
  v_add_f32 v8, v8, v28
  v_cvt_pk_bf16_f32 v26, v28, v29
  v_cvt_pk_bf16_f32 v27, v30, v31
  v_sub_f32 v32, v32, v6
  v_sub_f32 v96, v96, v5
  s_waitcnt lgkmcnt(6)
  v_mfma_f32_32x32x16_bf16 v[176:191], v[220:223], v[24:27], v[176:191]
  v_sub_f32 v97, v97, v5
  v_add_f32 v8, v8, v29
  v_exp_f32 v32, v32
  v_sub_f32 v33, v33, v6
  v_exp_f32 v96, v96
  v_exp_f32 v97, v97
  v_add_f32 v8, v8, v30
  v_exp_f32 v33, v33
  v_sub_f32 v34, v34, v6
  v_sub_f32 v98, v98, v5
  v_sub_f32 v35, v35, v6
  v_sub_f32 v99, v99, v5
  v_add_f32 v8, v8, v31
  v_exp_f32 v34, v34
  v_exp_f32 v98, v98
  v_exp_f32 v35, v35
  v_exp_f32 v99, v99
  v_sub_f32 v36, v36, v6
  v_sub_f32 v37, v37, v6
  v_sub_f32 v38, v38, v6
  v_sub_f32 v39, v39, v6
  v_add_f32 v8, v8, v32
  v_sub_f32 v100, v100, v5
  v_sub_f32 v101, v101, v5
  v_sub_f32 v102, v102, v5
  v_sub_f32 v103, v103, v5
  v_add_f32 v7, v96, v97
  v_exp_f32 v36, v36
  v_exp_f32 v37, v37
  v_exp_f32 v38, v38
  v_exp_f32 v39, v39
  v_add_f32 v8, v8, v33
  v_exp_f32 v100, v100
  v_exp_f32 v101, v101
  v_exp_f32 v102, v102
  v_exp_f32 v103, v103
  v_cvt_pk_bf16_f32 v32, v32, v33
  v_cvt_pk_bf16_f32 v96, v96, v97
  v_add_f32 v8, v8, v34
  v_add_f32 v7, v7, v98
  v_cvt_pk_bf16_f32 v33, v34, v35
  v_cvt_pk_bf16_f32 v97, v98, v99
  v_add_f32 v8, v8, v35
  v_add_f32 v7, v7, v99
  v_sub_f32 v40, v40, v6
  v_add_f32 v8, v8, v36
  v_cvt_pk_bf16_f32 v34, v36, v37
  v_cvt_pk_bf16_f32 v35, v38, v39
  v_sub_f32 v104, v104, v5
  v_add_f32 v7, v7, v100
  s_waitcnt lgkmcnt(5)
  v_mfma_f32_32x32x16_bf16 v[176:191], v[224:227], v[32:35], v[176:191]
  v_cvt_pk_bf16_f32 v98, v100, v101
  v_cvt_pk_bf16_f32 v99, v102, v103
  v_exp_f32 v40, v40
  v_sub_f32 v41, v41, v6
  v_add_f32 v8, v8, v37
  v_mfma_f32_32x32x16_bf16 v[160:175], v[216:219], v[96:99], 0
  ds_read_b128 v[216:219], v1 offset:30720
  v_exp_f32 v104, v104
  v_sub_f32 v105, v105, v5
  v_add_f32 v7, v7, v101
  v_exp_f32 v41, v41
  v_sub_f32 v42, v42, v6
  v_add_f32 v8, v8, v38
  v_exp_f32 v105, v105
  v_sub_f32 v106, v106, v5
  v_add_f32 v7, v7, v102
  v_sub_f32 v43, v43, v6
  v_sub_f32 v107, v107, v5
  v_exp_f32 v42, v42
  v_add_f32 v8, v8, v39
  v_exp_f32 v106, v106
  v_add_f32 v7, v7, v103
  v_exp_f32 v43, v43
  v_exp_f32 v107, v107
  v_sub_f32 v44, v44, v6
  v_sub_f32 v45, v45, v6
  v_sub_f32 v46, v46, v6
  v_sub_f32 v47, v47, v6
  v_add_f32 v8, v8, v40
  v_sub_f32 v108, v108, v5
  v_sub_f32 v109, v109, v5
  v_sub_f32 v110, v110, v5
  v_sub_f32 v111, v111, v5
  v_add_f32 v7, v7, v104
  v_exp_f32 v44, v44
  v_exp_f32 v45, v45
  v_exp_f32 v46, v46
  v_exp_f32 v47, v47
  v_add_f32 v8, v8, v41
  v_exp_f32 v108, v108
  v_exp_f32 v109, v109
  v_exp_f32 v110, v110
  v_exp_f32 v111, v111
  v_add_f32 v7, v7, v105
  v_cvt_pk_bf16_f32 v40, v40, v41
  v_cvt_pk_bf16_f32 v104, v104, v105
  v_add_f32 v8, v8, v42
  v_add_f32 v7, v7, v106
  v_cvt_pk_bf16_f32 v41, v42, v43
  v_cvt_pk_bf16_f32 v105, v106, v107
  v_add_f32 v8, v8, v43
  v_add_f32 v7, v7, v107
  v_add_f32 v8, v8, v44
  v_cvt_pk_bf16_f32 v42, v44, v45
  v_cvt_pk_bf16_f32 v43, v46, v47
  v_sub_f32 v48, v48, v6
  v_add_f32 v7, v7, v108
  s_waitcnt lgkmcnt(5)
  v_mfma_f32_32x32x16_bf16 v[176:191], v[228:231], v[40:43], v[176:191]
  v_cvt_pk_bf16_f32 v106, v108, v109
  v_cvt_pk_bf16_f32 v107, v110, v111
  v_sub_f32 v112, v112, v5
  v_add_f32 v8, v8, v45
  v_exp_f32 v48, v48
  v_mfma_f32_32x32x16_bf16 v[160:175], v[220:223], v[104:107], v[160:175]
  ds_read_b128 v[220:223], v1 offset:31744
  v_sub_f32 v49, v49, v6
  v_add_f32 v7, v7, v109
  v_exp_f32 v112, v112
  v_sub_f32 v113, v113, v5
  v_add_f32 v8, v8, v46
  v_exp_f32 v49, v49
  v_sub_f32 v50, v50, v6
  v_add_f32 v7, v7, v110
  v_exp_f32 v113, v113
  v_sub_f32 v114, v114, v5
  v_sub_f32 v51, v51, v6
  v_sub_f32 v115, v115, v5
  v_add_f32 v8, v8, v47
  v_exp_f32 v50, v50
  v_add_f32 v7, v7, v111
  v_exp_f32 v114, v114
  v_exp_f32 v51, v51
  v_exp_f32 v115, v115
  v_sub_f32 v52, v52, v6
  v_sub_f32 v53, v53, v6
  v_sub_f32 v54, v54, v6
  v_sub_f32 v55, v55, v6
  v_add_f32 v8, v8, v48
  v_sub_f32 v116, v116, v5
  v_sub_f32 v117, v117, v5
  v_sub_f32 v118, v118, v5
  v_sub_f32 v119, v119, v5
  v_add_f32 v7, v7, v112
  v_exp_f32 v52, v52
  v_exp_f32 v53, v53
  v_exp_f32 v54, v54
  v_exp_f32 v55, v55
  v_add_f32 v8, v8, v49
  v_exp_f32 v116, v116
  v_exp_f32 v117, v117
  v_exp_f32 v118, v118
  v_exp_f32 v119, v119
  v_add_f32 v7, v7, v113
  v_cvt_pk_bf16_f32 v48, v48, v49
  v_cvt_pk_bf16_f32 v112, v112, v113
  v_add_f32 v8, v8, v50
  v_add_f32 v7, v7, v114
  v_cvt_pk_bf16_f32 v49, v50, v51
  v_cvt_pk_bf16_f32 v113, v114, v115
  v_add_f32 v8, v8, v51
  v_add_f32 v7, v7, v115
  v_sub_f32 v56, v56, v6
  v_add_f32 v8, v8, v52
  v_cvt_pk_bf16_f32 v50, v52, v53
  v_cvt_pk_bf16_f32 v51, v54, v55
  v_sub_f32 v120, v120, v5
  v_add_f32 v7, v7, v116
  s_waitcnt lgkmcnt(5)
  v_mfma_f32_32x32x16_bf16 v[176:191], v[232:235], v[48:51], v[176:191]
  v_cvt_pk_bf16_f32 v114, v116, v117
  v_cvt_pk_bf16_f32 v115, v118, v119
  v_exp_f32 v56, v56
  v_sub_f32 v57, v57, v6
  v_add_f32 v8, v8, v53
  v_mfma_f32_32x32x16_bf16 v[160:175], v[224:227], v[112:115], v[160:175]
  v_exp_f32 v120, v120
  v_sub_f32 v121, v121, v5
  v_add_f32 v7, v7, v117
  v_exp_f32 v57, v57
  v_sub_f32 v58, v58, v6
  v_add_f32 v8, v8, v54
  v_exp_f32 v121, v121
  v_sub_f32 v122, v122, v5
  v_add_f32 v7, v7, v118
  v_sub_f32 v59, v59, v6
  v_sub_f32 v123, v123, v5
  v_exp_f32 v58, v58
  v_add_f32 v8, v8, v55
  v_exp_f32 v122, v122
  v_add_f32 v7, v7, v119
  v_exp_f32 v59, v59
  v_exp_f32 v123, v123
  v_sub_f32 v60, v60, v6
  v_sub_f32 v61, v61, v6
  v_sub_f32 v62, v62, v6
  v_sub_f32 v63, v63, v6
  v_add_f32 v8, v8, v56
  v_sub_f32 v124, v124, v5
  v_sub_f32 v125, v125, v5
  v_sub_f32 v126, v126, v5
  v_sub_f32 v127, v127, v5
  v_add_f32 v7, v7, v120
  v_exp_f32 v60, v60
  v_exp_f32 v61, v61
  v_exp_f32 v62, v62
  v_exp_f32 v63, v63
  v_add_f32 v8, v8, v57
  v_exp_f32 v124, v124
  v_exp_f32 v125, v125
  v_exp_f32 v126, v126
  v_exp_f32 v127, v127
  v_add_f32 v7, v7, v121
  v_cvt_pk_bf16_f32 v56, v56, v57
  v_cvt_pk_bf16_f32 v120, v120, v121
  v_add_f32 v8, v8, v58
  v_add_f32 v7, v7, v122
  v_cvt_pk_bf16_f32 v57, v58, v59
  v_cvt_pk_bf16_f32 v121, v122, v123
  v_add_f32 v8, v8, v59
  v_add_f32 v7, v7, v123
  v_add_f32 v8, v8, v60
  v_cvt_pk_bf16_f32 v58, v60, v61
  v_cvt_pk_bf16_f32 v59, v62, v63
  v_sub_f32 v64, v64, v6
  v_add_f32 v7, v7, v124
  s_waitcnt lgkmcnt(4)
  v_mfma_f32_32x32x16_bf16 v[176:191], v[236:239], v[56:59], v[176:191]
  v_cvt_pk_bf16_f32 v122, v124, v125
  v_cvt_pk_bf16_f32 v123, v126, v127
  v_sub_f32 v128, v128, v5
  v_add_f32 v8, v8, v61
  v_exp_f32 v64, v64
  v_mfma_f32_32x32x16_bf16 v[160:175], v[228:231], v[120:123], v[160:175]
  v_sub_f32 v65, v65, v6
  v_add_f32 v7, v7, v125
  v_exp_f32 v128, v128
  v_sub_f32 v129, v129, v5
  v_add_f32 v8, v8, v62
  v_exp_f32 v65, v65
  v_sub_f32 v66, v66, v6
  v_add_f32 v7, v7, v126
  v_exp_f32 v129, v129
  v_sub_f32 v130, v130, v5
  v_sub_f32 v67, v67, v6
  v_sub_f32 v131, v131, v5
  v_add_f32 v8, v8, v63
  v_exp_f32 v66, v66
  v_add_f32 v7, v7, v127
  v_exp_f32 v130, v130
  v_exp_f32 v67, v67
  v_exp_f32 v131, v131
  v_sub_f32 v68, v68, v6
  v_sub_f32 v69, v69, v6
  v_sub_f32 v70, v70, v6
  v_sub_f32 v71, v71, v6
  v_add_f32 v8, v8, v64
  v_sub_f32 v132, v132, v5
  v_sub_f32 v133, v133, v5
  v_sub_f32 v134, v134, v5
  v_sub_f32 v135, v135, v5
  v_add_f32 v7, v7, v128
  v_exp_f32 v68, v68
  v_exp_f32 v69, v69
  v_exp_f32 v70, v70
  v_exp_f32 v71, v71
  v_add_f32 v8, v8, v65
  v_exp_f32 v132, v132
  v_exp_f32 v133, v133
  v_exp_f32 v134, v134
  v_exp_f32 v135, v135
  v_add_f32 v7, v7, v129
  v_cvt_pk_bf16_f32 v64, v64, v65
  v_cvt_pk_bf16_f32 v128, v128, v129
  v_add_f32 v8, v8, v66
  v_add_f32 v7, v7, v130
  v_cvt_pk_bf16_f32 v65, v66, v67
  v_cvt_pk_bf16_f32 v129, v130, v131
  v_add_f32 v8, v8, v67
  v_add_f32 v7, v7, v131
  v_sub_f32 v72, v72, v6
  v_add_f32 v8, v8, v68
  v_cvt_pk_bf16_f32 v66, v68, v69
  v_cvt_pk_bf16_f32 v67, v70, v71
  v_sub_f32 v136, v136, v5
  v_add_f32 v7, v7, v132
  s_waitcnt lgkmcnt(3)
  v_mfma_f32_32x32x16_bf16 v[176:191], v[208:211], v[64:67], v[176:191]
  v_cvt_pk_bf16_f32 v130, v132, v133
  v_cvt_pk_bf16_f32 v131, v134, v135
  v_exp_f32 v72, v72
  v_sub_f32 v73, v73, v6
  v_add_f32 v8, v8, v69
  v_mfma_f32_32x32x16_bf16 v[160:175], v[232:235], v[128:131], v[160:175]
  v_exp_f32 v136, v136
  v_sub_f32 v137, v137, v5
  v_add_f32 v7, v7, v133
  v_exp_f32 v73, v73
  v_sub_f32 v74, v74, v6
  v_add_f32 v8, v8, v70
  v_exp_f32 v137, v137
  v_sub_f32 v138, v138, v5
  v_add_f32 v7, v7, v134
  v_sub_f32 v75, v75, v6
  v_sub_f32 v139, v139, v5
  v_exp_f32 v74, v74
  v_add_f32 v8, v8, v71
  v_exp_f32 v138, v138
  v_add_f32 v7, v7, v135
  v_exp_f32 v75, v75
  v_exp_f32 v139, v139
  v_sub_f32 v76, v76, v6
  v_sub_f32 v77, v77, v6
  v_sub_f32 v78, v78, v6
  v_sub_f32 v79, v79, v6
  v_add_f32 v8, v8, v72
  v_sub_f32 v140, v140, v5
  v_sub_f32 v141, v141, v5
  v_sub_f32 v142, v142, v5
  v_sub_f32 v143, v143, v5
  v_add_f32 v7, v7, v136
  v_exp_f32 v76, v76
  v_exp_f32 v77, v77
  v_exp_f32 v78, v78
  v_exp_f32 v79, v79
  v_add_f32 v8, v8, v73
  v_exp_f32 v140, v140
  v_exp_f32 v141, v141
  v_exp_f32 v142, v142
  v_exp_f32 v143, v143
  v_add_f32 v7, v7, v137
  v_cvt_pk_bf16_f32 v72, v72, v73
  v_cvt_pk_bf16_f32 v136, v136, v137
  v_add_f32 v8, v8, v74
  v_add_f32 v7, v7, v138
  v_cvt_pk_bf16_f32 v73, v74, v75
  v_cvt_pk_bf16_f32 v137, v138, v139
  v_add_f32 v8, v8, v75
  v_add_f32 v7, v7, v139
  v_add_f32 v8, v8, v76
  v_cvt_pk_bf16_f32 v74, v76, v77
  v_cvt_pk_bf16_f32 v75, v78, v79
  v_sub_f32 v80, v80, v6
  v_add_f32 v7, v7, v140
  s_waitcnt lgkmcnt(2)
  v_mfma_f32_32x32x16_bf16 v[176:191], v[212:215], v[72:75], v[176:191]
  v_cvt_pk_bf16_f32 v138, v140, v141
  v_cvt_pk_bf16_f32 v139, v142, v143
  v_sub_f32 v144, v144, v5
  v_add_f32 v8, v8, v77
  v_exp_f32 v80, v80
  v_mfma_f32_32x32x16_bf16 v[160:175], v[236:239], v[136:139], v[160:175]
  v_sub_f32 v81, v81, v6
  v_add_f32 v7, v7, v141
  v_exp_f32 v144, v144
  v_sub_f32 v145, v145, v5
  v_add_f32 v8, v8, v78
  v_exp_f32 v81, v81
  v_sub_f32 v82, v82, v6
  v_add_f32 v7, v7, v142
  v_exp_f32 v145, v145
  v_sub_f32 v146, v146, v5
  v_sub_f32 v83, v83, v6
  v_sub_f32 v147, v147, v5
  v_add_f32 v8, v8, v79
  v_exp_f32 v82, v82
  v_add_f32 v7, v7, v143
  v_exp_f32 v146, v146
  v_exp_f32 v83, v83
  v_exp_f32 v147, v147
  v_sub_f32 v84, v84, v6
  v_sub_f32 v85, v85, v6
  v_sub_f32 v86, v86, v6
  v_sub_f32 v87, v87, v6
  v_add_f32 v8, v8, v80
  v_sub_f32 v148, v148, v5
  v_sub_f32 v149, v149, v5
  v_sub_f32 v150, v150, v5
  v_sub_f32 v151, v151, v5
  v_add_f32 v7, v7, v144
  v_exp_f32 v84, v84
  v_exp_f32 v85, v85
  v_exp_f32 v86, v86
  v_exp_f32 v87, v87
  v_add_f32 v8, v8, v81
  v_exp_f32 v148, v148
  v_exp_f32 v149, v149
  v_exp_f32 v150, v150
  v_exp_f32 v151, v151
  v_add_f32 v7, v7, v145
  v_cvt_pk_bf16_f32 v80, v80, v81
  v_cvt_pk_bf16_f32 v144, v144, v145
  v_add_f32 v8, v8, v82
  v_add_f32 v7, v7, v146
  v_cvt_pk_bf16_f32 v81, v82, v83
  v_cvt_pk_bf16_f32 v145, v146, v147
  v_add_f32 v8, v8, v83
  v_add_f32 v7, v7, v147
  v_sub_f32 v88, v88, v6
  v_add_f32 v8, v8, v84
  v_cvt_pk_bf16_f32 v82, v84, v85
  v_cvt_pk_bf16_f32 v83, v86, v87
  v_sub_f32 v152, v152, v5
  v_add_f32 v7, v7, v148
  s_waitcnt lgkmcnt(1)
  v_mfma_f32_32x32x16_bf16 v[176:191], v[216:219], v[80:83], v[176:191]
  v_cvt_pk_bf16_f32 v146, v148, v149
  v_cvt_pk_bf16_f32 v147, v150, v151
  v_exp_f32 v88, v88
  v_sub_f32 v89, v89, v6
  v_add_f32 v8, v8, v85
  v_mfma_f32_32x32x16_bf16 v[160:175], v[208:211], v[144:147], v[160:175]
  v_exp_f32 v152, v152
  v_sub_f32 v153, v153, v5
  v_add_f32 v7, v7, v149
  v_exp_f32 v89, v89
  v_sub_f32 v90, v90, v6
  v_add_f32 v8, v8, v86
  v_exp_f32 v153, v153
  v_sub_f32 v154, v154, v5
  v_add_f32 v7, v7, v150
  v_sub_f32 v91, v91, v6
  v_sub_f32 v155, v155, v5
  v_exp_f32 v90, v90
  v_add_f32 v8, v8, v87
  v_exp_f32 v154, v154
  v_add_f32 v7, v7, v151
  v_exp_f32 v91, v91
  v_exp_f32 v155, v155
  v_sub_f32 v92, v92, v6
  v_sub_f32 v93, v93, v6
  v_sub_f32 v94, v94, v6
  v_sub_f32 v95, v95, v6
  v_add_f32 v8, v8, v88
  v_sub_f32 v156, v156, v5
  v_sub_f32 v157, v157, v5
  v_sub_f32 v158, v158, v5
  v_sub_f32 v159, v159, v5
  v_add_f32 v7, v7, v152
  v_exp_f32 v92, v92
  v_exp_f32 v93, v93
  v_exp_f32 v94, v94
  v_exp_f32 v95, v95
  v_add_f32 v8, v8, v89
  v_exp_f32 v156, v156
  v_exp_f32 v157, v157
  v_exp_f32 v158, v158
  v_exp_f32 v159, v159
  v_add_f32 v7, v7, v153
  v_cvt_pk_bf16_f32 v88, v88, v89
  v_cvt_pk_bf16_f32 v152, v152, v153
  v_add_f32 v8, v8, v90
  v_add_f32 v7, v7, v154
  v_cvt_pk_bf16_f32 v89, v90, v91
  v_cvt_pk_bf16_f32 v153, v154, v155
  v_add_f32 v8, v8, v91
  v_add_f32 v7, v7, v155
  v_cvt_pk_bf16_f32 v90, v92, v93
  v_cvt_pk_bf16_f32 v91, v94, v95
  v_cvt_pk_bf16_f32 v154, v156, v157
  v_cvt_pk_bf16_f32 v155, v158, v159
  s_waitcnt lgkmcnt(0)
  v_mfma_f32_32x32x16_bf16 v[176:191], v[220:223], v[88:91], v[176:191]
  v_add_f32 v8, v8, v92
  v_add_f32 v7, v7, v156
  v_add_f32 v8, v8, v93
  v_add_f32 v7, v7, v157
  v_add_f32 v8, v8, v94
  v_add_f32 v7, v7, v158
  v_mfma_f32_32x32x16_bf16 v[160:175], v[212:215], v[152:155], v[160:175]
  v_add_f32 v8, v8, v95
  v_add_f32 v7, v7, v159
  s_cmp_eq_u32 s5, 0
  s_nop 7
  s_cbranch_scc1 K1_SFIN
  ds_read_b128 v[208:211], v2 offset:24576
  ds_read_b128 v[212:215], v2 offset:25600
  ds_read_b128 v[216:219], v2 offset:28672
  ds_read_b128 v[220:223], v2 offset:29696
  ds_read_b128 v[224:227], v2 offset:20480
  ds_read_b128 v[228:231], v2 offset:21504
  ds_read_b128 v[232:235], v2 offset:12288
  ds_read_b128 v[236:239], v2 offset:13312
  v_mov_b32 v156, 0xf149f2ca
  v_sub_f32 v240, v156, v240
  v_sub_f32 v241, v156, v241
  v_sub_f32 v242, v156, v242
  v_sub_f32 v243, v156, v243
  v_sub_f32 v244, v156, v244
  v_sub_f32 v245, v156, v245
  v_sub_f32 v246, v156, v246
  v_sub_f32 v247, v156, v247
  v_sub_f32 v248, v156, v248
  v_sub_f32 v249, v156, v249
  v_sub_f32 v250, v156, v250
  v_sub_f32 v251, v156, v251
  v_sub_f32 v252, v156, v252
  v_sub_f32 v253, v156, v253
  v_sub_f32 v254, v156, v254
  v_sub_f32 v255, v156, v255
  s_waitcnt lgkmcnt(7)
  s_nop 0
  v_mfma_f32_32x32x16_bf16 v[16:31], v[208:211], v[192:195], v[240:255]
  ds_read_b128 v[208:211], v2 offset:4096
  s_waitcnt lgkmcnt(7)
  v_mfma_f32_32x32x16_bf16 v[16:31], v[212:215], v[196:199], v[16:31]
  ds_read_b128 v[212:215], v2 offset:5120
  s_waitcnt lgkmcnt(7)
  v_mfma_f32_32x32x16_bf16 v[32:47], v[216:219], v[192:195], 0
  s_waitcnt lgkmcnt(6)
  v_mfma_f32_32x32x16_bf16 v[32:47], v[220:223], v[196:199], v[32:47]
  s_nop 6
  v_max3_f32 v9, v16, v17, v5
  v_max3_f32 v9, v18, v19, v9
  v_max3_f32 v9, v20, v21, v9
  v_max3_f32 v9, v22, v23, v9
  v_max3_f32 v9, v24, v25, v9
  s_waitcnt lgkmcnt(5)
  v_mfma_f32_32x32x16_bf16 v[48:63], v[224:227], v[192:195], 0
  v_max3_f32 v9, v26, v27, v9
  v_max3_f32 v9, v28, v29, v9
  v_max3_f32 v9, v30, v31, v9
  v_mfma_f32_32x32x16_bf16 v[96:111], v[216:219], v[200:203], v[240:255]
  ds_read_b128 v[216:219], v2 offset:26624
  v_max3_f32 v9, v32, v33, v9
  v_max3_f32 v9, v34, v35, v9
  v_max3_f32 v9, v36, v37, v9
  v_max3_f32 v9, v38, v39, v9
  s_waitcnt lgkmcnt(5)
  v_mfma_f32_32x32x16_bf16 v[48:63], v[228:231], v[196:199], v[48:63]
  v_max3_f32 v9, v40, v41, v9
  v_max3_f32 v9, v42, v43, v9
  v_max3_f32 v9, v44, v45, v9
  v_max3_f32 v9, v46, v47, v9
  s_waitcnt lgkmcnt(4)
  v_mfma_f32_32x32x16_bf16 v[64:79], v[232:235], v[192:195], 0
  v_mfma_f32_32x32x16_bf16 v[96:111], v[220:223], v[204:207], v[96:111]
  ds_read_b128 v[220:223], v2 offset:27648
  s_nop 3
  v_max3_f32 v9, v48, v49, v9
  v_max3_f32 v9, v50, v51, v9
  v_max3_f32 v9, v52, v53, v9
  v_max3_f32 v9, v54, v55, v9
  v_mfma_f32_32x32x16_bf16 v[112:127], v[224:227], v[200:203], 0
  ds_read_b128 v[224:227], v2 offset:30720
  v_max3_f32 v9, v56, v57, v9
  v_max3_f32 v9, v58, v59, v9
  v_max3_f32 v9, v60, v61, v9
  v_max3_f32 v9, v62, v63, v9
  s_waitcnt lgkmcnt(5)
  v_mfma_f32_32x32x16_bf16 v[64:79], v[236:239], v[196:199], v[64:79]
  v_max3_f32 v11, v96, v97, v6
  v_max3_f32 v11, v98, v99, v11
  v_max3_f32 v11, v100, v101, v11
  v_max3_f32 v11, v102, v103, v11
  v_max3_f32 v11, v104, v105, v11
  s_waitcnt lgkmcnt(4)
  v_mfma_f32_32x32x16_bf16 v[80:95], v[208:211], v[192:195], 0
  v_max3_f32 v11, v106, v107, v11
  v_max3_f32 v11, v108, v109, v11
  v_max3_f32 v11, v110, v111, v11
  v_mfma_f32_32x32x16_bf16 v[112:127], v[228:231], v[204:207], v[112:127]
  ds_read_b128 v[228:231], v2 offset:31744
  v_max3_f32 v9, v64, v65, v9
  v_max3_f32 v9, v66, v67, v9
  v_max3_f32 v9, v68, v69, v9
  v_max3_f32 v9, v70, v71, v9
  v_mfma_f32_32x32x16_bf16 v[128:143], v[232:235], v[200:203], 0
  ds_read_b128 v[232:235], v2 offset:22528
  v_max3_f32 v9, v72, v73, v9
  v_max3_f32 v9, v74, v75, v9
  v_max3_f32 v9, v76, v77, v9
  v_max3_f32 v9, v78, v79, v9
  s_waitcnt lgkmcnt(5)
  v_mfma_f32_32x32x16_bf16 v[80:95], v[212:215], v[196:199], v[80:95]
  v_max3_f32 v11, v112, v113, v11
  v_max3_f32 v11, v114, v115, v11
  v_max3_f32 v11, v116, v117, v11
  v_max3_f32 v11, v118, v119, v11
  v_max3_f32 v11, v120, v121, v11
  v_mfma_f32_32x32x16_bf16 v[128:143], v[236:239], v[204:207], v[128:143]
  ds_read_b128 v[236:239], v2 offset:23552
  v_max3_f32 v11, v122, v123, v11
  v_max3_f32 v11, v124, v125, v11
  v_max3_f32 v11, v126, v127, v11
  v_mfma_f32_32x32x16_bf16 v[144:159], v[208:211], v[200:203], 0
  ds_read_b128 v[208:211], v2 offset:14336
  v_max3_f32 v9, v80, v81, v9
  v_max3_f32 v9, v82, v83, v9
  v_max3_f32 v9, v84, v85, v9
  v_max3_f32 v9, v86, v87, v9
  v_mfma_f32_32x32x16_bf16 v[144:159], v[212:215], v[204:207], v[144:159]
  ds_read_b128 v[212:215], v2 offset:15360
  v_max3_f32 v9, v88, v89, v9
  v_max3_f32 v11, v128, v129, v11
  v_max3_f32 v9, v90, v91, v9
  v_max3_f32 v11, v130, v131, v11
  v_max3_f32 v9, v92, v93, v9
  v_max3_f32 v11, v132, v133, v11
  v_max3_f32 v9, v94, v95, v9
  v_max3_f32 v11, v134, v135, v11
  v_mov_b32 v10, v9
  v_max3_f32 v11, v136, v137, v11
  v_max3_f32 v11, v138, v139, v11
  v_permlane32_swap_b32 v9, v10
  v_max3_f32 v11, v140, v141, v11
  v_max_f32 v9, v9, v10
  v_max3_f32 v11, v142, v143, v11
  v_sub_f32 v10, v5, v9
  v_mov_b32 v5, v9
  v_max3_f32 v11, v144, v145, v11
  v_exp_f32 v10, v10
  v_sub_f32 v16, v16, v5
  v_max3_f32 v11, v146, v147, v11
  v_exp_f32 v16, v16
  v_sub_f32 v17, v17, v5
  v_max3_f32 v11, v148, v149, v11
  v_exp_f32 v17, v17
  v_sub_f32 v18, v18, v5
  v_sub_f32 v19, v19, v5
  v_max3_f32 v11, v150, v151, v11
  v_mul_f32 v7, v7, v10
  v_exp_f32 v18, v18
  v_exp_f32 v19, v19
  v_sub_f32 v20, v20, v5
  v_sub_f32 v21, v21, v5
  v_sub_f32 v22, v22, v5
  v_sub_f32 v23, v23, v5
  v_add_f32 v7, v7, v16
  v_max3_f32 v11, v152, v153, v11
  v_exp_f32 v20, v20
  v_exp_f32 v21, v21
  v_exp_f32 v22, v22
  v_exp_f32 v23, v23
  v_add_f32 v7, v7, v17
  v_max3_f32 v11, v154, v155, v11
  v_cvt_pk_bf16_f32 v16, v16, v17
  v_add_f32 v7, v7, v18
  v_max3_f32 v11, v156, v157, v11
  v_cvt_pk_bf16_f32 v17, v18, v19
  v_add_f32 v7, v7, v19
  v_max3_f32 v11, v158, v159, v11
  v_mul_f32 v160, v160, v10
  v_mul_f32 v161, v161, v10
  v_mul_f32 v162, v162, v10
  v_mul_f32 v163, v163, v10
  v_mul_f32 v164, v164, v10
  v_mul_f32 v165, v165, v10
  v_mul_f32 v166, v166, v10
  v_mul_f32 v167, v167, v10
  v_mul_f32 v168, v168, v10
  v_mul_f32 v169, v169, v10
  v_mul_f32 v170, v170, v10
  v_mul_f32 v171, v171, v10
  v_mul_f32 v172, v172, v10
  v_mul_f32 v173, v173, v10
  v_mul_f32 v174, v174, v10
  v_mul_f32 v175, v175, v10
  v_sub_f32 v24, v24, v5
  v_add_f32 v7, v7, v20
  v_cvt_pk_bf16_f32 v18, v20, v21
  v_cvt_pk_bf16_f32 v19, v22, v23
  v_exp_f32 v24, v24
  s_waitcnt lgkmcnt(7)
  v_mfma_f32_32x32x16_bf16 v[160:175], v[216:219], v[16:19], v[160:175]
  ds_read_b128 v[216:219], v2 offset:6144
  v_sub_f32 v25, v25, v5
  v_add_f32 v7, v7, v21
  v_mov_b32 v12, v11
  v_exp_f32 v25, v25
  v_sub_f32 v26, v26, v5
  v_add_f32 v7, v7, v22
  v_sub_f32 v27, v27, v5
  v_exp_f32 v26, v26
  v_add_f32 v7, v7, v23
  v_exp_f32 v27, v27
  v_sub_f32 v28, v28, v5
  v_sub_f32 v29, v29, v5
  v_sub_f32 v30, v30, v5
  v_sub_f32 v31, v31, v5
  v_add_f32 v7, v7, v24
  v_permlane32_swap_b32 v11, v12
  v_exp_f32 v28, v28
  v_exp_f32 v29, v29
  v_exp_f32 v30, v30
  v_exp_f32 v31, v31
  v_add_f32 v7, v7, v25
  v_max_f32 v11, v11, v12
  v_cvt_pk_bf16_f32 v24, v24, v25
  v_add_f32 v7, v7, v26
  v_sub_f32 v12, v6, v11
  v_cvt_pk_bf16_f32 v25, v26, v27
  v_add_f32 v7, v7, v27
  v_mov_b32 v6, v11
  v_add_f32 v7, v7, v28
  v_cvt_pk_bf16_f32 v26, v28, v29
  v_cvt_pk_bf16_f32 v27, v30, v31
  v_sub_f32 v32, v32, v5
  v_exp_f32 v12, v12
  s_waitcnt lgkmcnt(7)
  v_mfma_f32_32x32x16_bf16 v[160:175], v[220:223], v[24:27], v[160:175]
  ds_read_b128 v[220:223], v2 offset:7168
  v_sub_f32 v96, v96, v6
  v_add_f32 v7, v7, v29
  v_exp_f32 v32, v32
  v_sub_f32 v33, v33, v5
  v_exp_f32 v96, v96
  v_sub_f32 v97, v97, v6
  v_add_f32 v7, v7, v30
  v_exp_f32 v33, v33
  v_sub_f32 v34, v34, v5
  v_exp_f32 v97, v97
  v_sub_f32 v98, v98, v6
  v_sub_f32 v35, v35, v5
  v_sub_f32 v99, v99, v6
  v_add_f32 v7, v7, v31
  v_exp_f32 v34, v34
  v_mul_f32 v8, v8, v12
  v_exp_f32 v98, v98
  v_exp_f32 v35, v35
  v_exp_f32 v99, v99
  v_sub_f32 v36, v36, v5
  v_sub_f32 v37, v37, v5
  v_sub_f32 v38, v38, v5
  v_sub_f32 v39, v39, v5
  v_add_f32 v7, v7, v32
  v_sub_f32 v100, v100, v6
  v_sub_f32 v101, v101, v6
  v_sub_f32 v102, v102, v6
  v_sub_f32 v103, v103, v6
  v_add_f32 v8, v8, v96
  v_exp_f32 v36, v36
  v_exp_f32 v37, v37
  v_exp_f32 v38, v38
  v_exp_f32 v39, v39
  v_add_f32 v7, v7, v33
  v_exp_f32 v100, v100
  v_exp_f32 v101, v101
  v_exp_f32 v102, v102
  v_exp_f32 v103, v103
  v_add_f32 v8, v8, v97
  v_cvt_pk_bf16_f32 v32, v32, v33
  v_cvt_pk_bf16_f32 v96, v96, v97
  v_add_f32 v7, v7, v34
  v_add_f32 v8, v8, v98
  v_cvt_pk_bf16_f32 v33, v34, v35
  v_cvt_pk_bf16_f32 v97, v98, v99
  v_add_f32 v7, v7, v35
  v_add_f32 v8, v8, v99
  v_sub_f32 v40, v40, v5
  v_add_f32 v7, v7, v36
  v_cvt_pk_bf16_f32 v34, v36, v37
  v_cvt_pk_bf16_f32 v35, v38, v39
  v_mul_f32 v176, v176, v12
  v_mul_f32 v177, v177, v12
  s_waitcnt lgkmcnt(7)
  v_mfma_f32_32x32x16_bf16 v[160:175], v[224:227], v[32:35], v[160:175]
  v_mul_f32 v178, v178, v12
  v_mul_f32 v179, v179, v12
  v_mul_f32 v180, v180, v12
  v_mul_f32 v181, v181, v12
  v_mul_f32 v182, v182, v12
  v_mul_f32 v183, v183, v12
  v_mul_f32 v184, v184, v12
  v_mul_f32 v185, v185, v12
  v_mul_f32 v186, v186, v12
  v_mul_f32 v187, v187, v12
  v_mul_f32 v188, v188, v12
  v_mul_f32 v189, v189, v12
  v_mul_f32 v190, v190, v12
  v_mul_f32 v191, v191, v12
  v_sub_f32 v104, v104, v6
  v_add_f32 v8, v8, v100
  v_cvt_pk_bf16_f32 v98, v100, v101
  v_cvt_pk_bf16_f32 v99, v102, v103
  v_exp_f32 v40, v40
  s_nop 0
  v_mfma_f32_32x32x16_bf16 v[176:191], v[224:227], v[96:99], v[176:191]
  v_sub_f32 v41, v41, v5
  v_add_f32 v7, v7, v37
  v_exp_f32 v104, v104
  v_sub_f32 v105, v105, v6
  v_add_f32 v8, v8, v101
  v_exp_f32 v41, v41
  v_sub_f32 v42, v42, v5
  v_add_f32 v7, v7, v38
  v_exp_f32 v105, v105
  v_sub_f32 v106, v106, v6
  v_add_f32 v8, v8, v102
  v_sub_f32 v43, v43, v5
  v_sub_f32 v107, v107, v6
  v_exp_f32 v42, v42
  v_add_f32 v7, v7, v39
  v_exp_f32 v106, v106
  v_add_f32 v8, v8, v103
  v_exp_f32 v43, v43
  v_exp_f32 v107, v107
  v_sub_f32 v44, v44, v5
  v_sub_f32 v45, v45, v5
  v_sub_f32 v46, v46, v5
  v_sub_f32 v47, v47, v5
  v_add_f32 v7, v7, v40
  v_sub_f32 v108, v108, v6
  v_sub_f32 v109, v109, v6
  v_sub_f32 v110, v110, v6
  v_sub_f32 v111, v111, v6
  v_add_f32 v8, v8, v104
  v_exp_f32 v44, v44
  v_exp_f32 v45, v45
  v_exp_f32 v46, v46
  v_exp_f32 v47, v47
  v_add_f32 v7, v7, v41
  v_exp_f32 v108, v108
  v_exp_f32 v109, v109
  v_exp_f32 v110, v110
  v_exp_f32 v111, v111
  v_add_f32 v8, v8, v105
  v_cvt_pk_bf16_f32 v40, v40, v41
  v_cvt_pk_bf16_f32 v104, v104, v105
  v_add_f32 v7, v7, v42
  v_add_f32 v8, v8, v106
  v_cvt_pk_bf16_f32 v41, v42, v43
  v_cvt_pk_bf16_f32 v105, v106, v107
  v_add_f32 v7, v7, v43
  v_add_f32 v8, v8, v107
  v_add_f32 v7, v7, v44
  v_cvt_pk_bf16_f32 v42, v44, v45
  v_cvt_pk_bf16_f32 v43, v46, v47
  v_sub_f32 v48, v48, v5
  v_add_f32 v8, v8, v108
  s_waitcnt lgkmcnt(6)
  v_mfma_f32_32x32x16_bf16 v[160:175], v[228:231], v[40:43], v[160:175]
  v_cvt_pk_bf16_f32 v106, v108, v109
  v_cvt_pk_bf16_f32 v107, v110, v111
  v_sub_f32 v112, v112, v6
  v_add_f32 v7, v7, v45
  v_exp_f32 v48, v48
  v_mfma_f32_32x32x16_bf16 v[176:191], v[228:231], v[104:107], v[176:191]
  v_sub_f32 v49, v49, v5
  v_add_f32 v8, v8, v109
  v_exp_f32 v112, v112
  v_sub_f32 v113, v113, v6
  v_add_f32 v7, v7, v46
  v_exp_f32 v49, v49
  v_sub_f32 v50, v50, v5
  v_add_f32 v8, v8, v110
  v_exp_f32 v113, v113
  v_sub_f32 v114, v114, v6
  v_sub_f32 v51, v51, v5
  v_sub_f32 v115, v115, v6
  v_add_f32 v7, v7, v47
  v_exp_f32 v50, v50
  v_add_f32 v8, v8, v111
  v_exp_f32 v114, v114
  v_exp_f32 v51, v51
  v_exp_f32 v115, v115
  v_sub_f32 v52, v52, v5
  v_sub_f32 v53, v53, v5
  v_sub_f32 v54, v54, v5
  v_sub_f32 v55, v55, v5
  v_add_f32 v7, v7, v48
  v_sub_f32 v116, v116, v6
  v_sub_f32 v117, v117, v6
  v_sub_f32 v118, v118, v6
  v_sub_f32 v119, v119, v6
  v_add_f32 v8, v8, v112
  v_exp_f32 v52, v52
  v_exp_f32 v53, v53
  v_exp_f32 v54, v54
  v_exp_f32 v55, v55
  v_add_f32 v7, v7, v49
  v_exp_f32 v116, v116
  v_exp_f32 v117, v117
  v_exp_f32 v118, v118
  v_exp_f32 v119, v119
  v_add_f32 v8, v8, v113
  v_cvt_pk_bf16_f32 v48, v48, v49
  v_cvt_pk_bf16_f32 v112, v112, v113
  v_add_f32 v7, v7, v50
  v_add_f32 v8, v8, v114
  v_cvt_pk_bf16_f32 v49, v50, v51
  v_cvt_pk_bf16_f32 v113, v114, v115
  v_add_f32 v7, v7, v51
  v_add_f32 v8, v8, v115
  v_sub_f32 v56, v56, v5
  v_add_f32 v7, v7, v52
  v_cvt_pk_bf16_f32 v50, v52, v53
  v_cvt_pk_bf16_f32 v51, v54, v55
  v_sub_f32 v120, v120, v6
  v_add_f32 v8, v8, v116
  s_waitcnt lgkmcnt(5)
  v_mfma_f32_32x32x16_bf16 v[160:175], v[232:235], v[48:51], v[160:175]
  v_cvt_pk_bf16_f32 v114, v116, v117
  v_cvt_pk_bf16_f32 v115, v118, v119
  v_exp_f32 v56, v56
  v_sub_f32 v57, v57, v5
  v_add_f32 v7, v7, v53
  v_mfma_f32_32x32x16_bf16 v[176:191], v[232:235], v[112:115], v[176:191]
  v_exp_f32 v120, v120
  v_sub_f32 v121, v121, v6
  v_add_f32 v8, v8, v117
  v_exp_f32 v57, v57
  v_sub_f32 v58, v58, v5
  v_add_f32 v7, v7, v54
  v_exp_f32 v121, v121
  v_sub_f32 v122, v122, v6
  v_add_f32 v8, v8, v118
  v_sub_f32 v59, v59, v5
  v_sub_f32 v123, v123, v6
  v_exp_f32 v58, v58
  v_add_f32 v7, v7, v55
  v_exp_f32 v122, v122
  v_add_f32 v8, v8, v119
  v_exp_f32 v59, v59
  v_exp_f32 v123, v123
  v_sub_f32 v60, v60, v5
  v_sub_f32 v61, v61, v5
  v_sub_f32 v62, v62, v5
  v_sub_f32 v63, v63, v5
  v_add_f32 v7, v7, v56
  v_sub_f32 v124, v124, v6
  v_sub_f32 v125, v125, v6
  v_sub_f32 v126, v126, v6
  v_sub_f32 v127, v127, v6
  v_add_f32 v8, v8, v120
  v_exp_f32 v60, v60
  v_exp_f32 v61, v61
  v_exp_f32 v62, v62
  v_exp_f32 v63, v63
  v_add_f32 v7, v7, v57
  v_exp_f32 v124, v124
  v_exp_f32 v125, v125
  v_exp_f32 v126, v126
  v_exp_f32 v127, v127
  v_add_f32 v8, v8, v121
  v_cvt_pk_bf16_f32 v56, v56, v57
  v_cvt_pk_bf16_f32 v120, v120, v121
  v_add_f32 v7, v7, v58
  v_add_f32 v8, v8, v122
  v_cvt_pk_bf16_f32 v57, v58, v59
  v_cvt_pk_bf16_f32 v121, v122, v123
  v_add_f32 v7, v7, v59
  v_add_f32 v8, v8, v123
  v_add_f32 v7, v7, v60
  v_cvt_pk_bf16_f32 v58, v60, v61
  v_cvt_pk_bf16_f32 v59, v62, v63
  v_sub_f32 v64, v64, v5
  v_add_f32 v8, v8, v124
  s_waitcnt lgkmcnt(4)
  v_mfma_f32_32x32x16_bf16 v[160:175], v[236:239], v[56:59], v[160:175]
  v_cvt_pk_bf16_f32 v122, v124, v125
  v_cvt_pk_bf16_f32 v123, v126, v127
  v_sub_f32 v128, v128, v6
  v_add_f32 v7, v7, v61
  v_exp_f32 v64, v64
  v_mfma_f32_32x32x16_bf16 v[176:191], v[236:239], v[120:123], v[176:191]
  v_sub_f32 v65, v65, v5
  v_add_f32 v8, v8, v125
  v_exp_f32 v128, v128
  v_sub_f32 v129, v129, v6
  v_add_f32 v7, v7, v62
  v_exp_f32 v65, v65
  v_sub_f32 v66, v66, v5
  v_add_f32 v8, v8, v126
  v_exp_f32 v129, v129
  v_sub_f32 v130, v130, v6
  v_sub_f32 v67, v67, v5
  v_sub_f32 v131, v131, v6
  v_add_f32 v7, v7, v63
  v_exp_f32 v66, v66
  v_add_f32 v8, v8, v127
  v_exp_f32 v130, v130
  v_exp_f32 v67, v67
  v_exp_f32 v131, v131
  v_sub_f32 v68, v68, v5
  v_sub_f32 v69, v69, v5
  v_sub_f32 v70, v70, v5
  v_sub_f32 v71, v71, v5
  v_add_f32 v7, v7, v64
  v_sub_f32 v132, v132, v6
  v_sub_f32 v133, v133, v6
  v_sub_f32 v134, v134, v6
  v_sub_f32 v135, v135, v6
  v_add_f32 v8, v8, v128
  v_exp_f32 v68, v68
  v_exp_f32 v69, v69
  v_exp_f32 v70, v70
  v_exp_f32 v71, v71
  v_add_f32 v7, v7, v65
  v_exp_f32 v132, v132
  v_exp_f32 v133, v133
  v_exp_f32 v134, v134
  v_exp_f32 v135, v135
  v_add_f32 v8, v8, v129
  v_cvt_pk_bf16_f32 v64, v64, v65
  v_cvt_pk_bf16_f32 v128, v128, v129
  v_add_f32 v7, v7, v66
  v_add_f32 v8, v8, v130
  v_cvt_pk_bf16_f32 v65, v66, v67
  v_cvt_pk_bf16_f32 v129, v130, v131
  v_add_f32 v7, v7, v67
  v_add_f32 v8, v8, v131
  v_sub_f32 v72, v72, v5
  v_add_f32 v7, v7, v68
  v_cvt_pk_bf16_f32 v66, v68, v69
  v_cvt_pk_bf16_f32 v67, v70, v71
  v_sub_f32 v136, v136, v6
  v_add_f32 v8, v8, v132
  s_waitcnt lgkmcnt(3)
  v_mfma_f32_32x32x16_bf16 v[160:175], v[208:211], v[64:67], v[160:175]
  v_cvt_pk_bf16_f32 v130, v132, v133
  v_cvt_pk_bf16_f32 v131, v134, v135
  v_exp_f32 v72, v72
  v_sub_f32 v73, v73, v5
  v_add_f32 v7, v7, v69
  v_mfma_f32_32x32x16_bf16 v[176:191], v[208:211], v[128:131], v[176:191]
  v_exp_f32 v136, v136
  v_sub_f32 v137, v137, v6
  v_add_f32 v8, v8, v133
  v_exp_f32 v73, v73
  v_sub_f32 v74, v74, v5
  v_add_f32 v7, v7, v70
  v_exp_f32 v137, v137
  v_sub_f32 v138, v138, v6
  v_add_f32 v8, v8, v134
  v_sub_f32 v75, v75, v5
  v_sub_f32 v139, v139, v6
  v_exp_f32 v74, v74
  v_add_f32 v7, v7, v71
  v_exp_f32 v138, v138
  v_add_f32 v8, v8, v135
  v_exp_f32 v75, v75
  v_exp_f32 v139, v139
  v_sub_f32 v76, v76, v5
  v_sub_f32 v77, v77, v5
  v_sub_f32 v78, v78, v5
  v_sub_f32 v79, v79, v5
  v_add_f32 v7, v7, v72
  v_sub_f32 v140, v140, v6
  v_sub_f32 v141, v141, v6
  v_sub_f32 v142, v142, v6
  v_sub_f32 v143, v143, v6
  v_add_f32 v8, v8, v136
  v_exp_f32 v76, v76
  v_exp_f32 v77, v77
  v_exp_f32 v78, v78
  v_exp_f32 v79, v79
  v_add_f32 v7, v7, v73
  v_exp_f32 v140, v140
  v_exp_f32 v141, v141
  v_exp_f32 v142, v142
  v_exp_f32 v143, v143
  v_add_f32 v8, v8, v137
  v_cvt_pk_bf16_f32 v72, v72, v73
  v_cvt_pk_bf16_f32 v136, v136, v137
  v_add_f32 v7, v7, v74
  v_add_f32 v8, v8, v138
  v_cvt_pk_bf16_f32 v73, v74, v75
  v_cvt_pk_bf16_f32 v137, v138, v139
  v_add_f32 v7, v7, v75
  v_add_f32 v8, v8, v139
  v_add_f32 v7, v7, v76
  v_cvt_pk_bf16_f32 v74, v76, v77
  v_cvt_pk_bf16_f32 v75, v78, v79
  v_sub_f32 v80, v80, v5
  v_add_f32 v8, v8, v140
  s_waitcnt lgkmcnt(2)
  v_mfma_f32_32x32x16_bf16 v[160:175], v[212:215], v[72:75], v[160:175]
  v_cvt_pk_bf16_f32 v138, v140, v141
  v_cvt_pk_bf16_f32 v139, v142, v143
  v_sub_f32 v144, v144, v6
  v_add_f32 v7, v7, v77
  v_exp_f32 v80, v80
  v_mfma_f32_32x32x16_bf16 v[176:191], v[212:215], v[136:139], v[176:191]
  v_sub_f32 v81, v81, v5
  v_add_f32 v8, v8, v141
  v_exp_f32 v144, v144
  v_sub_f32 v145, v145, v6
  v_add_f32 v7, v7, v78
  v_exp_f32 v81, v81
  v_sub_f32 v82, v82, v5
  v_add_f32 v8, v8, v142
  v_exp_f32 v145, v145
  v_sub_f32 v146, v146, v6
  v_sub_f32 v83, v83, v5
  v_sub_f32 v147, v147, v6
  v_add_f32 v7, v7, v79
  v_exp_f32 v82, v82
  v_add_f32 v8, v8, v143
  v_exp_f32 v146, v146
  v_exp_f32 v83, v83
  v_exp_f32 v147, v147
  v_sub_f32 v84, v84, v5
  v_sub_f32 v85, v85, v5
  v_sub_f32 v86, v86, v5
  v_sub_f32 v87, v87, v5
  v_add_f32 v7, v7, v80
  v_sub_f32 v148, v148, v6
  v_sub_f32 v149, v149, v6
  v_sub_f32 v150, v150, v6
  v_sub_f32 v151, v151, v6
  v_add_f32 v8, v8, v144
  v_exp_f32 v84, v84
  v_exp_f32 v85, v85
  v_exp_f32 v86, v86
  v_exp_f32 v87, v87
  v_add_f32 v7, v7, v81
  v_exp_f32 v148, v148
  v_exp_f32 v149, v149
  v_exp_f32 v150, v150
  v_exp_f32 v151, v151
  v_add_f32 v8, v8, v145
  v_cvt_pk_bf16_f32 v80, v80, v81
  v_cvt_pk_bf16_f32 v144, v144, v145
  v_add_f32 v7, v7, v82
  v_add_f32 v8, v8, v146
  v_cvt_pk_bf16_f32 v81, v82, v83
  v_cvt_pk_bf16_f32 v145, v146, v147
  v_add_f32 v7, v7, v83
  v_add_f32 v8, v8, v147
  v_sub_f32 v88, v88, v5
  v_add_f32 v7, v7, v84
  v_cvt_pk_bf16_f32 v82, v84, v85
  v_cvt_pk_bf16_f32 v83, v86, v87
  v_sub_f32 v152, v152, v6
  v_add_f32 v8, v8, v148
  s_waitcnt lgkmcnt(1)
  v_mfma_f32_32x32x16_bf16 v[160:175], v[216:219], v[80:83], v[160:175]
  v_cvt_pk_bf16_f32 v146, v148, v149
  v_cvt_pk_bf16_f32 v147, v150, v151
  v_exp_f32 v88, v88
  v_sub_f32 v89, v89, v5
  v_add_f32 v7, v7, v85
  v_mfma_f32_32x32x16_bf16 v[176:191], v[216:219], v[144:147], v[176:191]
  v_exp_f32 v152, v152
  v_sub_f32 v153, v153, v6
  v_add_f32 v8, v8, v149
  v_exp_f32 v89, v89
  v_sub_f32 v90, v90, v5
  v_add_f32 v7, v7, v86
  v_exp_f32 v153, v153
  v_sub_f32 v154, v154, v6
  v_add_f32 v8, v8, v150
  v_sub_f32 v91, v91, v5
  v_sub_f32 v155, v155, v6
  v_exp_f32 v90, v90
  v_add_f32 v7, v7, v87
  v_exp_f32 v154, v154
  v_add_f32 v8, v8, v151
  v_exp_f32 v91, v91
  v_exp_f32 v155, v155
  v_sub_f32 v92, v92, v5
  v_sub_f32 v93, v93, v5
  v_sub_f32 v94, v94, v5
  v_sub_f32 v95, v95, v5
  v_add_f32 v7, v7, v88
  v_sub_f32 v156, v156, v6
  v_sub_f32 v157, v157, v6
  v_sub_f32 v158, v158, v6
  v_sub_f32 v159, v159, v6
  v_add_f32 v8, v8, v152
  v_exp_f32 v92, v92
  v_exp_f32 v93, v93
  v_exp_f32 v94, v94
  v_exp_f32 v95, v95
  v_add_f32 v7, v7, v89
  v_exp_f32 v156, v156
  v_exp_f32 v157, v157
  v_exp_f32 v158, v158
  v_exp_f32 v159, v159
  v_add_f32 v8, v8, v153
  v_cvt_pk_bf16_f32 v88, v88, v89
  v_cvt_pk_bf16_f32 v152, v152, v153
  v_add_f32 v7, v7, v90
  v_add_f32 v8, v8, v154
  v_cvt_pk_bf16_f32 v89, v90, v91
  v_cvt_pk_bf16_f32 v153, v154, v155
  v_add_f32 v7, v7, v91
  v_add_f32 v8, v8, v155
  v_cvt_pk_bf16_f32 v90, v92, v93
  v_cvt_pk_bf16_f32 v91, v94, v95
  v_cvt_pk_bf16_f32 v154, v156, v157
  v_cvt_pk_bf16_f32 v155, v158, v159
  s_waitcnt lgkmcnt(0)
  v_mfma_f32_32x32x16_bf16 v[160:175], v[220:223], v[88:91], v[160:175]
  v_add_f32 v7, v7, v92
  v_add_f32 v8, v8, v156
  v_add_f32 v7, v7, v93
  v_add_f32 v8, v8, v157
  v_add_f32 v7, v7, v94
  v_add_f32 v8, v8, v158
  v_mfma_f32_32x32x16_bf16 v[176:191], v[220:223], v[152:155], v[176:191]
  v_add_f32 v7, v7, v95
  v_add_f32 v8, v8, v159
  s_nop 9
K1_SFIN:
  v_mov_b32 v9, v7
  v_mov_b32 v11, v8
  s_nop 0
  v_permlane32_swap_b32 v7, v9
  v_permlane32_swap_b32 v8, v11
  v_add_f32 v7, v7, v9
  v_add_f32 v8, v8, v11
  s_nop 0
  s_branch K1_FIN
.section .rodata,"a"
.p2align 6
.amdhsa_kernel concat_heads__sliding_block__sliding_block__prompt_kernel
  .amdhsa_next_free_vgpr 256
  .amdhsa_next_free_sgpr 100
  .amdhsa_accum_offset 256
  .amdhsa_group_segment_fixed_size 0
  .amdhsa_kernarg_size 72
  .amdhsa_user_sgpr_count 2
  .amdhsa_user_sgpr_kernarg_segment_ptr 1
  .amdhsa_system_sgpr_workgroup_id_x 1
.end_amdhsa_kernel
```
